```python
import torch

def _softmax(x, axis=-1):
    return torch.softmax(x, dim=axis)
def _gelu(x):
    return torch.nn.functional.gelu(x, approximate="tanh")
def _silu(x):
    return torch.nn.functional.silu(x)
def _sigmoid(x):
    return torch.sigmoid(x)
def _layernorm(x, axis=-1, eps=1e-5):
    m = x.mean(dim=axis, keepdim=True)
    v = x.var(dim=axis, keepdim=True, unbiased=False)
    return (x - m) / torch.sqrt(v + eps)
def _scatter_add(tgt, idx, src, axis=0):
    return tgt.clone().index_add_(axis, idx, src)
def _segment_sum(src, seg, n):
    out = torch.zeros((n,) + src.shape[1:], dtype=src.dtype)
    return out.index_add_(0, seg, src)
def _pad(x, pw):
    flat = tuple(v for pair in reversed(pw) for v in pair)
    return torch.nn.functional.pad(x, flat)

kernel_name = 'recurrent_scan__gqa_block_cached__mixer_token_mlp__prompt'

def setup_inputs():

    _w = (lambda a: (lambda t: t.to(torch.bfloat16) if t.is_floating_point() else t)(torch.as_tensor(a)))
    def _A_setup():
        B, Sq, D = 1, 2048, 512
        Hq, Hkv, Sk, Dh = 32, 8, 2048, 128
        assert Hq % Hkv == 0, (Hq, Hkv)
        return {
            "x": _w((lambda *s: torch.randn(*s, dtype=torch.bfloat16) * 0.05)(B, Sq, D)),
            "k_cache": _w((lambda *s: torch.randn(*s, dtype=torch.bfloat16) * 3.2)(B, Hkv, Sk, Dh)),
            "v_cache": _w((lambda *s: torch.randn(*s, dtype=torch.bfloat16) * 3.2)(B, Hkv, Sk, Dh)),
            "wq": _w((lambda *s: torch.randn(*s, dtype=torch.bfloat16) * 3.2)(D, Hq * Dh) * (D ** -0.5)),
            "wo": _w((lambda *s: torch.randn(*s, dtype=torch.bfloat16) * 3.2)(Hq * Dh, D) * ((Hq * Dh) ** -0.5)),
        }
    _A_in = _A_setup()

    def _B_setup():
        B, S, D, F = 1, 2048, 512, 1792
        return {
            "x": _w((lambda *s: torch.randn(*s, dtype=torch.bfloat16) * 0.05)(B, S, D)),
            "w1": _w((lambda *s: torch.randn(*s, dtype=torch.bfloat16) * 3.2)(S, F) * (S ** -0.5)),
            "b1": _w((lambda *s: torch.randn(*s, dtype=torch.bfloat16) * 3.2)(F) * 0.02),
            "w2": _w((lambda *s: torch.randn(*s, dtype=torch.bfloat16) * 0.4)(F, S) * (F ** -0.5)),
            "b2": _w((lambda *s: torch.randn(*s, dtype=torch.bfloat16) * 0.4)(S) * 0.02),
        }
    _B_in = _B_setup()

    return {
        "A_x": _A_in["x"],
        "A_k_cache": _A_in["k_cache"],
        "A_v_cache": _A_in["v_cache"],
        "A_wq": _A_in["wq"],
        "A_wo": _A_in["wo"],
        "B_x": _B_in["x"],
        "B_w1": _B_in["w1"],
        "B_b1": _B_in["b1"],
        "B_w2": _B_in["w2"],
        "B_b2": _B_in["b2"],
    }

def reference(A_x, A_k_cache, A_v_cache, A_wq, A_wo, B_x, B_w1, B_b1, B_w2, B_b2):
    def _A_ref(x, k_cache, v_cache, wq, wo):
        B, Sq, D = x.shape
        Hq, Dh = 32, 128
        Hkv = k_cache.shape[1]
        rep = Hq // Hkv
        q = (lambda x, *d: x.permute(*d))((x @ wq).reshape(B, Sq, Hq, Dh), 0, 2, 1, 3)
        k = (lambda x, n, axis: torch.repeat_interleave(x, n, dim=axis))(k_cache, rep, axis=1)
        v = (lambda x, n, axis: torch.repeat_interleave(x, n, dim=axis))(v_cache, rep, axis=1)
        scores = torch.einsum("bhqd,bhkd->bhqk", q, k) * (Dh ** -0.5)
        p = _softmax(scores, axis=-1)
        o = torch.einsum("bhqk,bhkd->bhqd", p, v)
        return (lambda x, *d: x.permute(*d))(o, 0, 2, 1, 3).reshape(B, Sq, Hq * Dh) @ wo

    def _B_ref(x, w1, b1, w2, b2):
        B, S, D = x.shape
        h = _layernorm(x, axis=-1)
        u = torch.einsum("bsd,sf->bdf", h, w1) + b1
        u = _gelu(u)
        y = torch.einsum("bdf,fs->bds", u, w2) + b2
        return (lambda x, *d: x.permute(*d))(y, 0, 2, 1)

    x = A_x
    xn = _layernorm(x, axis=-1)
    s = _A_ref(xn, A_k_cache, A_v_cache, A_wq, A_wo)
    g = _silu(_B_ref(xn, B_w1, B_b1, B_w2, B_b2))
    return x + s * g
```

```asm
; @launch grid=(256,1,1) block=(256,1,1) lds=163840
.amdgcn_target "amdgcn-amd-amdhsa--gfx950"
.text
.globl recurrent_scan__gqa_block_cached__mixer_token_mlp__prompt_kernel
.p2align 8
.type recurrent_scan__gqa_block_cached__mixer_token_mlp__prompt_kernel,@function
recurrent_scan__gqa_block_cached__mixer_token_mlp__prompt_kernel:
  s_load_dwordx2 s[4:5], s[0:1], 8
  s_load_dwordx2 s[6:7], s[0:1], 16
  s_load_dwordx2 s[22:23], s[0:1], 96
  s_load_dwordx2 s[36:37], s[0:1], 24
  s_load_dwordx2 s[56:57], s[0:1], 32
  s_load_dwordx2 s[62:63], s[0:1], 48
  s_load_dwordx2 s[60:61], s[0:1], 64
  s_load_dwordx2 s[58:59], s[0:1], 88
  s_load_dwordx2 s[100:101], s[0:1], 0
  s_cmp_ge_u32 s2, 256
  s_cbranch_scc1 L_k3_end
  v_lshrrev_b32 v1, 6, v0
  s_nop 0
  v_readfirstlane_b32 s24, v1
  v_and_b32 v0, 63, v0
  s_waitcnt lgkmcnt(0)
  s_and_b32 s25, s2, 7
  s_lshr_b32 s26, s2, 3
  s_mov_b32 s96, s100
  s_mov_b32 s97, s101
  s_mov_b32 s98, 2097152
  s_mov_b32 s99, 131072
  v_and_b32 v1, 15, v0
  v_lshlrev_b32 v1, 10, v1
  v_lshrrev_b32 v2, 4, v0
  v_lshl_add_u32 v1, v2, 4, v1
  s_lshl_b32 s42, s26, 6
  s_lshl_b32 s43, s24, 4
  s_add_u32 s42, s42, s43
  s_lshl_b32 s42, s42, 10
  buffer_load_dwordx4 v[48:51], v1, s[96:99], s42 offen
  buffer_load_dwordx4 v[52:55], v1, s[96:99], s42 offen offset:64
  buffer_load_dwordx4 v[56:59], v1, s[96:99], s42 offen offset:128
  buffer_load_dwordx4 v[60:63], v1, s[96:99], s42 offen offset:192
  buffer_load_dwordx4 v[64:67], v1, s[96:99], s42 offen offset:256
  buffer_load_dwordx4 v[68:71], v1, s[96:99], s42 offen offset:320
  buffer_load_dwordx4 v[72:75], v1, s[96:99], s42 offen offset:384
  buffer_load_dwordx4 v[76:79], v1, s[96:99], s42 offen offset:448
  buffer_load_dwordx4 v[80:83], v1, s[96:99], s42 offen offset:512
  buffer_load_dwordx4 v[84:87], v1, s[96:99], s42 offen offset:576
  buffer_load_dwordx4 v[88:91], v1, s[96:99], s42 offen offset:640
  buffer_load_dwordx4 v[92:95], v1, s[96:99], s42 offen offset:704
  buffer_load_dwordx4 v[96:99], v1, s[96:99], s42 offen offset:768
  buffer_load_dwordx4 v[100:103], v1, s[96:99], s42 offen offset:832
  buffer_load_dwordx4 v[104:107], v1, s[96:99], s42 offen offset:896
  buffer_load_dwordx4 v[108:111], v1, s[96:99], s42 offen offset:960
  s_mov_b32 s28, s36
  s_mov_b32 s29, s37
  s_mov_b32 s30, 4194304
  s_mov_b32 s31, 131072
  v_lshlrev_b32 v7, 4, v0
  s_lshl_b32 s42, s26, 4
  s_lshl_b32 s43, s24, 2
  s_add_u32 s42, s42, s43
  s_lshl_b32 s42, s42, 13
  s_lshl_b32 s43, s25, 10
  s_add_u32 s42, s42, s43
  buffer_load_dwordx4 a[192:195], v7, s[28:31], s42 offen
  s_add_u32 s42, s42, 8192
  buffer_load_dwordx4 a[196:199], v7, s[28:31], s42 offen
  s_add_u32 s42, s42, 8192
  buffer_load_dwordx4 a[200:203], v7, s[28:31], s42 offen
  s_add_u32 s42, s42, 8192
  buffer_load_dwordx4 a[204:207], v7, s[28:31], s42 offen
  s_add_u32 s42, s42, 8192
  s_lshl_b32 s27, s25, 19
  s_sub_u32 s40, 0x400000, s27
  s_add_u32 s8, s4, s27
  s_addc_u32 s9, s5, 0
  s_mov_b32 s10, s40
  s_mov_b32 s11, 131072
  s_add_u32 s12, s6, s27
  s_addc_u32 s13, s7, 0
  s_mov_b32 s14, s40
  s_mov_b32 s15, 131072
  s_mov_b32 s16, s22
  s_mov_b32 s17, s23
  s_mov_b32 s18, 33554432
  s_mov_b32 s19, 131072
  s_mov_b32 s32, s56
  s_mov_b32 s33, s57
  s_mov_b32 s34, 4194304
  s_mov_b32 s35, 131072
  s_lshr_b32 s46, s26, 3
  s_lshl_b32 s46, s46, 3
  s_add_u32 s46, s46, s25
  s_and_b32 s47, s26, 7
  s_cmp_lt_u32 s46, 28
  s_cselect_b32 s44, 7340032, 0
  s_cselect_b32 s45, 33554432, 0
  s_mov_b32 s48, s62
  s_mov_b32 s49, s63
  s_mov_b32 s50, s44
  s_mov_b32 s51, 131072
  s_mov_b32 s52, s60
  s_mov_b32 s53, s61
  s_mov_b32 s54, 7340032
  s_mov_b32 s55, 131072
  s_mov_b32 s56, s58
  s_mov_b32 s57, s59
  s_mov_b32 s58, 256
  s_mov_b32 s59, 131072
  s_mov_b32 s60, s22
  s_mov_b32 s61, s23
  s_mov_b32 s62, s45
  s_mov_b32 s63, 131072
  v_lshlrev_b32 v2, 25, v0
  s_lshl_b32 s44, s24, 9
  s_mul_i32 s44, s44, 3584
  buffer_load_dword a211, v2, s[48:51], s44 offen
  buffer_load_dword a212, v2, s[32:35], s27 offen
  v_and_b32 v2, 15, v0
  s_lshl_b32 s44, s26, 4
  v_add_u32 v2, s44, v2
  v_lshlrev_b32 v2, 7, v2
  v_cmp_gt_u32 vcc, 16, v0
  s_nop 1
  v_cndmask_b32 v2, -1, v2, vcc
  buffer_load_dword a209, v2, s[8:11], 0 offen
  buffer_load_dword a210, v2, s[12:15], 0 offen
  s_lshl_b32 s21, s24, 12
  s_mul_i32 s41, s24, 24576
  v_mov_b32 v112, 1065369472
  v_mov_b32 v113, 1065369472
  v_mov_b32 v114, 1065369472
  v_mov_b32 v115, 1065369472
  v_lshrrev_b32 v1, 4, v0
  v_and_b32 v2, 15, v0
  s_mov_b32 s43, 8192
  v_add_u32 v3, 0, v1
  v_lshlrev_b32 v3, 1, v3
  v_xor_b32 v3, v3, v2
  v_lshlrev_b32 v3, 4, v3
  v_mul_lo_u32 v44, v1, s43
  v_add_u32 v44, v44, v3
  v_add_u32 v3, 0, v1
  v_lshlrev_b32 v3, 1, v3
  v_xor_b32 v3, v3, v2
  v_lshlrev_b32 v3, 4, v3
  v_mul_lo_u32 v45, v1, s43
  v_add_u32 v45, v45, v3
  v_add_u32 v45, 31744, v45
  v_add_u32 v3, 4, v1
  v_lshlrev_b32 v3, 1, v3
  v_xor_b32 v3, v3, v2
  v_lshlrev_b32 v3, 4, v3
  v_mul_lo_u32 v46, v1, s43
  v_add_u32 v46, v46, v3
  v_add_u32 v46, 63488, v46
  v_add_u32 v3, 4, v1
  v_lshlrev_b32 v3, 1, v3
  v_xor_b32 v3, v3, v2
  v_lshlrev_b32 v3, 4, v3
  v_mul_lo_u32 v47, v1, s43
  v_add_u32 v47, v47, v3
  v_add_u32 v47, 95232, v47
  s_lshl_b32 s42, s25, 2
  s_add_u32 s42, s42, s24
  s_lshl_b32 s42, s42, 8
  v_mov_b32 v6, s41
  v_lshrrev_b32 v1, 4, v0
  v_bfe_u32 v2, v0, 2, 2
  v_and_b32 v3, 1, v1
  v_lshl_add_u32 v3, v3, 2, v2
  v_lshlrev_b32 v3, 1, v3
  v_mul_u32_u24 v4, 8, v1
  v_add_u32 v4, v4, v2
  v_lshlrev_b32 v4, 8, v4
  v_and_b32 v5, 1, v0
  v_lshl_add_u32 v4, v5, 3, v4
  v_add_u32 v4, v6, v4
  v_bfe_u32 v5, v0, 1, 1
  v_add_u32 v1, 0, v5
  v_xor_b32 v1, v1, v3
  v_lshl_add_u32 v32, v1, 4, v4
  v_add_u32 v1, 2, v5
  v_xor_b32 v1, v1, v3
  v_lshl_add_u32 v33, v1, 4, v4
  v_add_u32 v1, 4, v5
  v_xor_b32 v1, v1, v3
  v_lshl_add_u32 v34, v1, 4, v4
  v_add_u32 v1, 6, v5
  v_xor_b32 v1, v1, v3
  v_lshl_add_u32 v35, v1, 4, v4
  v_add_u32 v1, 8, v5
  v_xor_b32 v1, v1, v3
  v_lshl_add_u32 v36, v1, 4, v4
  v_add_u32 v1, 10, v5
  v_xor_b32 v1, v1, v3
  v_lshl_add_u32 v37, v1, 4, v4
  v_add_u32 v1, 12, v5
  v_xor_b32 v1, v1, v3
  v_lshl_add_u32 v38, v1, 4, v4
  v_add_u32 v1, 14, v5
  v_xor_b32 v1, v1, v3
  v_lshl_add_u32 v39, v1, 4, v4
  v_and_b32 v1, 15, v0
  v_lshrrev_b32 v2, 4, v0
  v_lshlrev_b32 v3, 10, v1
  v_add_u32 v3, 98304, v3
  v_add_u32 v4, 0, v2
  v_xor_b32 v4, v4, v1
  v_lshl_add_u32 v40, v4, 4, v3
  v_add_u32 v4, 4, v2
  v_xor_b32 v4, v4, v1
  v_lshl_add_u32 v41, v4, 4, v3
  v_add_u32 v4, 8, v2
  v_xor_b32 v4, v4, v1
  v_lshl_add_u32 v42, v4, 4, v3
  v_add_u32 v4, 12, v2
  v_xor_b32 v4, v4, v1
  v_lshl_add_u32 v43, v4, 4, v3
  v_lshrrev_b32 v2, 4, v0
  v_and_b32 v3, 15, v0
  v_add_u32 v4, 0, v2
  v_xor_b32 v4, v4, v3
  v_lshlrev_b32 v4, 4, v4
  v_lshl_add_u32 v116, v3, 8, v4
  v_add_u32 v4, 4, v2
  v_xor_b32 v4, v4, v3
  v_lshlrev_b32 v4, 4, v4
  v_lshl_add_u32 v117, v3, 8, v4
  v_add_u32 v4, 8, v2
  v_xor_b32 v4, v4, v3
  v_lshlrev_b32 v4, 4, v4
  v_lshl_add_u32 v118, v3, 8, v4
  v_add_u32 v4, 12, v2
  v_xor_b32 v4, v4, v3
  v_lshlrev_b32 v4, 4, v4
  v_lshl_add_u32 v119, v3, 8, v4
  v_lshrrev_b32 v4, 2, v3
  v_and_b32 v5, 3, v0
  v_lshl_add_u32 v7, v2, 2, v4
  v_and_b32 v1, 7, v7
  v_lshlrev_b32 v1, 1, v1
  v_lshlrev_b32 v7, 8, v7
  v_and_b32 v6, 1, v5
  v_lshl_add_u32 v7, v6, 3, v7
  v_add_u32 v7, 49152, v7
  v_lshrrev_b32 v6, 1, v5
  v_add_u32 v5, 0, v6
  v_xor_b32 v5, v5, v1
  v_lshl_add_u32 v120, v5, 4, v7
  v_add_u32 v5, 2, v6
  v_xor_b32 v5, v5, v1
  v_lshl_add_u32 v121, v5, 4, v7
  v_add_u32 v5, 4, v6
  v_xor_b32 v5, v5, v1
  v_lshl_add_u32 v122, v5, 4, v7
  v_add_u32 v5, 6, v6
  v_xor_b32 v5, v5, v1
  v_lshl_add_u32 v123, v5, 4, v7
  v_add_u32 v5, 8, v6
  v_xor_b32 v5, v5, v1
  v_lshl_add_u32 v124, v5, 4, v7
  v_add_u32 v5, 10, v6
  v_xor_b32 v5, v5, v1
  v_lshl_add_u32 v125, v5, 4, v7
  v_add_u32 v5, 12, v6
  v_xor_b32 v5, v5, v1
  v_lshl_add_u32 v126, v5, 4, v7
  v_add_u32 v5, 14, v6
  v_xor_b32 v5, v5, v1
  v_lshl_add_u32 v127, v5, 4, v7
  v_lshlrev_b32 v5, 8, v2
  v_add_u32 v5, s21, v5
  v_add_u32 v6, 0, v2
  v_xor_b32 v6, v6, v3
  v_lshl_add_u32 v8, v6, 4, v5
  v_add_u32 v6, 4, v2
  v_xor_b32 v6, v6, v3
  v_lshl_add_u32 v9, v6, 4, v5
  v_add_u32 v6, 8, v2
  v_xor_b32 v6, v6, v3
  v_lshl_add_u32 v10, v6, 4, v5
  v_add_u32 v6, 12, v2
  v_xor_b32 v6, v6, v3
  v_lshl_add_u32 v11, v6, 4, v5
  v_add_u32 v6, 0, v2
  v_lshlrev_b32 v6, 1, v6
  v_xor_b32 v6, v6, v3
  v_lshl_add_u32 v12, v6, 4, v5
  v_add_u32 v6, 4, v2
  v_lshlrev_b32 v6, 1, v6
  v_xor_b32 v6, v6, v3
  v_lshl_add_u32 v13, v6, 4, v5
  s_lshl_b32 s27, s24, 14
  s_add_u32 s27, s27, 98304
  s_mov_b32 s40, s27
  v_mov_b32 v26, s27
  v_lshrrev_b32 v1, 4, v0
  v_bfe_u32 v2, v0, 2, 2
  v_lshl_add_u32 v1, v1, 2, v2
  v_bfe_u32 v2, v1, 1, 2
  v_lshlrev_b32 v2, 1, v2
  v_lshlrev_b32 v1, 7, v1
  v_and_b32 v3, 1, v0
  v_lshl_add_u32 v1, v3, 3, v1
  v_add_u32 v1, v26, v1
  v_bfe_u32 v3, v0, 1, 1
  v_add_u32 v4, 0, v3
  v_xor_b32 v4, v4, v2
  v_lshl_add_u32 v14, v4, 4, v1
  v_add_u32 v4, 2, v3
  v_xor_b32 v4, v4, v2
  v_lshl_add_u32 v15, v4, 4, v1
  v_add_u32 v4, 4, v3
  v_xor_b32 v4, v4, v2
  v_lshl_add_u32 v16, v4, 4, v1
  v_add_u32 v4, 6, v3
  v_xor_b32 v4, v4, v2
  v_lshl_add_u32 v17, v4, 4, v1
  v_lshrrev_b32 v1, 3, v0
  v_bfe_u32 v2, v1, 1, 2
  v_lshlrev_b32 v2, 1, v2
  v_and_b32 v3, 7, v0
  v_xor_b32 v3, v3, v2
  v_lshlrev_b32 v3, 4, v3
  s_mov_b32 s43, 3584
  v_mul_lo_u32 v1, v1, s43
  v_add_u32 v18, v1, v3
  v_add_u32 v19, 27648, v18
  v_add_u32 v20, 27648, v19
  v_add_u32 v21, 27648, v20
  v_lshrrev_b32 v1, 3, v0
  v_bfe_u32 v2, v1, 1, 2
  v_lshlrev_b32 v2, 1, v2
  v_and_b32 v3, 7, v0
  v_xor_b32 v3, v3, v2
  v_lshlrev_b32 v3, 4, v3
  s_mov_b32 s43, 1024
  v_mul_lo_u32 v1, v1, s43
  v_add_u32 v22, v1, v3
  v_add_u32 v23, 7168, v22
  v_add_u32 v24, 7168, v23
  v_add_u32 v25, 7168, v24
  s_lshl_b32 s44, s24, 9
  s_mul_i32 s39, s44, 3584
  s_lshl_b32 s45, s46, 7
  s_add_u32 s39, s39, s45
  s_lshl_b32 s36, s44, 10
  s_lshl_b32 s45, s47, 7
  s_add_u32 s36, s36, s45
  s_add_u32 s36, s36, 2097152
  s_mov_b32 s38, 0
  s_mov_b32 s37, 0
  s_add_u32 m0, s41, 0
  s_nop 0
  buffer_load_dwordx4 v44, s[28:31], s42 offen lds
  buffer_load_dwordx4 v45, s[28:31], s42 offen offset:1024 lds
  buffer_load_dwordx4 v46, s[28:31], s42 offen offset:2048 lds
  buffer_load_dwordx4 v47, s[28:31], s42 offen offset:3072 lds
  s_add_u32 s42, s42, 131072
  s_add_u32 m0, s41, 4096
  s_nop 0
  buffer_load_dwordx4 v44, s[28:31], s42 offen lds
  buffer_load_dwordx4 v45, s[28:31], s42 offen offset:1024 lds
  buffer_load_dwordx4 v46, s[28:31], s42 offen offset:2048 lds
  buffer_load_dwordx4 v47, s[28:31], s42 offen offset:3072 lds
  s_add_u32 s42, s42, 131072
  s_waitcnt vmcnt(31)
  v_mfma_f32_16x16x32_bf16 v[28:31], v[112:115], v[48:51], 0
  v_mfma_f32_16x16x32_bf16 v[4:7], v[48:51], v[48:51], 0
  s_waitcnt vmcnt(30)
  v_lshlrev_b32 v128, 16, v48
  v_and_b32 v129, 4294901760, v48
  v_lshlrev_b32 v130, 16, v49
  v_and_b32 v131, 4294901760, v49
  v_lshlrev_b32 v132, 16, v50
  v_and_b32 v133, 4294901760, v50
  v_lshlrev_b32 v134, 16, v51
  v_and_b32 v135, 4294901760, v51
  v_mfma_f32_16x16x32_bf16 v[28:31], v[112:115], v[52:55], v[28:31]
  v_mfma_f32_16x16x32_bf16 v[4:7], v[52:55], v[52:55], v[4:7]
  s_waitcnt vmcnt(29)
  v_lshlrev_b32 v136, 16, v52
  v_and_b32 v137, 4294901760, v52
  v_lshlrev_b32 v138, 16, v53
  v_and_b32 v139, 4294901760, v53
  v_lshlrev_b32 v140, 16, v54
  v_and_b32 v141, 4294901760, v54
  v_lshlrev_b32 v142, 16, v55
  v_and_b32 v143, 4294901760, v55
  v_mfma_f32_16x16x32_bf16 v[28:31], v[112:115], v[56:59], v[28:31]
  v_mfma_f32_16x16x32_bf16 v[4:7], v[56:59], v[56:59], v[4:7]
  s_waitcnt vmcnt(28)
  v_lshlrev_b32 v144, 16, v56
  v_and_b32 v145, 4294901760, v56
  v_lshlrev_b32 v146, 16, v57
  v_and_b32 v147, 4294901760, v57
  v_lshlrev_b32 v148, 16, v58
  v_and_b32 v149, 4294901760, v58
  v_lshlrev_b32 v150, 16, v59
  v_and_b32 v151, 4294901760, v59
  v_mfma_f32_16x16x32_bf16 v[28:31], v[112:115], v[60:63], v[28:31]
  v_mfma_f32_16x16x32_bf16 v[4:7], v[60:63], v[60:63], v[4:7]
  s_waitcnt vmcnt(27)
  v_lshlrev_b32 v152, 16, v60
  v_and_b32 v153, 4294901760, v60
  v_lshlrev_b32 v154, 16, v61
  v_and_b32 v155, 4294901760, v61
  v_lshlrev_b32 v156, 16, v62
  v_and_b32 v157, 4294901760, v62
  v_lshlrev_b32 v158, 16, v63
  v_and_b32 v159, 4294901760, v63
  v_mfma_f32_16x16x32_bf16 v[28:31], v[112:115], v[64:67], v[28:31]
  v_mfma_f32_16x16x32_bf16 v[4:7], v[64:67], v[64:67], v[4:7]
  s_waitcnt vmcnt(26)
  v_lshlrev_b32 v160, 16, v64
  v_and_b32 v161, 4294901760, v64
  v_lshlrev_b32 v162, 16, v65
  v_and_b32 v163, 4294901760, v65
  v_lshlrev_b32 v164, 16, v66
  v_and_b32 v165, 4294901760, v66
  v_lshlrev_b32 v166, 16, v67
  v_and_b32 v167, 4294901760, v67
  v_mfma_f32_16x16x32_bf16 v[28:31], v[112:115], v[68:71], v[28:31]
  v_mfma_f32_16x16x32_bf16 v[4:7], v[68:71], v[68:71], v[4:7]
  s_waitcnt vmcnt(25)
  v_lshlrev_b32 v168, 16, v68
  v_and_b32 v169, 4294901760, v68
  v_lshlrev_b32 v170, 16, v69
  v_and_b32 v171, 4294901760, v69
  v_lshlrev_b32 v172, 16, v70
  v_and_b32 v173, 4294901760, v70
  v_lshlrev_b32 v174, 16, v71
  v_and_b32 v175, 4294901760, v71
  v_mfma_f32_16x16x32_bf16 v[28:31], v[112:115], v[72:75], v[28:31]
  v_mfma_f32_16x16x32_bf16 v[4:7], v[72:75], v[72:75], v[4:7]
  s_waitcnt vmcnt(24)
  v_lshlrev_b32 v176, 16, v72
  v_and_b32 v177, 4294901760, v72
  v_lshlrev_b32 v178, 16, v73
  v_and_b32 v179, 4294901760, v73
  v_lshlrev_b32 v180, 16, v74
  v_and_b32 v181, 4294901760, v74
  v_lshlrev_b32 v182, 16, v75
  v_and_b32 v183, 4294901760, v75
  v_mfma_f32_16x16x32_bf16 v[28:31], v[112:115], v[76:79], v[28:31]
  v_mfma_f32_16x16x32_bf16 v[4:7], v[76:79], v[76:79], v[4:7]
  s_waitcnt vmcnt(23)
  v_lshlrev_b32 v184, 16, v76
  v_and_b32 v185, 4294901760, v76
  v_lshlrev_b32 v186, 16, v77
  v_and_b32 v187, 4294901760, v77
  v_lshlrev_b32 v188, 16, v78
  v_and_b32 v189, 4294901760, v78
  v_lshlrev_b32 v190, 16, v79
  v_and_b32 v191, 4294901760, v79
  v_mfma_f32_16x16x32_bf16 v[28:31], v[112:115], v[80:83], v[28:31]
  v_mfma_f32_16x16x32_bf16 v[4:7], v[80:83], v[80:83], v[4:7]
  s_waitcnt vmcnt(22)
  v_lshlrev_b32 v192, 16, v80
  v_and_b32 v193, 4294901760, v80
  v_lshlrev_b32 v194, 16, v81
  v_and_b32 v195, 4294901760, v81
  v_lshlrev_b32 v196, 16, v82
  v_and_b32 v197, 4294901760, v82
  v_lshlrev_b32 v198, 16, v83
  v_and_b32 v199, 4294901760, v83
  v_mfma_f32_16x16x32_bf16 v[28:31], v[112:115], v[84:87], v[28:31]
  v_mfma_f32_16x16x32_bf16 v[4:7], v[84:87], v[84:87], v[4:7]
  s_waitcnt vmcnt(21)
  v_lshlrev_b32 v200, 16, v84
  v_and_b32 v201, 4294901760, v84
  v_lshlrev_b32 v202, 16, v85
  v_and_b32 v203, 4294901760, v85
  v_lshlrev_b32 v204, 16, v86
  v_and_b32 v205, 4294901760, v86
  v_lshlrev_b32 v206, 16, v87
  v_and_b32 v207, 4294901760, v87
  v_mfma_f32_16x16x32_bf16 v[28:31], v[112:115], v[88:91], v[28:31]
  v_mfma_f32_16x16x32_bf16 v[4:7], v[88:91], v[88:91], v[4:7]
  s_waitcnt vmcnt(20)
  v_lshlrev_b32 v208, 16, v88
  v_and_b32 v209, 4294901760, v88
  v_lshlrev_b32 v210, 16, v89
  v_and_b32 v211, 4294901760, v89
  v_lshlrev_b32 v212, 16, v90
  v_and_b32 v213, 4294901760, v90
  v_lshlrev_b32 v214, 16, v91
  v_and_b32 v215, 4294901760, v91
  v_mfma_f32_16x16x32_bf16 v[28:31], v[112:115], v[92:95], v[28:31]
  v_mfma_f32_16x16x32_bf16 v[4:7], v[92:95], v[92:95], v[4:7]
  s_waitcnt vmcnt(19)
  v_lshlrev_b32 v216, 16, v92
  v_and_b32 v217, 4294901760, v92
  v_lshlrev_b32 v218, 16, v93
  v_and_b32 v219, 4294901760, v93
  v_lshlrev_b32 v220, 16, v94
  v_and_b32 v221, 4294901760, v94
  v_lshlrev_b32 v222, 16, v95
  v_and_b32 v223, 4294901760, v95
  v_mfma_f32_16x16x32_bf16 v[28:31], v[112:115], v[96:99], v[28:31]
  v_mfma_f32_16x16x32_bf16 v[4:7], v[96:99], v[96:99], v[4:7]
  s_waitcnt vmcnt(18)
  v_lshlrev_b32 v224, 16, v96
  v_and_b32 v225, 4294901760, v96
  v_lshlrev_b32 v226, 16, v97
  v_and_b32 v227, 4294901760, v97
  v_lshlrev_b32 v228, 16, v98
  v_and_b32 v229, 4294901760, v98
  v_lshlrev_b32 v230, 16, v99
  v_and_b32 v231, 4294901760, v99
  v_mfma_f32_16x16x32_bf16 v[28:31], v[112:115], v[100:103], v[28:31]
  v_mfma_f32_16x16x32_bf16 v[4:7], v[100:103], v[100:103], v[4:7]
  s_waitcnt vmcnt(17)
  v_lshlrev_b32 v232, 16, v100
  v_and_b32 v233, 4294901760, v100
  v_lshlrev_b32 v234, 16, v101
  v_and_b32 v235, 4294901760, v101
  v_lshlrev_b32 v236, 16, v102
  v_and_b32 v237, 4294901760, v102
  v_lshlrev_b32 v238, 16, v103
  v_and_b32 v239, 4294901760, v103
  v_mfma_f32_16x16x32_bf16 v[28:31], v[112:115], v[104:107], v[28:31]
  v_mfma_f32_16x16x32_bf16 v[4:7], v[104:107], v[104:107], v[4:7]
  s_waitcnt vmcnt(16)
  v_lshlrev_b32 v240, 16, v104
  v_and_b32 v241, 4294901760, v104
  v_lshlrev_b32 v242, 16, v105
  v_and_b32 v243, 4294901760, v105
  v_lshlrev_b32 v244, 16, v106
  v_and_b32 v245, 4294901760, v106
  v_lshlrev_b32 v246, 16, v107
  v_and_b32 v247, 4294901760, v107
  v_mfma_f32_16x16x32_bf16 v[28:31], v[112:115], v[108:111], v[28:31]
  v_mfma_f32_16x16x32_bf16 v[4:7], v[108:111], v[108:111], v[4:7]
  v_lshlrev_b32 v248, 16, v108
  v_and_b32 v249, 4294901760, v108
  v_lshlrev_b32 v250, 16, v109
  v_and_b32 v251, 4294901760, v109
  v_lshlrev_b32 v252, 16, v110
  v_and_b32 v253, 4294901760, v110
  v_lshlrev_b32 v254, 16, v111
  v_and_b32 v255, 4294901760, v111
  v_and_b32 v1, 3, v0
  v_cmp_eq_u32 vcc, 2, v1
  s_nop 1
  v_cndmask_b32 v7, v7, v6, vcc
  v_cmp_eq_u32 vcc, 1, v1
  s_nop 1
  v_cndmask_b32 v7, v7, v5, vcc
  v_cmp_eq_u32 vcc, 0, v1
  s_nop 1
  v_cndmask_b32 v7, v7, v4, vcc
  v_and_b32 v1, 15, v0
  v_lshrrev_b32 v2, 2, v1
  v_lshl_add_u32 v2, v2, 4, v1
  v_lshlrev_b32 v2, 2, v2
  ds_bpermute_b32 v3, v2, v7
  v_mul_f32 v28, 0x3b000000, v28
  s_waitcnt lgkmcnt(0)
  v_mul_f32 v3, 0x3b000000, v3
  v_fma_f32 v3, -v28, v28, v3
  v_max_f32 v3, 0, v3
  v_add_f32 v3, 0x3727c5ac, v3
  v_rsq_f32 v2, v3
  s_nop 0
  v_mul_f32 v3, v28, v2
  v_sub_f32 v3, 0, v3
  v_fma_f32 v128, v128, v2, v3
  v_fma_f32 v129, v129, v2, v3
  v_fma_f32 v130, v130, v2, v3
  v_fma_f32 v131, v131, v2, v3
  v_fma_f32 v132, v132, v2, v3
  v_fma_f32 v133, v133, v2, v3
  v_fma_f32 v134, v134, v2, v3
  v_fma_f32 v135, v135, v2, v3
  v_fma_f32 v136, v136, v2, v3
  v_fma_f32 v137, v137, v2, v3
  v_fma_f32 v138, v138, v2, v3
  v_fma_f32 v139, v139, v2, v3
  v_fma_f32 v140, v140, v2, v3
  v_fma_f32 v141, v141, v2, v3
  v_fma_f32 v142, v142, v2, v3
  v_fma_f32 v143, v143, v2, v3
  v_fma_f32 v144, v144, v2, v3
  v_fma_f32 v145, v145, v2, v3
  v_fma_f32 v146, v146, v2, v3
  v_fma_f32 v147, v147, v2, v3
  v_fma_f32 v148, v148, v2, v3
  v_fma_f32 v149, v149, v2, v3
  v_fma_f32 v150, v150, v2, v3
  v_fma_f32 v151, v151, v2, v3
  v_fma_f32 v152, v152, v2, v3
  v_fma_f32 v153, v153, v2, v3
  v_fma_f32 v154, v154, v2, v3
  v_fma_f32 v155, v155, v2, v3
  v_fma_f32 v156, v156, v2, v3
  v_fma_f32 v157, v157, v2, v3
  v_fma_f32 v158, v158, v2, v3
  v_fma_f32 v159, v159, v2, v3
  v_fma_f32 v160, v160, v2, v3
  v_fma_f32 v161, v161, v2, v3
  v_fma_f32 v162, v162, v2, v3
  v_fma_f32 v163, v163, v2, v3
  v_fma_f32 v164, v164, v2, v3
  v_fma_f32 v165, v165, v2, v3
  v_fma_f32 v166, v166, v2, v3
  v_fma_f32 v167, v167, v2, v3
  v_fma_f32 v168, v168, v2, v3
  v_fma_f32 v169, v169, v2, v3
  v_fma_f32 v170, v170, v2, v3
  v_fma_f32 v171, v171, v2, v3
  v_fma_f32 v172, v172, v2, v3
  v_fma_f32 v173, v173, v2, v3
  v_fma_f32 v174, v174, v2, v3
  v_fma_f32 v175, v175, v2, v3
  v_fma_f32 v176, v176, v2, v3
  v_fma_f32 v177, v177, v2, v3
  v_fma_f32 v178, v178, v2, v3
  v_fma_f32 v179, v179, v2, v3
  v_fma_f32 v180, v180, v2, v3
  v_fma_f32 v181, v181, v2, v3
  v_fma_f32 v182, v182, v2, v3
  v_fma_f32 v183, v183, v2, v3
  v_fma_f32 v184, v184, v2, v3
  v_fma_f32 v185, v185, v2, v3
  v_fma_f32 v186, v186, v2, v3
  v_fma_f32 v187, v187, v2, v3
  v_fma_f32 v188, v188, v2, v3
  v_fma_f32 v189, v189, v2, v3
  v_fma_f32 v190, v190, v2, v3
  v_fma_f32 v191, v191, v2, v3
  v_fma_f32 v192, v192, v2, v3
  v_fma_f32 v193, v193, v2, v3
  v_fma_f32 v194, v194, v2, v3
  v_fma_f32 v195, v195, v2, v3
  v_fma_f32 v196, v196, v2, v3
  v_fma_f32 v197, v197, v2, v3
  v_fma_f32 v198, v198, v2, v3
  v_fma_f32 v199, v199, v2, v3
  v_fma_f32 v200, v200, v2, v3
  v_fma_f32 v201, v201, v2, v3
  v_fma_f32 v202, v202, v2, v3
  v_fma_f32 v203, v203, v2, v3
  v_fma_f32 v204, v204, v2, v3
  v_fma_f32 v205, v205, v2, v3
  v_fma_f32 v206, v206, v2, v3
  v_fma_f32 v207, v207, v2, v3
  v_fma_f32 v208, v208, v2, v3
  v_fma_f32 v209, v209, v2, v3
  v_fma_f32 v210, v210, v2, v3
  v_fma_f32 v211, v211, v2, v3
  v_fma_f32 v212, v212, v2, v3
  v_fma_f32 v213, v213, v2, v3
  v_fma_f32 v214, v214, v2, v3
  v_fma_f32 v215, v215, v2, v3
  v_fma_f32 v216, v216, v2, v3
  v_fma_f32 v217, v217, v2, v3
  v_fma_f32 v218, v218, v2, v3
  v_fma_f32 v219, v219, v2, v3
  v_fma_f32 v220, v220, v2, v3
  v_fma_f32 v221, v221, v2, v3
  v_fma_f32 v222, v222, v2, v3
  v_fma_f32 v223, v223, v2, v3
  v_fma_f32 v224, v224, v2, v3
  v_fma_f32 v225, v225, v2, v3
  v_fma_f32 v226, v226, v2, v3
  v_fma_f32 v227, v227, v2, v3
  v_fma_f32 v228, v228, v2, v3
  v_fma_f32 v229, v229, v2, v3
  v_fma_f32 v230, v230, v2, v3
  v_fma_f32 v231, v231, v2, v3
  v_fma_f32 v232, v232, v2, v3
  v_fma_f32 v233, v233, v2, v3
  v_fma_f32 v234, v234, v2, v3
  v_fma_f32 v235, v235, v2, v3
  v_fma_f32 v236, v236, v2, v3
  v_fma_f32 v237, v237, v2, v3
  v_fma_f32 v238, v238, v2, v3
  v_fma_f32 v239, v239, v2, v3
  v_fma_f32 v240, v240, v2, v3
  v_fma_f32 v241, v241, v2, v3
  v_fma_f32 v242, v242, v2, v3
  v_fma_f32 v243, v243, v2, v3
  v_fma_f32 v244, v244, v2, v3
  v_fma_f32 v245, v245, v2, v3
  v_fma_f32 v246, v246, v2, v3
  v_fma_f32 v247, v247, v2, v3
  v_fma_f32 v248, v248, v2, v3
  v_fma_f32 v249, v249, v2, v3
  v_fma_f32 v250, v250, v2, v3
  v_fma_f32 v251, v251, v2, v3
  v_fma_f32 v252, v252, v2, v3
  v_fma_f32 v253, v253, v2, v3
  v_fma_f32 v254, v254, v2, v3
  v_fma_f32 v255, v255, v2, v3
  v_and_b32 v4, 15, v0
  v_lshrrev_b32 v5, 4, v0
  s_lshl_b32 s43, s24, 14
  s_add_u32 s43, s43, 98304
  v_lshlrev_b32 v6, 10, v4
  v_add_u32 v6, s43, v6
  v_add_u32 v7, 0, v5
  v_xor_b32 v7, v7, v4
  v_lshl_add_u32 v28, v7, 4, v6
  v_add_u32 v7, 4, v5
  v_xor_b32 v7, v7, v4
  v_lshl_add_u32 v29, v7, 4, v6
  v_add_u32 v7, 8, v5
  v_xor_b32 v7, v7, v4
  v_lshl_add_u32 v30, v7, 4, v6
  v_add_u32 v7, 12, v5
  v_xor_b32 v7, v7, v4
  v_lshl_add_u32 v31, v7, 4, v6
  v_cvt_pk_bf16_f32 v48, v128, v129
  v_cvt_pk_bf16_f32 v49, v130, v131
  v_cvt_pk_bf16_f32 v50, v132, v133
  v_cvt_pk_bf16_f32 v51, v134, v135
  ds_write_b128 v28, v[48:51]
  v_cvt_pk_bf16_f32 v52, v136, v137
  v_cvt_pk_bf16_f32 v53, v138, v139
  v_cvt_pk_bf16_f32 v54, v140, v141
  v_cvt_pk_bf16_f32 v55, v142, v143
  ds_write_b128 v29, v[52:55]
  v_cvt_pk_bf16_f32 v56, v144, v145
  v_cvt_pk_bf16_f32 v57, v146, v147
  v_cvt_pk_bf16_f32 v58, v148, v149
  v_cvt_pk_bf16_f32 v59, v150, v151
  ds_write_b128 v30, v[56:59]
  v_cvt_pk_bf16_f32 v60, v152, v153
  v_cvt_pk_bf16_f32 v61, v154, v155
  v_cvt_pk_bf16_f32 v62, v156, v157
  v_cvt_pk_bf16_f32 v63, v158, v159
  ds_write_b128 v31, v[60:63]
  v_cvt_pk_bf16_f32 v64, v160, v161
  v_cvt_pk_bf16_f32 v65, v162, v163
  v_cvt_pk_bf16_f32 v66, v164, v165
  v_cvt_pk_bf16_f32 v67, v166, v167
  ds_write_b128 v28, v[64:67] offset:256
  v_cvt_pk_bf16_f32 v68, v168, v169
  v_cvt_pk_bf16_f32 v69, v170, v171
  v_cvt_pk_bf16_f32 v70, v172, v173
  v_cvt_pk_bf16_f32 v71, v174, v175
  ds_write_b128 v29, v[68:71] offset:256
  v_cvt_pk_bf16_f32 v72, v176, v177
  v_cvt_pk_bf16_f32 v73, v178, v179
  v_cvt_pk_bf16_f32 v74, v180, v181
  v_cvt_pk_bf16_f32 v75, v182, v183
  ds_write_b128 v30, v[72:75] offset:256
  v_cvt_pk_bf16_f32 v76, v184, v185
  v_cvt_pk_bf16_f32 v77, v186, v187
  v_cvt_pk_bf16_f32 v78, v188, v189
  v_cvt_pk_bf16_f32 v79, v190, v191
  ds_write_b128 v31, v[76:79] offset:256
  v_cvt_pk_bf16_f32 v80, v192, v193
  v_cvt_pk_bf16_f32 v81, v194, v195
  v_cvt_pk_bf16_f32 v82, v196, v197
  v_cvt_pk_bf16_f32 v83, v198, v199
  ds_write_b128 v28, v[80:83] offset:512
  v_cvt_pk_bf16_f32 v84, v200, v201
  v_cvt_pk_bf16_f32 v85, v202, v203
  v_cvt_pk_bf16_f32 v86, v204, v205
  v_cvt_pk_bf16_f32 v87, v206, v207
  ds_write_b128 v29, v[84:87] offset:512
  v_cvt_pk_bf16_f32 v88, v208, v209
  v_cvt_pk_bf16_f32 v89, v210, v211
  v_cvt_pk_bf16_f32 v90, v212, v213
  v_cvt_pk_bf16_f32 v91, v214, v215
  ds_write_b128 v30, v[88:91] offset:512
  v_cvt_pk_bf16_f32 v92, v216, v217
  v_cvt_pk_bf16_f32 v93, v218, v219
  v_cvt_pk_bf16_f32 v94, v220, v221
  v_cvt_pk_bf16_f32 v95, v222, v223
  ds_write_b128 v31, v[92:95] offset:512
  v_cvt_pk_bf16_f32 v96, v224, v225
  v_cvt_pk_bf16_f32 v97, v226, v227
  v_cvt_pk_bf16_f32 v98, v228, v229
  v_cvt_pk_bf16_f32 v99, v230, v231
  ds_write_b128 v28, v[96:99] offset:768
  v_cvt_pk_bf16_f32 v100, v232, v233
  v_cvt_pk_bf16_f32 v101, v234, v235
  v_cvt_pk_bf16_f32 v102, v236, v237
  v_cvt_pk_bf16_f32 v103, v238, v239
  ds_write_b128 v29, v[100:103] offset:768
  v_cvt_pk_bf16_f32 v104, v240, v241
  v_cvt_pk_bf16_f32 v105, v242, v243
  v_cvt_pk_bf16_f32 v106, v244, v245
  v_cvt_pk_bf16_f32 v107, v246, v247
  ds_write_b128 v30, v[104:107] offset:768
  v_cvt_pk_bf16_f32 v108, v248, v249
  v_cvt_pk_bf16_f32 v109, v250, v251
  v_cvt_pk_bf16_f32 v110, v252, v253
  v_cvt_pk_bf16_f32 v111, v254, v255
  ds_write_b128 v31, v[108:111] offset:768
  s_waitcnt lgkmcnt(0)
  s_barrier
  s_add_u32 m0, s41, 8192
  s_nop 0
  buffer_load_dwordx4 v44, s[28:31], s42 offen lds
  buffer_load_dwordx4 v45, s[28:31], s42 offen offset:1024 lds
  buffer_load_dwordx4 v46, s[28:31], s42 offen offset:2048 lds
  buffer_load_dwordx4 v47, s[28:31], s42 offen offset:3072 lds
  s_add_u32 s42, s42, 131072
  s_add_u32 m0, s41, 12288
  s_nop 0
  buffer_load_dwordx4 v44, s[28:31], s42 offen lds
  buffer_load_dwordx4 v45, s[28:31], s42 offen offset:1024 lds
  buffer_load_dwordx4 v46, s[28:31], s42 offen offset:2048 lds
  buffer_load_dwordx4 v47, s[28:31], s42 offen offset:3072 lds
  s_add_u32 s42, s42, 131072
  s_add_u32 m0, s41, 16384
  s_nop 0
  buffer_load_dwordx4 v44, s[28:31], s42 offen lds
  buffer_load_dwordx4 v45, s[28:31], s42 offen offset:1024 lds
  buffer_load_dwordx4 v46, s[28:31], s42 offen offset:2048 lds
  buffer_load_dwordx4 v47, s[28:31], s42 offen offset:3072 lds
  s_add_u32 s42, s42, 131072
  s_add_u32 m0, s41, 20480
  s_nop 0
  buffer_load_dwordx4 v44, s[28:31], s42 offen lds
  buffer_load_dwordx4 v45, s[28:31], s42 offen offset:1024 lds
  buffer_load_dwordx4 v46, s[28:31], s42 offen offset:2048 lds
  buffer_load_dwordx4 v47, s[28:31], s42 offen offset:3072 lds
  s_add_u32 s42, s42, 131072
  ds_read_b128 a[0:3], v40
  ds_read_b128 a[4:7], v40 offset:16384
  ds_read_b128 a[8:11], v40 offset:32768
  ds_read_b128 a[12:15], v40 offset:49152
  s_waitcnt vmcnt(16)
  ds_read_b64_tr_b16 a[64:65], v32
  ds_read_b64_tr_b16 a[66:67], v32 offset:1024
  ds_read_b64_tr_b16 a[68:69], v33
  ds_read_b64_tr_b16 a[70:71], v33 offset:1024
  ds_read_b64_tr_b16 a[72:73], v34
  ds_read_b64_tr_b16 a[74:75], v34 offset:1024
  ds_read_b64_tr_b16 a[76:77], v35
  ds_read_b64_tr_b16 a[78:79], v35 offset:1024
  ds_read_b64_tr_b16 a[80:81], v36
  ds_read_b64_tr_b16 a[82:83], v36 offset:1024
  ds_read_b64_tr_b16 a[84:85], v37
  ds_read_b64_tr_b16 a[86:87], v37 offset:1024
  ds_read_b64_tr_b16 a[88:89], v38
  ds_read_b64_tr_b16 a[90:91], v38 offset:1024
  ds_read_b64_tr_b16 a[92:93], v39
  ds_read_b64_tr_b16 a[94:95], v39 offset:1024
  s_waitcnt lgkmcnt(14)
  v_mfma_f32_16x16x32_bf16 v[128:131], a[64:67], a[0:3], 0
  ds_read_b128 a[16:19], v41
  ds_read_b128 a[20:23], v41 offset:16384
  s_lshl_b32 s44, s25, 3
  s_lshl_b32 s45, s24, 1
  s_add_u32 s44, s44, s45
  s_add_u32 s45, s44, 0
  s_and_b32 s5, s45, 15
  s_lshl_b32 s5, s5, 4
  s_lshl_b32 s45, s45, 10
  s_add_u32 s45, s45, 98304
  v_lshlrev_b32 v94, 4, v0
  v_xor_b32 v94, s5, v94
  v_mfma_f32_16x16x32_bf16 v[132:135], a[64:67], a[4:7], 0
  ds_read_b128 a[24:27], v41 offset:32768
  ds_read_b128 a[28:31], v41 offset:49152
  v_add_u32 v94, s45, v94
  ds_read_b128 v[80:83], v94
  v_mfma_f32_16x16x32_bf16 v[136:139], a[64:67], a[8:11], 0
  s_waitcnt vmcnt(8)
  s_add_u32 m0, s41, 0
  ds_read_b64_tr_b16 a[96:97], v32 offset:8192
  ds_read_b64_tr_b16 a[98:99], v32 offset:9216
  s_add_u32 s45, s44, 1
  s_and_b32 s5, s45, 15
  s_lshl_b32 s5, s5, 4
  s_lshl_b32 s45, s45, 10
  s_add_u32 s45, s45, 98304
  v_lshlrev_b32 v94, 4, v0
  v_xor_b32 v94, s5, v94
  v_mfma_f32_16x16x32_bf16 v[140:143], a[64:67], a[12:15], 0
  s_waitcnt lgkmcnt(7)
  buffer_load_dwordx4 v44, s[28:31], s42 offen lds
  v_mfma_f32_16x16x32_bf16 v[144:147], a[68:71], a[0:3], 0
  ds_read_b64_tr_b16 a[100:101], v33 offset:8192
  ds_read_b64_tr_b16 a[102:103], v33 offset:9216
  v_add_u32 v94, s45, v94
  ds_read_b128 v[84:87], v94
  v_mfma_f32_16x16x32_bf16 v[148:151], a[68:71], a[4:7], 0
  buffer_load_dwordx4 v45, s[28:31], s42 offen offset:1024 lds
  v_mfma_f32_16x16x32_bf16 v[152:155], a[68:71], a[8:11], 0
  s_waitcnt lgkmcnt(5)
  ds_read_b64_tr_b16 a[104:105], v34 offset:8192
  ds_read_b64_tr_b16 a[106:107], v34 offset:9216
  v_lshlrev_b32 v64, 16, v80
  v_and_b32 v65, 4294901760, v80
  v_mfma_f32_16x16x32_bf16 v[156:159], a[68:71], a[12:15], 0
  buffer_load_dwordx4 v46, s[28:31], s42 offen offset:2048 lds
  v_mfma_f32_16x16x32_bf16 v[160:163], a[72:75], a[0:3], 0
  ds_read_b64_tr_b16 a[108:109], v35 offset:8192
  ds_read_b64_tr_b16 a[110:111], v35 offset:9216
  v_lshlrev_b32 v66, 16, v81
  v_and_b32 v67, 4294901760, v81
  v_mfma_f32_16x16x32_bf16 v[164:167], a[72:75], a[4:7], 0
  buffer_load_dwordx4 v47, s[28:31], s42 offen offset:3072 lds
  v_mfma_f32_16x16x32_bf16 v[168:171], a[72:75], a[8:11], 0
  s_add_u32 s42, s42, 131072
  s_add_u32 m0, s41, 4096
  ds_read_b64_tr_b16 a[112:113], v36 offset:8192
  ds_read_b64_tr_b16 a[114:115], v36 offset:9216
  v_lshlrev_b32 v68, 16, v82
  v_and_b32 v69, 4294901760, v82
  v_mfma_f32_16x16x32_bf16 v[172:175], a[72:75], a[12:15], 0
  buffer_load_dwordx4 v44, s[28:31], s42 offen lds
  v_mfma_f32_16x16x32_bf16 v[176:179], a[76:79], a[0:3], 0
  ds_read_b64_tr_b16 a[116:117], v37 offset:8192
  ds_read_b64_tr_b16 a[118:119], v37 offset:9216
  v_lshlrev_b32 v70, 16, v83
  v_and_b32 v71, 4294901760, v83
  v_mfma_f32_16x16x32_bf16 v[180:183], a[76:79], a[4:7], 0
  buffer_load_dwordx4 v45, s[28:31], s42 offen offset:1024 lds
  v_mfma_f32_16x16x32_bf16 v[184:187], a[76:79], a[8:11], 0
  s_waitcnt lgkmcnt(8)
  ds_read_b64_tr_b16 a[120:121], v38 offset:8192
  ds_read_b64_tr_b16 a[122:123], v38 offset:9216
  v_lshlrev_b32 v72, 16, v84
  v_and_b32 v73, 4294901760, v84
  v_mfma_f32_16x16x32_bf16 v[188:191], a[76:79], a[12:15], 0
  buffer_load_dwordx4 v46, s[28:31], s42 offen offset:2048 lds
  v_mfma_f32_16x16x32_bf16 v[192:195], a[80:83], a[0:3], 0
  ds_read_b64_tr_b16 a[124:125], v39 offset:8192
  ds_read_b64_tr_b16 a[126:127], v39 offset:9216
  v_lshlrev_b32 v74, 16, v85
  v_and_b32 v75, 4294901760, v85
  v_mfma_f32_16x16x32_bf16 v[196:199], a[80:83], a[4:7], 0
  buffer_load_dwordx4 v47, s[28:31], s42 offen offset:3072 lds
  v_mfma_f32_16x16x32_bf16 v[200:203], a[80:83], a[8:11], 0
  s_add_u32 s42, s42, 131072
  v_lshlrev_b32 v76, 16, v86
  v_and_b32 v77, 4294901760, v86
  v_mfma_f32_16x16x32_bf16 v[204:207], a[80:83], a[12:15], 0
  v_lshlrev_b32 v78, 16, v87
  v_and_b32 v79, 4294901760, v87
  v_mfma_f32_16x16x32_bf16 v[208:211], a[84:87], a[0:3], 0
  v_add_f32 v88, v64, v65
  v_add_f32 v90, v72, v73
  v_mfma_f32_16x16x32_bf16 v[212:215], a[84:87], a[4:7], 0
  v_add_f32 v88, v88, v66
  v_add_f32 v90, v90, v74
  v_mfma_f32_16x16x32_bf16 v[216:219], a[84:87], a[8:11], 0
  v_add_f32 v88, v88, v67
  v_add_f32 v90, v90, v75
  v_mfma_f32_16x16x32_bf16 v[220:223], a[84:87], a[12:15], 0
  v_add_f32 v88, v88, v68
  v_add_f32 v90, v90, v76
  v_mfma_f32_16x16x32_bf16 v[224:227], a[88:91], a[0:3], 0
  v_add_f32 v88, v88, v69
  v_add_f32 v90, v90, v77
  v_mfma_f32_16x16x32_bf16 v[228:231], a[88:91], a[4:7], 0
  v_add_f32 v88, v88, v70
  v_add_f32 v90, v90, v78
  v_mfma_f32_16x16x32_bf16 v[232:235], a[88:91], a[8:11], 0
  v_add_f32 v88, v88, v71
  v_add_f32 v90, v90, v79
  v_mfma_f32_16x16x32_bf16 v[236:239], a[88:91], a[12:15], 0
  v_add_f32_dpp v88, v88, v88 quad_perm:[1,0,3,2] row_mask:0xf bank_mask:0xf
  v_add_f32_dpp v90, v90, v90 quad_perm:[1,0,3,2] row_mask:0xf bank_mask:0xf
  v_mfma_f32_16x16x32_bf16 v[240:243], a[92:95], a[0:3], 0
  v_add_f32_dpp v88, v88, v88 quad_perm:[2,3,0,1] row_mask:0xf bank_mask:0xf
  v_add_f32_dpp v90, v90, v90 quad_perm:[2,3,0,1] row_mask:0xf bank_mask:0xf
  v_mfma_f32_16x16x32_bf16 v[244:247], a[92:95], a[4:7], 0
  v_add_f32_dpp v88, v88, v88 row_half_mirror row_mask:0xf bank_mask:0xf
  v_add_f32_dpp v90, v90, v90 row_half_mirror row_mask:0xf bank_mask:0xf
  v_mfma_f32_16x16x32_bf16 v[248:251], a[92:95], a[8:11], 0
  v_add_f32_dpp v88, v88, v88 row_mirror row_mask:0xf bank_mask:0xf
  v_add_f32_dpp v90, v90, v90 row_mirror row_mask:0xf bank_mask:0xf
  v_mfma_f32_16x16x32_bf16 v[252:255], a[92:95], a[12:15], 0
  v_mov_b32 v89, v88
  v_mov_b32 v91, v90
  v_mfma_f32_16x16x32_bf16 v[128:131], a[96:99], a[16:19], v[128:131]
  ds_read_b128 a[0:3], v42
  ds_read_b128 a[4:7], v42 offset:16384
  v_permlane16_swap_b32 v88, v89
  v_permlane16_swap_b32 v90, v91
  v_mfma_f32_16x16x32_bf16 v[132:135], a[96:99], a[20:23], v[132:135]
  ds_read_b128 a[8:11], v42 offset:32768
  ds_read_b128 a[12:15], v42 offset:49152
  v_add_f32 v88, v88, v89
  v_add_f32 v90, v90, v91
  v_mfma_f32_16x16x32_bf16 v[136:139], a[96:99], a[24:27], v[136:139]
  s_waitcnt vmcnt(8)
  s_add_u32 m0, s41, 8192
  ds_read_b64_tr_b16 a[64:65], v32 offset:16384
  ds_read_b64_tr_b16 a[66:67], v32 offset:17408
  v_mov_b32 v89, v88
  v_mov_b32 v91, v90
  v_mfma_f32_16x16x32_bf16 v[140:143], a[96:99], a[28:31], v[140:143]
  s_waitcnt lgkmcnt(6)
  buffer_load_dwordx4 v44, s[28:31], s42 offen lds
  v_mfma_f32_16x16x32_bf16 v[144:147], a[100:103], a[16:19], v[144:147]
  ds_read_b64_tr_b16 a[68:69], v33 offset:16384
  ds_read_b64_tr_b16 a[70:71], v33 offset:17408
  v_permlane32_swap_b32 v88, v89
  v_permlane32_swap_b32 v90, v91
  v_mfma_f32_16x16x32_bf16 v[148:151], a[100:103], a[20:23], v[148:151]
  buffer_load_dwordx4 v45, s[28:31], s42 offen offset:1024 lds
  v_mfma_f32_16x16x32_bf16 v[152:155], a[100:103], a[24:27], v[152:155]
  ds_read_b64_tr_b16 a[72:73], v34 offset:16384
  ds_read_b64_tr_b16 a[74:75], v34 offset:17408
  v_add_f32 v88, v88, v89
  v_add_f32 v90, v90, v91
  v_mfma_f32_16x16x32_bf16 v[156:159], a[100:103], a[28:31], v[156:159]
  buffer_load_dwordx4 v46, s[28:31], s42 offen offset:2048 lds
  v_mfma_f32_16x16x32_bf16 v[160:163], a[104:107], a[16:19], v[160:163]
  ds_read_b64_tr_b16 a[76:77], v35 offset:16384
  ds_read_b64_tr_b16 a[78:79], v35 offset:17408
  v_mul_f32 v88, 0x3b000000, v88
  v_mul_f32 v90, 0x3b000000, v90
  v_mfma_f32_16x16x32_bf16 v[164:167], a[104:107], a[20:23], v[164:167]
  buffer_load_dwordx4 v47, s[28:31], s42 offen offset:3072 lds
  v_mfma_f32_16x16x32_bf16 v[168:171], a[104:107], a[24:27], v[168:171]
  s_add_u32 s42, s42, 131072
  s_add_u32 m0, s41, 12288
  ds_read_b64_tr_b16 a[80:81], v36 offset:16384
  ds_read_b64_tr_b16 a[82:83], v36 offset:17408
  v_sub_f32 v64, v64, v88
  v_sub_f32 v72, v72, v90
  v_mfma_f32_16x16x32_bf16 v[172:175], a[104:107], a[28:31], v[172:175]
  buffer_load_dwordx4 v44, s[28:31], s42 offen lds
  v_mfma_f32_16x16x32_bf16 v[176:179], a[108:111], a[16:19], v[176:179]
  ds_read_b64_tr_b16 a[84:85], v37 offset:16384
  ds_read_b64_tr_b16 a[86:87], v37 offset:17408
  v_sub_f32 v65, v65, v88
  v_sub_f32 v73, v73, v90
  v_mfma_f32_16x16x32_bf16 v[180:183], a[108:111], a[20:23], v[180:183]
  buffer_load_dwordx4 v45, s[28:31], s42 offen offset:1024 lds
  v_mfma_f32_16x16x32_bf16 v[184:187], a[108:111], a[24:27], v[184:187]
  ds_read_b64_tr_b16 a[88:89], v38 offset:16384
  ds_read_b64_tr_b16 a[90:91], v38 offset:17408
  v_sub_f32 v66, v66, v88
  v_sub_f32 v74, v74, v90
  v_mfma_f32_16x16x32_bf16 v[188:191], a[108:111], a[28:31], v[188:191]
  buffer_load_dwordx4 v46, s[28:31], s42 offen offset:2048 lds
  v_mfma_f32_16x16x32_bf16 v[192:195], a[112:115], a[16:19], v[192:195]
  ds_read_b64_tr_b16 a[92:93], v39 offset:16384
  ds_read_b64_tr_b16 a[94:95], v39 offset:17408
  v_sub_f32 v67, v67, v88
  v_sub_f32 v75, v75, v90
  v_mfma_f32_16x16x32_bf16 v[196:199], a[112:115], a[20:23], v[196:199]
  buffer_load_dwordx4 v47, s[28:31], s42 offen offset:3072 lds
  v_mfma_f32_16x16x32_bf16 v[200:203], a[112:115], a[24:27], v[200:203]
  s_add_u32 s42, s42, 131072
  v_sub_f32 v68, v68, v88
  v_sub_f32 v76, v76, v90
  v_mfma_f32_16x16x32_bf16 v[204:207], a[112:115], a[28:31], v[204:207]
  v_sub_f32 v69, v69, v88
  v_sub_f32 v77, v77, v90
  v_mfma_f32_16x16x32_bf16 v[208:211], a[116:119], a[16:19], v[208:211]
  v_sub_f32 v70, v70, v88
  v_sub_f32 v78, v78, v90
  v_mfma_f32_16x16x32_bf16 v[212:215], a[116:119], a[20:23], v[212:215]
  v_sub_f32 v71, v71, v88
  v_sub_f32 v79, v79, v90
  v_mfma_f32_16x16x32_bf16 v[216:219], a[116:119], a[24:27], v[216:219]
  v_mul_f32 v92, v64, v64
  v_mul_f32 v93, v72, v72
  v_mfma_f32_16x16x32_bf16 v[220:223], a[116:119], a[28:31], v[220:223]
  v_fmac_f32 v92, v65, v65
  v_fmac_f32 v93, v73, v73
  v_mfma_f32_16x16x32_bf16 v[224:227], a[120:123], a[16:19], v[224:227]
  v_fmac_f32 v92, v66, v66
  v_fmac_f32 v93, v74, v74
  v_mfma_f32_16x16x32_bf16 v[228:231], a[120:123], a[20:23], v[228:231]
  v_fmac_f32 v92, v67, v67
  v_fmac_f32 v93, v75, v75
  v_mfma_f32_16x16x32_bf16 v[232:235], a[120:123], a[24:27], v[232:235]
  v_fmac_f32 v92, v68, v68
  v_fmac_f32 v93, v76, v76
  v_mfma_f32_16x16x32_bf16 v[236:239], a[120:123], a[28:31], v[236:239]
  v_fmac_f32 v92, v69, v69
  v_fmac_f32 v93, v77, v77
  v_mfma_f32_16x16x32_bf16 v[240:243], a[124:127], a[16:19], v[240:243]
  v_fmac_f32 v92, v70, v70
  v_fmac_f32 v93, v78, v78
  v_mfma_f32_16x16x32_bf16 v[244:247], a[124:127], a[20:23], v[244:247]
  v_fmac_f32 v92, v71, v71
  v_fmac_f32 v93, v79, v79
  v_mfma_f32_16x16x32_bf16 v[248:251], a[124:127], a[24:27], v[248:251]
  v_add_f32_dpp v92, v92, v92 quad_perm:[1,0,3,2] row_mask:0xf bank_mask:0xf
  v_add_f32_dpp v93, v93, v93 quad_perm:[1,0,3,2] row_mask:0xf bank_mask:0xf
  v_mfma_f32_16x16x32_bf16 v[252:255], a[124:127], a[28:31], v[252:255]
  s_waitcnt lgkmcnt(14)
  v_add_f32_dpp v92, v92, v92 quad_perm:[2,3,0,1] row_mask:0xf bank_mask:0xf
  v_add_f32_dpp v93, v93, v93 quad_perm:[2,3,0,1] row_mask:0xf bank_mask:0xf
  v_mfma_f32_16x16x32_bf16 v[128:131], a[64:67], a[0:3], v[128:131]
  ds_read_b128 a[16:19], v43
  ds_read_b128 a[20:23], v43 offset:16384
  v_add_f32_dpp v92, v92, v92 row_half_mirror row_mask:0xf bank_mask:0xf
  v_add_f32_dpp v93, v93, v93 row_half_mirror row_mask:0xf bank_mask:0xf
  v_mfma_f32_16x16x32_bf16 v[132:135], a[64:67], a[4:7], v[132:135]
  ds_read_b128 a[24:27], v43 offset:32768
  ds_read_b128 a[28:31], v43 offset:49152
  v_add_f32_dpp v92, v92, v92 row_mirror row_mask:0xf bank_mask:0xf
  v_add_f32_dpp v93, v93, v93 row_mirror row_mask:0xf bank_mask:0xf
  v_mfma_f32_16x16x32_bf16 v[136:139], a[64:67], a[8:11], v[136:139]
  s_waitcnt vmcnt(8)
  s_add_u32 m0, s41, 16384
  ds_read_b64_tr_b16 a[96:97], v32
  ds_read_b64_tr_b16 a[98:99], v32 offset:1024
  v_mov_b32 v89, v92
  v_mov_b32 v91, v93
  v_mfma_f32_16x16x32_bf16 v[140:143], a[64:67], a[12:15], v[140:143]
  s_waitcnt lgkmcnt(6)
  buffer_load_dwordx4 v44, s[28:31], s42 offen lds
  v_mfma_f32_16x16x32_bf16 v[144:147], a[68:71], a[0:3], v[144:147]
  ds_read_b64_tr_b16 a[100:101], v33
  ds_read_b64_tr_b16 a[102:103], v33 offset:1024
  v_permlane16_swap_b32 v92, v89
  v_permlane16_swap_b32 v93, v91
  v_mfma_f32_16x16x32_bf16 v[148:151], a[68:71], a[4:7], v[148:151]
  buffer_load_dwordx4 v45, s[28:31], s42 offen offset:1024 lds
  v_mfma_f32_16x16x32_bf16 v[152:155], a[68:71], a[8:11], v[152:155]
  ds_read_b64_tr_b16 a[104:105], v34
  ds_read_b64_tr_b16 a[106:107], v34 offset:1024
  v_add_f32 v92, v92, v89
  v_add_f32 v93, v93, v91
  v_mfma_f32_16x16x32_bf16 v[156:159], a[68:71], a[12:15], v[156:159]
  buffer_load_dwordx4 v46, s[28:31], s42 offen offset:2048 lds
  v_mfma_f32_16x16x32_bf16 v[160:163], a[72:75], a[0:3], v[160:163]
  ds_read_b64_tr_b16 a[108:109], v35
  ds_read_b64_tr_b16 a[110:111], v35 offset:1024
  v_mov_b32 v89, v92
  v_mov_b32 v91, v93
  v_mfma_f32_16x16x32_bf16 v[164:167], a[72:75], a[4:7], v[164:167]
  buffer_load_dwordx4 v47, s[28:31], s42 offen offset:3072 lds
  v_mfma_f32_16x16x32_bf16 v[168:171], a[72:75], a[8:11], v[168:171]
  s_add_u32 s42, s42, 131072
  s_add_u32 m0, s41, 20480
  ds_read_b64_tr_b16 a[112:113], v36
  ds_read_b64_tr_b16 a[114:115], v36 offset:1024
  v_permlane32_swap_b32 v92, v89
  v_permlane32_swap_b32 v93, v91
  v_mfma_f32_16x16x32_bf16 v[172:175], a[72:75], a[12:15], v[172:175]
  buffer_load_dwordx4 v44, s[28:31], s42 offen lds
  v_mfma_f32_16x16x32_bf16 v[176:179], a[76:79], a[0:3], v[176:179]
  ds_read_b64_tr_b16 a[116:117], v37
  ds_read_b64_tr_b16 a[118:119], v37 offset:1024
  v_add_f32 v92, v92, v89
  v_add_f32 v93, v93, v91
  v_mfma_f32_16x16x32_bf16 v[180:183], a[76:79], a[4:7], v[180:183]
  buffer_load_dwordx4 v45, s[28:31], s42 offen offset:1024 lds
  v_mfma_f32_16x16x32_bf16 v[184:187], a[76:79], a[8:11], v[184:187]
  ds_read_b64_tr_b16 a[120:121], v38
  ds_read_b64_tr_b16 a[122:123], v38 offset:1024
  v_mov_b32 v89, 0x3727c5ac
  v_mov_b32 v91, 0x3727c5ac
  v_mfma_f32_16x16x32_bf16 v[188:191], a[76:79], a[12:15], v[188:191]
  buffer_load_dwordx4 v46, s[28:31], s42 offen offset:2048 lds
  v_mfma_f32_16x16x32_bf16 v[192:195], a[80:83], a[0:3], v[192:195]
  ds_read_b64_tr_b16 a[124:125], v39
  ds_read_b64_tr_b16 a[126:127], v39 offset:1024
  v_fmac_f32 v89, 0x3b000000, v92
  v_fmac_f32 v91, 0x3b000000, v93
  v_mfma_f32_16x16x32_bf16 v[196:199], a[80:83], a[4:7], v[196:199]
  buffer_load_dwordx4 v47, s[28:31], s42 offen offset:3072 lds
  v_mfma_f32_16x16x32_bf16 v[200:203], a[80:83], a[8:11], v[200:203]
  s_add_u32 s42, s42, 131072
  v_rsq_f32 v89, v89
  v_rsq_f32 v91, v91
  v_mfma_f32_16x16x32_bf16 v[204:207], a[80:83], a[12:15], v[204:207]
  v_mul_f32 v64, v64, v89
  v_mul_f32 v72, v72, v91
  v_mfma_f32_16x16x32_bf16 v[208:211], a[84:87], a[0:3], v[208:211]
  v_mul_f32 v65, v65, v89
  v_mul_f32 v73, v73, v91
  v_mfma_f32_16x16x32_bf16 v[212:215], a[84:87], a[4:7], v[212:215]
  v_mul_f32 v66, v66, v89
  v_mul_f32 v74, v74, v91
  v_mfma_f32_16x16x32_bf16 v[216:219], a[84:87], a[8:11], v[216:219]
  v_mul_f32 v67, v67, v89
  v_mul_f32 v75, v75, v91
  v_mfma_f32_16x16x32_bf16 v[220:223], a[84:87], a[12:15], v[220:223]
  v_mul_f32 v68, v68, v89
  v_mul_f32 v76, v76, v91
  v_mfma_f32_16x16x32_bf16 v[224:227], a[88:91], a[0:3], v[224:227]
  v_mul_f32 v69, v69, v89
  v_mul_f32 v77, v77, v91
  v_mfma_f32_16x16x32_bf16 v[228:231], a[88:91], a[4:7], v[228:231]
  v_mul_f32 v70, v70, v89
  v_mul_f32 v78, v78, v91
  v_mfma_f32_16x16x32_bf16 v[232:235], a[88:91], a[8:11], v[232:235]
  v_mul_f32 v71, v71, v89
  v_mul_f32 v79, v79, v91
  v_mfma_f32_16x16x32_bf16 v[236:239], a[88:91], a[12:15], v[236:239]
  v_cvt_pk_bf16_f32 v80, v64, v65
  v_cvt_pk_bf16_f32 v84, v72, v73
  v_mfma_f32_16x16x32_bf16 v[240:243], a[92:95], a[0:3], v[240:243]
  v_cvt_pk_bf16_f32 v81, v66, v67
  v_cvt_pk_bf16_f32 v85, v74, v75
  v_mfma_f32_16x16x32_bf16 v[244:247], a[92:95], a[4:7], v[244:247]
  v_cvt_pk_bf16_f32 v82, v68, v69
  v_cvt_pk_bf16_f32 v86, v76, v77
  v_mfma_f32_16x16x32_bf16 v[248:251], a[92:95], a[8:11], v[248:251]
  v_cvt_pk_bf16_f32 v83, v70, v71
  v_cvt_pk_bf16_f32 v87, v78, v79
  v_mfma_f32_16x16x32_bf16 v[252:255], a[92:95], a[12:15], v[252:255]
  s_waitcnt lgkmcnt(14)
  s_lshl_b32 s45, s26, 6
  s_add_u32 s45, s45, s44
  s_lshl_b32 s45, s45, 10
  s_add_u32 s45, s45, 2097152
  v_lshlrev_b32 v94, 4, v0
  buffer_store_dwordx4 v[80:83], v94, s[16:19], s45 offen sc1
  v_mfma_f32_16x16x32_bf16 v[128:131], a[96:99], a[16:19], v[128:131]
  ds_read_b128 a[0:3], v40 offset:256
  ds_read_b128 a[4:7], v40 offset:16640
  buffer_store_dwordx4 v[84:87], v94, s[16:19], s45 offen offset:1024 sc1
  v_lshlrev_b32 v95, 25, v0
  v_mfma_f32_16x16x32_bf16 v[132:135], a[96:99], a[20:23], v[132:135]
  ds_read_b128 a[8:11], v40 offset:33024
  ds_read_b128 a[12:15], v40 offset:49408
  v_mov_b32 v96, 0
  s_and_b32 s45, s2, 127
  s_lshl_b32 s45, s45, 8
  s_add_u32 s45, s45, 6160384
  buffer_store_dword v96, v95, s[16:19], s45 offen sc1
  v_mfma_f32_16x16x32_bf16 v[136:139], a[96:99], a[24:27], v[136:139]
  s_waitcnt vmcnt(11)
  s_add_u32 m0, s41, 0
  ds_read_b64_tr_b16 a[64:65], v32 offset:8192
  ds_read_b64_tr_b16 a[66:67], v32 offset:9216
  v_mfma_f32_16x16x32_bf16 v[140:143], a[96:99], a[28:31], v[140:143]
  s_waitcnt lgkmcnt(6)
  buffer_load_dwordx4 v44, s[28:31], s42 offen lds
  v_mfma_f32_16x16x32_bf16 v[144:147], a[100:103], a[16:19], v[144:147]
  ds_read_b64_tr_b16 a[68:69], v33 offset:8192
  ds_read_b64_tr_b16 a[70:71], v33 offset:9216
  v_mfma_f32_16x16x32_bf16 v[148:151], a[100:103], a[20:23], v[148:151]
  buffer_load_dwordx4 v45, s[28:31], s42 offen offset:1024 lds
  v_mfma_f32_16x16x32_bf16 v[152:155], a[100:103], a[24:27], v[152:155]
  ds_read_b64_tr_b16 a[72:73], v34 offset:8192
  ds_read_b64_tr_b16 a[74:75], v34 offset:9216
  v_mfma_f32_16x16x32_bf16 v[156:159], a[100:103], a[28:31], v[156:159]
  buffer_load_dwordx4 v46, s[28:31], s42 offen offset:2048 lds
  v_mfma_f32_16x16x32_bf16 v[160:163], a[104:107], a[16:19], v[160:163]
  ds_read_b64_tr_b16 a[76:77], v35 offset:8192
  ds_read_b64_tr_b16 a[78:79], v35 offset:9216
  v_mfma_f32_16x16x32_bf16 v[164:167], a[104:107], a[20:23], v[164:167]
  buffer_load_dwordx4 v47, s[28:31], s42 offen offset:3072 lds
  v_mfma_f32_16x16x32_bf16 v[168:171], a[104:107], a[24:27], v[168:171]
  s_add_u32 s42, s42, 131072
  s_add_u32 m0, s41, 4096
  ds_read_b64_tr_b16 a[80:81], v36 offset:8192
  ds_read_b64_tr_b16 a[82:83], v36 offset:9216
  v_mfma_f32_16x16x32_bf16 v[172:175], a[104:107], a[28:31], v[172:175]
  buffer_load_dwordx4 v44, s[28:31], s42 offen lds
  v_mfma_f32_16x16x32_bf16 v[176:179], a[108:111], a[16:19], v[176:179]
  ds_read_b64_tr_b16 a[84:85], v37 offset:8192
  ds_read_b64_tr_b16 a[86:87], v37 offset:9216
  v_mfma_f32_16x16x32_bf16 v[180:183], a[108:111], a[20:23], v[180:183]
  buffer_load_dwordx4 v45, s[28:31], s42 offen offset:1024 lds
  v_mfma_f32_16x16x32_bf16 v[184:187], a[108:111], a[24:27], v[184:187]
  ds_read_b64_tr_b16 a[88:89], v38 offset:8192
  ds_read_b64_tr_b16 a[90:91], v38 offset:9216
  v_mfma_f32_16x16x32_bf16 v[188:191], a[108:111], a[28:31], v[188:191]
  buffer_load_dwordx4 v46, s[28:31], s42 offen offset:2048 lds
  v_mfma_f32_16x16x32_bf16 v[192:195], a[112:115], a[16:19], v[192:195]
  ds_read_b64_tr_b16 a[92:93], v39 offset:8192
  ds_read_b64_tr_b16 a[94:95], v39 offset:9216
  v_mfma_f32_16x16x32_bf16 v[196:199], a[112:115], a[20:23], v[196:199]
  buffer_load_dwordx4 v47, s[28:31], s42 offen offset:3072 lds
  v_mfma_f32_16x16x32_bf16 v[200:203], a[112:115], a[24:27], v[200:203]
  s_add_u32 s42, s42, 131072
  v_mfma_f32_16x16x32_bf16 v[204:207], a[112:115], a[28:31], v[204:207]
  v_mfma_f32_16x16x32_bf16 v[208:211], a[116:119], a[16:19], v[208:211]
  v_mfma_f32_16x16x32_bf16 v[212:215], a[116:119], a[20:23], v[212:215]
  v_mfma_f32_16x16x32_bf16 v[216:219], a[116:119], a[24:27], v[216:219]
  v_mfma_f32_16x16x32_bf16 v[220:223], a[116:119], a[28:31], v[220:223]
  v_mfma_f32_16x16x32_bf16 v[224:227], a[120:123], a[16:19], v[224:227]
  v_mfma_f32_16x16x32_bf16 v[228:231], a[120:123], a[20:23], v[228:231]
  v_mfma_f32_16x16x32_bf16 v[232:235], a[120:123], a[24:27], v[232:235]
  v_mfma_f32_16x16x32_bf16 v[236:239], a[120:123], a[28:31], v[236:239]
  v_mfma_f32_16x16x32_bf16 v[240:243], a[124:127], a[16:19], v[240:243]
  v_mfma_f32_16x16x32_bf16 v[244:247], a[124:127], a[20:23], v[244:247]
  v_mfma_f32_16x16x32_bf16 v[248:251], a[124:127], a[24:27], v[248:251]
  v_mfma_f32_16x16x32_bf16 v[252:255], a[124:127], a[28:31], v[252:255]
  s_waitcnt lgkmcnt(14)
  v_mfma_f32_16x16x32_bf16 v[128:131], a[64:67], a[0:3], v[128:131]
  ds_read_b128 a[16:19], v41 offset:256
  ds_read_b128 a[20:23], v41 offset:16640
  v_mfma_f32_16x16x32_bf16 v[132:135], a[64:67], a[4:7], v[132:135]
  ds_read_b128 a[24:27], v41 offset:33024
  ds_read_b128 a[28:31], v41 offset:49408
  v_mfma_f32_16x16x32_bf16 v[136:139], a[64:67], a[8:11], v[136:139]
  s_waitcnt vmcnt(11)
  s_add_u32 m0, s41, 8192
  ds_read_b64_tr_b16 a[96:97], v32 offset:16384
  ds_read_b64_tr_b16 a[98:99], v32 offset:17408
  v_mfma_f32_16x16x32_bf16 v[140:143], a[64:67], a[12:15], v[140:143]
  s_waitcnt lgkmcnt(6)
  buffer_load_dwordx4 v44, s[28:31], s42 offen lds
  v_mfma_f32_16x16x32_bf16 v[144:147], a[68:71], a[0:3], v[144:147]
  ds_read_b64_tr_b16 a[100:101], v33 offset:16384
  ds_read_b64_tr_b16 a[102:103], v33 offset:17408
  v_mfma_f32_16x16x32_bf16 v[148:151], a[68:71], a[4:7], v[148:151]
  buffer_load_dwordx4 v45, s[28:31], s42 offen offset:1024 lds
  v_mfma_f32_16x16x32_bf16 v[152:155], a[68:71], a[8:11], v[152:155]
  ds_read_b64_tr_b16 a[104:105], v34 offset:16384
  ds_read_b64_tr_b16 a[106:107], v34 offset:17408
  v_mfma_f32_16x16x32_bf16 v[156:159], a[68:71], a[12:15], v[156:159]
  buffer_load_dwordx4 v46, s[28:31], s42 offen offset:2048 lds
  v_mfma_f32_16x16x32_bf16 v[160:163], a[72:75], a[0:3], v[160:163]
  ds_read_b64_tr_b16 a[108:109], v35 offset:16384
  ds_read_b64_tr_b16 a[110:111], v35 offset:17408
  v_mfma_f32_16x16x32_bf16 v[164:167], a[72:75], a[4:7], v[164:167]
  buffer_load_dwordx4 v47, s[28:31], s42 offen offset:3072 lds
  v_mfma_f32_16x16x32_bf16 v[168:171], a[72:75], a[8:11], v[168:171]
  s_add_u32 s42, s42, 131072
  s_add_u32 m0, s41, 12288
  ds_read_b64_tr_b16 a[112:113], v36 offset:16384
  ds_read_b64_tr_b16 a[114:115], v36 offset:17408
  v_mfma_f32_16x16x32_bf16 v[172:175], a[72:75], a[12:15], v[172:175]
  buffer_load_dwordx4 v44, s[28:31], s42 offen lds
  v_mfma_f32_16x16x32_bf16 v[176:179], a[76:79], a[0:3], v[176:179]
  ds_read_b64_tr_b16 a[116:117], v37 offset:16384
  ds_read_b64_tr_b16 a[118:119], v37 offset:17408
  v_mfma_f32_16x16x32_bf16 v[180:183], a[76:79], a[4:7], v[180:183]
  buffer_load_dwordx4 v45, s[28:31], s42 offen offset:1024 lds
  v_mfma_f32_16x16x32_bf16 v[184:187], a[76:79], a[8:11], v[184:187]
  ds_read_b64_tr_b16 a[120:121], v38 offset:16384
  ds_read_b64_tr_b16 a[122:123], v38 offset:17408
  v_mfma_f32_16x16x32_bf16 v[188:191], a[76:79], a[12:15], v[188:191]
  buffer_load_dwordx4 v46, s[28:31], s42 offen offset:2048 lds
  v_mfma_f32_16x16x32_bf16 v[192:195], a[80:83], a[0:3], v[192:195]
  ds_read_b64_tr_b16 a[124:125], v39 offset:16384
  ds_read_b64_tr_b16 a[126:127], v39 offset:17408
  v_mfma_f32_16x16x32_bf16 v[196:199], a[80:83], a[4:7], v[196:199]
  buffer_load_dwordx4 v47, s[28:31], s42 offen offset:3072 lds
  v_mfma_f32_16x16x32_bf16 v[200:203], a[80:83], a[8:11], v[200:203]
  s_add_u32 s42, s42, 131072
  v_mfma_f32_16x16x32_bf16 v[204:207], a[80:83], a[12:15], v[204:207]
  v_mfma_f32_16x16x32_bf16 v[208:211], a[84:87], a[0:3], v[208:211]
  v_mfma_f32_16x16x32_bf16 v[212:215], a[84:87], a[4:7], v[212:215]
  v_mfma_f32_16x16x32_bf16 v[216:219], a[84:87], a[8:11], v[216:219]
  v_mfma_f32_16x16x32_bf16 v[220:223], a[84:87], a[12:15], v[220:223]
  v_mfma_f32_16x16x32_bf16 v[224:227], a[88:91], a[0:3], v[224:227]
  v_mfma_f32_16x16x32_bf16 v[228:231], a[88:91], a[4:7], v[228:231]
  v_mfma_f32_16x16x32_bf16 v[232:235], a[88:91], a[8:11], v[232:235]
  v_mfma_f32_16x16x32_bf16 v[236:239], a[88:91], a[12:15], v[236:239]
  v_mfma_f32_16x16x32_bf16 v[240:243], a[92:95], a[0:3], v[240:243]
  v_mfma_f32_16x16x32_bf16 v[244:247], a[92:95], a[4:7], v[244:247]
  v_mfma_f32_16x16x32_bf16 v[248:251], a[92:95], a[8:11], v[248:251]
  v_mfma_f32_16x16x32_bf16 v[252:255], a[92:95], a[12:15], v[252:255]
  s_waitcnt lgkmcnt(14)
  v_mfma_f32_16x16x32_bf16 v[128:131], a[96:99], a[16:19], v[128:131]
  ds_read_b128 a[0:3], v42 offset:256
  ds_read_b128 a[4:7], v42 offset:16640
  v_mfma_f32_16x16x32_bf16 v[132:135], a[96:99], a[20:23], v[132:135]
  ds_read_b128 a[8:11], v42 offset:33024
  ds_read_b128 a[12:15], v42 offset:49408
  v_mfma_f32_16x16x32_bf16 v[136:139], a[96:99], a[24:27], v[136:139]
  s_waitcnt vmcnt(8)
  s_add_u32 m0, s41, 16384
  ds_read_b64_tr_b16 a[64:65], v32
  ds_read_b64_tr_b16 a[66:67], v32 offset:1024
  v_mfma_f32_16x16x32_bf16 v[140:143], a[96:99], a[28:31], v[140:143]
  s_waitcnt lgkmcnt(6)
  buffer_load_dwordx4 v44, s[28:31], s42 offen lds
  v_mfma_f32_16x16x32_bf16 v[144:147], a[100:103], a[16:19], v[144:147]
  ds_read_b64_tr_b16 a[68:69], v33
  ds_read_b64_tr_b16 a[70:71], v33 offset:1024
  v_mfma_f32_16x16x32_bf16 v[148:151], a[100:103], a[20:23], v[148:151]
  buffer_load_dwordx4 v45, s[28:31], s42 offen offset:1024 lds
  v_mfma_f32_16x16x32_bf16 v[152:155], a[100:103], a[24:27], v[152:155]
  ds_read_b64_tr_b16 a[72:73], v34
  ds_read_b64_tr_b16 a[74:75], v34 offset:1024
  v_mfma_f32_16x16x32_bf16 v[156:159], a[100:103], a[28:31], v[156:159]
  buffer_load_dwordx4 v46, s[28:31], s42 offen offset:2048 lds
  v_mfma_f32_16x16x32_bf16 v[160:163], a[104:107], a[16:19], v[160:163]
  ds_read_b64_tr_b16 a[76:77], v35
  ds_read_b64_tr_b16 a[78:79], v35 offset:1024
  v_mfma_f32_16x16x32_bf16 v[164:167], a[104:107], a[20:23], v[164:167]
  buffer_load_dwordx4 v47, s[28:31], s42 offen offset:3072 lds
  v_mfma_f32_16x16x32_bf16 v[168:171], a[104:107], a[24:27], v[168:171]
  s_add_u32 s42, s42, 131072
  s_add_u32 m0, s41, 20480
  ds_read_b64_tr_b16 a[80:81], v36
  ds_read_b64_tr_b16 a[82:83], v36 offset:1024
  v_mfma_f32_16x16x32_bf16 v[172:175], a[104:107], a[28:31], v[172:175]
  buffer_load_dwordx4 v44, s[28:31], s42 offen lds
  v_mfma_f32_16x16x32_bf16 v[176:179], a[108:111], a[16:19], v[176:179]
  ds_read_b64_tr_b16 a[84:85], v37
  ds_read_b64_tr_b16 a[86:87], v37 offset:1024
  v_mfma_f32_16x16x32_bf16 v[180:183], a[108:111], a[20:23], v[180:183]
  buffer_load_dwordx4 v45, s[28:31], s42 offen offset:1024 lds
  v_mfma_f32_16x16x32_bf16 v[184:187], a[108:111], a[24:27], v[184:187]
  ds_read_b64_tr_b16 a[88:89], v38
  ds_read_b64_tr_b16 a[90:91], v38 offset:1024
  v_mfma_f32_16x16x32_bf16 v[188:191], a[108:111], a[28:31], v[188:191]
  buffer_load_dwordx4 v46, s[28:31], s42 offen offset:2048 lds
  v_mfma_f32_16x16x32_bf16 v[192:195], a[112:115], a[16:19], v[192:195]
  ds_read_b64_tr_b16 a[92:93], v39
  ds_read_b64_tr_b16 a[94:95], v39 offset:1024
  v_mfma_f32_16x16x32_bf16 v[196:199], a[112:115], a[20:23], v[196:199]
  buffer_load_dwordx4 v47, s[28:31], s42 offen offset:3072 lds
  v_mfma_f32_16x16x32_bf16 v[200:203], a[112:115], a[24:27], v[200:203]
  s_add_u32 s42, s42, 131072
  v_mfma_f32_16x16x32_bf16 v[204:207], a[112:115], a[28:31], v[204:207]
  v_mfma_f32_16x16x32_bf16 v[208:211], a[116:119], a[16:19], v[208:211]
  v_mfma_f32_16x16x32_bf16 v[212:215], a[116:119], a[20:23], v[212:215]
  v_mfma_f32_16x16x32_bf16 v[216:219], a[116:119], a[24:27], v[216:219]
  v_mfma_f32_16x16x32_bf16 v[220:223], a[116:119], a[28:31], v[220:223]
  v_mfma_f32_16x16x32_bf16 v[224:227], a[120:123], a[16:19], v[224:227]
  v_mfma_f32_16x16x32_bf16 v[228:231], a[120:123], a[20:23], v[228:231]
  v_mfma_f32_16x16x32_bf16 v[232:235], a[120:123], a[24:27], v[232:235]
  v_mfma_f32_16x16x32_bf16 v[236:239], a[120:123], a[28:31], v[236:239]
  v_mfma_f32_16x16x32_bf16 v[240:243], a[124:127], a[16:19], v[240:243]
  v_mfma_f32_16x16x32_bf16 v[244:247], a[124:127], a[20:23], v[244:247]
  v_mfma_f32_16x16x32_bf16 v[248:251], a[124:127], a[24:27], v[248:251]
  v_mfma_f32_16x16x32_bf16 v[252:255], a[124:127], a[28:31], v[252:255]
  s_nop 0
  s_barrier
  v_mov_b32 v4, 1
  v_lshlrev_b32 v5, 25, v0
  s_and_b32 s44, s2, 3
  s_lshl_b32 s44, s44, 6
  s_cmp_eq_u32 s24, 0
  s_cselect_b32 s44, s44, 0x1000
  buffer_atomic_add v4, v5, s[56:59], s44 offen sc1
  s_waitcnt lgkmcnt(14)
  v_mfma_f32_16x16x32_bf16 v[128:131], a[64:67], a[0:3], v[128:131]
  ds_read_b128 a[16:19], v43 offset:256
  ds_read_b128 a[20:23], v43 offset:16640
  v_mfma_f32_16x16x32_bf16 v[132:135], a[64:67], a[4:7], v[132:135]
  ds_read_b128 a[24:27], v43 offset:33024
  ds_read_b128 a[28:31], v43 offset:49408
  v_mfma_f32_16x16x32_bf16 v[136:139], a[64:67], a[8:11], v[136:139]
  s_waitcnt vmcnt(9)
  s_add_u32 m0, s41, 0
  ds_read_b64_tr_b16 a[96:97], v32 offset:8192
  ds_read_b64_tr_b16 a[98:99], v32 offset:9216
  v_mfma_f32_16x16x32_bf16 v[140:143], a[64:67], a[12:15], v[140:143]
  s_waitcnt lgkmcnt(6)
  buffer_load_dwordx4 v44, s[28:31], s42 offen lds
  v_mfma_f32_16x16x32_bf16 v[144:147], a[68:71], a[0:3], v[144:147]
  ds_read_b64_tr_b16 a[100:101], v33 offset:8192
  ds_read_b64_tr_b16 a[102:103], v33 offset:9216
  v_mfma_f32_16x16x32_bf16 v[148:151], a[68:71], a[4:7], v[148:151]
  buffer_load_dwordx4 v45, s[28:31], s42 offen offset:1024 lds
  v_mfma_f32_16x16x32_bf16 v[152:155], a[68:71], a[8:11], v[152:155]
  ds_read_b64_tr_b16 a[104:105], v34 offset:8192
  ds_read_b64_tr_b16 a[106:107], v34 offset:9216
  v_mfma_f32_16x16x32_bf16 v[156:159], a[68:71], a[12:15], v[156:159]
  buffer_load_dwordx4 v46, s[28:31], s42 offen offset:2048 lds
  v_mfma_f32_16x16x32_bf16 v[160:163], a[72:75], a[0:3], v[160:163]
  ds_read_b64_tr_b16 a[108:109], v35 offset:8192
  ds_read_b64_tr_b16 a[110:111], v35 offset:9216
  v_mfma_f32_16x16x32_bf16 v[164:167], a[72:75], a[4:7], v[164:167]
  buffer_load_dwordx4 v47, s[28:31], s42 offen offset:3072 lds
  v_mfma_f32_16x16x32_bf16 v[168:171], a[72:75], a[8:11], v[168:171]
  s_add_u32 s42, s42, 131072
  s_add_u32 m0, s41, 4096
  ds_read_b64_tr_b16 a[112:113], v36 offset:8192
  ds_read_b64_tr_b16 a[114:115], v36 offset:9216
  v_mfma_f32_16x16x32_bf16 v[172:175], a[72:75], a[12:15], v[172:175]
  buffer_load_dwordx4 v44, s[28:31], s42 offen lds
  v_mfma_f32_16x16x32_bf16 v[176:179], a[76:79], a[0:3], v[176:179]
  ds_read_b64_tr_b16 a[116:117], v37 offset:8192
  ds_read_b64_tr_b16 a[118:119], v37 offset:9216
  v_mfma_f32_16x16x32_bf16 v[180:183], a[76:79], a[4:7], v[180:183]
  buffer_load_dwordx4 v45, s[28:31], s42 offen offset:1024 lds
  v_mfma_f32_16x16x32_bf16 v[184:187], a[76:79], a[8:11], v[184:187]
  ds_read_b64_tr_b16 a[120:121], v38 offset:8192
  ds_read_b64_tr_b16 a[122:123], v38 offset:9216
  v_mfma_f32_16x16x32_bf16 v[188:191], a[76:79], a[12:15], v[188:191]
  buffer_load_dwordx4 v46, s[28:31], s42 offen offset:2048 lds
  v_mfma_f32_16x16x32_bf16 v[192:195], a[80:83], a[0:3], v[192:195]
  ds_read_b64_tr_b16 a[124:125], v39 offset:8192
  ds_read_b64_tr_b16 a[126:127], v39 offset:9216
  v_mfma_f32_16x16x32_bf16 v[196:199], a[80:83], a[4:7], v[196:199]
  buffer_load_dwordx4 v47, s[28:31], s42 offen offset:3072 lds
  v_mfma_f32_16x16x32_bf16 v[200:203], a[80:83], a[8:11], v[200:203]
  s_add_u32 s42, s42, 131072
  v_mfma_f32_16x16x32_bf16 v[204:207], a[80:83], a[12:15], v[204:207]
  v_mfma_f32_16x16x32_bf16 v[208:211], a[84:87], a[0:3], v[208:211]
  v_mfma_f32_16x16x32_bf16 v[212:215], a[84:87], a[4:7], v[212:215]
  v_mfma_f32_16x16x32_bf16 v[216:219], a[84:87], a[8:11], v[216:219]
  v_mfma_f32_16x16x32_bf16 v[220:223], a[84:87], a[12:15], v[220:223]
  v_mfma_f32_16x16x32_bf16 v[224:227], a[88:91], a[0:3], v[224:227]
  v_mfma_f32_16x16x32_bf16 v[228:231], a[88:91], a[4:7], v[228:231]
  v_mfma_f32_16x16x32_bf16 v[232:235], a[88:91], a[8:11], v[232:235]
  v_mfma_f32_16x16x32_bf16 v[236:239], a[88:91], a[12:15], v[236:239]
  v_mfma_f32_16x16x32_bf16 v[240:243], a[92:95], a[0:3], v[240:243]
  v_mfma_f32_16x16x32_bf16 v[244:247], a[92:95], a[4:7], v[244:247]
  v_mfma_f32_16x16x32_bf16 v[248:251], a[92:95], a[8:11], v[248:251]
  v_mfma_f32_16x16x32_bf16 v[252:255], a[92:95], a[12:15], v[252:255]
  s_waitcnt lgkmcnt(14)
  v_mfma_f32_16x16x32_bf16 v[128:131], a[96:99], a[16:19], v[128:131]
  ds_read_b128 a[0:3], v40 offset:512
  ds_read_b128 a[4:7], v40 offset:16896
  v_mfma_f32_16x16x32_bf16 v[132:135], a[96:99], a[20:23], v[132:135]
  ds_read_b128 a[8:11], v40 offset:33280
  ds_read_b128 a[12:15], v40 offset:49664
  v_mfma_f32_16x16x32_bf16 v[136:139], a[96:99], a[24:27], v[136:139]
  s_waitcnt vmcnt(9)
  s_add_u32 m0, s41, 8192
  ds_read_b64_tr_b16 a[64:65], v32 offset:16384
  ds_read_b64_tr_b16 a[66:67], v32 offset:17408
  v_mfma_f32_16x16x32_bf16 v[140:143], a[96:99], a[28:31], v[140:143]
  s_waitcnt lgkmcnt(6)
  buffer_load_dwordx4 v44, s[28:31], s42 offen lds
  v_mfma_f32_16x16x32_bf16 v[144:147], a[100:103], a[16:19], v[144:147]
  ds_read_b64_tr_b16 a[68:69], v33 offset:16384
  ds_read_b64_tr_b16 a[70:71], v33 offset:17408
  v_mfma_f32_16x16x32_bf16 v[148:151], a[100:103], a[20:23], v[148:151]
  buffer_load_dwordx4 v45, s[28:31], s42 offen offset:1024 lds
  v_mfma_f32_16x16x32_bf16 v[152:155], a[100:103], a[24:27], v[152:155]
  ds_read_b64_tr_b16 a[72:73], v34 offset:16384
  ds_read_b64_tr_b16 a[74:75], v34 offset:17408
  v_mfma_f32_16x16x32_bf16 v[156:159], a[100:103], a[28:31], v[156:159]
  buffer_load_dwordx4 v46, s[28:31], s42 offen offset:2048 lds
  v_mfma_f32_16x16x32_bf16 v[160:163], a[104:107], a[16:19], v[160:163]
  ds_read_b64_tr_b16 a[76:77], v35 offset:16384
  ds_read_b64_tr_b16 a[78:79], v35 offset:17408
  v_mfma_f32_16x16x32_bf16 v[164:167], a[104:107], a[20:23], v[164:167]
  buffer_load_dwordx4 v47, s[28:31], s42 offen offset:3072 lds
  v_mfma_f32_16x16x32_bf16 v[168:171], a[104:107], a[24:27], v[168:171]
  s_add_u32 s42, s42, 131072
  s_add_u32 m0, s41, 12288
  ds_read_b64_tr_b16 a[80:81], v36 offset:16384
  ds_read_b64_tr_b16 a[82:83], v36 offset:17408
  v_mfma_f32_16x16x32_bf16 v[172:175], a[104:107], a[28:31], v[172:175]
  buffer_load_dwordx4 v44, s[28:31], s42 offen lds
  v_mfma_f32_16x16x32_bf16 v[176:179], a[108:111], a[16:19], v[176:179]
  ds_read_b64_tr_b16 a[84:85], v37 offset:16384
  ds_read_b64_tr_b16 a[86:87], v37 offset:17408
  v_mfma_f32_16x16x32_bf16 v[180:183], a[108:111], a[20:23], v[180:183]
  buffer_load_dwordx4 v45, s[28:31], s42 offen offset:1024 lds
  v_mfma_f32_16x16x32_bf16 v[184:187], a[108:111], a[24:27], v[184:187]
  ds_read_b64_tr_b16 a[88:89], v38 offset:16384
  ds_read_b64_tr_b16 a[90:91], v38 offset:17408
  v_mfma_f32_16x16x32_bf16 v[188:191], a[108:111], a[28:31], v[188:191]
  buffer_load_dwordx4 v46, s[28:31], s42 offen offset:2048 lds
  v_mfma_f32_16x16x32_bf16 v[192:195], a[112:115], a[16:19], v[192:195]
  ds_read_b64_tr_b16 a[92:93], v39 offset:16384
  ds_read_b64_tr_b16 a[94:95], v39 offset:17408
  v_mfma_f32_16x16x32_bf16 v[196:199], a[112:115], a[20:23], v[196:199]
  buffer_load_dwordx4 v47, s[28:31], s42 offen offset:3072 lds
  v_mfma_f32_16x16x32_bf16 v[200:203], a[112:115], a[24:27], v[200:203]
  s_add_u32 s42, s42, 131072
  v_mfma_f32_16x16x32_bf16 v[204:207], a[112:115], a[28:31], v[204:207]
  v_mfma_f32_16x16x32_bf16 v[208:211], a[116:119], a[16:19], v[208:211]
  v_mfma_f32_16x16x32_bf16 v[212:215], a[116:119], a[20:23], v[212:215]
  v_mfma_f32_16x16x32_bf16 v[216:219], a[116:119], a[24:27], v[216:219]
  v_mfma_f32_16x16x32_bf16 v[220:223], a[116:119], a[28:31], v[220:223]
  v_mfma_f32_16x16x32_bf16 v[224:227], a[120:123], a[16:19], v[224:227]
  v_mfma_f32_16x16x32_bf16 v[228:231], a[120:123], a[20:23], v[228:231]
  v_mfma_f32_16x16x32_bf16 v[232:235], a[120:123], a[24:27], v[232:235]
  v_mfma_f32_16x16x32_bf16 v[236:239], a[120:123], a[28:31], v[236:239]
  v_mfma_f32_16x16x32_bf16 v[240:243], a[124:127], a[16:19], v[240:243]
  v_mfma_f32_16x16x32_bf16 v[244:247], a[124:127], a[20:23], v[244:247]
  v_mfma_f32_16x16x32_bf16 v[248:251], a[124:127], a[24:27], v[248:251]
  v_mfma_f32_16x16x32_bf16 v[252:255], a[124:127], a[28:31], v[252:255]
  s_waitcnt lgkmcnt(14)
  v_mfma_f32_16x16x32_bf16 v[128:131], a[64:67], a[0:3], v[128:131]
  ds_read_b128 a[16:19], v41 offset:512
  ds_read_b128 a[20:23], v41 offset:16896
  v_mfma_f32_16x16x32_bf16 v[132:135], a[64:67], a[4:7], v[132:135]
  ds_read_b128 a[24:27], v41 offset:33280
  ds_read_b128 a[28:31], v41 offset:49664
  v_mfma_f32_16x16x32_bf16 v[136:139], a[64:67], a[8:11], v[136:139]
  s_waitcnt vmcnt(8)
  s_add_u32 m0, s41, 16384
  ds_read_b64_tr_b16 a[96:97], v32
  ds_read_b64_tr_b16 a[98:99], v32 offset:1024
  v_mfma_f32_16x16x32_bf16 v[140:143], a[64:67], a[12:15], v[140:143]
  s_waitcnt lgkmcnt(6)
  buffer_load_dwordx4 v44, s[28:31], s42 offen lds
  v_mfma_f32_16x16x32_bf16 v[144:147], a[68:71], a[0:3], v[144:147]
  ds_read_b64_tr_b16 a[100:101], v33
  ds_read_b64_tr_b16 a[102:103], v33 offset:1024
  v_mfma_f32_16x16x32_bf16 v[148:151], a[68:71], a[4:7], v[148:151]
  buffer_load_dwordx4 v45, s[28:31], s42 offen offset:1024 lds
  v_mfma_f32_16x16x32_bf16 v[152:155], a[68:71], a[8:11], v[152:155]
  ds_read_b64_tr_b16 a[104:105], v34
  ds_read_b64_tr_b16 a[106:107], v34 offset:1024
  v_mfma_f32_16x16x32_bf16 v[156:159], a[68:71], a[12:15], v[156:159]
  buffer_load_dwordx4 v46, s[28:31], s42 offen offset:2048 lds
  v_mfma_f32_16x16x32_bf16 v[160:163], a[72:75], a[0:3], v[160:163]
  ds_read_b64_tr_b16 a[108:109], v35
  ds_read_b64_tr_b16 a[110:111], v35 offset:1024
  v_mfma_f32_16x16x32_bf16 v[164:167], a[72:75], a[4:7], v[164:167]
  buffer_load_dwordx4 v47, s[28:31], s42 offen offset:3072 lds
  v_mfma_f32_16x16x32_bf16 v[168:171], a[72:75], a[8:11], v[168:171]
  s_add_u32 s42, s42, 131072
  s_add_u32 m0, s41, 20480
  ds_read_b64_tr_b16 a[112:113], v36
  ds_read_b64_tr_b16 a[114:115], v36 offset:1024
  v_mfma_f32_16x16x32_bf16 v[172:175], a[72:75], a[12:15], v[172:175]
  buffer_load_dwordx4 v44, s[28:31], s42 offen lds
  v_mfma_f32_16x16x32_bf16 v[176:179], a[76:79], a[0:3], v[176:179]
  ds_read_b64_tr_b16 a[116:117], v37
  ds_read_b64_tr_b16 a[118:119], v37 offset:1024
  v_mfma_f32_16x16x32_bf16 v[180:183], a[76:79], a[4:7], v[180:183]
  buffer_load_dwordx4 v45, s[28:31], s42 offen offset:1024 lds
  v_mfma_f32_16x16x32_bf16 v[184:187], a[76:79], a[8:11], v[184:187]
  ds_read_b64_tr_b16 a[120:121], v38
  ds_read_b64_tr_b16 a[122:123], v38 offset:1024
  v_mfma_f32_16x16x32_bf16 v[188:191], a[76:79], a[12:15], v[188:191]
  buffer_load_dwordx4 v46, s[28:31], s42 offen offset:2048 lds
  v_mfma_f32_16x16x32_bf16 v[192:195], a[80:83], a[0:3], v[192:195]
  ds_read_b64_tr_b16 a[124:125], v39
  ds_read_b64_tr_b16 a[126:127], v39 offset:1024
  v_mfma_f32_16x16x32_bf16 v[196:199], a[80:83], a[4:7], v[196:199]
  buffer_load_dwordx4 v47, s[28:31], s42 offen offset:3072 lds
  v_mfma_f32_16x16x32_bf16 v[200:203], a[80:83], a[8:11], v[200:203]
  s_add_u32 s42, s42, 131072
  v_mfma_f32_16x16x32_bf16 v[204:207], a[80:83], a[12:15], v[204:207]
  v_mfma_f32_16x16x32_bf16 v[208:211], a[84:87], a[0:3], v[208:211]
  v_mfma_f32_16x16x32_bf16 v[212:215], a[84:87], a[4:7], v[212:215]
  v_mfma_f32_16x16x32_bf16 v[216:219], a[84:87], a[8:11], v[216:219]
  v_mfma_f32_16x16x32_bf16 v[220:223], a[84:87], a[12:15], v[220:223]
  v_mfma_f32_16x16x32_bf16 v[224:227], a[88:91], a[0:3], v[224:227]
  v_mfma_f32_16x16x32_bf16 v[228:231], a[88:91], a[4:7], v[228:231]
  v_mfma_f32_16x16x32_bf16 v[232:235], a[88:91], a[8:11], v[232:235]
  v_mfma_f32_16x16x32_bf16 v[236:239], a[88:91], a[12:15], v[236:239]
  v_mfma_f32_16x16x32_bf16 v[240:243], a[92:95], a[0:3], v[240:243]
  v_mfma_f32_16x16x32_bf16 v[244:247], a[92:95], a[4:7], v[244:247]
  v_mfma_f32_16x16x32_bf16 v[248:251], a[92:95], a[8:11], v[248:251]
  v_mfma_f32_16x16x32_bf16 v[252:255], a[92:95], a[12:15], v[252:255]
  s_waitcnt lgkmcnt(14)
  v_mfma_f32_16x16x32_bf16 v[128:131], a[96:99], a[16:19], v[128:131]
  ds_read_b128 a[0:3], v42 offset:512
  ds_read_b128 a[4:7], v42 offset:16896
  v_mfma_f32_16x16x32_bf16 v[132:135], a[96:99], a[20:23], v[132:135]
  ds_read_b128 a[8:11], v42 offset:33280
  ds_read_b128 a[12:15], v42 offset:49664
  v_mfma_f32_16x16x32_bf16 v[136:139], a[96:99], a[24:27], v[136:139]
  s_waitcnt vmcnt(8)
  s_add_u32 m0, s41, 0
  ds_read_b64_tr_b16 a[64:65], v32 offset:8192
  ds_read_b64_tr_b16 a[66:67], v32 offset:9216
  v_mfma_f32_16x16x32_bf16 v[140:143], a[96:99], a[28:31], v[140:143]
  s_waitcnt lgkmcnt(6)
  buffer_load_dwordx4 v44, s[28:31], s42 offen lds
  v_mfma_f32_16x16x32_bf16 v[144:147], a[100:103], a[16:19], v[144:147]
  ds_read_b64_tr_b16 a[68:69], v33 offset:8192
  ds_read_b64_tr_b16 a[70:71], v33 offset:9216
  v_mfma_f32_16x16x32_bf16 v[148:151], a[100:103], a[20:23], v[148:151]
  buffer_load_dwordx4 v45, s[28:31], s42 offen offset:1024 lds
  v_mfma_f32_16x16x32_bf16 v[152:155], a[100:103], a[24:27], v[152:155]
  ds_read_b64_tr_b16 a[72:73], v34 offset:8192
  ds_read_b64_tr_b16 a[74:75], v34 offset:9216
  v_mfma_f32_16x16x32_bf16 v[156:159], a[100:103], a[28:31], v[156:159]
  buffer_load_dwordx4 v46, s[28:31], s42 offen offset:2048 lds
  v_mfma_f32_16x16x32_bf16 v[160:163], a[104:107], a[16:19], v[160:163]
  ds_read_b64_tr_b16 a[76:77], v35 offset:8192
  ds_read_b64_tr_b16 a[78:79], v35 offset:9216
  v_mfma_f32_16x16x32_bf16 v[164:167], a[104:107], a[20:23], v[164:167]
  buffer_load_dwordx4 v47, s[28:31], s42 offen offset:3072 lds
  v_mfma_f32_16x16x32_bf16 v[168:171], a[104:107], a[24:27], v[168:171]
  s_add_u32 s42, s42, 131072
  s_add_u32 m0, s41, 4096
  ds_read_b64_tr_b16 a[80:81], v36 offset:8192
  ds_read_b64_tr_b16 a[82:83], v36 offset:9216
  v_mfma_f32_16x16x32_bf16 v[172:175], a[104:107], a[28:31], v[172:175]
  buffer_load_dwordx4 v44, s[28:31], s42 offen lds
  v_mfma_f32_16x16x32_bf16 v[176:179], a[108:111], a[16:19], v[176:179]
  ds_read_b64_tr_b16 a[84:85], v37 offset:8192
  ds_read_b64_tr_b16 a[86:87], v37 offset:9216
  v_mfma_f32_16x16x32_bf16 v[180:183], a[108:111], a[20:23], v[180:183]
  buffer_load_dwordx4 v45, s[28:31], s42 offen offset:1024 lds
  v_mfma_f32_16x16x32_bf16 v[184:187], a[108:111], a[24:27], v[184:187]
  ds_read_b64_tr_b16 a[88:89], v38 offset:8192
  ds_read_b64_tr_b16 a[90:91], v38 offset:9216
  v_mfma_f32_16x16x32_bf16 v[188:191], a[108:111], a[28:31], v[188:191]
  buffer_load_dwordx4 v46, s[28:31], s42 offen offset:2048 lds
  v_mfma_f32_16x16x32_bf16 v[192:195], a[112:115], a[16:19], v[192:195]
  ds_read_b64_tr_b16 a[92:93], v39 offset:8192
  ds_read_b64_tr_b16 a[94:95], v39 offset:9216
  v_mfma_f32_16x16x32_bf16 v[196:199], a[112:115], a[20:23], v[196:199]
  buffer_load_dwordx4 v47, s[28:31], s42 offen offset:3072 lds
  v_mfma_f32_16x16x32_bf16 v[200:203], a[112:115], a[24:27], v[200:203]
  s_add_u32 s42, s42, 131072
  v_mfma_f32_16x16x32_bf16 v[204:207], a[112:115], a[28:31], v[204:207]
  v_mfma_f32_16x16x32_bf16 v[208:211], a[116:119], a[16:19], v[208:211]
  v_mfma_f32_16x16x32_bf16 v[212:215], a[116:119], a[20:23], v[212:215]
  v_mfma_f32_16x16x32_bf16 v[216:219], a[116:119], a[24:27], v[216:219]
  v_mfma_f32_16x16x32_bf16 v[220:223], a[116:119], a[28:31], v[220:223]
  v_mfma_f32_16x16x32_bf16 v[224:227], a[120:123], a[16:19], v[224:227]
  v_mfma_f32_16x16x32_bf16 v[228:231], a[120:123], a[20:23], v[228:231]
  v_mfma_f32_16x16x32_bf16 v[232:235], a[120:123], a[24:27], v[232:235]
  v_mfma_f32_16x16x32_bf16 v[236:239], a[120:123], a[28:31], v[236:239]
  v_mfma_f32_16x16x32_bf16 v[240:243], a[124:127], a[16:19], v[240:243]
  v_mfma_f32_16x16x32_bf16 v[244:247], a[124:127], a[20:23], v[244:247]
  v_mfma_f32_16x16x32_bf16 v[248:251], a[124:127], a[24:27], v[248:251]
  v_mfma_f32_16x16x32_bf16 v[252:255], a[124:127], a[28:31], v[252:255]
  s_waitcnt lgkmcnt(14)
  v_mfma_f32_16x16x32_bf16 v[128:131], a[64:67], a[0:3], v[128:131]
  ds_read_b128 a[16:19], v43 offset:512
  ds_read_b128 a[20:23], v43 offset:16896
  v_mfma_f32_16x16x32_bf16 v[132:135], a[64:67], a[4:7], v[132:135]
  ds_read_b128 a[24:27], v43 offset:33280
  ds_read_b128 a[28:31], v43 offset:49664
  v_mfma_f32_16x16x32_bf16 v[136:139], a[64:67], a[8:11], v[136:139]
  s_waitcnt vmcnt(8)
  s_add_u32 m0, s41, 8192
  ds_read_b64_tr_b16 a[96:97], v32 offset:16384
  ds_read_b64_tr_b16 a[98:99], v32 offset:17408
  v_mfma_f32_16x16x32_bf16 v[140:143], a[64:67], a[12:15], v[140:143]
  s_waitcnt lgkmcnt(6)
  buffer_load_dwordx4 v44, s[28:31], s42 offen lds
  v_mfma_f32_16x16x32_bf16 v[144:147], a[68:71], a[0:3], v[144:147]
  ds_read_b64_tr_b16 a[100:101], v33 offset:16384
  ds_read_b64_tr_b16 a[102:103], v33 offset:17408
  v_mfma_f32_16x16x32_bf16 v[148:151], a[68:71], a[4:7], v[148:151]
  buffer_load_dwordx4 v45, s[28:31], s42 offen offset:1024 lds
  v_mfma_f32_16x16x32_bf16 v[152:155], a[68:71], a[8:11], v[152:155]
  ds_read_b64_tr_b16 a[104:105], v34 offset:16384
  ds_read_b64_tr_b16 a[106:107], v34 offset:17408
  v_mfma_f32_16x16x32_bf16 v[156:159], a[68:71], a[12:15], v[156:159]
  buffer_load_dwordx4 v46, s[28:31], s42 offen offset:2048 lds
  v_mfma_f32_16x16x32_bf16 v[160:163], a[72:75], a[0:3], v[160:163]
  ds_read_b64_tr_b16 a[108:109], v35 offset:16384
  ds_read_b64_tr_b16 a[110:111], v35 offset:17408
  v_mfma_f32_16x16x32_bf16 v[164:167], a[72:75], a[4:7], v[164:167]
  buffer_load_dwordx4 v47, s[28:31], s42 offen offset:3072 lds
  v_mfma_f32_16x16x32_bf16 v[168:171], a[72:75], a[8:11], v[168:171]
  s_add_u32 s42, s42, 131072
  s_add_u32 m0, s41, 12288
  ds_read_b64_tr_b16 a[112:113], v36 offset:16384
  ds_read_b64_tr_b16 a[114:115], v36 offset:17408
  v_mfma_f32_16x16x32_bf16 v[172:175], a[72:75], a[12:15], v[172:175]
  buffer_load_dwordx4 v44, s[28:31], s42 offen lds
  v_mfma_f32_16x16x32_bf16 v[176:179], a[76:79], a[0:3], v[176:179]
  ds_read_b64_tr_b16 a[116:117], v37 offset:16384
  ds_read_b64_tr_b16 a[118:119], v37 offset:17408
  v_mfma_f32_16x16x32_bf16 v[180:183], a[76:79], a[4:7], v[180:183]
  buffer_load_dwordx4 v45, s[28:31], s42 offen offset:1024 lds
  v_mfma_f32_16x16x32_bf16 v[184:187], a[76:79], a[8:11], v[184:187]
  ds_read_b64_tr_b16 a[120:121], v38 offset:16384
  ds_read_b64_tr_b16 a[122:123], v38 offset:17408
  v_mfma_f32_16x16x32_bf16 v[188:191], a[76:79], a[12:15], v[188:191]
  buffer_load_dwordx4 v46, s[28:31], s42 offen offset:2048 lds
  v_mfma_f32_16x16x32_bf16 v[192:195], a[80:83], a[0:3], v[192:195]
  ds_read_b64_tr_b16 a[124:125], v39 offset:16384
  ds_read_b64_tr_b16 a[126:127], v39 offset:17408
  v_mfma_f32_16x16x32_bf16 v[196:199], a[80:83], a[4:7], v[196:199]
  buffer_load_dwordx4 v47, s[28:31], s42 offen offset:3072 lds
  v_mfma_f32_16x16x32_bf16 v[200:203], a[80:83], a[8:11], v[200:203]
  s_add_u32 s42, s42, 131072
  v_mfma_f32_16x16x32_bf16 v[204:207], a[80:83], a[12:15], v[204:207]
  v_mfma_f32_16x16x32_bf16 v[208:211], a[84:87], a[0:3], v[208:211]
  v_mfma_f32_16x16x32_bf16 v[212:215], a[84:87], a[4:7], v[212:215]
  v_mfma_f32_16x16x32_bf16 v[216:219], a[84:87], a[8:11], v[216:219]
  v_mfma_f32_16x16x32_bf16 v[220:223], a[84:87], a[12:15], v[220:223]
  v_mfma_f32_16x16x32_bf16 v[224:227], a[88:91], a[0:3], v[224:227]
  v_mfma_f32_16x16x32_bf16 v[228:231], a[88:91], a[4:7], v[228:231]
  v_mfma_f32_16x16x32_bf16 v[232:235], a[88:91], a[8:11], v[232:235]
  v_mfma_f32_16x16x32_bf16 v[236:239], a[88:91], a[12:15], v[236:239]
  v_mfma_f32_16x16x32_bf16 v[240:243], a[92:95], a[0:3], v[240:243]
  v_mfma_f32_16x16x32_bf16 v[244:247], a[92:95], a[4:7], v[244:247]
  v_mfma_f32_16x16x32_bf16 v[248:251], a[92:95], a[8:11], v[248:251]
  v_mfma_f32_16x16x32_bf16 v[252:255], a[92:95], a[12:15], v[252:255]
  s_waitcnt lgkmcnt(14)
  v_mfma_f32_16x16x32_bf16 v[128:131], a[96:99], a[16:19], v[128:131]
  ds_read_b128 a[0:3], v40 offset:768
  ds_read_b128 a[4:7], v40 offset:17152
  v_mfma_f32_16x16x32_bf16 v[132:135], a[96:99], a[20:23], v[132:135]
  ds_read_b128 a[8:11], v40 offset:33536
  ds_read_b128 a[12:15], v40 offset:49920
  v_mfma_f32_16x16x32_bf16 v[136:139], a[96:99], a[24:27], v[136:139]
  s_waitcnt vmcnt(8)
  s_add_u32 m0, s41, 16384
  ds_read_b64_tr_b16 a[64:65], v32
  ds_read_b64_tr_b16 a[66:67], v32 offset:1024
  v_mfma_f32_16x16x32_bf16 v[140:143], a[96:99], a[28:31], v[140:143]
  s_waitcnt lgkmcnt(6)
  buffer_load_dwordx4 v44, s[28:31], s42 offen lds
  v_mfma_f32_16x16x32_bf16 v[144:147], a[100:103], a[16:19], v[144:147]
  ds_read_b64_tr_b16 a[68:69], v33
  ds_read_b64_tr_b16 a[70:71], v33 offset:1024
  v_mfma_f32_16x16x32_bf16 v[148:151], a[100:103], a[20:23], v[148:151]
  buffer_load_dwordx4 v45, s[28:31], s42 offen offset:1024 lds
  v_mfma_f32_16x16x32_bf16 v[152:155], a[100:103], a[24:27], v[152:155]
  ds_read_b64_tr_b16 a[72:73], v34
  ds_read_b64_tr_b16 a[74:75], v34 offset:1024
  v_mfma_f32_16x16x32_bf16 v[156:159], a[100:103], a[28:31], v[156:159]
  buffer_load_dwordx4 v46, s[28:31], s42 offen offset:2048 lds
  v_mfma_f32_16x16x32_bf16 v[160:163], a[104:107], a[16:19], v[160:163]
  ds_read_b64_tr_b16 a[76:77], v35
  ds_read_b64_tr_b16 a[78:79], v35 offset:1024
  v_mfma_f32_16x16x32_bf16 v[164:167], a[104:107], a[20:23], v[164:167]
  buffer_load_dwordx4 v47, s[28:31], s42 offen offset:3072 lds
  v_mfma_f32_16x16x32_bf16 v[168:171], a[104:107], a[24:27], v[168:171]
  s_add_u32 s42, s42, 131072
  s_add_u32 m0, s41, 20480
  ds_read_b64_tr_b16 a[80:81], v36
  ds_read_b64_tr_b16 a[82:83], v36 offset:1024
  v_mfma_f32_16x16x32_bf16 v[172:175], a[104:107], a[28:31], v[172:175]
  buffer_load_dwordx4 v44, s[28:31], s42 offen lds
  v_mfma_f32_16x16x32_bf16 v[176:179], a[108:111], a[16:19], v[176:179]
  ds_read_b64_tr_b16 a[84:85], v37
  ds_read_b64_tr_b16 a[86:87], v37 offset:1024
  v_mfma_f32_16x16x32_bf16 v[180:183], a[108:111], a[20:23], v[180:183]
  buffer_load_dwordx4 v45, s[28:31], s42 offen offset:1024 lds
  v_mfma_f32_16x16x32_bf16 v[184:187], a[108:111], a[24:27], v[184:187]
  ds_read_b64_tr_b16 a[88:89], v38
  ds_read_b64_tr_b16 a[90:91], v38 offset:1024
  v_mfma_f32_16x16x32_bf16 v[188:191], a[108:111], a[28:31], v[188:191]
  buffer_load_dwordx4 v46, s[28:31], s42 offen offset:2048 lds
  v_mfma_f32_16x16x32_bf16 v[192:195], a[112:115], a[16:19], v[192:195]
  ds_read_b64_tr_b16 a[92:93], v39
  ds_read_b64_tr_b16 a[94:95], v39 offset:1024
  v_mfma_f32_16x16x32_bf16 v[196:199], a[112:115], a[20:23], v[196:199]
  buffer_load_dwordx4 v47, s[28:31], s42 offen offset:3072 lds
  v_mfma_f32_16x16x32_bf16 v[200:203], a[112:115], a[24:27], v[200:203]
  s_add_u32 s42, s42, 131072
  v_mfma_f32_16x16x32_bf16 v[204:207], a[112:115], a[28:31], v[204:207]
  v_mfma_f32_16x16x32_bf16 v[208:211], a[116:119], a[16:19], v[208:211]
  v_mfma_f32_16x16x32_bf16 v[212:215], a[116:119], a[20:23], v[212:215]
  v_mfma_f32_16x16x32_bf16 v[216:219], a[116:119], a[24:27], v[216:219]
  v_mfma_f32_16x16x32_bf16 v[220:223], a[116:119], a[28:31], v[220:223]
  v_mfma_f32_16x16x32_bf16 v[224:227], a[120:123], a[16:19], v[224:227]
  v_mfma_f32_16x16x32_bf16 v[228:231], a[120:123], a[20:23], v[228:231]
  v_mfma_f32_16x16x32_bf16 v[232:235], a[120:123], a[24:27], v[232:235]
  v_mfma_f32_16x16x32_bf16 v[236:239], a[120:123], a[28:31], v[236:239]
  v_mfma_f32_16x16x32_bf16 v[240:243], a[124:127], a[16:19], v[240:243]
  v_mfma_f32_16x16x32_bf16 v[244:247], a[124:127], a[20:23], v[244:247]
  v_mfma_f32_16x16x32_bf16 v[248:251], a[124:127], a[24:27], v[248:251]
  v_mfma_f32_16x16x32_bf16 v[252:255], a[124:127], a[28:31], v[252:255]
  s_waitcnt lgkmcnt(14)
  v_and_b32 v1, 3, v0
  v_lshlrev_b32 v1, 6, v1
  buffer_load_dword v6, v1, s[56:59], 0 offen sc1
  v_mfma_f32_16x16x32_bf16 v[128:131], a[64:67], a[0:3], v[128:131]
  ds_read_b128 a[16:19], v41 offset:768
  ds_read_b128 a[20:23], v41 offset:17152
  v_mfma_f32_16x16x32_bf16 v[132:135], a[64:67], a[4:7], v[132:135]
  ds_read_b128 a[24:27], v41 offset:33536
  ds_read_b128 a[28:31], v41 offset:49920
  v_mfma_f32_16x16x32_bf16 v[136:139], a[64:67], a[8:11], v[136:139]
  s_waitcnt vmcnt(9)
  s_add_u32 m0, s41, 0
  ds_read_b64_tr_b16 a[96:97], v32 offset:8192
  ds_read_b64_tr_b16 a[98:99], v32 offset:9216
  v_mfma_f32_16x16x32_bf16 v[140:143], a[64:67], a[12:15], v[140:143]
  s_waitcnt lgkmcnt(6)
  buffer_load_dwordx4 v44, s[28:31], s42 offen lds
  v_mfma_f32_16x16x32_bf16 v[144:147], a[68:71], a[0:3], v[144:147]
  ds_read_b64_tr_b16 a[100:101], v33 offset:8192
  ds_read_b64_tr_b16 a[102:103], v33 offset:9216
  v_mfma_f32_16x16x32_bf16 v[148:151], a[68:71], a[4:7], v[148:151]
  buffer_load_dwordx4 v45, s[28:31], s42 offen offset:1024 lds
  v_mfma_f32_16x16x32_bf16 v[152:155], a[68:71], a[8:11], v[152:155]
  ds_read_b64_tr_b16 a[104:105], v34 offset:8192
  ds_read_b64_tr_b16 a[106:107], v34 offset:9216
  v_mfma_f32_16x16x32_bf16 v[156:159], a[68:71], a[12:15], v[156:159]
  buffer_load_dwordx4 v46, s[28:31], s42 offen offset:2048 lds
  v_mfma_f32_16x16x32_bf16 v[160:163], a[72:75], a[0:3], v[160:163]
  ds_read_b64_tr_b16 a[108:109], v35 offset:8192
  ds_read_b64_tr_b16 a[110:111], v35 offset:9216
  v_mfma_f32_16x16x32_bf16 v[164:167], a[72:75], a[4:7], v[164:167]
  buffer_load_dwordx4 v47, s[28:31], s42 offen offset:3072 lds
  v_mfma_f32_16x16x32_bf16 v[168:171], a[72:75], a[8:11], v[168:171]
  s_add_u32 s42, s42, 131072
  s_add_u32 m0, s41, 4096
  ds_read_b64_tr_b16 a[112:113], v36 offset:8192
  ds_read_b64_tr_b16 a[114:115], v36 offset:9216
  v_mfma_f32_16x16x32_bf16 v[172:175], a[72:75], a[12:15], v[172:175]
  buffer_load_dwordx4 v44, s[28:31], s42 offen lds
  v_mfma_f32_16x16x32_bf16 v[176:179], a[76:79], a[0:3], v[176:179]
  ds_read_b64_tr_b16 a[116:117], v37 offset:8192
  ds_read_b64_tr_b16 a[118:119], v37 offset:9216
  v_mfma_f32_16x16x32_bf16 v[180:183], a[76:79], a[4:7], v[180:183]
  buffer_load_dwordx4 v45, s[28:31], s42 offen offset:1024 lds
  v_mfma_f32_16x16x32_bf16 v[184:187], a[76:79], a[8:11], v[184:187]
  ds_read_b64_tr_b16 a[120:121], v38 offset:8192
  ds_read_b64_tr_b16 a[122:123], v38 offset:9216
  v_mfma_f32_16x16x32_bf16 v[188:191], a[76:79], a[12:15], v[188:191]
  buffer_load_dwordx4 v46, s[28:31], s42 offen offset:2048 lds
  v_mfma_f32_16x16x32_bf16 v[192:195], a[80:83], a[0:3], v[192:195]
  ds_read_b64_tr_b16 a[124:125], v39 offset:8192
  ds_read_b64_tr_b16 a[126:127], v39 offset:9216
  v_mfma_f32_16x16x32_bf16 v[196:199], a[80:83], a[4:7], v[196:199]
  buffer_load_dwordx4 v47, s[28:31], s42 offen offset:3072 lds
  v_mfma_f32_16x16x32_bf16 v[200:203], a[80:83], a[8:11], v[200:203]
  s_add_u32 s42, s42, 131072
  v_mfma_f32_16x16x32_bf16 v[204:207], a[80:83], a[12:15], v[204:207]
  v_mfma_f32_16x16x32_bf16 v[208:211], a[84:87], a[0:3], v[208:211]
  v_mfma_f32_16x16x32_bf16 v[212:215], a[84:87], a[4:7], v[212:215]
  v_mfma_f32_16x16x32_bf16 v[216:219], a[84:87], a[8:11], v[216:219]
  v_mfma_f32_16x16x32_bf16 v[220:223], a[84:87], a[12:15], v[220:223]
  v_mfma_f32_16x16x32_bf16 v[224:227], a[88:91], a[0:3], v[224:227]
  v_mfma_f32_16x16x32_bf16 v[228:231], a[88:91], a[4:7], v[228:231]
  v_mfma_f32_16x16x32_bf16 v[232:235], a[88:91], a[8:11], v[232:235]
  v_mfma_f32_16x16x32_bf16 v[236:239], a[88:91], a[12:15], v[236:239]
  v_mfma_f32_16x16x32_bf16 v[240:243], a[92:95], a[0:3], v[240:243]
  v_mfma_f32_16x16x32_bf16 v[244:247], a[92:95], a[4:7], v[244:247]
  v_mfma_f32_16x16x32_bf16 v[248:251], a[92:95], a[8:11], v[248:251]
  v_mfma_f32_16x16x32_bf16 v[252:255], a[92:95], a[12:15], v[252:255]
  s_waitcnt lgkmcnt(14)
  v_mfma_f32_16x16x32_bf16 v[128:131], a[96:99], a[16:19], v[128:131]
  ds_read_b128 a[0:3], v42 offset:768
  ds_read_b128 a[4:7], v42 offset:17152
  v_mfma_f32_16x16x32_bf16 v[132:135], a[96:99], a[20:23], v[132:135]
  ds_read_b128 a[8:11], v42 offset:33536
  ds_read_b128 a[12:15], v42 offset:49920
  v_mfma_f32_16x16x32_bf16 v[136:139], a[96:99], a[24:27], v[136:139]
  s_waitcnt vmcnt(9)
  ds_read_b64_tr_b16 a[64:65], v32 offset:16384
  ds_read_b64_tr_b16 a[66:67], v32 offset:17408
  v_mfma_f32_16x16x32_bf16 v[140:143], a[96:99], a[28:31], v[140:143]
  s_waitcnt lgkmcnt(15)
  ds_read_b64_tr_b16 a[68:69], v33 offset:16384
  ds_read_b64_tr_b16 a[70:71], v33 offset:17408
  v_mfma_f32_16x16x32_bf16 v[144:147], a[100:103], a[16:19], v[144:147]
  ds_read_b64_tr_b16 a[72:73], v34 offset:16384
  ds_read_b64_tr_b16 a[74:75], v34 offset:17408
  v_mfma_f32_16x16x32_bf16 v[148:151], a[100:103], a[20:23], v[148:151]
  ds_read_b64_tr_b16 a[76:77], v35 offset:16384
  ds_read_b64_tr_b16 a[78:79], v35 offset:17408
  v_mfma_f32_16x16x32_bf16 v[152:155], a[100:103], a[24:27], v[152:155]
  ds_read_b64_tr_b16 a[80:81], v36 offset:16384
  ds_read_b64_tr_b16 a[82:83], v36 offset:17408
  v_mfma_f32_16x16x32_bf16 v[156:159], a[100:103], a[28:31], v[156:159]
  ds_read_b64_tr_b16 a[84:85], v37 offset:16384
  ds_read_b64_tr_b16 a[86:87], v37 offset:17408
  v_mfma_f32_16x16x32_bf16 v[160:163], a[104:107], a[16:19], v[160:163]
  ds_read_b64_tr_b16 a[88:89], v38 offset:16384
  ds_read_b64_tr_b16 a[90:91], v38 offset:17408
  v_mfma_f32_16x16x32_bf16 v[164:167], a[104:107], a[20:23], v[164:167]
  ds_read_b64_tr_b16 a[92:93], v39 offset:16384
  ds_read_b64_tr_b16 a[94:95], v39 offset:17408
  v_mfma_f32_16x16x32_bf16 v[168:171], a[104:107], a[24:27], v[168:171]
  v_mfma_f32_16x16x32_bf16 v[172:175], a[104:107], a[28:31], v[172:175]
  s_waitcnt lgkmcnt(15)
  v_mfma_f32_16x16x32_bf16 v[176:179], a[108:111], a[16:19], v[176:179]
  v_mfma_f32_16x16x32_bf16 v[180:183], a[108:111], a[20:23], v[180:183]
  v_mfma_f32_16x16x32_bf16 v[184:187], a[108:111], a[24:27], v[184:187]
  v_mfma_f32_16x16x32_bf16 v[188:191], a[108:111], a[28:31], v[188:191]
  v_mfma_f32_16x16x32_bf16 v[192:195], a[112:115], a[16:19], v[192:195]
  v_mfma_f32_16x16x32_bf16 v[196:199], a[112:115], a[20:23], v[196:199]
  v_mfma_f32_16x16x32_bf16 v[200:203], a[112:115], a[24:27], v[200:203]
  v_mfma_f32_16x16x32_bf16 v[204:207], a[112:115], a[28:31], v[204:207]
  v_mfma_f32_16x16x32_bf16 v[208:211], a[116:119], a[16:19], v[208:211]
  v_mfma_f32_16x16x32_bf16 v[212:215], a[116:119], a[20:23], v[212:215]
  v_mfma_f32_16x16x32_bf16 v[216:219], a[116:119], a[24:27], v[216:219]
  v_mfma_f32_16x16x32_bf16 v[220:223], a[116:119], a[28:31], v[220:223]
  v_mfma_f32_16x16x32_bf16 v[224:227], a[120:123], a[16:19], v[224:227]
  v_mfma_f32_16x16x32_bf16 v[228:231], a[120:123], a[20:23], v[228:231]
  v_mfma_f32_16x16x32_bf16 v[232:235], a[120:123], a[24:27], v[232:235]
  v_mfma_f32_16x16x32_bf16 v[236:239], a[120:123], a[28:31], v[236:239]
  v_mfma_f32_16x16x32_bf16 v[240:243], a[124:127], a[16:19], v[240:243]
  v_mfma_f32_16x16x32_bf16 v[244:247], a[124:127], a[20:23], v[244:247]
  v_mfma_f32_16x16x32_bf16 v[248:251], a[124:127], a[24:27], v[248:251]
  v_mfma_f32_16x16x32_bf16 v[252:255], a[124:127], a[28:31], v[252:255]
  s_waitcnt lgkmcnt(14)
  v_mfma_f32_16x16x32_bf16 v[128:131], a[64:67], a[0:3], v[128:131]
  ds_read_b128 a[16:19], v43 offset:768
  ds_read_b128 a[20:23], v43 offset:17152
  v_mfma_f32_16x16x32_bf16 v[132:135], a[64:67], a[4:7], v[132:135]
  ds_read_b128 a[24:27], v43 offset:33536
  ds_read_b128 a[28:31], v43 offset:49920
  v_mfma_f32_16x16x32_bf16 v[136:139], a[64:67], a[8:11], v[136:139]
  s_waitcnt vmcnt(0)
  ds_read_b64_tr_b16 a[96:97], v32
  ds_read_b64_tr_b16 a[98:99], v32 offset:1024
  v_mfma_f32_16x16x32_bf16 v[140:143], a[64:67], a[12:15], v[140:143]
  s_waitcnt lgkmcnt(15)
  ds_read_b64_tr_b16 a[100:101], v33
  ds_read_b64_tr_b16 a[102:103], v33 offset:1024
  v_mfma_f32_16x16x32_bf16 v[144:147], a[68:71], a[0:3], v[144:147]
  ds_read_b64_tr_b16 a[104:105], v34
  ds_read_b64_tr_b16 a[106:107], v34 offset:1024
  v_mfma_f32_16x16x32_bf16 v[148:151], a[68:71], a[4:7], v[148:151]
  ds_read_b64_tr_b16 a[108:109], v35
  ds_read_b64_tr_b16 a[110:111], v35 offset:1024
  v_mfma_f32_16x16x32_bf16 v[152:155], a[68:71], a[8:11], v[152:155]
  ds_read_b64_tr_b16 a[112:113], v36
  ds_read_b64_tr_b16 a[114:115], v36 offset:1024
  v_mfma_f32_16x16x32_bf16 v[156:159], a[68:71], a[12:15], v[156:159]
  ds_read_b64_tr_b16 a[116:117], v37
  ds_read_b64_tr_b16 a[118:119], v37 offset:1024
  v_mfma_f32_16x16x32_bf16 v[160:163], a[72:75], a[0:3], v[160:163]
  ds_read_b64_tr_b16 a[120:121], v38
  ds_read_b64_tr_b16 a[122:123], v38 offset:1024
  v_mfma_f32_16x16x32_bf16 v[164:167], a[72:75], a[4:7], v[164:167]
  ds_read_b64_tr_b16 a[124:125], v39
  ds_read_b64_tr_b16 a[126:127], v39 offset:1024
  v_mfma_f32_16x16x32_bf16 v[168:171], a[72:75], a[8:11], v[168:171]
  v_mfma_f32_16x16x32_bf16 v[172:175], a[72:75], a[12:15], v[172:175]
  s_waitcnt lgkmcnt(15)
  v_mfma_f32_16x16x32_bf16 v[176:179], a[76:79], a[0:3], v[176:179]
  v_mfma_f32_16x16x32_bf16 v[180:183], a[76:79], a[4:7], v[180:183]
  v_mfma_f32_16x16x32_bf16 v[184:187], a[76:79], a[8:11], v[184:187]
  v_mfma_f32_16x16x32_bf16 v[188:191], a[76:79], a[12:15], v[188:191]
  v_mfma_f32_16x16x32_bf16 v[192:195], a[80:83], a[0:3], v[192:195]
  v_mfma_f32_16x16x32_bf16 v[196:199], a[80:83], a[4:7], v[196:199]
  v_mfma_f32_16x16x32_bf16 v[200:203], a[80:83], a[8:11], v[200:203]
  v_mfma_f32_16x16x32_bf16 v[204:207], a[80:83], a[12:15], v[204:207]
  v_mfma_f32_16x16x32_bf16 v[208:211], a[84:87], a[0:3], v[208:211]
  v_mfma_f32_16x16x32_bf16 v[212:215], a[84:87], a[4:7], v[212:215]
  v_mfma_f32_16x16x32_bf16 v[216:219], a[84:87], a[8:11], v[216:219]
  v_mfma_f32_16x16x32_bf16 v[220:223], a[84:87], a[12:15], v[220:223]
  v_mfma_f32_16x16x32_bf16 v[224:227], a[88:91], a[0:3], v[224:227]
  v_mfma_f32_16x16x32_bf16 v[228:231], a[88:91], a[4:7], v[228:231]
  v_mfma_f32_16x16x32_bf16 v[232:235], a[88:91], a[8:11], v[232:235]
  v_mfma_f32_16x16x32_bf16 v[236:239], a[88:91], a[12:15], v[236:239]
  v_mfma_f32_16x16x32_bf16 v[240:243], a[92:95], a[0:3], v[240:243]
  v_mfma_f32_16x16x32_bf16 v[244:247], a[92:95], a[4:7], v[244:247]
  v_mfma_f32_16x16x32_bf16 v[248:251], a[92:95], a[8:11], v[248:251]
  v_mfma_f32_16x16x32_bf16 v[252:255], a[92:95], a[12:15], v[252:255]
  s_waitcnt lgkmcnt(0)
  s_mov_b32 s45, 0
L_k3_hpoll:
  v_cmp_le_u32 vcc, 64, v6
  s_nop 3
  s_cmp_eq_u64 vcc, -1
  s_cbranch_scc1 L_k3_hpollok
  s_sleep 4
  buffer_load_dword v6, v1, s[56:59], 0 offen sc1
  s_waitcnt vmcnt(0)
  s_add_u32 s45, s45, 1
  s_cmp_lt_u32 s45, 262144
  s_cbranch_scc1 L_k3_hpoll
L_k3_hpollok:
  s_barrier
  v_mfma_f32_16x16x32_bf16 v[128:131], a[96:99], a[16:19], v[128:131]
  s_mov_b32 s20, 0
  v_mfma_f32_16x16x32_bf16 v[132:135], a[96:99], a[20:23], v[132:135]
  v_mfma_f32_16x16x32_bf16 v[136:139], a[96:99], a[24:27], v[136:139]
  s_add_u32 m0, s21, 0
  v_mfma_f32_16x16x32_bf16 v[140:143], a[96:99], a[28:31], v[140:143]
  buffer_load_dwordx4 v8, s[8:11], s20 offen lds
  v_mfma_f32_16x16x32_bf16 v[144:147], a[100:103], a[16:19], v[144:147]
  v_mfma_f32_16x16x32_bf16 v[148:151], a[100:103], a[20:23], v[148:151]
  buffer_load_dwordx4 v9, s[8:11], s20 offen offset:1024 lds
  v_mfma_f32_16x16x32_bf16 v[152:155], a[100:103], a[24:27], v[152:155]
  v_mfma_f32_16x16x32_bf16 v[156:159], a[100:103], a[28:31], v[156:159]
  buffer_load_dwordx4 v10, s[8:11], s20 offen offset:2048 lds
  v_mfma_f32_16x16x32_bf16 v[160:163], a[104:107], a[16:19], v[160:163]
  v_mfma_f32_16x16x32_bf16 v[164:167], a[104:107], a[20:23], v[164:167]
  buffer_load_dwordx4 v11, s[8:11], s20 offen offset:3072 lds
  v_mfma_f32_16x16x32_bf16 v[168:171], a[104:107], a[24:27], v[168:171]
  s_add_u32 m0, s21, 49152
  v_mfma_f32_16x16x32_bf16 v[172:175], a[104:107], a[28:31], v[172:175]
  buffer_load_dwordx4 v12, s[12:15], s20 offen lds
  v_mfma_f32_16x16x32_bf16 v[176:179], a[108:111], a[16:19], v[176:179]
  v_mfma_f32_16x16x32_bf16 v[180:183], a[108:111], a[20:23], v[180:183]
  buffer_load_dwordx4 v13, s[12:15], s20 offen offset:1024 lds
  v_mfma_f32_16x16x32_bf16 v[184:187], a[108:111], a[24:27], v[184:187]
  v_mfma_f32_16x16x32_bf16 v[188:191], a[108:111], a[28:31], v[188:191]
  buffer_load_dwordx4 v12, s[12:15], s20 offen offset:2048 lds
  v_mfma_f32_16x16x32_bf16 v[192:195], a[112:115], a[16:19], v[192:195]
  v_mfma_f32_16x16x32_bf16 v[196:199], a[112:115], a[20:23], v[196:199]
  buffer_load_dwordx4 v13, s[12:15], s20 offen offset:3072 lds
  v_mfma_f32_16x16x32_bf16 v[200:203], a[112:115], a[24:27], v[200:203]
  s_add_u32 s20, s20, 16384
  v_mfma_f32_16x16x32_bf16 v[204:207], a[112:115], a[28:31], v[204:207]
  v_mfma_f32_16x16x32_bf16 v[208:211], a[116:119], a[16:19], v[208:211]
  v_mfma_f32_16x16x32_bf16 v[212:215], a[116:119], a[20:23], v[212:215]
  v_mfma_f32_16x16x32_bf16 v[216:219], a[116:119], a[24:27], v[216:219]
  v_mfma_f32_16x16x32_bf16 v[220:223], a[116:119], a[28:31], v[220:223]
  v_mfma_f32_16x16x32_bf16 v[224:227], a[120:123], a[16:19], v[224:227]
  v_mfma_f32_16x16x32_bf16 v[228:231], a[120:123], a[20:23], v[228:231]
  v_mfma_f32_16x16x32_bf16 v[232:235], a[120:123], a[24:27], v[232:235]
  v_mfma_f32_16x16x32_bf16 v[236:239], a[120:123], a[28:31], v[236:239]
  v_mfma_f32_16x16x32_bf16 v[240:243], a[124:127], a[16:19], v[240:243]
  v_mfma_f32_16x16x32_bf16 v[244:247], a[124:127], a[20:23], v[244:247]
  v_mfma_f32_16x16x32_bf16 v[248:251], a[124:127], a[24:27], v[248:251]
  v_mfma_f32_16x16x32_bf16 v[252:255], a[124:127], a[28:31], v[252:255]
  s_load_dwordx2 s[96:97], s[0:1], 56
  s_load_dwordx2 s[98:99], s[0:1], 72
  s_load_dwordx2 s[100:101], s[0:1], 80
  s_mov_b32 s44, 0x3e0293ee
  v_mul_f32 v128, s44, v128
  v_mul_f32 v144, s44, v144
  v_mul_f32 v129, s44, v129
  v_mul_f32 v145, s44, v145
  v_mul_f32 v130, s44, v130
  v_mul_f32 v146, s44, v146
  v_mul_f32 v131, s44, v131
  v_mul_f32 v147, s44, v147
  v_cvt_pk_bf16_f32 v48, v128, v129
  v_cvt_pk_bf16_f32 v49, v130, v131
  s_mov_b32 m0, s40
  s_nop 0
  buffer_load_dwordx4 v18, s[48:51], s39 offen lds
  v_cvt_pk_bf16_f32 v50, v144, v145
  v_cvt_pk_bf16_f32 v51, v146, v147
  s_nop 0
  v_permlane32_swap_b32 v48, v50
  v_permlane32_swap_b32 v49, v51
  s_nop 0
  v_permlane16_swap_b32 v48, v50
  v_permlane16_swap_b32 v49, v51
  v_accvgpr_write_b32 a0, v48
  v_accvgpr_write_b32 a1, v49
  v_accvgpr_write_b32 a2, v50
  v_accvgpr_write_b32 a3, v51
  s_mov_b32 m0, s40
  s_nop 0
  buffer_load_dwordx4 v19, s[48:51], s39 offen offset:1024 lds
  v_mul_f32 v132, s44, v132
  v_mul_f32 v148, s44, v148
  v_mul_f32 v133, s44, v133
  v_mul_f32 v149, s44, v149
  v_mul_f32 v134, s44, v134
  v_mul_f32 v150, s44, v150
  v_mul_f32 v135, s44, v135
  v_mul_f32 v151, s44, v151
  v_cvt_pk_bf16_f32 v52, v132, v133
  v_cvt_pk_bf16_f32 v53, v134, v135
  s_mov_b32 m0, s40
  s_nop 0
  buffer_load_dwordx4 v20, s[48:51], s39 offen offset:2048 lds
  v_cvt_pk_bf16_f32 v54, v148, v149
  v_cvt_pk_bf16_f32 v55, v150, v151
  s_nop 0
  v_permlane32_swap_b32 v52, v54
  v_permlane32_swap_b32 v53, v55
  s_nop 0
  v_permlane16_swap_b32 v52, v54
  v_permlane16_swap_b32 v53, v55
  v_accvgpr_write_b32 a4, v52
  v_accvgpr_write_b32 a5, v53
  v_accvgpr_write_b32 a6, v54
  v_accvgpr_write_b32 a7, v55
  s_mov_b32 m0, s40
  s_nop 0
  buffer_load_dwordx4 v21, s[48:51], s39 offen offset:3072 lds
  s_add_u32 s39, s39, 114688
  v_mul_f32 v136, s44, v136
  v_mul_f32 v152, s44, v152
  v_mul_f32 v137, s44, v137
  v_mul_f32 v153, s44, v153
  v_mul_f32 v138, s44, v138
  v_mul_f32 v154, s44, v154
  v_mul_f32 v139, s44, v139
  v_mul_f32 v155, s44, v155
  v_cvt_pk_bf16_f32 v48, v136, v137
  v_cvt_pk_bf16_f32 v49, v138, v139
  s_add_u32 m0, s40, 4096
  s_nop 0
  buffer_load_dwordx4 v22, s[16:19], s36 offen sc1 lds
  v_cvt_pk_bf16_f32 v50, v152, v153
  v_cvt_pk_bf16_f32 v51, v154, v155
  s_nop 0
  v_permlane32_swap_b32 v48, v50
  v_permlane32_swap_b32 v49, v51
  s_nop 0
  v_permlane16_swap_b32 v48, v50
  v_permlane16_swap_b32 v49, v51
  v_accvgpr_write_b32 a8, v48
  v_accvgpr_write_b32 a9, v49
  v_accvgpr_write_b32 a10, v50
  v_accvgpr_write_b32 a11, v51
  s_add_u32 m0, s40, 4096
  s_nop 0
  buffer_load_dwordx4 v23, s[16:19], s36 offen offset:1024 sc1 lds
  v_mul_f32 v140, s44, v140
  v_mul_f32 v156, s44, v156
  v_mul_f32 v141, s44, v141
  v_mul_f32 v157, s44, v157
  v_mul_f32 v142, s44, v142
  v_mul_f32 v158, s44, v158
  v_mul_f32 v143, s44, v143
  v_mul_f32 v159, s44, v159
  v_cvt_pk_bf16_f32 v52, v140, v141
  v_cvt_pk_bf16_f32 v53, v142, v143
  s_add_u32 m0, s40, 4096
  s_nop 0
  buffer_load_dwordx4 v24, s[16:19], s36 offen offset:2048 sc1 lds
  v_cvt_pk_bf16_f32 v54, v156, v157
  v_cvt_pk_bf16_f32 v55, v158, v159
  s_nop 0
  v_permlane32_swap_b32 v52, v54
  v_permlane32_swap_b32 v53, v55
  s_nop 0
  v_permlane16_swap_b32 v52, v54
  v_permlane16_swap_b32 v53, v55
  v_accvgpr_write_b32 a12, v52
  v_accvgpr_write_b32 a13, v53
  v_accvgpr_write_b32 a14, v54
  v_accvgpr_write_b32 a15, v55
  s_add_u32 m0, s40, 4096
  s_nop 0
  buffer_load_dwordx4 v25, s[16:19], s36 offen offset:3072 sc1 lds
  s_add_u32 s36, s36, 32768
  s_xor_b32 s40, s40, 8192
  v_mul_f32 v160, s44, v160
  v_mul_f32 v176, s44, v176
  v_mul_f32 v161, s44, v161
  v_mul_f32 v177, s44, v177
  v_mul_f32 v162, s44, v162
  v_mul_f32 v178, s44, v178
  v_mul_f32 v163, s44, v163
  v_mul_f32 v179, s44, v179
  v_cvt_pk_bf16_f32 v48, v160, v161
  v_cvt_pk_bf16_f32 v49, v162, v163
  s_add_u32 m0, s21, 16384
  s_nop 0
  buffer_load_dwordx4 v8, s[8:11], s20 offen lds
  v_cvt_pk_bf16_f32 v50, v176, v177
  v_cvt_pk_bf16_f32 v51, v178, v179
  s_nop 0
  v_permlane32_swap_b32 v48, v50
  v_permlane32_swap_b32 v49, v51
  s_nop 0
  v_permlane16_swap_b32 v48, v50
  v_permlane16_swap_b32 v49, v51
  v_accvgpr_write_b32 a16, v48
  v_accvgpr_write_b32 a17, v49
  v_accvgpr_write_b32 a18, v50
  v_accvgpr_write_b32 a19, v51
  s_add_u32 m0, s21, 16384
  s_nop 0
  buffer_load_dwordx4 v9, s[8:11], s20 offen offset:1024 lds
  v_mul_f32 v164, s44, v164
  v_mul_f32 v180, s44, v180
  v_mul_f32 v165, s44, v165
  v_mul_f32 v181, s44, v181
  v_mul_f32 v166, s44, v166
  v_mul_f32 v182, s44, v182
  v_mul_f32 v167, s44, v167
  v_mul_f32 v183, s44, v183
  v_cvt_pk_bf16_f32 v52, v164, v165
  v_cvt_pk_bf16_f32 v53, v166, v167
  s_add_u32 m0, s21, 16384
  s_nop 0
  buffer_load_dwordx4 v10, s[8:11], s20 offen offset:2048 lds
  v_cvt_pk_bf16_f32 v54, v180, v181
  v_cvt_pk_bf16_f32 v55, v182, v183
  s_nop 0
  v_permlane32_swap_b32 v52, v54
  v_permlane32_swap_b32 v53, v55
  s_nop 0
  v_permlane16_swap_b32 v52, v54
  v_permlane16_swap_b32 v53, v55
  v_accvgpr_write_b32 a20, v52
  v_accvgpr_write_b32 a21, v53
  v_accvgpr_write_b32 a22, v54
  v_accvgpr_write_b32 a23, v55
  s_add_u32 m0, s21, 16384
  s_nop 0
  buffer_load_dwordx4 v11, s[8:11], s20 offen offset:3072 lds
  v_mul_f32 v168, s44, v168
  v_mul_f32 v184, s44, v184
  v_mul_f32 v169, s44, v169
  v_mul_f32 v185, s44, v185
  v_mul_f32 v170, s44, v170
  v_mul_f32 v186, s44, v186
  v_mul_f32 v171, s44, v171
  v_mul_f32 v187, s44, v187
  v_cvt_pk_bf16_f32 v48, v168, v169
  v_cvt_pk_bf16_f32 v49, v170, v171
  s_add_u32 m0, s21, 65536
  s_nop 0
  buffer_load_dwordx4 v12, s[12:15], s20 offen lds
  v_cvt_pk_bf16_f32 v50, v184, v185
  v_cvt_pk_bf16_f32 v51, v186, v187
  s_nop 0
  v_permlane32_swap_b32 v48, v50
  v_permlane32_swap_b32 v49, v51
  s_nop 0
  v_permlane16_swap_b32 v48, v50
  v_permlane16_swap_b32 v49, v51
  v_accvgpr_write_b32 a24, v48
  v_accvgpr_write_b32 a25, v49
  v_accvgpr_write_b32 a26, v50
  v_accvgpr_write_b32 a27, v51
  s_add_u32 m0, s21, 65536
  s_nop 0
  buffer_load_dwordx4 v13, s[12:15], s20 offen offset:1024 lds
  v_mul_f32 v172, s44, v172
  v_mul_f32 v188, s44, v188
  v_mul_f32 v173, s44, v173
  v_mul_f32 v189, s44, v189
  v_mul_f32 v174, s44, v174
  v_mul_f32 v190, s44, v190
  v_mul_f32 v175, s44, v175
  v_mul_f32 v191, s44, v191
  v_cvt_pk_bf16_f32 v52, v172, v173
  v_cvt_pk_bf16_f32 v53, v174, v175
  s_add_u32 m0, s21, 65536
  s_nop 0
  buffer_load_dwordx4 v12, s[12:15], s20 offen offset:2048 lds
  v_cvt_pk_bf16_f32 v54, v188, v189
  v_cvt_pk_bf16_f32 v55, v190, v191
  s_nop 0
  v_permlane32_swap_b32 v52, v54
  v_permlane32_swap_b32 v53, v55
  s_nop 0
  v_permlane16_swap_b32 v52, v54
  v_permlane16_swap_b32 v53, v55
  v_accvgpr_write_b32 a28, v52
  v_accvgpr_write_b32 a29, v53
  v_accvgpr_write_b32 a30, v54
  v_accvgpr_write_b32 a31, v55
  s_add_u32 m0, s21, 65536
  s_nop 0
  buffer_load_dwordx4 v13, s[12:15], s20 offen offset:3072 lds
  s_add_u32 s20, s20, 16384
  v_mul_f32 v192, s44, v192
  v_mul_f32 v208, s44, v208
  v_mul_f32 v193, s44, v193
  v_mul_f32 v209, s44, v209
  v_mul_f32 v194, s44, v194
  v_mul_f32 v210, s44, v210
  v_mul_f32 v195, s44, v195
  v_mul_f32 v211, s44, v211
  v_cvt_pk_bf16_f32 v48, v192, v193
  v_cvt_pk_bf16_f32 v49, v194, v195
  s_mov_b32 m0, s40
  s_nop 0
  buffer_load_dwordx4 v18, s[48:51], s39 offen lds
  v_cvt_pk_bf16_f32 v50, v208, v209
  v_cvt_pk_bf16_f32 v51, v210, v211
  s_nop 0
  v_permlane32_swap_b32 v48, v50
  v_permlane32_swap_b32 v49, v51
  s_nop 0
  v_permlane16_swap_b32 v48, v50
  v_permlane16_swap_b32 v49, v51
  v_accvgpr_write_b32 a32, v48
  v_accvgpr_write_b32 a33, v49
  v_accvgpr_write_b32 a34, v50
  v_accvgpr_write_b32 a35, v51
  s_mov_b32 m0, s40
  s_nop 0
  buffer_load_dwordx4 v19, s[48:51], s39 offen offset:1024 lds
  v_mul_f32 v196, s44, v196
  v_mul_f32 v212, s44, v212
  v_mul_f32 v197, s44, v197
  v_mul_f32 v213, s44, v213
  v_mul_f32 v198, s44, v198
  v_mul_f32 v214, s44, v214
  v_mul_f32 v199, s44, v199
  v_mul_f32 v215, s44, v215
  v_cvt_pk_bf16_f32 v52, v196, v197
  v_cvt_pk_bf16_f32 v53, v198, v199
  s_mov_b32 m0, s40
  s_nop 0
  buffer_load_dwordx4 v20, s[48:51], s39 offen offset:2048 lds
  v_cvt_pk_bf16_f32 v54, v212, v213
  v_cvt_pk_bf16_f32 v55, v214, v215
  s_nop 0
  v_permlane32_swap_b32 v52, v54
  v_permlane32_swap_b32 v53, v55
  s_nop 0
  v_permlane16_swap_b32 v52, v54
  v_permlane16_swap_b32 v53, v55
  v_accvgpr_write_b32 a36, v52
  v_accvgpr_write_b32 a37, v53
  v_accvgpr_write_b32 a38, v54
  v_accvgpr_write_b32 a39, v55
  s_mov_b32 m0, s40
  s_nop 0
  buffer_load_dwordx4 v21, s[48:51], s39 offen offset:3072 lds
  s_add_u32 s39, s39, 114688
  v_mul_f32 v200, s44, v200
  v_mul_f32 v216, s44, v216
  v_mul_f32 v201, s44, v201
  v_mul_f32 v217, s44, v217
  v_mul_f32 v202, s44, v202
  v_mul_f32 v218, s44, v218
  v_mul_f32 v203, s44, v203
  v_mul_f32 v219, s44, v219
  v_cvt_pk_bf16_f32 v48, v200, v201
  v_cvt_pk_bf16_f32 v49, v202, v203
  s_add_u32 m0, s40, 4096
  s_nop 0
  buffer_load_dwordx4 v22, s[16:19], s36 offen sc1 lds
  v_cvt_pk_bf16_f32 v50, v216, v217
  v_cvt_pk_bf16_f32 v51, v218, v219
  s_nop 0
  v_permlane32_swap_b32 v48, v50
  v_permlane32_swap_b32 v49, v51
  s_nop 0
  v_permlane16_swap_b32 v48, v50
  v_permlane16_swap_b32 v49, v51
  v_accvgpr_write_b32 a40, v48
  v_accvgpr_write_b32 a41, v49
  v_accvgpr_write_b32 a42, v50
  v_accvgpr_write_b32 a43, v51
  s_add_u32 m0, s40, 4096
  s_nop 0
  buffer_load_dwordx4 v23, s[16:19], s36 offen offset:1024 sc1 lds
  v_mul_f32 v204, s44, v204
  v_mul_f32 v220, s44, v220
  v_mul_f32 v205, s44, v205
  v_mul_f32 v221, s44, v221
  v_mul_f32 v206, s44, v206
  v_mul_f32 v222, s44, v222
  v_mul_f32 v207, s44, v207
  v_mul_f32 v223, s44, v223
  v_cvt_pk_bf16_f32 v52, v204, v205
  v_cvt_pk_bf16_f32 v53, v206, v207
  s_add_u32 m0, s40, 4096
  s_nop 0
  buffer_load_dwordx4 v24, s[16:19], s36 offen offset:2048 sc1 lds
  v_cvt_pk_bf16_f32 v54, v220, v221
  v_cvt_pk_bf16_f32 v55, v222, v223
  s_nop 0
  v_permlane32_swap_b32 v52, v54
  v_permlane32_swap_b32 v53, v55
  s_nop 0
  v_permlane16_swap_b32 v52, v54
  v_permlane16_swap_b32 v53, v55
  v_accvgpr_write_b32 a44, v52
  v_accvgpr_write_b32 a45, v53
  v_accvgpr_write_b32 a46, v54
  v_accvgpr_write_b32 a47, v55
  s_add_u32 m0, s40, 4096
  s_nop 0
  buffer_load_dwordx4 v25, s[16:19], s36 offen offset:3072 sc1 lds
  s_add_u32 s36, s36, 32768
  s_xor_b32 s40, s40, 8192
  v_mul_f32 v224, s44, v224
  v_mul_f32 v240, s44, v240
  v_mul_f32 v225, s44, v225
  v_mul_f32 v241, s44, v241
  v_mul_f32 v226, s44, v226
  v_mul_f32 v242, s44, v242
  v_mul_f32 v227, s44, v227
  v_mul_f32 v243, s44, v243
  v_cvt_pk_bf16_f32 v48, v224, v225
  v_cvt_pk_bf16_f32 v49, v226, v227
  v_cvt_pk_bf16_f32 v50, v240, v241
  v_cvt_pk_bf16_f32 v51, v242, v243
  s_nop 0
  v_permlane32_swap_b32 v48, v50
  v_permlane32_swap_b32 v49, v51
  s_nop 0
  v_permlane16_swap_b32 v48, v50
  v_permlane16_swap_b32 v49, v51
  v_accvgpr_write_b32 a48, v48
  v_accvgpr_write_b32 a49, v49
  v_accvgpr_write_b32 a50, v50
  v_accvgpr_write_b32 a51, v51
  v_mul_f32 v228, s44, v228
  v_mul_f32 v244, s44, v244
  v_mul_f32 v229, s44, v229
  v_mul_f32 v245, s44, v245
  v_mul_f32 v230, s44, v230
  v_mul_f32 v246, s44, v246
  v_mul_f32 v231, s44, v231
  v_mul_f32 v247, s44, v247
  v_cvt_pk_bf16_f32 v52, v228, v229
  v_cvt_pk_bf16_f32 v53, v230, v231
  v_cvt_pk_bf16_f32 v54, v244, v245
  v_cvt_pk_bf16_f32 v55, v246, v247
  s_nop 0
  v_permlane32_swap_b32 v52, v54
  v_permlane32_swap_b32 v53, v55
  s_nop 0
  v_permlane16_swap_b32 v52, v54
  v_permlane16_swap_b32 v53, v55
  v_accvgpr_write_b32 a52, v52
  v_accvgpr_write_b32 a53, v53
  v_accvgpr_write_b32 a54, v54
  v_accvgpr_write_b32 a55, v55
  v_mul_f32 v232, s44, v232
  v_mul_f32 v248, s44, v248
  v_mul_f32 v233, s44, v233
  v_mul_f32 v249, s44, v249
  v_mul_f32 v234, s44, v234
  v_mul_f32 v250, s44, v250
  v_mul_f32 v235, s44, v235
  v_mul_f32 v251, s44, v251
  v_cvt_pk_bf16_f32 v48, v232, v233
  v_cvt_pk_bf16_f32 v49, v234, v235
  v_cvt_pk_bf16_f32 v50, v248, v249
  v_cvt_pk_bf16_f32 v51, v250, v251
  s_nop 0
  v_permlane32_swap_b32 v48, v50
  v_permlane32_swap_b32 v49, v51
  s_nop 0
  v_permlane16_swap_b32 v48, v50
  v_permlane16_swap_b32 v49, v51
  v_accvgpr_write_b32 a56, v48
  v_accvgpr_write_b32 a57, v49
  v_accvgpr_write_b32 a58, v50
  v_accvgpr_write_b32 a59, v51
  v_mul_f32 v236, s44, v236
  v_mul_f32 v252, s44, v252
  v_mul_f32 v237, s44, v237
  v_mul_f32 v253, s44, v253
  v_mul_f32 v238, s44, v238
  v_mul_f32 v254, s44, v254
  v_mul_f32 v239, s44, v239
  v_mul_f32 v255, s44, v255
  v_cvt_pk_bf16_f32 v52, v236, v237
  v_cvt_pk_bf16_f32 v53, v238, v239
  v_cvt_pk_bf16_f32 v54, v252, v253
  v_cvt_pk_bf16_f32 v55, v254, v255
  s_nop 0
  v_permlane32_swap_b32 v52, v54
  v_permlane32_swap_b32 v53, v55
  s_nop 0
  v_permlane16_swap_b32 v52, v54
  v_permlane16_swap_b32 v53, v55
  v_accvgpr_write_b32 a60, v52
  v_accvgpr_write_b32 a61, v53
  v_accvgpr_write_b32 a62, v54
  v_accvgpr_write_b32 a63, v55
  s_waitcnt vmcnt(24)
  s_barrier
  ds_read_b128 a[64:67], v116
  ds_read_b128 a[68:71], v117
  ds_read_b128 a[72:75], v118
  ds_read_b128 a[76:79], v119
  ds_read_b128 a[80:83], v116 offset:4096
  ds_read_b128 a[84:87], v117 offset:4096
  ds_read_b128 a[88:91], v118 offset:4096
  ds_read_b128 a[92:95], v119 offset:4096
  s_waitcnt lgkmcnt(0)
  v_mfma_f32_16x16x32_bf16 v[32:35], a[64:67], a[0:3], 0
  v_mfma_f32_16x16x32_bf16 v[32:35], a[68:71], a[16:19], v[32:35]
  v_mfma_f32_16x16x32_bf16 v[32:35], a[72:75], a[32:35], v[32:35]
  v_mfma_f32_16x16x32_bf16 v[32:35], a[76:79], a[48:51], v[32:35]
  v_mfma_f32_16x16x32_bf16 v[36:39], a[80:83], a[0:3], 0
  v_mfma_f32_16x16x32_bf16 v[36:39], a[84:87], a[16:19], v[36:39]
  v_mfma_f32_16x16x32_bf16 v[36:39], a[88:91], a[32:35], v[36:39]
  v_mfma_f32_16x16x32_bf16 v[36:39], a[92:95], a[48:51], v[36:39]
  v_mfma_f32_16x16x32_bf16 v[40:43], a[64:67], a[4:7], 0
  v_mfma_f32_16x16x32_bf16 v[40:43], a[68:71], a[20:23], v[40:43]
  v_mfma_f32_16x16x32_bf16 v[40:43], a[72:75], a[36:39], v[40:43]
  v_mfma_f32_16x16x32_bf16 v[40:43], a[76:79], a[52:55], v[40:43]
  v_mfma_f32_16x16x32_bf16 v[44:47], a[80:83], a[4:7], 0
  v_mfma_f32_16x16x32_bf16 v[44:47], a[84:87], a[20:23], v[44:47]
  v_mfma_f32_16x16x32_bf16 v[44:47], a[88:91], a[36:39], v[44:47]
  v_mfma_f32_16x16x32_bf16 v[44:47], a[92:95], a[52:55], v[44:47]
  v_mfma_f32_16x16x32_bf16 v[48:51], a[64:67], a[8:11], 0
  v_mfma_f32_16x16x32_bf16 v[48:51], a[68:71], a[24:27], v[48:51]
  v_mfma_f32_16x16x32_bf16 v[48:51], a[72:75], a[40:43], v[48:51]
  v_mfma_f32_16x16x32_bf16 v[48:51], a[76:79], a[56:59], v[48:51]
  v_mfma_f32_16x16x32_bf16 v[52:55], a[80:83], a[8:11], 0
  v_mfma_f32_16x16x32_bf16 v[52:55], a[84:87], a[24:27], v[52:55]
  v_mfma_f32_16x16x32_bf16 v[52:55], a[88:91], a[40:43], v[52:55]
  v_mfma_f32_16x16x32_bf16 v[52:55], a[92:95], a[56:59], v[52:55]
  v_mfma_f32_16x16x32_bf16 v[56:59], a[64:67], a[12:15], 0
  v_mfma_f32_16x16x32_bf16 v[56:59], a[68:71], a[28:31], v[56:59]
  v_mfma_f32_16x16x32_bf16 v[56:59], a[72:75], a[44:47], v[56:59]
  v_mfma_f32_16x16x32_bf16 v[56:59], a[76:79], a[60:63], v[56:59]
  v_mfma_f32_16x16x32_bf16 v[60:63], a[80:83], a[12:15], 0
  v_mfma_f32_16x16x32_bf16 v[60:63], a[84:87], a[28:31], v[60:63]
  v_mfma_f32_16x16x32_bf16 v[60:63], a[88:91], a[44:47], v[60:63]
  v_mfma_f32_16x16x32_bf16 v[60:63], a[92:95], a[60:63], v[60:63]
  v_max3_f32 v28, v32, v33, v34
  v_max3_f32 v28, v28, v35, v36
  v_max3_f32 v28, v28, v37, v38
  v_max_f32 v28, v28, v39
  v_max3_f32 v29, v40, v41, v42
  v_max3_f32 v29, v29, v43, v44
  v_max3_f32 v29, v29, v45, v46
  v_max_f32 v29, v29, v47
  v_max3_f32 v30, v48, v49, v50
  v_max3_f32 v30, v30, v51, v52
  v_max3_f32 v30, v30, v53, v54
  v_max_f32 v30, v30, v55
  v_max3_f32 v31, v56, v57, v58
  v_max3_f32 v31, v31, v59, v60
  v_max3_f32 v31, v31, v61, v62
  v_max_f32 v31, v31, v63
  v_mov_b32 v5, v28
  s_nop 1
  v_permlane16_swap_b32 v28, v5
  v_max_f32 v28, v28, v5
  v_mov_b32 v5, v28
  s_nop 1
  v_permlane32_swap_b32 v28, v5
  v_max_f32 v28, v28, v5
  v_sub_f32 v64, 0xc2c80000, v28
  v_sub_f32 v65, 0xc2c80000, v28
  v_sub_f32 v66, 0xc2c80000, v28
  v_sub_f32 v67, 0xc2c80000, v28
  v_add_f32 v32, v32, v64
  v_add_f32 v33, v33, v64
  v_add_f32 v34, v34, v64
  v_add_f32 v35, v35, v64
  v_add_f32 v36, v36, v64
  v_add_f32 v37, v37, v64
  v_add_f32 v38, v38, v64
  v_add_f32 v39, v39, v64
  v_mov_b32 v5, v29
  s_nop 1
  v_permlane16_swap_b32 v29, v5
  v_max_f32 v29, v29, v5
  v_mov_b32 v5, v29
  s_nop 1
  v_permlane32_swap_b32 v29, v5
  v_max_f32 v29, v29, v5
  v_sub_f32 v68, 0xc2c80000, v29
  v_sub_f32 v69, 0xc2c80000, v29
  v_sub_f32 v70, 0xc2c80000, v29
  v_sub_f32 v71, 0xc2c80000, v29
  v_add_f32 v40, v40, v68
  v_add_f32 v41, v41, v68
  v_add_f32 v42, v42, v68
  v_add_f32 v43, v43, v68
  v_add_f32 v44, v44, v68
  v_add_f32 v45, v45, v68
  v_add_f32 v46, v46, v68
  v_add_f32 v47, v47, v68
  v_mov_b32 v5, v30
  s_nop 1
  v_permlane16_swap_b32 v30, v5
  v_max_f32 v30, v30, v5
  v_mov_b32 v5, v30
  s_nop 1
  v_permlane32_swap_b32 v30, v5
  v_max_f32 v30, v30, v5
  v_sub_f32 v72, 0xc2c80000, v30
  v_sub_f32 v73, 0xc2c80000, v30
  v_sub_f32 v74, 0xc2c80000, v30
  v_sub_f32 v75, 0xc2c80000, v30
  v_add_f32 v48, v48, v72
  v_add_f32 v49, v49, v72
  v_add_f32 v50, v50, v72
  v_add_f32 v51, v51, v72
  v_add_f32 v52, v52, v72
  v_add_f32 v53, v53, v72
  v_add_f32 v54, v54, v72
  v_add_f32 v55, v55, v72
  v_mov_b32 v5, v31
  s_nop 1
  v_permlane16_swap_b32 v31, v5
  v_max_f32 v31, v31, v5
  v_mov_b32 v5, v31
  s_nop 1
  v_permlane32_swap_b32 v31, v5
  v_max_f32 v31, v31, v5
  v_sub_f32 v76, 0xc2c80000, v31
  v_sub_f32 v77, 0xc2c80000, v31
  v_sub_f32 v78, 0xc2c80000, v31
  v_sub_f32 v79, 0xc2c80000, v31
  v_add_f32 v56, v56, v76
  v_add_f32 v57, v57, v76
  v_add_f32 v58, v58, v76
  v_add_f32 v59, v59, v76
  v_add_f32 v60, v60, v76
  v_add_f32 v61, v61, v76
  v_add_f32 v62, v62, v76
  v_add_f32 v63, v63, v76
  s_waitcnt vmcnt(16)
  ds_read_b64_tr_b16 a[192:193], v14
  ds_read_b64_tr_b16 a[194:195], v14 offset:2048
  ds_read_b64_tr_b16 a[196:197], v15
  ds_read_b64_tr_b16 a[198:199], v15 offset:2048
  s_add_u32 m0, s21, 32768
  s_nop 0
  buffer_load_dwordx4 v8, s[8:11], s20 offen lds
  ds_read_b64_tr_b16 a[200:201], v16
  ds_read_b64_tr_b16 a[202:203], v16 offset:2048
  buffer_load_dwordx4 v9, s[8:11], s20 offen offset:1024 lds
  ds_read_b64_tr_b16 a[204:205], v17
  ds_read_b64_tr_b16 a[206:207], v17 offset:2048
  ds_read_b64_tr_b16 a[208:209], v14 offset:4096
  buffer_load_dwordx4 v10, s[8:11], s20 offen offset:2048 lds
  ds_read_b64_tr_b16 a[210:211], v14 offset:6144
  ds_read_b64_tr_b16 a[212:213], v15 offset:4096
  buffer_load_dwordx4 v11, s[8:11], s20 offen offset:3072 lds
  ds_read_b64_tr_b16 a[214:215], v15 offset:6144
  ds_read_b64_tr_b16 a[216:217], v16 offset:4096
  ds_read_b64_tr_b16 a[218:219], v16 offset:6144
  v_exp_f32 v32, v32
  s_add_u32 m0, s21, 81920
  s_nop 0
  buffer_load_dwordx4 v12, s[12:15], s20 offen lds
  v_exp_f32 v33, v33
  ds_read_b64_tr_b16 a[220:221], v17 offset:4096
  ds_read_b64_tr_b16 a[222:223], v17 offset:6144
  v_exp_f32 v34, v34
  v_cvt_pk_bf16_f32 v96, v32, v33
  v_exp_f32 v35, v35
  buffer_load_dwordx4 v13, s[12:15], s20 offen offset:1024 lds
  ds_read_b64_tr_b16 a[96:97], v120
  ds_read_b64_tr_b16 a[98:99], v120 offset:4096
  v_exp_f32 v36, v36
  ds_read_b64_tr_b16 a[100:101], v121
  v_cvt_pk_bf16_f32 v97, v34, v35
  v_exp_f32 v37, v37
  ds_read_b64_tr_b16 a[102:103], v121 offset:4096
  ds_read_b64_tr_b16 a[104:105], v122
  buffer_load_dwordx4 v12, s[12:15], s20 offen offset:2048 lds
  v_exp_f32 v38, v38
  ds_read_b64_tr_b16 a[106:107], v122 offset:4096
  v_cvt_pk_bf16_f32 v98, v36, v37
  v_exp_f32 v39, v39
  v_exp_f32 v40, v40
  ds_read_b64_tr_b16 a[108:109], v123
  v_cvt_pk_bf16_f32 v99, v38, v39
  buffer_load_dwordx4 v13, s[12:15], s20 offen offset:3072 lds
  s_add_u32 s20, s20, 16384
  ds_read_b64_tr_b16 a[110:111], v123 offset:4096
  ds_read_b64_tr_b16 a[112:113], v124
  v_exp_f32 v41, v41
  v_exp_f32 v42, v42
  ds_read_b64_tr_b16 a[114:115], v124 offset:4096
  v_cvt_pk_bf16_f32 v100, v40, v41
  ds_read_b64_tr_b16 a[116:117], v125
  ds_read_b64_tr_b16 a[118:119], v125 offset:4096
  v_exp_f32 v43, v43
  v_exp_f32 v44, v44
  ds_read_b64_tr_b16 a[120:121], v126
  v_cvt_pk_bf16_f32 v101, v42, v43
  v_exp_f32 v45, v45
  ds_read_b64_tr_b16 a[122:123], v126 offset:4096
  ds_read_b64_tr_b16 a[124:125], v127
  s_waitcnt lgkmcnt(15)
  v_mfma_f32_16x16x32_bf16 a[128:131], a[192:195], a[208:211], 0
  v_exp_f32 v46, v46
  v_mfma_f32_16x16x32_bf16 a[132:135], a[192:195], a[212:215], 0
  ds_read_b64_tr_b16 a[126:127], v127 offset:4096
  v_cvt_pk_bf16_f32 v102, v44, v45
  v_mfma_f32_16x16x32_bf16 a[136:139], a[192:195], a[216:219], 0
  v_exp_f32 v47, v47
  v_mfma_f32_16x16x32_bf16 a[140:143], a[192:195], a[220:223], 0
  v_cvt_pk_bf16_f32 v103, v46, v47
  v_mfma_f32_16x16x32_bf16 a[144:147], a[196:199], a[208:211], 0
  v_exp_f32 v48, v48
  v_mfma_f32_16x16x32_bf16 a[148:151], a[196:199], a[212:215], 0
  v_exp_f32 v49, v49
  v_mfma_f32_16x16x32_bf16 a[152:155], a[196:199], a[216:219], 0
  v_exp_f32 v50, v50
  v_mfma_f32_16x16x32_bf16 a[156:159], a[196:199], a[220:223], 0
  s_waitcnt lgkmcnt(14)
  ds_read_b128 a[64:67], v116 offset:8192
  v_xor_b32 v14, 8192, v14
  v_mfma_f32_16x16x32_bf16 v[128:131], a[96:99], v[96:99], 0
  s_waitcnt lgkmcnt(13)
  v_xor_b32 v15, 8192, v15
  v_xor_b32 v16, 8192, v16
  v_mfma_f32_16x16x32_bf16 v[144:147], a[100:103], v[96:99], 0
  s_waitcnt lgkmcnt(11)
  v_xor_b32 v17, 8192, v17
  v_cvt_pk_bf16_f32 v104, v48, v49
  v_mfma_f32_16x16x32_bf16 v[160:163], a[104:107], v[96:99], 0
  s_waitcnt lgkmcnt(9)
  ds_read_b128 a[68:71], v117 offset:8192
  v_mfma_f32_16x16x32_bf16 v[176:179], a[108:111], v[96:99], 0
  s_waitcnt lgkmcnt(8)
  v_exp_f32 v51, v51
  v_mfma_f32_16x16x32_bf16 v[192:195], a[112:115], v[96:99], 0
  s_waitcnt lgkmcnt(6)
  ds_read_b128 a[72:75], v118 offset:8192
  v_mfma_f32_16x16x32_bf16 v[208:211], a[116:119], v[96:99], 0
  s_waitcnt lgkmcnt(5)
  v_exp_f32 v52, v52
  v_mfma_f32_16x16x32_bf16 v[224:227], a[120:123], v[96:99], 0
  s_waitcnt lgkmcnt(3)
  ds_read_b128 a[76:79], v119 offset:8192
  v_cvt_pk_bf16_f32 v105, v50, v51
  v_mfma_f32_16x16x32_bf16 v[240:243], a[124:127], v[96:99], 0
  v_exp_f32 v53, v53
  v_mfma_f32_16x16x32_bf16 v[80:83], v[112:115], v[96:99], 0
  ds_read_b128 a[80:83], v116 offset:12288
  v_mfma_f32_16x16x32_bf16 v[132:135], a[96:99], v[100:103], 0
  v_exp_f32 v54, v54
  v_mfma_f32_16x16x32_bf16 v[148:151], a[100:103], v[100:103], 0
  ds_read_b128 a[84:87], v117 offset:12288
  v_cvt_pk_bf16_f32 v106, v52, v53
  v_mfma_f32_16x16x32_bf16 v[164:167], a[104:107], v[100:103], 0
  v_mfma_f32_16x16x32_bf16 v[180:183], a[108:111], v[100:103], 0
  v_exp_f32 v55, v55
  v_mfma_f32_16x16x32_bf16 v[196:199], a[112:115], v[100:103], 0
  ds_read_b128 a[88:91], v118 offset:12288
  v_mfma_f32_16x16x32_bf16 v[212:215], a[116:119], v[100:103], 0
  v_exp_f32 v56, v56
  v_mfma_f32_16x16x32_bf16 v[228:231], a[120:123], v[100:103], 0
  ds_read_b128 a[92:95], v119 offset:12288
  v_cvt_pk_bf16_f32 v107, v54, v55
  v_mfma_f32_16x16x32_bf16 v[244:247], a[124:127], v[100:103], 0
  s_add_u32 s38, s38, 1
  v_mfma_f32_16x16x32_bf16 v[84:87], v[112:115], v[100:103], 0
  s_waitcnt lgkmcnt(7)
  s_mov_b32 m0, s40
  v_exp_f32 v57, v57
  v_mfma_f32_16x16x32_bf16 v[32:35], a[64:67], a[0:3], v[64:67]
  s_waitcnt lgkmcnt(6)
  buffer_load_dwordx4 v18, s[48:51], s39 offen lds
  v_mfma_f32_16x16x32_bf16 v[32:35], a[68:71], a[16:19], v[32:35]
  s_waitcnt lgkmcnt(5)
  v_exp_f32 v58, v58
  v_mfma_f32_16x16x32_bf16 v[32:35], a[72:75], a[32:35], v[32:35]
  s_waitcnt lgkmcnt(4)
  v_cvt_pk_bf16_f32 v108, v56, v57
  v_mfma_f32_16x16x32_bf16 v[32:35], a[76:79], a[48:51], v[32:35]
  s_waitcnt lgkmcnt(3)
  v_mfma_f32_16x16x32_bf16 v[36:39], a[80:83], a[0:3], v[64:67]
  s_waitcnt lgkmcnt(2)
  v_exp_f32 v59, v59
  v_mfma_f32_16x16x32_bf16 v[36:39], a[84:87], a[16:19], v[36:39]
  s_waitcnt lgkmcnt(1)
  v_mfma_f32_16x16x32_bf16 v[36:39], a[88:91], a[32:35], v[36:39]
  s_waitcnt lgkmcnt(0)
  buffer_load_dwordx4 v19, s[48:51], s39 offen offset:1024 lds
  v_mfma_f32_16x16x32_bf16 v[36:39], a[92:95], a[48:51], v[36:39]
  v_exp_f32 v60, v60
  v_mfma_f32_16x16x32_bf16 v[40:43], a[64:67], a[4:7], v[68:71]
  v_cvt_pk_bf16_f32 v109, v58, v59
  v_mfma_f32_16x16x32_bf16 v[40:43], a[68:71], a[20:23], v[40:43]
  v_exp_f32 v61, v61
  v_mfma_f32_16x16x32_bf16 v[40:43], a[72:75], a[36:39], v[40:43]
  v_mfma_f32_16x16x32_bf16 v[40:43], a[76:79], a[52:55], v[40:43]
  v_exp_f32 v62, v62
  v_mfma_f32_16x16x32_bf16 v[44:47], a[80:83], a[4:7], v[68:71]
  buffer_load_dwordx4 v20, s[48:51], s39 offen offset:2048 lds
  v_mfma_f32_16x16x32_bf16 v[44:47], a[84:87], a[20:23], v[44:47]
  v_cvt_pk_bf16_f32 v110, v60, v61
  v_mfma_f32_16x16x32_bf16 v[44:47], a[88:91], a[36:39], v[44:47]
  v_mfma_f32_16x16x32_bf16 v[44:47], a[92:95], a[52:55], v[44:47]
  v_exp_f32 v63, v63
  v_mfma_f32_16x16x32_bf16 a[160:163], a[200:203], a[208:211], 0
  v_cvt_pk_bf16_f32 v111, v62, v63
  v_mfma_f32_16x16x32_bf16 a[164:167], a[200:203], a[212:215], 0
  v_mfma_f32_16x16x32_bf16 a[168:171], a[200:203], a[216:219], 0
  v_mfma_f32_16x16x32_bf16 a[172:175], a[200:203], a[220:223], 0
  buffer_load_dwordx4 v21, s[48:51], s39 offen offset:3072 lds
  v_mfma_f32_16x16x32_bf16 a[176:179], a[204:207], a[208:211], 0
  v_exp_f32 v32, v32
  v_mfma_f32_16x16x32_bf16 a[180:183], a[204:207], a[212:215], 0
  v_exp_f32 v33, v33
  v_mfma_f32_16x16x32_bf16 a[184:187], a[204:207], a[216:219], 0
  v_exp_f32 v34, v34
  v_mfma_f32_16x16x32_bf16 a[188:191], a[204:207], a[220:223], 0
  s_add_u32 s39, s39, 114688
  v_cvt_pk_bf16_f32 v96, v32, v33
  v_mfma_f32_16x16x32_bf16 v[136:139], a[96:99], v[104:107], 0
  s_add_u32 m0, s40, 4096
  v_mfma_f32_16x16x32_bf16 v[152:155], a[100:103], v[104:107], 0
  buffer_load_dwordx4 v22, s[16:19], s36 offen sc1 lds
  v_mfma_f32_16x16x32_bf16 v[168:171], a[104:107], v[104:107], 0
  v_exp_f32 v35, v35
  v_mfma_f32_16x16x32_bf16 v[184:187], a[108:111], v[104:107], 0
  v_exp_f32 v36, v36
  v_mfma_f32_16x16x32_bf16 v[200:203], a[112:115], v[104:107], 0
  v_mfma_f32_16x16x32_bf16 v[216:219], a[116:119], v[104:107], 0
  v_cvt_pk_bf16_f32 v97, v34, v35
  v_mfma_f32_16x16x32_bf16 v[232:235], a[120:123], v[104:107], 0
  v_mfma_f32_16x16x32_bf16 v[248:251], a[124:127], v[104:107], 0
  buffer_load_dwordx4 v23, s[16:19], s36 offen offset:1024 sc1 lds
  v_mfma_f32_16x16x32_bf16 v[88:91], v[112:115], v[104:107], 0
  v_exp_f32 v37, v37
  v_mfma_f32_16x16x32_bf16 v[140:143], a[96:99], v[108:111], 0
  v_exp_f32 v38, v38
  v_mfma_f32_16x16x32_bf16 v[156:159], a[100:103], v[108:111], 0
  ds_read_b64_tr_b16 a[96:97], v120 offset:8192
  ds_read_b64_tr_b16 a[98:99], v120 offset:12288
  v_mfma_f32_16x16x32_bf16 v[172:175], a[104:107], v[108:111], 0
  ds_read_b64_tr_b16 a[100:101], v121 offset:8192
  v_cvt_pk_bf16_f32 v98, v36, v37
  v_mfma_f32_16x16x32_bf16 v[188:191], a[108:111], v[108:111], 0
  ds_read_b64_tr_b16 a[102:103], v121 offset:12288
  v_mfma_f32_16x16x32_bf16 v[204:207], a[112:115], v[108:111], 0
  buffer_load_dwordx4 v24, s[16:19], s36 offen offset:2048 sc1 lds
  v_mfma_f32_16x16x32_bf16 v[220:223], a[116:119], v[108:111], 0
  v_exp_f32 v39, v39
  v_mfma_f32_16x16x32_bf16 v[236:239], a[120:123], v[108:111], 0
  ds_read_b64_tr_b16 a[104:105], v122 offset:8192
  ds_read_b64_tr_b16 a[106:107], v122 offset:12288
  v_mfma_f32_16x16x32_bf16 v[252:255], a[124:127], v[108:111], 0
  v_exp_f32 v40, v40
  v_mfma_f32_16x16x32_bf16 v[92:95], v[112:115], v[108:111], 0
  ds_read_b64_tr_b16 a[108:109], v123 offset:8192
  v_cvt_pk_bf16_f32 v99, v38, v39
  v_mfma_f32_16x16x32_bf16 v[48:51], a[64:67], a[8:11], v[72:75]
  ds_read_b64_tr_b16 a[110:111], v123 offset:12288
  ds_read_b64_tr_b16 a[112:113], v124 offset:8192
  v_mfma_f32_16x16x32_bf16 v[48:51], a[68:71], a[24:27], v[48:51]
  v_exp_f32 v41, v41
  v_mfma_f32_16x16x32_bf16 v[48:51], a[72:75], a[40:43], v[48:51]
  buffer_load_dwordx4 v25, s[16:19], s36 offen offset:3072 sc1 lds
  v_mfma_f32_16x16x32_bf16 v[48:51], a[76:79], a[56:59], v[48:51]
  ds_read_b64_tr_b16 a[114:115], v124 offset:12288
  ds_read_b64_tr_b16 a[116:117], v125 offset:8192
  v_mfma_f32_16x16x32_bf16 v[52:55], a[80:83], a[8:11], v[72:75]
  v_exp_f32 v42, v42
  v_mfma_f32_16x16x32_bf16 v[52:55], a[84:87], a[24:27], v[52:55]
  ds_read_b64_tr_b16 a[118:119], v125 offset:12288
  v_cvt_pk_bf16_f32 v100, v40, v41
  v_mfma_f32_16x16x32_bf16 v[52:55], a[88:91], a[40:43], v[52:55]
  s_add_u32 s36, s36, 32768
  ds_read_b64_tr_b16 a[120:121], v126 offset:8192
  ds_read_b64_tr_b16 a[122:123], v126 offset:12288
  v_mfma_f32_16x16x32_bf16 v[52:55], a[92:95], a[56:59], v[52:55]
  v_exp_f32 v43, v43
  v_mfma_f32_16x16x32_bf16 v[56:59], a[64:67], a[12:15], v[76:79]
  ds_read_b64_tr_b16 a[124:125], v127 offset:8192
  ds_read_b64_tr_b16 a[126:127], v127 offset:12288
  v_mfma_f32_16x16x32_bf16 v[56:59], a[68:71], a[28:31], v[56:59]
  v_exp_f32 v44, v44
  v_mfma_f32_16x16x32_bf16 v[56:59], a[72:75], a[44:47], v[56:59]
  v_cvt_pk_bf16_f32 v101, v42, v43
  v_mfma_f32_16x16x32_bf16 v[56:59], a[76:79], a[60:63], v[56:59]
  v_exp_f32 v45, v45
  v_mfma_f32_16x16x32_bf16 v[60:63], a[80:83], a[12:15], v[76:79]
  v_exp_f32 v46, v46
  v_mfma_f32_16x16x32_bf16 v[60:63], a[84:87], a[28:31], v[60:63]
  v_mfma_f32_16x16x32_bf16 v[60:63], a[88:91], a[44:47], v[60:63]
  v_mfma_f32_16x16x32_bf16 v[60:63], a[92:95], a[60:63], v[60:63]
  s_xor_b32 s40, s40, 8192
  s_waitcnt vmcnt(16) lgkmcnt(0)
  s_barrier
  s_mov_b32 s4, 5
L_k3_loopA:
  v_mfma_f32_16x16x32_bf16 v[128:131], a[96:99], v[96:99], v[128:131]
  ds_read_b128 a[64:67], v116 offset:16384
  v_cvt_pk_bf16_f32 v102, v44, v45
  v_mfma_f32_16x16x32_bf16 v[144:147], a[100:103], v[96:99], v[144:147]
  v_exp_f32 v47, v47
  v_mfma_f32_16x16x32_bf16 v[160:163], a[104:107], v[96:99], v[160:163]
  ds_read_b128 a[68:71], v117 offset:16384
  v_cvt_pk_bf16_f32 v103, v46, v47
  v_mfma_f32_16x16x32_bf16 v[176:179], a[108:111], v[96:99], v[176:179]
  ds_read_b128 a[72:75], v118 offset:16384
  v_mfma_f32_16x16x32_bf16 v[192:195], a[112:115], v[96:99], v[192:195]
  v_exp_f32 v48, v48
  v_mfma_f32_16x16x32_bf16 v[208:211], a[116:119], v[96:99], v[208:211]
  ds_read_b64_tr_b16 a[192:193], v14
  ds_read_b128 a[76:79], v119 offset:16384
  v_mfma_f32_16x16x32_bf16 v[224:227], a[120:123], v[96:99], v[224:227]
  v_exp_f32 v49, v49
  v_mfma_f32_16x16x32_bf16 v[240:243], a[124:127], v[96:99], v[240:243]
  v_exp_f32 v50, v50
  v_mfma_f32_16x16x32_bf16 v[80:83], v[112:115], v[96:99], v[80:83]
  ds_read_b64_tr_b16 a[194:195], v14 offset:2048
  v_cvt_pk_bf16_f32 v104, v48, v49
  v_mfma_f32_16x16x32_bf16 v[132:135], a[96:99], v[100:103], v[132:135]
  ds_read_b128 a[80:83], v116 offset:20480
  ds_read_b64_tr_b16 a[196:197], v15
  v_mfma_f32_16x16x32_bf16 v[148:151], a[100:103], v[100:103], v[148:151]
  v_exp_f32 v51, v51
  v_mfma_f32_16x16x32_bf16 v[164:167], a[104:107], v[100:103], v[164:167]
  s_add_u32 m0, s21, 0
  v_exp_f32 v52, v52
  v_mfma_f32_16x16x32_bf16 v[180:183], a[108:111], v[100:103], v[180:183]
  buffer_load_dwordx4 v8, s[8:11], s20 offen lds
  v_mfma_f32_16x16x32_bf16 v[196:199], a[112:115], v[100:103], v[196:199]
  ds_read_b128 a[84:87], v117 offset:20480
  ds_read_b64_tr_b16 a[198:199], v15 offset:2048
  v_mfma_f32_16x16x32_bf16 v[212:215], a[116:119], v[100:103], v[212:215]
  ds_read_b128 a[88:91], v118 offset:20480
  v_cvt_pk_bf16_f32 v105, v50, v51
  v_mfma_f32_16x16x32_bf16 v[228:231], a[120:123], v[100:103], v[228:231]
  v_exp_f32 v53, v53
  v_mfma_f32_16x16x32_bf16 v[244:247], a[124:127], v[100:103], v[244:247]
  ds_read_b64_tr_b16 a[200:201], v16
  ds_read_b128 a[92:95], v119 offset:20480
  v_mfma_f32_16x16x32_bf16 v[84:87], v[112:115], v[100:103], v[84:87]
  s_waitcnt lgkmcnt(12)
  v_exp_f32 v54, v54
  v_mfma_f32_16x16x32_bf16 v[32:35], a[64:67], a[0:3], v[64:67]
  s_waitcnt lgkmcnt(11)
  buffer_load_dwordx4 v9, s[8:11], s20 offen offset:1024 lds
  v_mfma_f32_16x16x32_bf16 v[32:35], a[68:71], a[16:19], v[32:35]
  s_waitcnt lgkmcnt(10)
  ds_read_b64_tr_b16 a[202:203], v16 offset:2048
  v_cvt_pk_bf16_f32 v106, v52, v53
  v_mfma_f32_16x16x32_bf16 v[32:35], a[72:75], a[32:35], v[32:35]
  s_waitcnt lgkmcnt(9)
  v_exp_f32 v55, v55
  v_mfma_f32_16x16x32_bf16 v[32:35], a[76:79], a[48:51], v[32:35]
  s_waitcnt lgkmcnt(7)
  v_exp_f32 v56, v56
  v_mfma_f32_16x16x32_bf16 v[36:39], a[80:83], a[0:3], v[64:67]
  s_waitcnt lgkmcnt(5)
  ds_read_b64_tr_b16 a[204:205], v17
  v_cvt_pk_bf16_f32 v107, v54, v55
  v_mfma_f32_16x16x32_bf16 v[36:39], a[84:87], a[16:19], v[36:39]
  s_waitcnt lgkmcnt(4)
  v_exp_f32 v57, v57
  v_mfma_f32_16x16x32_bf16 v[36:39], a[88:91], a[32:35], v[36:39]
  s_waitcnt lgkmcnt(2)
  buffer_load_dwordx4 v10, s[8:11], s20 offen offset:2048 lds
  v_mfma_f32_16x16x32_bf16 v[36:39], a[92:95], a[48:51], v[36:39]
  ds_read_b64_tr_b16 a[206:207], v17 offset:2048
  ds_read_b64_tr_b16 a[208:209], v14 offset:4096
  v_mfma_f32_16x16x32_bf16 v[40:43], a[64:67], a[4:7], v[68:71]
  v_exp_f32 v58, v58
  v_mfma_f32_16x16x32_bf16 v[40:43], a[68:71], a[20:23], v[40:43]
  ds_read_b64_tr_b16 a[210:211], v14 offset:6144
  v_cvt_pk_bf16_f32 v108, v56, v57
  v_mfma_f32_16x16x32_bf16 v[40:43], a[72:75], a[36:39], v[40:43]
  v_exp_f32 v59, v59
  v_mfma_f32_16x16x32_bf16 v[40:43], a[76:79], a[52:55], v[40:43]
  v_exp_f32 v60, v60
  v_mfma_f32_16x16x32_bf16 v[44:47], a[80:83], a[4:7], v[68:71]
  buffer_load_dwordx4 v11, s[8:11], s20 offen offset:3072 lds
  v_mfma_f32_16x16x32_bf16 v[44:47], a[84:87], a[20:23], v[44:47]
  ds_read_b64_tr_b16 a[212:213], v15 offset:4096
  v_cvt_pk_bf16_f32 v109, v58, v59
  v_mfma_f32_16x16x32_bf16 v[44:47], a[88:91], a[36:39], v[44:47]
  v_exp_f32 v61, v61
  v_mfma_f32_16x16x32_bf16 v[44:47], a[92:95], a[52:55], v[44:47]
  v_exp_f32 v62, v62
  v_mfma_f32_16x16x32_bf16 v[136:139], a[96:99], v[104:107], v[136:139]
  ds_read_b64_tr_b16 a[214:215], v15 offset:6144
  v_cvt_pk_bf16_f32 v110, v60, v61
  v_mfma_f32_16x16x32_bf16 v[152:155], a[100:103], v[104:107], v[152:155]
  v_exp_f32 v63, v63
  v_mfma_f32_16x16x32_bf16 v[168:171], a[104:107], v[104:107], v[168:171]
  ds_read_b64_tr_b16 a[216:217], v16 offset:4096
  v_cvt_pk_bf16_f32 v111, v62, v63
  v_mfma_f32_16x16x32_bf16 v[184:187], a[108:111], v[104:107], v[184:187]
  ds_read_b64_tr_b16 a[218:219], v16 offset:6144
  v_mfma_f32_16x16x32_bf16 v[200:203], a[112:115], v[104:107], v[200:203]
  s_add_u32 m0, s21, 49152
  v_exp_f32 v32, v32
  v_mfma_f32_16x16x32_bf16 v[216:219], a[116:119], v[104:107], v[216:219]
  buffer_load_dwordx4 v12, s[12:15], s20 offen lds
  v_mfma_f32_16x16x32_bf16 v[232:235], a[120:123], v[104:107], v[232:235]
  v_exp_f32 v33, v33
  v_mfma_f32_16x16x32_bf16 v[248:251], a[124:127], v[104:107], v[248:251]
  ds_read_b64_tr_b16 a[220:221], v17 offset:4096
  ds_read_b64_tr_b16 a[222:223], v17 offset:6144
  v_mfma_f32_16x16x32_bf16 v[88:91], v[112:115], v[104:107], v[88:91]
  v_exp_f32 v34, v34
  v_mfma_f32_16x16x32_bf16 v[140:143], a[96:99], v[108:111], v[140:143]
  v_cvt_pk_bf16_f32 v96, v32, v33
  v_mfma_f32_16x16x32_bf16 v[156:159], a[100:103], v[108:111], v[156:159]
  v_exp_f32 v35, v35
  v_mfma_f32_16x16x32_bf16 v[172:175], a[104:107], v[108:111], v[172:175]
  buffer_load_dwordx4 v13, s[12:15], s20 offen offset:1024 lds
  v_mfma_f32_16x16x32_bf16 v[188:191], a[108:111], v[108:111], v[188:191]
  ds_read_b64_tr_b16 a[96:97], v120 offset:16384
  ds_read_b64_tr_b16 a[98:99], v120 offset:20480
  v_mfma_f32_16x16x32_bf16 v[204:207], a[112:115], v[108:111], v[204:207]
  v_exp_f32 v36, v36
  v_mfma_f32_16x16x32_bf16 v[220:223], a[116:119], v[108:111], v[220:223]
  ds_read_b64_tr_b16 a[100:101], v121 offset:16384
  v_cvt_pk_bf16_f32 v97, v34, v35
  v_mfma_f32_16x16x32_bf16 v[236:239], a[120:123], v[108:111], v[236:239]
  v_exp_f32 v37, v37
  v_mfma_f32_16x16x32_bf16 v[252:255], a[124:127], v[108:111], v[252:255]
  ds_read_b64_tr_b16 a[102:103], v121 offset:20480
  ds_read_b64_tr_b16 a[104:105], v122 offset:16384
  v_mfma_f32_16x16x32_bf16 v[92:95], v[112:115], v[108:111], v[92:95]
  buffer_load_dwordx4 v12, s[12:15], s20 offen offset:2048 lds
  v_mfma_f32_16x16x32_bf16 v[48:51], a[64:67], a[8:11], v[72:75]
  v_exp_f32 v38, v38
  v_mfma_f32_16x16x32_bf16 v[48:51], a[68:71], a[24:27], v[48:51]
  ds_read_b64_tr_b16 a[106:107], v122 offset:20480
  v_cvt_pk_bf16_f32 v98, v36, v37
  v_mfma_f32_16x16x32_bf16 v[48:51], a[72:75], a[40:43], v[48:51]
  v_exp_f32 v39, v39
  v_mfma_f32_16x16x32_bf16 v[48:51], a[76:79], a[56:59], v[48:51]
  v_exp_f32 v40, v40
  v_mfma_f32_16x16x32_bf16 v[52:55], a[80:83], a[8:11], v[72:75]
  ds_read_b64_tr_b16 a[108:109], v123 offset:16384
  v_cvt_pk_bf16_f32 v99, v38, v39
  v_mfma_f32_16x16x32_bf16 v[52:55], a[84:87], a[24:27], v[52:55]
  buffer_load_dwordx4 v13, s[12:15], s20 offen offset:3072 lds
  s_add_u32 s20, s20, 16384
  v_mfma_f32_16x16x32_bf16 v[52:55], a[88:91], a[40:43], v[52:55]
  ds_read_b64_tr_b16 a[110:111], v123 offset:20480
  ds_read_b64_tr_b16 a[112:113], v124 offset:16384
  v_mfma_f32_16x16x32_bf16 v[52:55], a[92:95], a[56:59], v[52:55]
  v_exp_f32 v41, v41
  v_mfma_f32_16x16x32_bf16 v[56:59], a[64:67], a[12:15], v[76:79]
  v_exp_f32 v42, v42
  v_mfma_f32_16x16x32_bf16 v[56:59], a[68:71], a[28:31], v[56:59]
  ds_read_b64_tr_b16 a[114:115], v124 offset:20480
  v_cvt_pk_bf16_f32 v100, v40, v41
  v_mfma_f32_16x16x32_bf16 v[56:59], a[72:75], a[44:47], v[56:59]
  ds_read_b64_tr_b16 a[116:117], v125 offset:16384
  ds_read_b64_tr_b16 a[118:119], v125 offset:20480
  v_mfma_f32_16x16x32_bf16 v[56:59], a[76:79], a[60:63], v[56:59]
  v_exp_f32 v43, v43
  v_mfma_f32_16x16x32_bf16 v[60:63], a[80:83], a[12:15], v[76:79]
  v_exp_f32 v44, v44
  v_mfma_f32_16x16x32_bf16 v[60:63], a[84:87], a[28:31], v[60:63]
  ds_read_b64_tr_b16 a[120:121], v126 offset:16384
  v_cvt_pk_bf16_f32 v101, v42, v43
  v_mfma_f32_16x16x32_bf16 v[60:63], a[88:91], a[44:47], v[60:63]
  v_exp_f32 v45, v45
  v_mfma_f32_16x16x32_bf16 v[60:63], a[92:95], a[60:63], v[60:63]
  s_waitcnt lgkmcnt(15)
  ds_read_b64_tr_b16 a[122:123], v126 offset:20480
  ds_read_b64_tr_b16 a[124:125], v127 offset:16384
  v_mfma_f32_16x16x32_bf16 a[128:131], a[192:195], a[208:211], a[128:131]
  v_exp_f32 v46, v46
  v_mfma_f32_16x16x32_bf16 a[132:135], a[192:195], a[212:215], a[132:135]
  ds_read_b64_tr_b16 a[126:127], v127 offset:20480
  v_cvt_pk_bf16_f32 v102, v44, v45
  v_mfma_f32_16x16x32_bf16 a[136:139], a[192:195], a[216:219], a[136:139]
  s_waitcnt lgkmcnt(15)
  v_exp_f32 v47, v47
  v_mfma_f32_16x16x32_bf16 a[140:143], a[192:195], a[220:223], a[140:143]
  v_cvt_pk_bf16_f32 v103, v46, v47
  v_mfma_f32_16x16x32_bf16 a[144:147], a[196:199], a[208:211], a[144:147]
  v_exp_f32 v48, v48
  v_mfma_f32_16x16x32_bf16 a[148:151], a[196:199], a[212:215], a[148:151]
  v_exp_f32 v49, v49
  v_mfma_f32_16x16x32_bf16 a[152:155], a[196:199], a[216:219], a[152:155]
  v_exp_f32 v50, v50
  v_mfma_f32_16x16x32_bf16 a[156:159], a[196:199], a[220:223], a[156:159]
  s_waitcnt lgkmcnt(14)
  ds_read_b128 a[64:67], v116 offset:24576
  v_xor_b32 v14, 8192, v14
  v_mfma_f32_16x16x32_bf16 v[128:131], a[96:99], v[96:99], v[128:131]
  s_waitcnt lgkmcnt(13)
  v_xor_b32 v15, 8192, v15
  v_xor_b32 v16, 8192, v16
  v_mfma_f32_16x16x32_bf16 v[144:147], a[100:103], v[96:99], v[144:147]
  s_waitcnt lgkmcnt(11)
  v_xor_b32 v17, 8192, v17
  v_cvt_pk_bf16_f32 v104, v48, v49
  v_mfma_f32_16x16x32_bf16 v[160:163], a[104:107], v[96:99], v[160:163]
  s_waitcnt lgkmcnt(9)
  ds_read_b128 a[68:71], v117 offset:24576
  v_mfma_f32_16x16x32_bf16 v[176:179], a[108:111], v[96:99], v[176:179]
  s_waitcnt lgkmcnt(8)
  v_exp_f32 v51, v51
  v_mfma_f32_16x16x32_bf16 v[192:195], a[112:115], v[96:99], v[192:195]
  s_waitcnt lgkmcnt(6)
  ds_read_b128 a[72:75], v118 offset:24576
  v_mfma_f32_16x16x32_bf16 v[208:211], a[116:119], v[96:99], v[208:211]
  s_waitcnt lgkmcnt(5)
  v_exp_f32 v52, v52
  v_mfma_f32_16x16x32_bf16 v[224:227], a[120:123], v[96:99], v[224:227]
  s_waitcnt lgkmcnt(3)
  ds_read_b128 a[76:79], v119 offset:24576
  v_cvt_pk_bf16_f32 v105, v50, v51
  v_mfma_f32_16x16x32_bf16 v[240:243], a[124:127], v[96:99], v[240:243]
  v_exp_f32 v53, v53
  v_mfma_f32_16x16x32_bf16 v[80:83], v[112:115], v[96:99], v[80:83]
  ds_read_b128 a[80:83], v116 offset:28672
  v_mfma_f32_16x16x32_bf16 v[132:135], a[96:99], v[100:103], v[132:135]
  v_exp_f32 v54, v54
  v_mfma_f32_16x16x32_bf16 v[148:151], a[100:103], v[100:103], v[148:151]
  ds_read_b128 a[84:87], v117 offset:28672
  v_cvt_pk_bf16_f32 v106, v52, v53
  v_mfma_f32_16x16x32_bf16 v[164:167], a[104:107], v[100:103], v[164:167]
  v_mfma_f32_16x16x32_bf16 v[180:183], a[108:111], v[100:103], v[180:183]
  v_exp_f32 v55, v55
  v_mfma_f32_16x16x32_bf16 v[196:199], a[112:115], v[100:103], v[196:199]
  ds_read_b128 a[88:91], v118 offset:28672
  v_mfma_f32_16x16x32_bf16 v[212:215], a[116:119], v[100:103], v[212:215]
  v_exp_f32 v56, v56
  v_mfma_f32_16x16x32_bf16 v[228:231], a[120:123], v[100:103], v[228:231]
  ds_read_b128 a[92:95], v119 offset:28672
  v_cvt_pk_bf16_f32 v107, v54, v55
  v_mfma_f32_16x16x32_bf16 v[244:247], a[124:127], v[100:103], v[244:247]
  s_cmp_gt_u32 s38, 13
  s_cselect_b32 s37, 0x30000, 0
  s_add_u32 s38, s38, 1
  s_max_u32 s5, s40, s37
  v_mfma_f32_16x16x32_bf16 v[84:87], v[112:115], v[100:103], v[84:87]
  s_waitcnt lgkmcnt(7)
  s_mov_b32 m0, s5
  v_exp_f32 v57, v57
  v_mfma_f32_16x16x32_bf16 v[32:35], a[64:67], a[0:3], v[64:67]
  s_waitcnt lgkmcnt(6)
  buffer_load_dwordx4 v18, s[48:51], s39 offen lds
  v_mfma_f32_16x16x32_bf16 v[32:35], a[68:71], a[16:19], v[32:35]
  s_waitcnt lgkmcnt(5)
  v_exp_f32 v58, v58
  v_mfma_f32_16x16x32_bf16 v[32:35], a[72:75], a[32:35], v[32:35]
  s_waitcnt lgkmcnt(4)
  v_cvt_pk_bf16_f32 v108, v56, v57
  v_mfma_f32_16x16x32_bf16 v[32:35], a[76:79], a[48:51], v[32:35]
  s_waitcnt lgkmcnt(3)
  v_mfma_f32_16x16x32_bf16 v[36:39], a[80:83], a[0:3], v[64:67]
  s_waitcnt lgkmcnt(2)
  v_exp_f32 v59, v59
  v_mfma_f32_16x16x32_bf16 v[36:39], a[84:87], a[16:19], v[36:39]
  s_waitcnt lgkmcnt(1)
  v_mfma_f32_16x16x32_bf16 v[36:39], a[88:91], a[32:35], v[36:39]
  s_waitcnt lgkmcnt(0)
  buffer_load_dwordx4 v19, s[48:51], s39 offen offset:1024 lds
  v_mfma_f32_16x16x32_bf16 v[36:39], a[92:95], a[48:51], v[36:39]
  v_exp_f32 v60, v60
  v_mfma_f32_16x16x32_bf16 v[40:43], a[64:67], a[4:7], v[68:71]
  v_cvt_pk_bf16_f32 v109, v58, v59
  v_mfma_f32_16x16x32_bf16 v[40:43], a[68:71], a[20:23], v[40:43]
  v_exp_f32 v61, v61
  v_mfma_f32_16x16x32_bf16 v[40:43], a[72:75], a[36:39], v[40:43]
  v_mfma_f32_16x16x32_bf16 v[40:43], a[76:79], a[52:55], v[40:43]
  v_exp_f32 v62, v62
  v_mfma_f32_16x16x32_bf16 v[44:47], a[80:83], a[4:7], v[68:71]
  buffer_load_dwordx4 v20, s[48:51], s39 offen offset:2048 lds
  v_mfma_f32_16x16x32_bf16 v[44:47], a[84:87], a[20:23], v[44:47]
  v_cvt_pk_bf16_f32 v110, v60, v61
  v_mfma_f32_16x16x32_bf16 v[44:47], a[88:91], a[36:39], v[44:47]
  v_mfma_f32_16x16x32_bf16 v[44:47], a[92:95], a[52:55], v[44:47]
  v_exp_f32 v63, v63
  v_mfma_f32_16x16x32_bf16 a[160:163], a[200:203], a[208:211], a[160:163]
  v_cvt_pk_bf16_f32 v111, v62, v63
  v_mfma_f32_16x16x32_bf16 a[164:167], a[200:203], a[212:215], a[164:167]
  v_mfma_f32_16x16x32_bf16 a[168:171], a[200:203], a[216:219], a[168:171]
  v_mfma_f32_16x16x32_bf16 a[172:175], a[200:203], a[220:223], a[172:175]
  buffer_load_dwordx4 v21, s[48:51], s39 offen offset:3072 lds
  v_mfma_f32_16x16x32_bf16 a[176:179], a[204:207], a[208:211], a[176:179]
  v_exp_f32 v32, v32
  v_mfma_f32_16x16x32_bf16 a[180:183], a[204:207], a[212:215], a[180:183]
  v_exp_f32 v33, v33
  v_mfma_f32_16x16x32_bf16 a[184:187], a[204:207], a[216:219], a[184:187]
  v_exp_f32 v34, v34
  v_mfma_f32_16x16x32_bf16 a[188:191], a[204:207], a[220:223], a[188:191]
  s_add_u32 s39, s39, 114688
  v_cvt_pk_bf16_f32 v96, v32, v33
  v_mfma_f32_16x16x32_bf16 v[136:139], a[96:99], v[104:107], v[136:139]
  s_add_u32 m0, s5, 4096
  v_mfma_f32_16x16x32_bf16 v[152:155], a[100:103], v[104:107], v[152:155]
  buffer_load_dwordx4 v22, s[16:19], s36 offen sc1 lds
  v_mfma_f32_16x16x32_bf16 v[168:171], a[104:107], v[104:107], v[168:171]
  v_exp_f32 v35, v35
  v_mfma_f32_16x16x32_bf16 v[184:187], a[108:111], v[104:107], v[184:187]
  v_exp_f32 v36, v36
  v_mfma_f32_16x16x32_bf16 v[200:203], a[112:115], v[104:107], v[200:203]
  v_mfma_f32_16x16x32_bf16 v[216:219], a[116:119], v[104:107], v[216:219]
  v_cvt_pk_bf16_f32 v97, v34, v35
  v_mfma_f32_16x16x32_bf16 v[232:235], a[120:123], v[104:107], v[232:235]
  v_mfma_f32_16x16x32_bf16 v[248:251], a[124:127], v[104:107], v[248:251]
  buffer_load_dwordx4 v23, s[16:19], s36 offen offset:1024 sc1 lds
  v_mfma_f32_16x16x32_bf16 v[88:91], v[112:115], v[104:107], v[88:91]
  v_exp_f32 v37, v37
  v_mfma_f32_16x16x32_bf16 v[140:143], a[96:99], v[108:111], v[140:143]
  v_exp_f32 v38, v38
  v_mfma_f32_16x16x32_bf16 v[156:159], a[100:103], v[108:111], v[156:159]
  ds_read_b64_tr_b16 a[96:97], v120 offset:24576
  ds_read_b64_tr_b16 a[98:99], v120 offset:28672
  v_mfma_f32_16x16x32_bf16 v[172:175], a[104:107], v[108:111], v[172:175]
  ds_read_b64_tr_b16 a[100:101], v121 offset:24576
  v_cvt_pk_bf16_f32 v98, v36, v37
  v_mfma_f32_16x16x32_bf16 v[188:191], a[108:111], v[108:111], v[188:191]
  ds_read_b64_tr_b16 a[102:103], v121 offset:28672
  v_mfma_f32_16x16x32_bf16 v[204:207], a[112:115], v[108:111], v[204:207]
  buffer_load_dwordx4 v24, s[16:19], s36 offen offset:2048 sc1 lds
  v_mfma_f32_16x16x32_bf16 v[220:223], a[116:119], v[108:111], v[220:223]
  v_exp_f32 v39, v39
  v_mfma_f32_16x16x32_bf16 v[236:239], a[120:123], v[108:111], v[236:239]
  ds_read_b64_tr_b16 a[104:105], v122 offset:24576
  ds_read_b64_tr_b16 a[106:107], v122 offset:28672
  v_mfma_f32_16x16x32_bf16 v[252:255], a[124:127], v[108:111], v[252:255]
  v_exp_f32 v40, v40
  v_mfma_f32_16x16x32_bf16 v[92:95], v[112:115], v[108:111], v[92:95]
  ds_read_b64_tr_b16 a[108:109], v123 offset:24576
  v_cvt_pk_bf16_f32 v99, v38, v39
  v_mfma_f32_16x16x32_bf16 v[48:51], a[64:67], a[8:11], v[72:75]
  ds_read_b64_tr_b16 a[110:111], v123 offset:28672
  ds_read_b64_tr_b16 a[112:113], v124 offset:24576
  v_mfma_f32_16x16x32_bf16 v[48:51], a[68:71], a[24:27], v[48:51]
  v_exp_f32 v41, v41
  v_mfma_f32_16x16x32_bf16 v[48:51], a[72:75], a[40:43], v[48:51]
  buffer_load_dwordx4 v25, s[16:19], s36 offen offset:3072 sc1 lds
  v_mfma_f32_16x16x32_bf16 v[48:51], a[76:79], a[56:59], v[48:51]
  ds_read_b64_tr_b16 a[114:115], v124 offset:28672
  ds_read_b64_tr_b16 a[116:117], v125 offset:24576
  v_mfma_f32_16x16x32_bf16 v[52:55], a[80:83], a[8:11], v[72:75]
  v_exp_f32 v42, v42
  v_mfma_f32_16x16x32_bf16 v[52:55], a[84:87], a[24:27], v[52:55]
  ds_read_b64_tr_b16 a[118:119], v125 offset:28672
  v_cvt_pk_bf16_f32 v100, v40, v41
  v_mfma_f32_16x16x32_bf16 v[52:55], a[88:91], a[40:43], v[52:55]
  s_add_u32 s36, s36, 32768
  ds_read_b64_tr_b16 a[120:121], v126 offset:24576
  ds_read_b64_tr_b16 a[122:123], v126 offset:28672
  v_mfma_f32_16x16x32_bf16 v[52:55], a[92:95], a[56:59], v[52:55]
  v_exp_f32 v43, v43
  v_mfma_f32_16x16x32_bf16 v[56:59], a[64:67], a[12:15], v[76:79]
  ds_read_b64_tr_b16 a[124:125], v127 offset:24576
  ds_read_b64_tr_b16 a[126:127], v127 offset:28672
  v_mfma_f32_16x16x32_bf16 v[56:59], a[68:71], a[28:31], v[56:59]
  v_exp_f32 v44, v44
  v_mfma_f32_16x16x32_bf16 v[56:59], a[72:75], a[44:47], v[56:59]
  v_cvt_pk_bf16_f32 v101, v42, v43
  v_mfma_f32_16x16x32_bf16 v[56:59], a[76:79], a[60:63], v[56:59]
  v_exp_f32 v45, v45
  v_mfma_f32_16x16x32_bf16 v[60:63], a[80:83], a[12:15], v[76:79]
  v_exp_f32 v46, v46
  v_mfma_f32_16x16x32_bf16 v[60:63], a[84:87], a[28:31], v[60:63]
  v_mfma_f32_16x16x32_bf16 v[60:63], a[88:91], a[44:47], v[60:63]
  v_mfma_f32_16x16x32_bf16 v[60:63], a[92:95], a[60:63], v[60:63]
  s_xor_b32 s40, s40, 8192
  s_waitcnt vmcnt(16) lgkmcnt(0)
  s_barrier
  v_mfma_f32_16x16x32_bf16 v[128:131], a[96:99], v[96:99], v[128:131]
  ds_read_b128 a[64:67], v116 offset:32768
  v_cvt_pk_bf16_f32 v102, v44, v45
  v_mfma_f32_16x16x32_bf16 v[144:147], a[100:103], v[96:99], v[144:147]
  v_exp_f32 v47, v47
  v_mfma_f32_16x16x32_bf16 v[160:163], a[104:107], v[96:99], v[160:163]
  ds_read_b128 a[68:71], v117 offset:32768
  v_cvt_pk_bf16_f32 v103, v46, v47
  v_mfma_f32_16x16x32_bf16 v[176:179], a[108:111], v[96:99], v[176:179]
  ds_read_b128 a[72:75], v118 offset:32768
  v_mfma_f32_16x16x32_bf16 v[192:195], a[112:115], v[96:99], v[192:195]
  v_exp_f32 v48, v48
  v_mfma_f32_16x16x32_bf16 v[208:211], a[116:119], v[96:99], v[208:211]
  ds_read_b64_tr_b16 a[192:193], v14
  ds_read_b128 a[76:79], v119 offset:32768
  v_mfma_f32_16x16x32_bf16 v[224:227], a[120:123], v[96:99], v[224:227]
  v_exp_f32 v49, v49
  v_mfma_f32_16x16x32_bf16 v[240:243], a[124:127], v[96:99], v[240:243]
  v_exp_f32 v50, v50
  v_mfma_f32_16x16x32_bf16 v[80:83], v[112:115], v[96:99], v[80:83]
  ds_read_b64_tr_b16 a[194:195], v14 offset:2048
  v_cvt_pk_bf16_f32 v104, v48, v49
  v_mfma_f32_16x16x32_bf16 v[132:135], a[96:99], v[100:103], v[132:135]
  ds_read_b128 a[80:83], v116 offset:36864
  ds_read_b64_tr_b16 a[196:197], v15
  v_mfma_f32_16x16x32_bf16 v[148:151], a[100:103], v[100:103], v[148:151]
  v_exp_f32 v51, v51
  v_mfma_f32_16x16x32_bf16 v[164:167], a[104:107], v[100:103], v[164:167]
  s_add_u32 m0, s21, 16384
  v_exp_f32 v52, v52
  v_mfma_f32_16x16x32_bf16 v[180:183], a[108:111], v[100:103], v[180:183]
  buffer_load_dwordx4 v8, s[8:11], s20 offen lds
  v_mfma_f32_16x16x32_bf16 v[196:199], a[112:115], v[100:103], v[196:199]
  ds_read_b128 a[84:87], v117 offset:36864
  ds_read_b64_tr_b16 a[198:199], v15 offset:2048
  v_mfma_f32_16x16x32_bf16 v[212:215], a[116:119], v[100:103], v[212:215]
  ds_read_b128 a[88:91], v118 offset:36864
  v_cvt_pk_bf16_f32 v105, v50, v51
  v_mfma_f32_16x16x32_bf16 v[228:231], a[120:123], v[100:103], v[228:231]
  v_exp_f32 v53, v53
  v_mfma_f32_16x16x32_bf16 v[244:247], a[124:127], v[100:103], v[244:247]
  ds_read_b64_tr_b16 a[200:201], v16
  ds_read_b128 a[92:95], v119 offset:36864
  v_mfma_f32_16x16x32_bf16 v[84:87], v[112:115], v[100:103], v[84:87]
  s_waitcnt lgkmcnt(12)
  v_exp_f32 v54, v54
  v_mfma_f32_16x16x32_bf16 v[32:35], a[64:67], a[0:3], v[64:67]
  s_waitcnt lgkmcnt(11)
  buffer_load_dwordx4 v9, s[8:11], s20 offen offset:1024 lds
  v_mfma_f32_16x16x32_bf16 v[32:35], a[68:71], a[16:19], v[32:35]
  s_waitcnt lgkmcnt(10)
  ds_read_b64_tr_b16 a[202:203], v16 offset:2048
  v_cvt_pk_bf16_f32 v106, v52, v53
  v_mfma_f32_16x16x32_bf16 v[32:35], a[72:75], a[32:35], v[32:35]
  s_waitcnt lgkmcnt(9)
  v_exp_f32 v55, v55
  v_mfma_f32_16x16x32_bf16 v[32:35], a[76:79], a[48:51], v[32:35]
  s_waitcnt lgkmcnt(7)
  v_exp_f32 v56, v56
  v_mfma_f32_16x16x32_bf16 v[36:39], a[80:83], a[0:3], v[64:67]
  s_waitcnt lgkmcnt(5)
  ds_read_b64_tr_b16 a[204:205], v17
  v_cvt_pk_bf16_f32 v107, v54, v55
  v_mfma_f32_16x16x32_bf16 v[36:39], a[84:87], a[16:19], v[36:39]
  s_waitcnt lgkmcnt(4)
  v_exp_f32 v57, v57
  v_mfma_f32_16x16x32_bf16 v[36:39], a[88:91], a[32:35], v[36:39]
  s_waitcnt lgkmcnt(2)
  buffer_load_dwordx4 v10, s[8:11], s20 offen offset:2048 lds
  v_mfma_f32_16x16x32_bf16 v[36:39], a[92:95], a[48:51], v[36:39]
  ds_read_b64_tr_b16 a[206:207], v17 offset:2048
  ds_read_b64_tr_b16 a[208:209], v14 offset:4096
  v_mfma_f32_16x16x32_bf16 v[40:43], a[64:67], a[4:7], v[68:71]
  v_exp_f32 v58, v58
  v_mfma_f32_16x16x32_bf16 v[40:43], a[68:71], a[20:23], v[40:43]
  ds_read_b64_tr_b16 a[210:211], v14 offset:6144
  v_cvt_pk_bf16_f32 v108, v56, v57
  v_mfma_f32_16x16x32_bf16 v[40:43], a[72:75], a[36:39], v[40:43]
  v_exp_f32 v59, v59
  v_mfma_f32_16x16x32_bf16 v[40:43], a[76:79], a[52:55], v[40:43]
  v_exp_f32 v60, v60
  v_mfma_f32_16x16x32_bf16 v[44:47], a[80:83], a[4:7], v[68:71]
  buffer_load_dwordx4 v11, s[8:11], s20 offen offset:3072 lds
  v_mfma_f32_16x16x32_bf16 v[44:47], a[84:87], a[20:23], v[44:47]
  ds_read_b64_tr_b16 a[212:213], v15 offset:4096
  v_cvt_pk_bf16_f32 v109, v58, v59
  v_mfma_f32_16x16x32_bf16 v[44:47], a[88:91], a[36:39], v[44:47]
  v_exp_f32 v61, v61
  v_mfma_f32_16x16x32_bf16 v[44:47], a[92:95], a[52:55], v[44:47]
  v_exp_f32 v62, v62
  v_mfma_f32_16x16x32_bf16 v[136:139], a[96:99], v[104:107], v[136:139]
  ds_read_b64_tr_b16 a[214:215], v15 offset:6144
  v_cvt_pk_bf16_f32 v110, v60, v61
  v_mfma_f32_16x16x32_bf16 v[152:155], a[100:103], v[104:107], v[152:155]
  v_exp_f32 v63, v63
  v_mfma_f32_16x16x32_bf16 v[168:171], a[104:107], v[104:107], v[168:171]
  ds_read_b64_tr_b16 a[216:217], v16 offset:4096
  v_cvt_pk_bf16_f32 v111, v62, v63
  v_mfma_f32_16x16x32_bf16 v[184:187], a[108:111], v[104:107], v[184:187]
  ds_read_b64_tr_b16 a[218:219], v16 offset:6144
  v_mfma_f32_16x16x32_bf16 v[200:203], a[112:115], v[104:107], v[200:203]
  s_add_u32 m0, s21, 65536
  v_exp_f32 v32, v32
  v_mfma_f32_16x16x32_bf16 v[216:219], a[116:119], v[104:107], v[216:219]
  buffer_load_dwordx4 v12, s[12:15], s20 offen lds
  v_mfma_f32_16x16x32_bf16 v[232:235], a[120:123], v[104:107], v[232:235]
  v_exp_f32 v33, v33
  v_mfma_f32_16x16x32_bf16 v[248:251], a[124:127], v[104:107], v[248:251]
  ds_read_b64_tr_b16 a[220:221], v17 offset:4096
  ds_read_b64_tr_b16 a[222:223], v17 offset:6144
  v_mfma_f32_16x16x32_bf16 v[88:91], v[112:115], v[104:107], v[88:91]
  v_exp_f32 v34, v34
  v_mfma_f32_16x16x32_bf16 v[140:143], a[96:99], v[108:111], v[140:143]
  v_cvt_pk_bf16_f32 v96, v32, v33
  v_mfma_f32_16x16x32_bf16 v[156:159], a[100:103], v[108:111], v[156:159]
  v_exp_f32 v35, v35
  v_mfma_f32_16x16x32_bf16 v[172:175], a[104:107], v[108:111], v[172:175]
  buffer_load_dwordx4 v13, s[12:15], s20 offen offset:1024 lds
  v_mfma_f32_16x16x32_bf16 v[188:191], a[108:111], v[108:111], v[188:191]
  ds_read_b64_tr_b16 a[96:97], v120 offset:32768
  ds_read_b64_tr_b16 a[98:99], v120 offset:36864
  v_mfma_f32_16x16x32_bf16 v[204:207], a[112:115], v[108:111], v[204:207]
  v_exp_f32 v36, v36
  v_mfma_f32_16x16x32_bf16 v[220:223], a[116:119], v[108:111], v[220:223]
  ds_read_b64_tr_b16 a[100:101], v121 offset:32768
  v_cvt_pk_bf16_f32 v97, v34, v35
  v_mfma_f32_16x16x32_bf16 v[236:239], a[120:123], v[108:111], v[236:239]
  v_exp_f32 v37, v37
  v_mfma_f32_16x16x32_bf16 v[252:255], a[124:127], v[108:111], v[252:255]
  ds_read_b64_tr_b16 a[102:103], v121 offset:36864
  ds_read_b64_tr_b16 a[104:105], v122 offset:32768
  v_mfma_f32_16x16x32_bf16 v[92:95], v[112:115], v[108:111], v[92:95]
  buffer_load_dwordx4 v12, s[12:15], s20 offen offset:2048 lds
  v_mfma_f32_16x16x32_bf16 v[48:51], a[64:67], a[8:11], v[72:75]
  v_exp_f32 v38, v38
  v_mfma_f32_16x16x32_bf16 v[48:51], a[68:71], a[24:27], v[48:51]
  ds_read_b64_tr_b16 a[106:107], v122 offset:36864
  v_cvt_pk_bf16_f32 v98, v36, v37
  v_mfma_f32_16x16x32_bf16 v[48:51], a[72:75], a[40:43], v[48:51]
  v_exp_f32 v39, v39
  v_mfma_f32_16x16x32_bf16 v[48:51], a[76:79], a[56:59], v[48:51]
  v_exp_f32 v40, v40
  v_mfma_f32_16x16x32_bf16 v[52:55], a[80:83], a[8:11], v[72:75]
  ds_read_b64_tr_b16 a[108:109], v123 offset:32768
  v_cvt_pk_bf16_f32 v99, v38, v39
  v_mfma_f32_16x16x32_bf16 v[52:55], a[84:87], a[24:27], v[52:55]
  buffer_load_dwordx4 v13, s[12:15], s20 offen offset:3072 lds
  s_add_u32 s20, s20, 16384
  v_mfma_f32_16x16x32_bf16 v[52:55], a[88:91], a[40:43], v[52:55]
  ds_read_b64_tr_b16 a[110:111], v123 offset:36864
  ds_read_b64_tr_b16 a[112:113], v124 offset:32768
  v_mfma_f32_16x16x32_bf16 v[52:55], a[92:95], a[56:59], v[52:55]
  v_exp_f32 v41, v41
  v_mfma_f32_16x16x32_bf16 v[56:59], a[64:67], a[12:15], v[76:79]
  v_exp_f32 v42, v42
  v_mfma_f32_16x16x32_bf16 v[56:59], a[68:71], a[28:31], v[56:59]
  ds_read_b64_tr_b16 a[114:115], v124 offset:36864
  v_cvt_pk_bf16_f32 v100, v40, v41
  v_mfma_f32_16x16x32_bf16 v[56:59], a[72:75], a[44:47], v[56:59]
  ds_read_b64_tr_b16 a[116:117], v125 offset:32768
  ds_read_b64_tr_b16 a[118:119], v125 offset:36864
  v_mfma_f32_16x16x32_bf16 v[56:59], a[76:79], a[60:63], v[56:59]
  v_exp_f32 v43, v43
  v_mfma_f32_16x16x32_bf16 v[60:63], a[80:83], a[12:15], v[76:79]
  v_exp_f32 v44, v44
  v_mfma_f32_16x16x32_bf16 v[60:63], a[84:87], a[28:31], v[60:63]
  ds_read_b64_tr_b16 a[120:121], v126 offset:32768
  v_cvt_pk_bf16_f32 v101, v42, v43
  v_mfma_f32_16x16x32_bf16 v[60:63], a[88:91], a[44:47], v[60:63]
  v_exp_f32 v45, v45
  v_mfma_f32_16x16x32_bf16 v[60:63], a[92:95], a[60:63], v[60:63]
  s_waitcnt lgkmcnt(15)
  ds_read_b64_tr_b16 a[122:123], v126 offset:36864
  ds_read_b64_tr_b16 a[124:125], v127 offset:32768
  v_mfma_f32_16x16x32_bf16 a[128:131], a[192:195], a[208:211], a[128:131]
  v_exp_f32 v46, v46
  v_mfma_f32_16x16x32_bf16 a[132:135], a[192:195], a[212:215], a[132:135]
  ds_read_b64_tr_b16 a[126:127], v127 offset:36864
  v_cvt_pk_bf16_f32 v102, v44, v45
  v_mfma_f32_16x16x32_bf16 a[136:139], a[192:195], a[216:219], a[136:139]
  s_waitcnt lgkmcnt(15)
  v_exp_f32 v47, v47
  v_mfma_f32_16x16x32_bf16 a[140:143], a[192:195], a[220:223], a[140:143]
  v_cvt_pk_bf16_f32 v103, v46, v47
  v_mfma_f32_16x16x32_bf16 a[144:147], a[196:199], a[208:211], a[144:147]
  v_exp_f32 v48, v48
  v_mfma_f32_16x16x32_bf16 a[148:151], a[196:199], a[212:215], a[148:151]
  v_exp_f32 v49, v49
  v_mfma_f32_16x16x32_bf16 a[152:155], a[196:199], a[216:219], a[152:155]
  v_exp_f32 v50, v50
  v_mfma_f32_16x16x32_bf16 a[156:159], a[196:199], a[220:223], a[156:159]
  s_waitcnt lgkmcnt(14)
  ds_read_b128 a[64:67], v116 offset:40960
  v_xor_b32 v14, 8192, v14
  v_mfma_f32_16x16x32_bf16 v[128:131], a[96:99], v[96:99], v[128:131]
  s_waitcnt lgkmcnt(13)
  v_xor_b32 v15, 8192, v15
  v_xor_b32 v16, 8192, v16
  v_mfma_f32_16x16x32_bf16 v[144:147], a[100:103], v[96:99], v[144:147]
  s_waitcnt lgkmcnt(11)
  v_xor_b32 v17, 8192, v17
  v_cvt_pk_bf16_f32 v104, v48, v49
  v_mfma_f32_16x16x32_bf16 v[160:163], a[104:107], v[96:99], v[160:163]
  s_waitcnt lgkmcnt(9)
  ds_read_b128 a[68:71], v117 offset:40960
  v_mfma_f32_16x16x32_bf16 v[176:179], a[108:111], v[96:99], v[176:179]
  s_waitcnt lgkmcnt(8)
  v_exp_f32 v51, v51
  v_mfma_f32_16x16x32_bf16 v[192:195], a[112:115], v[96:99], v[192:195]
  s_waitcnt lgkmcnt(6)
  ds_read_b128 a[72:75], v118 offset:40960
  v_mfma_f32_16x16x32_bf16 v[208:211], a[116:119], v[96:99], v[208:211]
  s_waitcnt lgkmcnt(5)
  v_exp_f32 v52, v52
  v_mfma_f32_16x16x32_bf16 v[224:227], a[120:123], v[96:99], v[224:227]
  s_waitcnt lgkmcnt(3)
  ds_read_b128 a[76:79], v119 offset:40960
  v_cvt_pk_bf16_f32 v105, v50, v51
  v_mfma_f32_16x16x32_bf16 v[240:243], a[124:127], v[96:99], v[240:243]
  v_exp_f32 v53, v53
  v_mfma_f32_16x16x32_bf16 v[80:83], v[112:115], v[96:99], v[80:83]
  ds_read_b128 a[80:83], v116 offset:45056
  v_mfma_f32_16x16x32_bf16 v[132:135], a[96:99], v[100:103], v[132:135]
  v_exp_f32 v54, v54
  v_mfma_f32_16x16x32_bf16 v[148:151], a[100:103], v[100:103], v[148:151]
  ds_read_b128 a[84:87], v117 offset:45056
  v_cvt_pk_bf16_f32 v106, v52, v53
  v_mfma_f32_16x16x32_bf16 v[164:167], a[104:107], v[100:103], v[164:167]
  v_mfma_f32_16x16x32_bf16 v[180:183], a[108:111], v[100:103], v[180:183]
  v_exp_f32 v55, v55
  v_mfma_f32_16x16x32_bf16 v[196:199], a[112:115], v[100:103], v[196:199]
  ds_read_b128 a[88:91], v118 offset:45056
  v_mfma_f32_16x16x32_bf16 v[212:215], a[116:119], v[100:103], v[212:215]
  v_exp_f32 v56, v56
  v_mfma_f32_16x16x32_bf16 v[228:231], a[120:123], v[100:103], v[228:231]
  ds_read_b128 a[92:95], v119 offset:45056
  v_cvt_pk_bf16_f32 v107, v54, v55
  v_mfma_f32_16x16x32_bf16 v[244:247], a[124:127], v[100:103], v[244:247]
  s_cmp_gt_u32 s38, 13
  s_cselect_b32 s37, 0x30000, 0
  s_add_u32 s38, s38, 1
  s_max_u32 s5, s40, s37
  v_mfma_f32_16x16x32_bf16 v[84:87], v[112:115], v[100:103], v[84:87]
  s_waitcnt lgkmcnt(7)
  s_mov_b32 m0, s5
  v_exp_f32 v57, v57
  v_mfma_f32_16x16x32_bf16 v[32:35], a[64:67], a[0:3], v[64:67]
  s_waitcnt lgkmcnt(6)
  buffer_load_dwordx4 v18, s[48:51], s39 offen lds
  v_mfma_f32_16x16x32_bf16 v[32:35], a[68:71], a[16:19], v[32:35]
  s_waitcnt lgkmcnt(5)
  v_exp_f32 v58, v58
  v_mfma_f32_16x16x32_bf16 v[32:35], a[72:75], a[32:35], v[32:35]
  s_waitcnt lgkmcnt(4)
  v_cvt_pk_bf16_f32 v108, v56, v57
  v_mfma_f32_16x16x32_bf16 v[32:35], a[76:79], a[48:51], v[32:35]
  s_waitcnt lgkmcnt(3)
  v_mfma_f32_16x16x32_bf16 v[36:39], a[80:83], a[0:3], v[64:67]
  s_waitcnt lgkmcnt(2)
  v_exp_f32 v59, v59
  v_mfma_f32_16x16x32_bf16 v[36:39], a[84:87], a[16:19], v[36:39]
  s_waitcnt lgkmcnt(1)
  v_mfma_f32_16x16x32_bf16 v[36:39], a[88:91], a[32:35], v[36:39]
  s_waitcnt lgkmcnt(0)
  buffer_load_dwordx4 v19, s[48:51], s39 offen offset:1024 lds
  v_mfma_f32_16x16x32_bf16 v[36:39], a[92:95], a[48:51], v[36:39]
  v_exp_f32 v60, v60
  v_mfma_f32_16x16x32_bf16 v[40:43], a[64:67], a[4:7], v[68:71]
  v_cvt_pk_bf16_f32 v109, v58, v59
  v_mfma_f32_16x16x32_bf16 v[40:43], a[68:71], a[20:23], v[40:43]
  v_exp_f32 v61, v61
  v_mfma_f32_16x16x32_bf16 v[40:43], a[72:75], a[36:39], v[40:43]
  v_mfma_f32_16x16x32_bf16 v[40:43], a[76:79], a[52:55], v[40:43]
  v_exp_f32 v62, v62
  v_mfma_f32_16x16x32_bf16 v[44:47], a[80:83], a[4:7], v[68:71]
  buffer_load_dwordx4 v20, s[48:51], s39 offen offset:2048 lds
  v_mfma_f32_16x16x32_bf16 v[44:47], a[84:87], a[20:23], v[44:47]
  v_cvt_pk_bf16_f32 v110, v60, v61
  v_mfma_f32_16x16x32_bf16 v[44:47], a[88:91], a[36:39], v[44:47]
  v_mfma_f32_16x16x32_bf16 v[44:47], a[92:95], a[52:55], v[44:47]
  v_exp_f32 v63, v63
  v_mfma_f32_16x16x32_bf16 a[160:163], a[200:203], a[208:211], a[160:163]
  v_cvt_pk_bf16_f32 v111, v62, v63
  v_mfma_f32_16x16x32_bf16 a[164:167], a[200:203], a[212:215], a[164:167]
  v_mfma_f32_16x16x32_bf16 a[168:171], a[200:203], a[216:219], a[168:171]
  v_mfma_f32_16x16x32_bf16 a[172:175], a[200:203], a[220:223], a[172:175]
  buffer_load_dwordx4 v21, s[48:51], s39 offen offset:3072 lds
  v_mfma_f32_16x16x32_bf16 a[176:179], a[204:207], a[208:211], a[176:179]
  v_exp_f32 v32, v32
  v_mfma_f32_16x16x32_bf16 a[180:183], a[204:207], a[212:215], a[180:183]
  v_exp_f32 v33, v33
  v_mfma_f32_16x16x32_bf16 a[184:187], a[204:207], a[216:219], a[184:187]
  v_exp_f32 v34, v34
  v_mfma_f32_16x16x32_bf16 a[188:191], a[204:207], a[220:223], a[188:191]
  s_add_u32 s39, s39, 114688
  v_cvt_pk_bf16_f32 v96, v32, v33
  v_mfma_f32_16x16x32_bf16 v[136:139], a[96:99], v[104:107], v[136:139]
  s_add_u32 m0, s5, 4096
  v_mfma_f32_16x16x32_bf16 v[152:155], a[100:103], v[104:107], v[152:155]
  buffer_load_dwordx4 v22, s[16:19], s36 offen sc1 lds
  v_mfma_f32_16x16x32_bf16 v[168:171], a[104:107], v[104:107], v[168:171]
  v_exp_f32 v35, v35
  v_mfma_f32_16x16x32_bf16 v[184:187], a[108:111], v[104:107], v[184:187]
  v_exp_f32 v36, v36
  v_mfma_f32_16x16x32_bf16 v[200:203], a[112:115], v[104:107], v[200:203]
  v_mfma_f32_16x16x32_bf16 v[216:219], a[116:119], v[104:107], v[216:219]
  v_cvt_pk_bf16_f32 v97, v34, v35
  v_mfma_f32_16x16x32_bf16 v[232:235], a[120:123], v[104:107], v[232:235]
  v_mfma_f32_16x16x32_bf16 v[248:251], a[124:127], v[104:107], v[248:251]
  buffer_load_dwordx4 v23, s[16:19], s36 offen offset:1024 sc1 lds
  v_mfma_f32_16x16x32_bf16 v[88:91], v[112:115], v[104:107], v[88:91]
  v_exp_f32 v37, v37
  v_mfma_f32_16x16x32_bf16 v[140:143], a[96:99], v[108:111], v[140:143]
  v_exp_f32 v38, v38
  v_mfma_f32_16x16x32_bf16 v[156:159], a[100:103], v[108:111], v[156:159]
  ds_read_b64_tr_b16 a[96:97], v120 offset:40960
  ds_read_b64_tr_b16 a[98:99], v120 offset:45056
  v_mfma_f32_16x16x32_bf16 v[172:175], a[104:107], v[108:111], v[172:175]
  ds_read_b64_tr_b16 a[100:101], v121 offset:40960
  v_cvt_pk_bf16_f32 v98, v36, v37
  v_mfma_f32_16x16x32_bf16 v[188:191], a[108:111], v[108:111], v[188:191]
  ds_read_b64_tr_b16 a[102:103], v121 offset:45056
  v_mfma_f32_16x16x32_bf16 v[204:207], a[112:115], v[108:111], v[204:207]
  buffer_load_dwordx4 v24, s[16:19], s36 offen offset:2048 sc1 lds
  v_mfma_f32_16x16x32_bf16 v[220:223], a[116:119], v[108:111], v[220:223]
  v_exp_f32 v39, v39
  v_mfma_f32_16x16x32_bf16 v[236:239], a[120:123], v[108:111], v[236:239]
  ds_read_b64_tr_b16 a[104:105], v122 offset:40960
  ds_read_b64_tr_b16 a[106:107], v122 offset:45056
  v_mfma_f32_16x16x32_bf16 v[252:255], a[124:127], v[108:111], v[252:255]
  v_exp_f32 v40, v40
  v_mfma_f32_16x16x32_bf16 v[92:95], v[112:115], v[108:111], v[92:95]
  ds_read_b64_tr_b16 a[108:109], v123 offset:40960
  v_cvt_pk_bf16_f32 v99, v38, v39
  v_mfma_f32_16x16x32_bf16 v[48:51], a[64:67], a[8:11], v[72:75]
  ds_read_b64_tr_b16 a[110:111], v123 offset:45056
  ds_read_b64_tr_b16 a[112:113], v124 offset:40960
  v_mfma_f32_16x16x32_bf16 v[48:51], a[68:71], a[24:27], v[48:51]
  v_exp_f32 v41, v41
  v_mfma_f32_16x16x32_bf16 v[48:51], a[72:75], a[40:43], v[48:51]
  buffer_load_dwordx4 v25, s[16:19], s36 offen offset:3072 sc1 lds
  v_mfma_f32_16x16x32_bf16 v[48:51], a[76:79], a[56:59], v[48:51]
  ds_read_b64_tr_b16 a[114:115], v124 offset:45056
  ds_read_b64_tr_b16 a[116:117], v125 offset:40960
  v_mfma_f32_16x16x32_bf16 v[52:55], a[80:83], a[8:11], v[72:75]
  v_exp_f32 v42, v42
  v_mfma_f32_16x16x32_bf16 v[52:55], a[84:87], a[24:27], v[52:55]
  ds_read_b64_tr_b16 a[118:119], v125 offset:45056
  v_cvt_pk_bf16_f32 v100, v40, v41
  v_mfma_f32_16x16x32_bf16 v[52:55], a[88:91], a[40:43], v[52:55]
  s_add_u32 s36, s36, 32768
  ds_read_b64_tr_b16 a[120:121], v126 offset:40960
  ds_read_b64_tr_b16 a[122:123], v126 offset:45056
  v_mfma_f32_16x16x32_bf16 v[52:55], a[92:95], a[56:59], v[52:55]
  v_exp_f32 v43, v43
  v_mfma_f32_16x16x32_bf16 v[56:59], a[64:67], a[12:15], v[76:79]
  ds_read_b64_tr_b16 a[124:125], v127 offset:40960
  ds_read_b64_tr_b16 a[126:127], v127 offset:45056
  v_mfma_f32_16x16x32_bf16 v[56:59], a[68:71], a[28:31], v[56:59]
  v_exp_f32 v44, v44
  v_mfma_f32_16x16x32_bf16 v[56:59], a[72:75], a[44:47], v[56:59]
  v_cvt_pk_bf16_f32 v101, v42, v43
  v_mfma_f32_16x16x32_bf16 v[56:59], a[76:79], a[60:63], v[56:59]
  v_exp_f32 v45, v45
  v_mfma_f32_16x16x32_bf16 v[60:63], a[80:83], a[12:15], v[76:79]
  v_exp_f32 v46, v46
  v_mfma_f32_16x16x32_bf16 v[60:63], a[84:87], a[28:31], v[60:63]
  v_mfma_f32_16x16x32_bf16 v[60:63], a[88:91], a[44:47], v[60:63]
  v_mfma_f32_16x16x32_bf16 v[60:63], a[92:95], a[60:63], v[60:63]
  s_xor_b32 s40, s40, 8192
  s_waitcnt vmcnt(16) lgkmcnt(0)
  s_barrier
  v_mfma_f32_16x16x32_bf16 v[128:131], a[96:99], v[96:99], v[128:131]
  ds_read_b128 a[64:67], v116
  v_cvt_pk_bf16_f32 v102, v44, v45
  v_mfma_f32_16x16x32_bf16 v[144:147], a[100:103], v[96:99], v[144:147]
  v_exp_f32 v47, v47
  v_mfma_f32_16x16x32_bf16 v[160:163], a[104:107], v[96:99], v[160:163]
  ds_read_b128 a[68:71], v117
  v_cvt_pk_bf16_f32 v103, v46, v47
  v_mfma_f32_16x16x32_bf16 v[176:179], a[108:111], v[96:99], v[176:179]
  ds_read_b128 a[72:75], v118
  v_mfma_f32_16x16x32_bf16 v[192:195], a[112:115], v[96:99], v[192:195]
  v_exp_f32 v48, v48
  v_mfma_f32_16x16x32_bf16 v[208:211], a[116:119], v[96:99], v[208:211]
  ds_read_b64_tr_b16 a[192:193], v14
  ds_read_b128 a[76:79], v119
  v_mfma_f32_16x16x32_bf16 v[224:227], a[120:123], v[96:99], v[224:227]
  v_exp_f32 v49, v49
  v_mfma_f32_16x16x32_bf16 v[240:243], a[124:127], v[96:99], v[240:243]
  v_exp_f32 v50, v50
  v_mfma_f32_16x16x32_bf16 v[80:83], v[112:115], v[96:99], v[80:83]
  ds_read_b64_tr_b16 a[194:195], v14 offset:2048
  v_cvt_pk_bf16_f32 v104, v48, v49
  v_mfma_f32_16x16x32_bf16 v[132:135], a[96:99], v[100:103], v[132:135]
  ds_read_b128 a[80:83], v116 offset:4096
  ds_read_b64_tr_b16 a[196:197], v15
  v_mfma_f32_16x16x32_bf16 v[148:151], a[100:103], v[100:103], v[148:151]
  v_exp_f32 v51, v51
  v_mfma_f32_16x16x32_bf16 v[164:167], a[104:107], v[100:103], v[164:167]
  s_add_u32 m0, s21, 32768
  v_exp_f32 v52, v52
  v_mfma_f32_16x16x32_bf16 v[180:183], a[108:111], v[100:103], v[180:183]
  buffer_load_dwordx4 v8, s[8:11], s20 offen lds
  v_mfma_f32_16x16x32_bf16 v[196:199], a[112:115], v[100:103], v[196:199]
  ds_read_b128 a[84:87], v117 offset:4096
  ds_read_b64_tr_b16 a[198:199], v15 offset:2048
  v_mfma_f32_16x16x32_bf16 v[212:215], a[116:119], v[100:103], v[212:215]
  ds_read_b128 a[88:91], v118 offset:4096
  v_cvt_pk_bf16_f32 v105, v50, v51
  v_mfma_f32_16x16x32_bf16 v[228:231], a[120:123], v[100:103], v[228:231]
  v_exp_f32 v53, v53
  v_mfma_f32_16x16x32_bf16 v[244:247], a[124:127], v[100:103], v[244:247]
  ds_read_b64_tr_b16 a[200:201], v16
  ds_read_b128 a[92:95], v119 offset:4096
  v_mfma_f32_16x16x32_bf16 v[84:87], v[112:115], v[100:103], v[84:87]
  s_waitcnt lgkmcnt(12)
  v_exp_f32 v54, v54
  v_mfma_f32_16x16x32_bf16 v[32:35], a[64:67], a[0:3], v[64:67]
  s_waitcnt lgkmcnt(11)
  buffer_load_dwordx4 v9, s[8:11], s20 offen offset:1024 lds
  v_mfma_f32_16x16x32_bf16 v[32:35], a[68:71], a[16:19], v[32:35]
  s_waitcnt lgkmcnt(10)
  ds_read_b64_tr_b16 a[202:203], v16 offset:2048
  v_cvt_pk_bf16_f32 v106, v52, v53
  v_mfma_f32_16x16x32_bf16 v[32:35], a[72:75], a[32:35], v[32:35]
  s_waitcnt lgkmcnt(9)
  v_exp_f32 v55, v55
  v_mfma_f32_16x16x32_bf16 v[32:35], a[76:79], a[48:51], v[32:35]
  s_waitcnt lgkmcnt(7)
  v_exp_f32 v56, v56
  v_mfma_f32_16x16x32_bf16 v[36:39], a[80:83], a[0:3], v[64:67]
  s_waitcnt lgkmcnt(5)
  ds_read_b64_tr_b16 a[204:205], v17
  v_cvt_pk_bf16_f32 v107, v54, v55
  v_mfma_f32_16x16x32_bf16 v[36:39], a[84:87], a[16:19], v[36:39]
  s_waitcnt lgkmcnt(4)
  v_exp_f32 v57, v57
  v_mfma_f32_16x16x32_bf16 v[36:39], a[88:91], a[32:35], v[36:39]
  s_waitcnt lgkmcnt(2)
  buffer_load_dwordx4 v10, s[8:11], s20 offen offset:2048 lds
  v_mfma_f32_16x16x32_bf16 v[36:39], a[92:95], a[48:51], v[36:39]
  ds_read_b64_tr_b16 a[206:207], v17 offset:2048
  ds_read_b64_tr_b16 a[208:209], v14 offset:4096
  v_mfma_f32_16x16x32_bf16 v[40:43], a[64:67], a[4:7], v[68:71]
  v_exp_f32 v58, v58
  v_mfma_f32_16x16x32_bf16 v[40:43], a[68:71], a[20:23], v[40:43]
  ds_read_b64_tr_b16 a[210:211], v14 offset:6144
  v_cvt_pk_bf16_f32 v108, v56, v57
  v_mfma_f32_16x16x32_bf16 v[40:43], a[72:75], a[36:39], v[40:43]
  v_exp_f32 v59, v59
  v_mfma_f32_16x16x32_bf16 v[40:43], a[76:79], a[52:55], v[40:43]
  v_exp_f32 v60, v60
  v_mfma_f32_16x16x32_bf16 v[44:47], a[80:83], a[4:7], v[68:71]
  buffer_load_dwordx4 v11, s[8:11], s20 offen offset:3072 lds
  v_mfma_f32_16x16x32_bf16 v[44:47], a[84:87], a[20:23], v[44:47]
  ds_read_b64_tr_b16 a[212:213], v15 offset:4096
  v_cvt_pk_bf16_f32 v109, v58, v59
  v_mfma_f32_16x16x32_bf16 v[44:47], a[88:91], a[36:39], v[44:47]
  v_exp_f32 v61, v61
  v_mfma_f32_16x16x32_bf16 v[44:47], a[92:95], a[52:55], v[44:47]
  v_exp_f32 v62, v62
  v_mfma_f32_16x16x32_bf16 v[136:139], a[96:99], v[104:107], v[136:139]
  ds_read_b64_tr_b16 a[214:215], v15 offset:6144
  v_cvt_pk_bf16_f32 v110, v60, v61
  v_mfma_f32_16x16x32_bf16 v[152:155], a[100:103], v[104:107], v[152:155]
  v_exp_f32 v63, v63
  v_mfma_f32_16x16x32_bf16 v[168:171], a[104:107], v[104:107], v[168:171]
  ds_read_b64_tr_b16 a[216:217], v16 offset:4096
  v_cvt_pk_bf16_f32 v111, v62, v63
  v_mfma_f32_16x16x32_bf16 v[184:187], a[108:111], v[104:107], v[184:187]
  ds_read_b64_tr_b16 a[218:219], v16 offset:6144
  v_mfma_f32_16x16x32_bf16 v[200:203], a[112:115], v[104:107], v[200:203]
  s_add_u32 m0, s21, 81920
  v_exp_f32 v32, v32
  v_mfma_f32_16x16x32_bf16 v[216:219], a[116:119], v[104:107], v[216:219]
  buffer_load_dwordx4 v12, s[12:15], s20 offen lds
  v_mfma_f32_16x16x32_bf16 v[232:235], a[120:123], v[104:107], v[232:235]
  v_exp_f32 v33, v33
  v_mfma_f32_16x16x32_bf16 v[248:251], a[124:127], v[104:107], v[248:251]
  ds_read_b64_tr_b16 a[220:221], v17 offset:4096
  ds_read_b64_tr_b16 a[222:223], v17 offset:6144
  v_mfma_f32_16x16x32_bf16 v[88:91], v[112:115], v[104:107], v[88:91]
  v_exp_f32 v34, v34
  v_mfma_f32_16x16x32_bf16 v[140:143], a[96:99], v[108:111], v[140:143]
  v_cvt_pk_bf16_f32 v96, v32, v33
  v_mfma_f32_16x16x32_bf16 v[156:159], a[100:103], v[108:111], v[156:159]
  v_exp_f32 v35, v35
  v_mfma_f32_16x16x32_bf16 v[172:175], a[104:107], v[108:111], v[172:175]
  buffer_load_dwordx4 v13, s[12:15], s20 offen offset:1024 lds
  v_mfma_f32_16x16x32_bf16 v[188:191], a[108:111], v[108:111], v[188:191]
  ds_read_b64_tr_b16 a[96:97], v120
  ds_read_b64_tr_b16 a[98:99], v120 offset:4096
  v_mfma_f32_16x16x32_bf16 v[204:207], a[112:115], v[108:111], v[204:207]
  v_exp_f32 v36, v36
  v_mfma_f32_16x16x32_bf16 v[220:223], a[116:119], v[108:111], v[220:223]
  ds_read_b64_tr_b16 a[100:101], v121
  v_cvt_pk_bf16_f32 v97, v34, v35
  v_mfma_f32_16x16x32_bf16 v[236:239], a[120:123], v[108:111], v[236:239]
  v_exp_f32 v37, v37
  v_mfma_f32_16x16x32_bf16 v[252:255], a[124:127], v[108:111], v[252:255]
  ds_read_b64_tr_b16 a[102:103], v121 offset:4096
  ds_read_b64_tr_b16 a[104:105], v122
  v_mfma_f32_16x16x32_bf16 v[92:95], v[112:115], v[108:111], v[92:95]
  buffer_load_dwordx4 v12, s[12:15], s20 offen offset:2048 lds
  v_mfma_f32_16x16x32_bf16 v[48:51], a[64:67], a[8:11], v[72:75]
  v_exp_f32 v38, v38
  v_mfma_f32_16x16x32_bf16 v[48:51], a[68:71], a[24:27], v[48:51]
  ds_read_b64_tr_b16 a[106:107], v122 offset:4096
  v_cvt_pk_bf16_f32 v98, v36, v37
  v_mfma_f32_16x16x32_bf16 v[48:51], a[72:75], a[40:43], v[48:51]
  v_exp_f32 v39, v39
  v_mfma_f32_16x16x32_bf16 v[48:51], a[76:79], a[56:59], v[48:51]
  v_exp_f32 v40, v40
  v_mfma_f32_16x16x32_bf16 v[52:55], a[80:83], a[8:11], v[72:75]
  ds_read_b64_tr_b16 a[108:109], v123
  v_cvt_pk_bf16_f32 v99, v38, v39
  v_mfma_f32_16x16x32_bf16 v[52:55], a[84:87], a[24:27], v[52:55]
  buffer_load_dwordx4 v13, s[12:15], s20 offen offset:3072 lds
  s_add_u32 s20, s20, 16384
  v_mfma_f32_16x16x32_bf16 v[52:55], a[88:91], a[40:43], v[52:55]
  ds_read_b64_tr_b16 a[110:111], v123 offset:4096
  ds_read_b64_tr_b16 a[112:113], v124
  v_mfma_f32_16x16x32_bf16 v[52:55], a[92:95], a[56:59], v[52:55]
  v_exp_f32 v41, v41
  v_mfma_f32_16x16x32_bf16 v[56:59], a[64:67], a[12:15], v[76:79]
  v_exp_f32 v42, v42
  v_mfma_f32_16x16x32_bf16 v[56:59], a[68:71], a[28:31], v[56:59]
  ds_read_b64_tr_b16 a[114:115], v124 offset:4096
  v_cvt_pk_bf16_f32 v100, v40, v41
  v_mfma_f32_16x16x32_bf16 v[56:59], a[72:75], a[44:47], v[56:59]
  ds_read_b64_tr_b16 a[116:117], v125
  ds_read_b64_tr_b16 a[118:119], v125 offset:4096
  v_mfma_f32_16x16x32_bf16 v[56:59], a[76:79], a[60:63], v[56:59]
  v_exp_f32 v43, v43
  v_mfma_f32_16x16x32_bf16 v[60:63], a[80:83], a[12:15], v[76:79]
  v_exp_f32 v44, v44
  v_mfma_f32_16x16x32_bf16 v[60:63], a[84:87], a[28:31], v[60:63]
  ds_read_b64_tr_b16 a[120:121], v126
  v_cvt_pk_bf16_f32 v101, v42, v43
  v_mfma_f32_16x16x32_bf16 v[60:63], a[88:91], a[44:47], v[60:63]
  v_exp_f32 v45, v45
  v_mfma_f32_16x16x32_bf16 v[60:63], a[92:95], a[60:63], v[60:63]
  s_waitcnt lgkmcnt(15)
  ds_read_b64_tr_b16 a[122:123], v126 offset:4096
  ds_read_b64_tr_b16 a[124:125], v127
  v_mfma_f32_16x16x32_bf16 a[128:131], a[192:195], a[208:211], a[128:131]
  v_exp_f32 v46, v46
  v_mfma_f32_16x16x32_bf16 a[132:135], a[192:195], a[212:215], a[132:135]
  ds_read_b64_tr_b16 a[126:127], v127 offset:4096
  v_cvt_pk_bf16_f32 v102, v44, v45
  v_mfma_f32_16x16x32_bf16 a[136:139], a[192:195], a[216:219], a[136:139]
  s_waitcnt lgkmcnt(15)
  v_exp_f32 v47, v47
  v_mfma_f32_16x16x32_bf16 a[140:143], a[192:195], a[220:223], a[140:143]
  v_cvt_pk_bf16_f32 v103, v46, v47
  v_mfma_f32_16x16x32_bf16 a[144:147], a[196:199], a[208:211], a[144:147]
  v_exp_f32 v48, v48
  v_mfma_f32_16x16x32_bf16 a[148:151], a[196:199], a[212:215], a[148:151]
  v_exp_f32 v49, v49
  v_mfma_f32_16x16x32_bf16 a[152:155], a[196:199], a[216:219], a[152:155]
  v_exp_f32 v50, v50
  v_mfma_f32_16x16x32_bf16 a[156:159], a[196:199], a[220:223], a[156:159]
  s_waitcnt lgkmcnt(14)
  ds_read_b128 a[64:67], v116 offset:8192
  v_xor_b32 v14, 8192, v14
  v_mfma_f32_16x16x32_bf16 v[128:131], a[96:99], v[96:99], v[128:131]
  s_waitcnt lgkmcnt(13)
  v_xor_b32 v15, 8192, v15
  v_xor_b32 v16, 8192, v16
  v_mfma_f32_16x16x32_bf16 v[144:147], a[100:103], v[96:99], v[144:147]
  s_waitcnt lgkmcnt(11)
  v_xor_b32 v17, 8192, v17
  v_cvt_pk_bf16_f32 v104, v48, v49
  v_mfma_f32_16x16x32_bf16 v[160:163], a[104:107], v[96:99], v[160:163]
  s_waitcnt lgkmcnt(9)
  ds_read_b128 a[68:71], v117 offset:8192
  v_mfma_f32_16x16x32_bf16 v[176:179], a[108:111], v[96:99], v[176:179]
  s_waitcnt lgkmcnt(8)
  v_exp_f32 v51, v51
  v_mfma_f32_16x16x32_bf16 v[192:195], a[112:115], v[96:99], v[192:195]
  s_waitcnt lgkmcnt(6)
  ds_read_b128 a[72:75], v118 offset:8192
  v_mfma_f32_16x16x32_bf16 v[208:211], a[116:119], v[96:99], v[208:211]
  s_waitcnt lgkmcnt(5)
  v_exp_f32 v52, v52
  v_mfma_f32_16x16x32_bf16 v[224:227], a[120:123], v[96:99], v[224:227]
  s_waitcnt lgkmcnt(3)
  ds_read_b128 a[76:79], v119 offset:8192
  v_cvt_pk_bf16_f32 v105, v50, v51
  v_mfma_f32_16x16x32_bf16 v[240:243], a[124:127], v[96:99], v[240:243]
  v_exp_f32 v53, v53
  v_mfma_f32_16x16x32_bf16 v[80:83], v[112:115], v[96:99], v[80:83]
  ds_read_b128 a[80:83], v116 offset:12288
  v_mfma_f32_16x16x32_bf16 v[132:135], a[96:99], v[100:103], v[132:135]
  v_exp_f32 v54, v54
  v_mfma_f32_16x16x32_bf16 v[148:151], a[100:103], v[100:103], v[148:151]
  ds_read_b128 a[84:87], v117 offset:12288
  v_cvt_pk_bf16_f32 v106, v52, v53
  v_mfma_f32_16x16x32_bf16 v[164:167], a[104:107], v[100:103], v[164:167]
  v_mfma_f32_16x16x32_bf16 v[180:183], a[108:111], v[100:103], v[180:183]
  v_exp_f32 v55, v55
  v_mfma_f32_16x16x32_bf16 v[196:199], a[112:115], v[100:103], v[196:199]
  ds_read_b128 a[88:91], v118 offset:12288
  v_mfma_f32_16x16x32_bf16 v[212:215], a[116:119], v[100:103], v[212:215]
  v_exp_f32 v56, v56
  v_mfma_f32_16x16x32_bf16 v[228:231], a[120:123], v[100:103], v[228:231]
  ds_read_b128 a[92:95], v119 offset:12288
  v_cvt_pk_bf16_f32 v107, v54, v55
  v_mfma_f32_16x16x32_bf16 v[244:247], a[124:127], v[100:103], v[244:247]
  s_cmp_gt_u32 s38, 13
  s_cselect_b32 s37, 0x30000, 0
  s_add_u32 s38, s38, 1
  s_max_u32 s5, s40, s37
  v_mfma_f32_16x16x32_bf16 v[84:87], v[112:115], v[100:103], v[84:87]
  s_waitcnt lgkmcnt(7)
  s_mov_b32 m0, s5
  v_exp_f32 v57, v57
  v_mfma_f32_16x16x32_bf16 v[32:35], a[64:67], a[0:3], v[64:67]
  s_waitcnt lgkmcnt(6)
  buffer_load_dwordx4 v18, s[48:51], s39 offen lds
  v_mfma_f32_16x16x32_bf16 v[32:35], a[68:71], a[16:19], v[32:35]
  s_waitcnt lgkmcnt(5)
  v_exp_f32 v58, v58
  v_mfma_f32_16x16x32_bf16 v[32:35], a[72:75], a[32:35], v[32:35]
  s_waitcnt lgkmcnt(4)
  v_cvt_pk_bf16_f32 v108, v56, v57
  v_mfma_f32_16x16x32_bf16 v[32:35], a[76:79], a[48:51], v[32:35]
  s_waitcnt lgkmcnt(3)
  v_mfma_f32_16x16x32_bf16 v[36:39], a[80:83], a[0:3], v[64:67]
  s_waitcnt lgkmcnt(2)
  v_exp_f32 v59, v59
  v_mfma_f32_16x16x32_bf16 v[36:39], a[84:87], a[16:19], v[36:39]
  s_waitcnt lgkmcnt(1)
  v_mfma_f32_16x16x32_bf16 v[36:39], a[88:91], a[32:35], v[36:39]
  s_waitcnt lgkmcnt(0)
  buffer_load_dwordx4 v19, s[48:51], s39 offen offset:1024 lds
  v_mfma_f32_16x16x32_bf16 v[36:39], a[92:95], a[48:51], v[36:39]
  v_exp_f32 v60, v60
  v_mfma_f32_16x16x32_bf16 v[40:43], a[64:67], a[4:7], v[68:71]
  v_cvt_pk_bf16_f32 v109, v58, v59
  v_mfma_f32_16x16x32_bf16 v[40:43], a[68:71], a[20:23], v[40:43]
  v_exp_f32 v61, v61
  v_mfma_f32_16x16x32_bf16 v[40:43], a[72:75], a[36:39], v[40:43]
  v_mfma_f32_16x16x32_bf16 v[40:43], a[76:79], a[52:55], v[40:43]
  v_exp_f32 v62, v62
  v_mfma_f32_16x16x32_bf16 v[44:47], a[80:83], a[4:7], v[68:71]
  buffer_load_dwordx4 v20, s[48:51], s39 offen offset:2048 lds
  v_mfma_f32_16x16x32_bf16 v[44:47], a[84:87], a[20:23], v[44:47]
  v_cvt_pk_bf16_f32 v110, v60, v61
  v_mfma_f32_16x16x32_bf16 v[44:47], a[88:91], a[36:39], v[44:47]
  v_mfma_f32_16x16x32_bf16 v[44:47], a[92:95], a[52:55], v[44:47]
  v_exp_f32 v63, v63
  v_mfma_f32_16x16x32_bf16 a[160:163], a[200:203], a[208:211], a[160:163]
  v_cvt_pk_bf16_f32 v111, v62, v63
  v_mfma_f32_16x16x32_bf16 a[164:167], a[200:203], a[212:215], a[164:167]
  v_mfma_f32_16x16x32_bf16 a[168:171], a[200:203], a[216:219], a[168:171]
  v_mfma_f32_16x16x32_bf16 a[172:175], a[200:203], a[220:223], a[172:175]
  buffer_load_dwordx4 v21, s[48:51], s39 offen offset:3072 lds
  v_mfma_f32_16x16x32_bf16 a[176:179], a[204:207], a[208:211], a[176:179]
  v_exp_f32 v32, v32
  v_mfma_f32_16x16x32_bf16 a[180:183], a[204:207], a[212:215], a[180:183]
  v_exp_f32 v33, v33
  v_mfma_f32_16x16x32_bf16 a[184:187], a[204:207], a[216:219], a[184:187]
  v_exp_f32 v34, v34
  v_mfma_f32_16x16x32_bf16 a[188:191], a[204:207], a[220:223], a[188:191]
  s_add_u32 s39, s39, 114688
  v_cvt_pk_bf16_f32 v96, v32, v33
  v_mfma_f32_16x16x32_bf16 v[136:139], a[96:99], v[104:107], v[136:139]
  s_add_u32 m0, s5, 4096
  v_mfma_f32_16x16x32_bf16 v[152:155], a[100:103], v[104:107], v[152:155]
  buffer_load_dwordx4 v22, s[16:19], s36 offen sc1 lds
  v_mfma_f32_16x16x32_bf16 v[168:171], a[104:107], v[104:107], v[168:171]
  v_exp_f32 v35, v35
  v_mfma_f32_16x16x32_bf16 v[184:187], a[108:111], v[104:107], v[184:187]
  v_exp_f32 v36, v36
  v_mfma_f32_16x16x32_bf16 v[200:203], a[112:115], v[104:107], v[200:203]
  v_mfma_f32_16x16x32_bf16 v[216:219], a[116:119], v[104:107], v[216:219]
  v_cvt_pk_bf16_f32 v97, v34, v35
  v_mfma_f32_16x16x32_bf16 v[232:235], a[120:123], v[104:107], v[232:235]
  v_mfma_f32_16x16x32_bf16 v[248:251], a[124:127], v[104:107], v[248:251]
  buffer_load_dwordx4 v23, s[16:19], s36 offen offset:1024 sc1 lds
  v_mfma_f32_16x16x32_bf16 v[88:91], v[112:115], v[104:107], v[88:91]
  v_exp_f32 v37, v37
  v_mfma_f32_16x16x32_bf16 v[140:143], a[96:99], v[108:111], v[140:143]
  v_exp_f32 v38, v38
  v_mfma_f32_16x16x32_bf16 v[156:159], a[100:103], v[108:111], v[156:159]
  ds_read_b64_tr_b16 a[96:97], v120 offset:8192
  ds_read_b64_tr_b16 a[98:99], v120 offset:12288
  v_mfma_f32_16x16x32_bf16 v[172:175], a[104:107], v[108:111], v[172:175]
  ds_read_b64_tr_b16 a[100:101], v121 offset:8192
  v_cvt_pk_bf16_f32 v98, v36, v37
  v_mfma_f32_16x16x32_bf16 v[188:191], a[108:111], v[108:111], v[188:191]
  ds_read_b64_tr_b16 a[102:103], v121 offset:12288
  v_mfma_f32_16x16x32_bf16 v[204:207], a[112:115], v[108:111], v[204:207]
  buffer_load_dwordx4 v24, s[16:19], s36 offen offset:2048 sc1 lds
  v_mfma_f32_16x16x32_bf16 v[220:223], a[116:119], v[108:111], v[220:223]
  v_exp_f32 v39, v39
  v_mfma_f32_16x16x32_bf16 v[236:239], a[120:123], v[108:111], v[236:239]
  ds_read_b64_tr_b16 a[104:105], v122 offset:8192
  ds_read_b64_tr_b16 a[106:107], v122 offset:12288
  v_mfma_f32_16x16x32_bf16 v[252:255], a[124:127], v[108:111], v[252:255]
  v_exp_f32 v40, v40
  v_mfma_f32_16x16x32_bf16 v[92:95], v[112:115], v[108:111], v[92:95]
  ds_read_b64_tr_b16 a[108:109], v123 offset:8192
  v_cvt_pk_bf16_f32 v99, v38, v39
  v_mfma_f32_16x16x32_bf16 v[48:51], a[64:67], a[8:11], v[72:75]
  ds_read_b64_tr_b16 a[110:111], v123 offset:12288
  ds_read_b64_tr_b16 a[112:113], v124 offset:8192
  v_mfma_f32_16x16x32_bf16 v[48:51], a[68:71], a[24:27], v[48:51]
  v_exp_f32 v41, v41
  v_mfma_f32_16x16x32_bf16 v[48:51], a[72:75], a[40:43], v[48:51]
  buffer_load_dwordx4 v25, s[16:19], s36 offen offset:3072 sc1 lds
  v_mfma_f32_16x16x32_bf16 v[48:51], a[76:79], a[56:59], v[48:51]
  ds_read_b64_tr_b16 a[114:115], v124 offset:12288
  ds_read_b64_tr_b16 a[116:117], v125 offset:8192
  v_mfma_f32_16x16x32_bf16 v[52:55], a[80:83], a[8:11], v[72:75]
  v_exp_f32 v42, v42
  v_mfma_f32_16x16x32_bf16 v[52:55], a[84:87], a[24:27], v[52:55]
  ds_read_b64_tr_b16 a[118:119], v125 offset:12288
  v_cvt_pk_bf16_f32 v100, v40, v41
  v_mfma_f32_16x16x32_bf16 v[52:55], a[88:91], a[40:43], v[52:55]
  s_add_u32 s36, s36, 32768
  ds_read_b64_tr_b16 a[120:121], v126 offset:8192
  ds_read_b64_tr_b16 a[122:123], v126 offset:12288
  v_mfma_f32_16x16x32_bf16 v[52:55], a[92:95], a[56:59], v[52:55]
  v_exp_f32 v43, v43
  v_mfma_f32_16x16x32_bf16 v[56:59], a[64:67], a[12:15], v[76:79]
  ds_read_b64_tr_b16 a[124:125], v127 offset:8192
  ds_read_b64_tr_b16 a[126:127], v127 offset:12288
  v_mfma_f32_16x16x32_bf16 v[56:59], a[68:71], a[28:31], v[56:59]
  v_exp_f32 v44, v44
  v_mfma_f32_16x16x32_bf16 v[56:59], a[72:75], a[44:47], v[56:59]
  v_cvt_pk_bf16_f32 v101, v42, v43
  v_mfma_f32_16x16x32_bf16 v[56:59], a[76:79], a[60:63], v[56:59]
  v_exp_f32 v45, v45
  v_mfma_f32_16x16x32_bf16 v[60:63], a[80:83], a[12:15], v[76:79]
  v_exp_f32 v46, v46
  v_mfma_f32_16x16x32_bf16 v[60:63], a[84:87], a[28:31], v[60:63]
  v_mfma_f32_16x16x32_bf16 v[60:63], a[88:91], a[44:47], v[60:63]
  v_mfma_f32_16x16x32_bf16 v[60:63], a[92:95], a[60:63], v[60:63]
  s_xor_b32 s40, s40, 8192
  s_waitcnt vmcnt(16) lgkmcnt(0)
  s_barrier
  s_sub_u32 s4, s4, 1
  s_cmp_lg_u32 s4, 0
  s_cbranch_scc1 L_k3_loopA
  s_mov_b32 s28, s96
  s_mov_b32 s29, s97
  s_mov_b32 s30, 3584
  s_mov_b32 s31, 131072
  v_mfma_f32_16x16x32_bf16 v[128:131], a[96:99], v[96:99], v[128:131]
  ds_read_b128 a[64:67], v116 offset:16384
  v_cvt_pk_bf16_f32 v102, v44, v45
  v_mfma_f32_16x16x32_bf16 v[144:147], a[100:103], v[96:99], v[144:147]
  v_exp_f32 v47, v47
  v_mfma_f32_16x16x32_bf16 v[160:163], a[104:107], v[96:99], v[160:163]
  ds_read_b128 a[68:71], v117 offset:16384
  v_cvt_pk_bf16_f32 v103, v46, v47
  v_mfma_f32_16x16x32_bf16 v[176:179], a[108:111], v[96:99], v[176:179]
  ds_read_b128 a[72:75], v118 offset:16384
  v_mfma_f32_16x16x32_bf16 v[192:195], a[112:115], v[96:99], v[192:195]
  v_exp_f32 v48, v48
  v_mfma_f32_16x16x32_bf16 v[208:211], a[116:119], v[96:99], v[208:211]
  v_exp_f32 v49, v49
  v_mfma_f32_16x16x32_bf16 v[224:227], a[120:123], v[96:99], v[224:227]
  ds_read_b128 a[76:79], v119 offset:16384
  v_mfma_f32_16x16x32_bf16 v[240:243], a[124:127], v[96:99], v[240:243]
  s_lshl_b32 s44, s46, 7
  v_lshrrev_b32 v1, 4, v0
  v_lshlrev_b32 v1, 3, v1
  v_mfma_f32_16x16x32_bf16 v[80:83], v[112:115], v[96:99], v[80:83]
  v_exp_f32 v50, v50
  v_mfma_f32_16x16x32_bf16 v[132:135], a[96:99], v[100:103], v[132:135]
  buffer_load_dwordx2 a[192:193], v1, s[28:31], s44 offen
  v_mfma_f32_16x16x32_bf16 v[148:151], a[100:103], v[100:103], v[148:151]
  ds_read_b128 a[80:83], v116 offset:20480
  v_cvt_pk_bf16_f32 v104, v48, v49
  v_mfma_f32_16x16x32_bf16 v[164:167], a[104:107], v[100:103], v[164:167]
  buffer_load_dwordx2 a[194:195], v1, s[28:31], s44 offen offset:32
  v_mfma_f32_16x16x32_bf16 v[180:183], a[108:111], v[100:103], v[180:183]
  v_exp_f32 v51, v51
  v_mfma_f32_16x16x32_bf16 v[196:199], a[112:115], v[100:103], v[196:199]
  buffer_load_dwordx2 a[196:197], v1, s[28:31], s44 offen offset:64
  v_mfma_f32_16x16x32_bf16 v[212:215], a[116:119], v[100:103], v[212:215]
  ds_read_b128 a[84:87], v117 offset:20480
  v_exp_f32 v52, v52
  v_mfma_f32_16x16x32_bf16 v[228:231], a[120:123], v[100:103], v[228:231]
  buffer_load_dwordx2 a[198:199], v1, s[28:31], s44 offen offset:96
  v_cvt_pk_bf16_f32 v105, v50, v51
  v_mfma_f32_16x16x32_bf16 v[244:247], a[124:127], v[100:103], v[244:247]
  ds_read_b128 a[88:91], v118 offset:20480
  v_lshlrev_b32 v27, 4, v0
  v_exp_f32 v53, v53
  v_mfma_f32_16x16x32_bf16 v[84:87], v[112:115], v[100:103], v[84:87]
  s_waitcnt lgkmcnt(6)
  v_exp_f32 v54, v54
  v_mfma_f32_16x16x32_bf16 v[32:35], a[64:67], a[0:3], v[64:67]
  s_waitcnt lgkmcnt(5)
  s_mul_i32 s44, s47, 224
  s_mul_i32 s45, s24, 56
  s_add_u32 s44, s44, s45
  s_add_u32 m0, s21, 0
  ds_read_b128 a[92:95], v119 offset:20480
  v_cvt_pk_bf16_f32 v106, v52, v53
  v_mfma_f32_16x16x32_bf16 v[32:35], a[68:71], a[16:19], v[32:35]
  s_waitcnt lgkmcnt(5)
  buffer_load_dwordx4 v8, s[8:11], s20 offen lds
  v_mfma_f32_16x16x32_bf16 v[32:35], a[72:75], a[32:35], v[32:35]
  s_waitcnt lgkmcnt(4)
  v_add_u32 v26, s27, v27
  v_add_u32 v2, s44, v0
  v_mfma_f32_16x16x32_bf16 v[32:35], a[76:79], a[48:51], v[32:35]
  s_waitcnt lgkmcnt(3)
  v_exp_f32 v55, v55
  v_mfma_f32_16x16x32_bf16 v[36:39], a[80:83], a[0:3], v[64:67]
  s_waitcnt lgkmcnt(2)
  v_exp_f32 v56, v56
  v_mfma_f32_16x16x32_bf16 v[36:39], a[84:87], a[16:19], v[36:39]
  s_waitcnt lgkmcnt(1)
  s_lshl_b32 s45, s46, 7
  v_lshlrev_b32 v2, 12, v2
  v_cvt_pk_bf16_f32 v107, v54, v55
  v_mfma_f32_16x16x32_bf16 v[36:39], a[88:91], a[32:35], v[36:39]
  s_waitcnt lgkmcnt(0)
  buffer_load_dword a200, v2, s[52:55], s45 offen
  v_mfma_f32_16x16x32_bf16 v[36:39], a[92:95], a[48:51], v[36:39]
  ds_write_b128 v26, a[128:131]
  ds_write_b128 v26, a[132:135] offset:1024
  v_exp_f32 v57, v57
  v_mfma_f32_16x16x32_bf16 v[40:43], a[64:67], a[4:7], v[68:71]
  buffer_load_dwordx4 v9, s[8:11], s20 offen offset:1024 lds
  v_mfma_f32_16x16x32_bf16 v[40:43], a[68:71], a[20:23], v[40:43]
  v_exp_f32 v58, v58
  v_mfma_f32_16x16x32_bf16 v[40:43], a[72:75], a[36:39], v[40:43]
  v_cvt_pk_bf16_f32 v108, v56, v57
  v_mfma_f32_16x16x32_bf16 v[40:43], a[76:79], a[52:55], v[40:43]
  buffer_load_dwordx4 v10, s[8:11], s20 offen offset:2048 lds
  v_mfma_f32_16x16x32_bf16 v[44:47], a[80:83], a[4:7], v[68:71]
  v_exp_f32 v59, v59
  v_mfma_f32_16x16x32_bf16 v[44:47], a[84:87], a[20:23], v[44:47]
  v_exp_f32 v60, v60
  v_mfma_f32_16x16x32_bf16 v[44:47], a[88:91], a[36:39], v[44:47]
  ds_write_b128 v26, a[136:139] offset:2048
  v_cvt_pk_bf16_f32 v109, v58, v59
  v_mfma_f32_16x16x32_bf16 v[44:47], a[92:95], a[52:55], v[44:47]
  v_exp_f32 v61, v61
  v_mfma_f32_16x16x32_bf16 v[136:139], a[96:99], v[104:107], v[136:139]
  buffer_load_dwordx4 v11, s[8:11], s20 offen offset:3072 lds
  v_mfma_f32_16x16x32_bf16 v[152:155], a[100:103], v[104:107], v[152:155]
  v_exp_f32 v62, v62
  v_mfma_f32_16x16x32_bf16 v[168:171], a[104:107], v[104:107], v[168:171]
  ds_write_b128 v26, a[140:143] offset:3072
  v_cvt_pk_bf16_f32 v110, v60, v61
  v_mfma_f32_16x16x32_bf16 v[184:187], a[108:111], v[104:107], v[184:187]
  v_exp_f32 v63, v63
  v_mfma_f32_16x16x32_bf16 v[200:203], a[112:115], v[104:107], v[200:203]
  ds_write_b128 v26, a[144:147] offset:4096
  v_cvt_pk_bf16_f32 v111, v62, v63
  v_mfma_f32_16x16x32_bf16 v[216:219], a[116:119], v[104:107], v[216:219]
  v_exp_f32 v32, v32
  v_mfma_f32_16x16x32_bf16 v[232:235], a[120:123], v[104:107], v[232:235]
  v_exp_f32 v33, v33
  v_mfma_f32_16x16x32_bf16 v[248:251], a[124:127], v[104:107], v[248:251]
  v_exp_f32 v34, v34
  v_mfma_f32_16x16x32_bf16 v[88:91], v[112:115], v[104:107], v[88:91]
  ds_write_b128 v26, a[148:151] offset:5120
  v_cvt_pk_bf16_f32 v96, v32, v33
  v_mfma_f32_16x16x32_bf16 v[140:143], a[96:99], v[108:111], v[140:143]
  v_exp_f32 v35, v35
  v_mfma_f32_16x16x32_bf16 v[156:159], a[100:103], v[108:111], v[156:159]
  ds_read_b64_tr_b16 a[96:97], v120 offset:16384
  ds_read_b64_tr_b16 a[98:99], v120 offset:20480
  v_mfma_f32_16x16x32_bf16 v[172:175], a[104:107], v[108:111], v[172:175]
  v_exp_f32 v36, v36
  v_mfma_f32_16x16x32_bf16 v[188:191], a[108:111], v[108:111], v[188:191]
  ds_read_b64_tr_b16 a[100:101], v121 offset:16384
  v_cvt_pk_bf16_f32 v97, v34, v35
  v_mfma_f32_16x16x32_bf16 v[204:207], a[112:115], v[108:111], v[204:207]
  ds_read_b64_tr_b16 a[102:103], v121 offset:20480
  ds_write_b128 v26, a[152:155] offset:6144
  v_mfma_f32_16x16x32_bf16 v[220:223], a[116:119], v[108:111], v[220:223]
  v_exp_f32 v37, v37
  v_mfma_f32_16x16x32_bf16 v[236:239], a[120:123], v[108:111], v[236:239]
  ds_read_b64_tr_b16 a[104:105], v122 offset:16384
  ds_read_b64_tr_b16 a[106:107], v122 offset:20480
  v_mfma_f32_16x16x32_bf16 v[252:255], a[124:127], v[108:111], v[252:255]
  v_exp_f32 v38, v38
  v_mfma_f32_16x16x32_bf16 v[92:95], v[112:115], v[108:111], v[92:95]
  ds_read_b64_tr_b16 a[108:109], v123 offset:16384
  v_cvt_pk_bf16_f32 v98, v36, v37
  v_mfma_f32_16x16x32_bf16 v[48:51], a[64:67], a[8:11], v[72:75]
  ds_read_b64_tr_b16 a[110:111], v123 offset:20480
  ds_write_b128 v26, a[156:159] offset:7168
  v_mfma_f32_16x16x32_bf16 v[48:51], a[68:71], a[24:27], v[48:51]
  v_exp_f32 v39, v39
  v_mfma_f32_16x16x32_bf16 v[48:51], a[72:75], a[40:43], v[48:51]
  ds_read_b64_tr_b16 a[112:113], v124 offset:16384
  ds_read_b64_tr_b16 a[114:115], v124 offset:20480
  v_mfma_f32_16x16x32_bf16 v[48:51], a[76:79], a[56:59], v[48:51]
  v_exp_f32 v40, v40
  v_mfma_f32_16x16x32_bf16 v[52:55], a[80:83], a[8:11], v[72:75]
  ds_read_b64_tr_b16 a[116:117], v125 offset:16384
  v_cvt_pk_bf16_f32 v99, v38, v39
  v_mfma_f32_16x16x32_bf16 v[52:55], a[84:87], a[24:27], v[52:55]
  ds_read_b64_tr_b16 a[118:119], v125 offset:20480
  ds_write_b128 v26, a[160:163] offset:8192
  v_mfma_f32_16x16x32_bf16 v[52:55], a[88:91], a[40:43], v[52:55]
  v_exp_f32 v41, v41
  v_mfma_f32_16x16x32_bf16 v[52:55], a[92:95], a[56:59], v[52:55]
  ds_read_b64_tr_b16 a[120:121], v126 offset:16384
  ds_read_b64_tr_b16 a[122:123], v126 offset:20480
  v_mfma_f32_16x16x32_bf16 v[56:59], a[64:67], a[12:15], v[76:79]
  v_exp_f32 v42, v42
  v_mfma_f32_16x16x32_bf16 v[56:59], a[68:71], a[28:31], v[56:59]
  ds_read_b64_tr_b16 a[124:125], v127 offset:16384
  v_cvt_pk_bf16_f32 v100, v40, v41
  v_mfma_f32_16x16x32_bf16 v[56:59], a[72:75], a[44:47], v[56:59]
  v_exp_f32 v43, v43
  v_mfma_f32_16x16x32_bf16 v[56:59], a[76:79], a[60:63], v[56:59]
  ds_write_b128 v26, a[164:167] offset:9216
  ds_read_b64_tr_b16 a[126:127], v127 offset:20480
  v_mfma_f32_16x16x32_bf16 v[60:63], a[80:83], a[12:15], v[76:79]
  v_exp_f32 v44, v44
  v_mfma_f32_16x16x32_bf16 v[60:63], a[84:87], a[28:31], v[60:63]
  ds_write_b128 v26, a[168:171] offset:10240
  v_cvt_pk_bf16_f32 v101, v42, v43
  v_mfma_f32_16x16x32_bf16 v[60:63], a[88:91], a[44:47], v[60:63]
  v_exp_f32 v45, v45
  v_mfma_f32_16x16x32_bf16 v[60:63], a[92:95], a[60:63], v[60:63]
  s_waitcnt lgkmcnt(15)
  v_exp_f32 v46, v46
  v_mfma_f32_16x16x32_bf16 v[128:131], a[96:99], v[96:99], v[128:131]
  ds_read_b128 a[64:67], v116 offset:24576
  v_cvt_pk_bf16_f32 v102, v44, v45
  v_mfma_f32_16x16x32_bf16 v[144:147], a[100:103], v[96:99], v[144:147]
  s_waitcnt lgkmcnt(15)
  v_exp_f32 v47, v47
  v_mfma_f32_16x16x32_bf16 v[160:163], a[104:107], v[96:99], v[160:163]
  s_waitcnt lgkmcnt(13)
  ds_write_b128 v26, a[172:175] offset:11264
  ds_read_b128 a[68:71], v117 offset:24576
  v_mfma_f32_16x16x32_bf16 v[176:179], a[108:111], v[96:99], v[176:179]
  s_waitcnt lgkmcnt(12)
  ds_read_b128 a[72:75], v118 offset:24576
  v_cvt_pk_bf16_f32 v103, v46, v47
  v_mfma_f32_16x16x32_bf16 v[192:195], a[112:115], v[96:99], v[192:195]
  s_waitcnt lgkmcnt(11)
  v_exp_f32 v48, v48
  v_mfma_f32_16x16x32_bf16 v[208:211], a[116:119], v[96:99], v[208:211]
  s_waitcnt lgkmcnt(8)
  v_exp_f32 v49, v49
  v_mfma_f32_16x16x32_bf16 v[224:227], a[120:123], v[96:99], v[224:227]
  s_waitcnt lgkmcnt(5)
  ds_write_b128 v26, a[176:179] offset:12288
  ds_read_b128 a[76:79], v119 offset:24576
  v_mfma_f32_16x16x32_bf16 v[240:243], a[124:127], v[96:99], v[240:243]
  v_exp_f32 v50, v50
  v_mfma_f32_16x16x32_bf16 v[80:83], v[112:115], v[96:99], v[80:83]
  ds_read_b128 a[80:83], v116 offset:28672
  v_cvt_pk_bf16_f32 v104, v48, v49
  v_mfma_f32_16x16x32_bf16 v[132:135], a[96:99], v[100:103], v[132:135]
  v_exp_f32 v51, v51
  v_mfma_f32_16x16x32_bf16 v[148:151], a[100:103], v[100:103], v[148:151]
  ds_write_b128 v26, a[180:183] offset:13312
  ds_read_b128 a[84:87], v117 offset:28672
  v_mfma_f32_16x16x32_bf16 v[164:167], a[104:107], v[100:103], v[164:167]
  v_exp_f32 v52, v52
  v_mfma_f32_16x16x32_bf16 v[180:183], a[108:111], v[100:103], v[180:183]
  ds_read_b128 a[88:91], v118 offset:28672
  v_cvt_pk_bf16_f32 v105, v50, v51
  v_mfma_f32_16x16x32_bf16 v[196:199], a[112:115], v[100:103], v[196:199]
  v_exp_f32 v53, v53
  v_mfma_f32_16x16x32_bf16 v[212:215], a[116:119], v[100:103], v[212:215]
  ds_write_b128 v26, a[184:187] offset:14336
  ds_read_b128 a[92:95], v119 offset:28672
  v_mfma_f32_16x16x32_bf16 v[228:231], a[120:123], v[100:103], v[228:231]
  v_exp_f32 v54, v54
  v_mfma_f32_16x16x32_bf16 v[244:247], a[124:127], v[100:103], v[244:247]
  v_cvt_pk_bf16_f32 v106, v52, v53
  v_mfma_f32_16x16x32_bf16 v[84:87], v[112:115], v[100:103], v[84:87]
  s_waitcnt lgkmcnt(11)
  v_exp_f32 v55, v55
  v_mfma_f32_16x16x32_bf16 v[32:35], a[64:67], a[0:3], v[64:67]
  s_waitcnt lgkmcnt(9)
  s_add_u32 m0, s21, 49152
  ds_write_b128 v26, a[188:191] offset:15360
  v_mfma_f32_16x16x32_bf16 v[32:35], a[68:71], a[16:19], v[32:35]
  s_waitcnt lgkmcnt(9)
  buffer_load_dwordx4 v12, s[12:15], s20 offen lds
  v_mfma_f32_16x16x32_bf16 v[32:35], a[72:75], a[32:35], v[32:35]
  s_waitcnt lgkmcnt(7)
  v_exp_f32 v56, v56
  v_mfma_f32_16x16x32_bf16 v[32:35], a[76:79], a[48:51], v[32:35]
  s_waitcnt lgkmcnt(6)
  s_lshl_b32 s43, s24, 10
  s_add_u32 s43, s43, 98304
  v_cvt_pk_bf16_f32 v107, v54, v55
  v_add_u32 v27, s43, v27
  v_mfma_f32_16x16x32_bf16 v[36:39], a[80:83], a[0:3], v[64:67]
  s_waitcnt lgkmcnt(4)
  v_exp_f32 v57, v57
  v_mfma_f32_16x16x32_bf16 v[36:39], a[84:87], a[16:19], v[36:39]
  s_waitcnt lgkmcnt(3)
  v_exp_f32 v58, v58
  v_mfma_f32_16x16x32_bf16 v[36:39], a[88:91], a[32:35], v[36:39]
  s_waitcnt lgkmcnt(1)
  v_cvt_pk_bf16_f32 v108, v56, v57
  v_mfma_f32_16x16x32_bf16 v[36:39], a[92:95], a[48:51], v[36:39]
  buffer_load_dwordx4 v13, s[12:15], s20 offen offset:1024 lds
  v_mfma_f32_16x16x32_bf16 v[40:43], a[64:67], a[4:7], v[68:71]
  v_exp_f32 v59, v59
  v_mfma_f32_16x16x32_bf16 v[40:43], a[68:71], a[20:23], v[40:43]
  v_exp_f32 v60, v60
  v_mfma_f32_16x16x32_bf16 v[40:43], a[72:75], a[36:39], v[40:43]
  v_cvt_pk_bf16_f32 v109, v58, v59
  v_mfma_f32_16x16x32_bf16 v[40:43], a[76:79], a[52:55], v[40:43]
  buffer_load_dwordx4 v12, s[12:15], s20 offen offset:2048 lds
  v_mfma_f32_16x16x32_bf16 v[44:47], a[80:83], a[4:7], v[68:71]
  v_exp_f32 v61, v61
  v_mfma_f32_16x16x32_bf16 v[44:47], a[84:87], a[20:23], v[44:47]
  v_exp_f32 v62, v62
  v_mfma_f32_16x16x32_bf16 v[44:47], a[88:91], a[36:39], v[44:47]
  v_cvt_pk_bf16_f32 v110, v60, v61
  v_mfma_f32_16x16x32_bf16 v[44:47], a[92:95], a[52:55], v[44:47]
  v_exp_f32 v63, v63
  v_mfma_f32_16x16x32_bf16 v[136:139], a[96:99], v[104:107], v[136:139]
  buffer_load_dwordx4 v13, s[12:15], s20 offen offset:3072 lds
  s_add_u32 s20, s20, 16384
  v_mfma_f32_16x16x32_bf16 v[152:155], a[100:103], v[104:107], v[152:155]
  v_cvt_pk_bf16_f32 v111, v62, v63
  v_mfma_f32_16x16x32_bf16 v[168:171], a[104:107], v[104:107], v[168:171]
  v_mfma_f32_16x16x32_bf16 v[184:187], a[108:111], v[104:107], v[184:187]
  v_mfma_f32_16x16x32_bf16 v[200:203], a[112:115], v[104:107], v[200:203]
  v_exp_f32 v32, v32
  v_mfma_f32_16x16x32_bf16 v[216:219], a[116:119], v[104:107], v[216:219]
  v_exp_f32 v33, v33
  v_mfma_f32_16x16x32_bf16 v[232:235], a[120:123], v[104:107], v[232:235]
  v_exp_f32 v34, v34
  v_mfma_f32_16x16x32_bf16 v[248:251], a[124:127], v[104:107], v[248:251]
  v_cvt_pk_bf16_f32 v96, v32, v33
  v_mfma_f32_16x16x32_bf16 v[88:91], v[112:115], v[104:107], v[88:91]
  v_exp_f32 v35, v35
  v_mfma_f32_16x16x32_bf16 v[140:143], a[96:99], v[108:111], v[140:143]
  v_exp_f32 v36, v36
  v_mfma_f32_16x16x32_bf16 v[156:159], a[100:103], v[108:111], v[156:159]
  ds_read_b64_tr_b16 a[96:97], v120 offset:24576
  ds_read_b64_tr_b16 a[98:99], v120 offset:28672
  v_mfma_f32_16x16x32_bf16 v[172:175], a[104:107], v[108:111], v[172:175]
  ds_read_b64_tr_b16 a[100:101], v121 offset:24576
  v_cvt_pk_bf16_f32 v97, v34, v35
  v_mfma_f32_16x16x32_bf16 v[188:191], a[108:111], v[108:111], v[188:191]
  ds_read_b64_tr_b16 a[102:103], v121 offset:28672
  v_mfma_f32_16x16x32_bf16 v[204:207], a[112:115], v[108:111], v[204:207]
  v_exp_f32 v37, v37
  v_mfma_f32_16x16x32_bf16 v[220:223], a[116:119], v[108:111], v[220:223]
  ds_read_b64_tr_b16 a[104:105], v122 offset:24576
  ds_read_b64_tr_b16 a[106:107], v122 offset:28672
  v_mfma_f32_16x16x32_bf16 v[236:239], a[120:123], v[108:111], v[236:239]
  v_exp_f32 v38, v38
  v_mfma_f32_16x16x32_bf16 v[252:255], a[124:127], v[108:111], v[252:255]
  ds_read_b64_tr_b16 a[108:109], v123 offset:24576
  v_cvt_pk_bf16_f32 v98, v36, v37
  v_mfma_f32_16x16x32_bf16 v[92:95], v[112:115], v[108:111], v[92:95]
  ds_read_b64_tr_b16 a[110:111], v123 offset:28672
  ds_read_b64_tr_b16 a[112:113], v124 offset:24576
  v_mfma_f32_16x16x32_bf16 v[48:51], a[64:67], a[8:11], v[72:75]
  v_exp_f32 v39, v39
  v_mfma_f32_16x16x32_bf16 v[48:51], a[68:71], a[24:27], v[48:51]
  v_exp_f32 v40, v40
  v_mfma_f32_16x16x32_bf16 v[48:51], a[72:75], a[40:43], v[48:51]
  ds_read_b64_tr_b16 a[114:115], v124 offset:28672
  v_cvt_pk_bf16_f32 v99, v38, v39
  v_mfma_f32_16x16x32_bf16 v[48:51], a[76:79], a[56:59], v[48:51]
  ds_read_b64_tr_b16 a[116:117], v125 offset:24576
  ds_read_b64_tr_b16 a[118:119], v125 offset:28672
  v_mfma_f32_16x16x32_bf16 v[52:55], a[80:83], a[8:11], v[72:75]
  v_exp_f32 v41, v41
  v_mfma_f32_16x16x32_bf16 v[52:55], a[84:87], a[24:27], v[52:55]
  ds_read_b64_tr_b16 a[120:121], v126 offset:24576
  ds_read_b64_tr_b16 a[122:123], v126 offset:28672
  v_mfma_f32_16x16x32_bf16 v[52:55], a[88:91], a[40:43], v[52:55]
  v_exp_f32 v42, v42
  v_mfma_f32_16x16x32_bf16 v[52:55], a[92:95], a[56:59], v[52:55]
  ds_read_b64_tr_b16 a[124:125], v127 offset:24576
  v_cvt_pk_bf16_f32 v100, v40, v41
  v_mfma_f32_16x16x32_bf16 v[56:59], a[64:67], a[12:15], v[76:79]
  v_exp_f32 v43, v43
  v_mfma_f32_16x16x32_bf16 v[56:59], a[68:71], a[28:31], v[56:59]
  ds_read_b64_tr_b16 a[126:127], v127 offset:28672
  v_mfma_f32_16x16x32_bf16 v[56:59], a[72:75], a[44:47], v[56:59]
  v_exp_f32 v44, v44
  v_mfma_f32_16x16x32_bf16 v[56:59], a[76:79], a[60:63], v[56:59]
  v_cvt_pk_bf16_f32 v101, v42, v43
  v_mfma_f32_16x16x32_bf16 v[60:63], a[80:83], a[12:15], v[76:79]
  v_exp_f32 v45, v45
  v_mfma_f32_16x16x32_bf16 v[60:63], a[84:87], a[28:31], v[60:63]
  v_exp_f32 v46, v46
  v_mfma_f32_16x16x32_bf16 v[60:63], a[88:91], a[44:47], v[60:63]
  v_mfma_f32_16x16x32_bf16 v[60:63], a[92:95], a[60:63], v[60:63]
  s_waitcnt vmcnt(13) lgkmcnt(0)
  s_barrier
  v_mfma_f32_16x16x32_bf16 v[128:131], a[96:99], v[96:99], v[128:131]
  s_mov_b32 s45, 0xbdd2d3e8
  ds_read_b128 a[64:67], v116 offset:32768
  v_cvt_pk_bf16_f32 v102, v44, v45
  v_mfma_f32_16x16x32_bf16 v[144:147], a[100:103], v[96:99], v[144:147]
  s_lshl_b32 s43, s47, 2
  s_add_u32 s43, s43, s24
  s_mul_i32 s43, s43, 56
  s_lshl_b32 s39, s46, 1
  s_add_u32 s43, s43, s39
  s_lshl_b32 s43, s43, 10
  s_add_u32 s43, s43, 4194304
  v_mov_b32 v1, 0xc0135761
  v_lshlrev_b32 v26, 4, v0
  v_mfma_f32_16x16x32_bf16 v[160:163], a[104:107], v[96:99], v[160:163]
  ds_read_b64 v[18:19], v27
  ds_read_b64 v[20:21], v27 offset:16384
  v_mfma_f32_16x16x32_bf16 v[176:179], a[108:111], v[96:99], v[176:179]
  v_exp_f32 v47, v47
  v_mfma_f32_16x16x32_bf16 v[192:195], a[112:115], v[96:99], v[192:195]
  ds_read_b64 v[22:23], v27 offset:32768
  ds_read_b128 a[68:71], v117 offset:32768
  v_mfma_f32_16x16x32_bf16 v[208:211], a[116:119], v[96:99], v[208:211]
  ds_read_b64 v[24:25], v27 offset:49152
  v_cvt_pk_bf16_f32 v103, v46, v47
  v_mfma_f32_16x16x32_bf16 v[224:227], a[120:123], v[96:99], v[224:227]
  ds_read_b64 v[28:29], v27 offset:8
  ds_read_b64 v[30:31], v27 offset:16392
  v_mfma_f32_16x16x32_bf16 v[240:243], a[124:127], v[96:99], v[240:243]
  ds_read_b64 v[2:3], v27 offset:32776
  ds_read_b128 a[72:75], v118 offset:32768
  v_exp_f32 v48, v48
  v_mfma_f32_16x16x32_bf16 v[80:83], v[112:115], v[96:99], v[80:83]
  s_waitcnt vmcnt(12)
  ds_read_b64 v[4:5], v27 offset:49160
  v_accvgpr_read_b32 v6, a192
  v_exp_f32 v49, v49
  v_mfma_f32_16x16x32_bf16 v[132:135], a[96:99], v[100:103], v[132:135]
  s_waitcnt lgkmcnt(5)
  s_waitcnt lgkmcnt(8)
  ds_read_b128 a[76:79], v119 offset:32768
  v_add_f32 v18, v18, v20
  v_add_f32 v24, v24, v22
  v_exp_f32 v50, v50
  v_mfma_f32_16x16x32_bf16 v[148:151], a[100:103], v[100:103], v[148:151]
  v_add_f32 v24, v24, v18
  v_lshlrev_b32 v7, 16, v6
  v_add_f32 v24, v24, v7
  v_mfma_f32_16x16x32_bf16 v[164:167], a[104:107], v[100:103], v[164:167]
  v_cvt_pk_bf16_f32 v104, v48, v49
  v_mul_f32 v7, v24, v24
  v_fma_f32 v7, v7, s45, v1
  v_mfma_f32_16x16x32_bf16 v[180:183], a[108:111], v[100:103], v[180:183]
  ds_read_b128 a[80:83], v116 offset:36864
  v_mul_f32 v7, v7, v24
  v_exp_f32 v51, v51
  v_mfma_f32_16x16x32_bf16 v[196:199], a[112:115], v[100:103], v[196:199]
  v_exp_f32 v7, v7
  s_nop 0
  v_add_f32 v7, 1.0, v7
  v_mfma_f32_16x16x32_bf16 v[212:215], a[116:119], v[100:103], v[212:215]
  v_exp_f32 v52, v52
  v_rcp_f32 v7, v7
  v_mfma_f32_16x16x32_bf16 v[228:231], a[120:123], v[100:103], v[228:231]
  ds_read_b128 a[84:87], v117 offset:36864
  v_mul_f32 v24, v24, v7
  v_add_f32 v19, v19, v21
  v_cvt_pk_bf16_f32 v105, v50, v51
  v_mfma_f32_16x16x32_bf16 v[244:247], a[124:127], v[100:103], v[244:247]
  ds_read_b128 a[88:91], v118 offset:36864
  v_add_f32 v25, v25, v23
  v_add_f32 v25, v25, v19
  v_and_b32 v7, 4294901760, v6
  v_mfma_f32_16x16x32_bf16 v[84:87], v[112:115], v[100:103], v[84:87]
  v_exp_f32 v53, v53
  v_add_f32 v25, v25, v7
  v_mul_f32 v7, v25, v25
  v_mfma_f32_16x16x32_bf16 v[32:35], a[64:67], a[0:3], v[64:67]
  s_add_u32 m0, s21, 16384
  ds_read_b128 a[92:95], v119 offset:36864
  v_exp_f32 v54, v54
  v_fma_f32 v7, v7, s45, v1
  v_mfma_f32_16x16x32_bf16 v[32:35], a[68:71], a[16:19], v[32:35]
  s_waitcnt lgkmcnt(6)
  buffer_load_dwordx4 v8, s[8:11], s20 offen lds
  v_mfma_f32_16x16x32_bf16 v[32:35], a[72:75], a[32:35], v[32:35]
  s_waitcnt lgkmcnt(4)
  v_mul_f32 v7, v7, v25
  v_cvt_pk_bf16_f32 v106, v52, v53
  v_exp_f32 v7, v7
  v_mfma_f32_16x16x32_bf16 v[32:35], a[76:79], a[48:51], v[32:35]
  s_waitcnt lgkmcnt(3)
  v_add_f32 v7, 1.0, v7
  v_rcp_f32 v7, v7
  s_nop 0
  v_mul_f32 v25, v25, v7
  v_mfma_f32_16x16x32_bf16 v[36:39], a[80:83], a[0:3], v[64:67]
  s_waitcnt lgkmcnt(2)
  v_exp_f32 v55, v55
  v_cvt_pk_bf16_f32 v6, v24, v25
  v_accvgpr_write_b32 a240, v6
  v_mfma_f32_16x16x32_bf16 v[36:39], a[84:87], a[16:19], v[36:39]
  s_waitcnt lgkmcnt(1)
  ds_read_b64 v[18:19], v27 offset:4096
  ds_read_b64 v[20:21], v27 offset:20480
  v_exp_f32 v56, v56
  v_mfma_f32_16x16x32_bf16 v[36:39], a[88:91], a[32:35], v[36:39]
  s_waitcnt lgkmcnt(2)
  ds_read_b64 v[22:23], v27 offset:36864
  ds_read_b64 v[24:25], v27 offset:53248
  v_cvt_pk_bf16_f32 v107, v54, v55
  v_accvgpr_read_b32 v6, a193
  v_mfma_f32_16x16x32_bf16 v[36:39], a[92:95], a[48:51], v[36:39]
  buffer_load_dwordx4 v9, s[8:11], s20 offen offset:1024 lds
  v_mfma_f32_16x16x32_bf16 v[40:43], a[64:67], a[4:7], v[68:71]
  v_add_f32 v28, v28, v30
  v_add_f32 v4, v4, v2
  v_exp_f32 v57, v57
  v_mfma_f32_16x16x32_bf16 v[40:43], a[68:71], a[20:23], v[40:43]
  v_add_f32 v4, v4, v28
  v_lshlrev_b32 v7, 16, v6
  v_exp_f32 v58, v58
  v_mfma_f32_16x16x32_bf16 v[40:43], a[72:75], a[36:39], v[40:43]
  v_add_f32 v4, v4, v7
  v_mul_f32 v7, v4, v4
  v_cvt_pk_bf16_f32 v108, v56, v57
  v_fma_f32 v7, v7, s45, v1
  v_mfma_f32_16x16x32_bf16 v[40:43], a[76:79], a[52:55], v[40:43]
  buffer_load_dwordx4 v10, s[8:11], s20 offen offset:2048 lds
  v_mfma_f32_16x16x32_bf16 v[44:47], a[80:83], a[4:7], v[68:71]
  v_mul_f32 v7, v7, v4
  v_exp_f32 v7, v7
  v_exp_f32 v59, v59
  v_mfma_f32_16x16x32_bf16 v[44:47], a[84:87], a[20:23], v[44:47]
  v_add_f32 v7, 1.0, v7
  v_rcp_f32 v7, v7
  s_nop 0
  v_mul_f32 v4, v4, v7
  v_mfma_f32_16x16x32_bf16 v[44:47], a[88:91], a[36:39], v[44:47]
  v_exp_f32 v60, v60
  v_add_f32 v29, v29, v31
  v_add_f32 v5, v5, v3
  v_mfma_f32_16x16x32_bf16 v[44:47], a[92:95], a[52:55], v[44:47]
  v_cvt_pk_bf16_f32 v109, v58, v59
  v_add_f32 v5, v5, v29
  v_and_b32 v7, 4294901760, v6
  v_add_f32 v5, v5, v7
  v_mfma_f32_16x16x32_bf16 v[136:139], a[96:99], v[104:107], v[136:139]
  buffer_load_dwordx4 v11, s[8:11], s20 offen offset:3072 lds
  v_mfma_f32_16x16x32_bf16 v[152:155], a[100:103], v[104:107], v[152:155]
  v_exp_f32 v61, v61
  v_mul_f32 v7, v5, v5
  v_fma_f32 v7, v7, s45, v1
  v_mfma_f32_16x16x32_bf16 v[168:171], a[104:107], v[104:107], v[168:171]
  v_mul_f32 v7, v7, v5
  v_exp_f32 v62, v62
  v_exp_f32 v7, v7
  v_mfma_f32_16x16x32_bf16 v[184:187], a[108:111], v[104:107], v[184:187]
  v_add_f32 v7, 1.0, v7
  v_cvt_pk_bf16_f32 v110, v60, v61
  v_rcp_f32 v7, v7
  v_mfma_f32_16x16x32_bf16 v[200:203], a[112:115], v[104:107], v[200:203]
  v_mul_f32 v5, v5, v7
  v_cvt_pk_bf16_f32 v6, v4, v5
  v_exp_f32 v63, v63
  v_mfma_f32_16x16x32_bf16 v[216:219], a[116:119], v[104:107], v[216:219]
  ds_read_b64 v[28:29], v27 offset:4104
  ds_read_b64 v[30:31], v27 offset:20488
  v_accvgpr_write_b32 a241, v6
  v_cvt_pk_bf16_f32 v111, v62, v63
  v_mfma_f32_16x16x32_bf16 v[232:235], a[120:123], v[104:107], v[232:235]
  ds_read_b64 v[2:3], v27 offset:36872
  ds_read_b64 v[4:5], v27 offset:53256
  v_mfma_f32_16x16x32_bf16 v[248:251], a[124:127], v[104:107], v[248:251]
  s_waitcnt lgkmcnt(6)
  s_waitcnt vmcnt(15)
  v_exp_f32 v32, v32
  v_accvgpr_read_b32 v6, a194
  v_add_f32 v18, v18, v20
  v_mfma_f32_16x16x32_bf16 v[88:91], v[112:115], v[104:107], v[88:91]
  s_waitcnt lgkmcnt(4)
  v_add_f32 v24, v24, v22
  v_add_f32 v24, v24, v18
  v_exp_f32 v33, v33
  v_mfma_f32_16x16x32_bf16 v[140:143], a[96:99], v[108:111], v[140:143]
  v_lshlrev_b32 v7, 16, v6
  v_add_f32 v24, v24, v7
  v_exp_f32 v34, v34
  v_mfma_f32_16x16x32_bf16 v[156:159], a[100:103], v[108:111], v[156:159]
  v_mul_f32 v7, v24, v24
  v_fma_f32 v7, v7, s45, v1
  v_mfma_f32_16x16x32_bf16 v[172:175], a[104:107], v[108:111], v[172:175]
  v_cvt_pk_bf16_f32 v96, v32, v33
  v_mul_f32 v7, v7, v24
  v_exp_f32 v7, v7
  v_mfma_f32_16x16x32_bf16 v[188:191], a[108:111], v[108:111], v[188:191]
  ds_read_b64_tr_b16 a[96:97], v120 offset:32768
  v_add_f32 v7, 1.0, v7
  v_exp_f32 v35, v35
  v_mfma_f32_16x16x32_bf16 v[204:207], a[112:115], v[108:111], v[204:207]
  v_rcp_f32 v7, v7
  s_nop 0
  v_mul_f32 v24, v24, v7
  v_add_f32 v19, v19, v21
  v_mfma_f32_16x16x32_bf16 v[220:223], a[116:119], v[108:111], v[220:223]
  ds_read_b64_tr_b16 a[98:99], v120 offset:36864
  v_exp_f32 v36, v36
  v_add_f32 v25, v25, v23
  v_mfma_f32_16x16x32_bf16 v[236:239], a[120:123], v[108:111], v[236:239]
  ds_read_b64_tr_b16 a[100:101], v121 offset:32768
  v_add_f32 v25, v25, v19
  v_cvt_pk_bf16_f32 v97, v34, v35
  v_and_b32 v7, 4294901760, v6
  v_mfma_f32_16x16x32_bf16 v[252:255], a[124:127], v[108:111], v[252:255]
  ds_read_b64_tr_b16 a[102:103], v121 offset:36864
  v_add_f32 v25, v25, v7
  v_mul_f32 v7, v25, v25
  v_exp_f32 v37, v37
  v_mfma_f32_16x16x32_bf16 v[92:95], v[112:115], v[108:111], v[92:95]
  ds_read_b64_tr_b16 a[104:105], v122 offset:32768
  v_fma_f32 v7, v7, s45, v1
  v_mul_f32 v7, v7, v25
  v_mfma_f32_16x16x32_bf16 v[48:51], a[64:67], a[8:11], v[72:75]
  v_exp_f32 v7, v7
  v_exp_f32 v38, v38
  v_mfma_f32_16x16x32_bf16 v[48:51], a[68:71], a[24:27], v[48:51]
  ds_read_b64_tr_b16 a[106:107], v122 offset:36864
  v_add_f32 v7, 1.0, v7
  v_rcp_f32 v7, v7
  v_mfma_f32_16x16x32_bf16 v[48:51], a[72:75], a[40:43], v[48:51]
  ds_read_b64_tr_b16 a[108:109], v123 offset:32768
  v_cvt_pk_bf16_f32 v98, v36, v37
  v_mul_f32 v25, v25, v7
  v_cvt_pk_bf16_f32 v6, v24, v25
  v_mfma_f32_16x16x32_bf16 v[48:51], a[76:79], a[56:59], v[48:51]
  ds_read_b64_tr_b16 a[110:111], v123 offset:36864
  v_accvgpr_write_b32 a242, v6
  v_exp_f32 v39, v39
  v_mfma_f32_16x16x32_bf16 v[52:55], a[80:83], a[8:11], v[72:75]
  ds_read_b64 v[18:19], v27 offset:8192
  ds_read_b64 v[20:21], v27 offset:24576
  ds_read_b64_tr_b16 a[112:113], v124 offset:32768
  ds_read_b64 v[22:23], v27 offset:40960
  v_mfma_f32_16x16x32_bf16 v[52:55], a[84:87], a[24:27], v[52:55]
  ds_read_b64 v[24:25], v27 offset:57344
  ds_read_b64_tr_b16 a[114:115], v124 offset:36864
  v_exp_f32 v40, v40
  v_mfma_f32_16x16x32_bf16 v[52:55], a[88:91], a[40:43], v[52:55]
  s_waitcnt lgkmcnt(15)
  ds_read_b64_tr_b16 a[116:117], v125 offset:32768
  v_accvgpr_read_b32 v6, a195
  v_cvt_pk_bf16_f32 v99, v38, v39
  v_add_f32 v28, v28, v30
  v_mfma_f32_16x16x32_bf16 v[52:55], a[92:95], a[56:59], v[52:55]
  s_waitcnt lgkmcnt(15)
  ds_read_b64_tr_b16 a[118:119], v125 offset:36864
  v_add_f32 v4, v4, v2
  v_add_f32 v4, v4, v28
  v_exp_f32 v41, v41
  v_mfma_f32_16x16x32_bf16 v[56:59], a[64:67], a[12:15], v[76:79]
  ds_read_b64_tr_b16 a[120:121], v126 offset:32768
  v_lshlrev_b32 v7, 16, v6
  v_add_f32 v4, v4, v7
  v_mul_f32 v7, v4, v4
  v_mfma_f32_16x16x32_bf16 v[56:59], a[68:71], a[28:31], v[56:59]
  ds_read_b64_tr_b16 a[122:123], v126 offset:36864
  v_exp_f32 v42, v42
  v_fma_f32 v7, v7, s45, v1
  v_mfma_f32_16x16x32_bf16 v[56:59], a[72:75], a[44:47], v[56:59]
  v_mul_f32 v7, v7, v4
  v_cvt_pk_bf16_f32 v100, v40, v41
  v_exp_f32 v7, v7
  v_mfma_f32_16x16x32_bf16 v[56:59], a[76:79], a[60:63], v[56:59]
  ds_read_b64_tr_b16 a[124:125], v127 offset:32768
  v_add_f32 v7, 1.0, v7
  v_rcp_f32 v7, v7
  v_mfma_f32_16x16x32_bf16 v[60:63], a[80:83], a[12:15], v[76:79]
  ds_read_b64_tr_b16 a[126:127], v127 offset:36864
  v_exp_f32 v43, v43
  v_mul_f32 v4, v4, v7
  v_mfma_f32_16x16x32_bf16 v[60:63], a[84:87], a[28:31], v[60:63]
  v_add_f32 v29, v29, v31
  v_add_f32 v5, v5, v3
  v_exp_f32 v44, v44
  v_mfma_f32_16x16x32_bf16 v[60:63], a[88:91], a[44:47], v[60:63]
  v_add_f32 v5, v5, v29
  v_and_b32 v7, 4294901760, v6
  v_add_f32 v5, v5, v7
  v_cvt_pk_bf16_f32 v101, v42, v43
  v_mfma_f32_16x16x32_bf16 v[60:63], a[92:95], a[60:63], v[60:63]
  s_waitcnt lgkmcnt(15)
  v_mul_f32 v7, v5, v5
  v_fma_f32 v7, v7, s45, v1
  v_exp_f32 v45, v45
  v_mfma_f32_16x16x32_bf16 v[128:131], a[96:99], v[96:99], v[128:131]
  ds_read_b128 a[64:67], v116 offset:40960
  v_mul_f32 v7, v7, v5
  v_exp_f32 v7, v7
  v_mfma_f32_16x16x32_bf16 v[144:147], a[100:103], v[96:99], v[144:147]
  s_waitcnt lgkmcnt(15)
  ds_read_b128 a[68:71], v117 offset:40960
  v_add_f32 v7, 1.0, v7
  v_exp_f32 v46, v46
  v_mfma_f32_16x16x32_bf16 v[160:163], a[104:107], v[96:99], v[160:163]
  s_waitcnt lgkmcnt(14)
  v_rcp_f32 v7, v7
  s_nop 0
  v_mul_f32 v5, v5, v7
  v_cvt_pk_bf16_f32 v6, v4, v5
  v_mfma_f32_16x16x32_bf16 v[176:179], a[108:111], v[96:99], v[176:179]
  s_waitcnt lgkmcnt(8)
  v_cvt_pk_bf16_f32 v102, v44, v45
  v_accvgpr_write_b32 a243, v6
  v_mfma_f32_16x16x32_bf16 v[192:195], a[112:115], v[96:99], v[192:195]
  s_waitcnt lgkmcnt(6)
  buffer_store_dwordx4 a[240:243], v26, s[60:63], s43 offen sc1
  v_exp_f32 v47, v47
  v_mfma_f32_16x16x32_bf16 v[208:211], a[116:119], v[96:99], v[208:211]
  s_waitcnt lgkmcnt(4)
  ds_read_b64 v[28:29], v27 offset:8200
  ds_read_b64 v[30:31], v27 offset:24584
  ds_read_b64 v[2:3], v27 offset:40968
  v_cvt_pk_bf16_f32 v103, v46, v47
  v_mfma_f32_16x16x32_bf16 v[224:227], a[120:123], v[96:99], v[224:227]
  s_waitcnt lgkmcnt(5)
  s_waitcnt vmcnt(15)
  ds_read_b64 v[4:5], v27 offset:57352
  v_accvgpr_read_b32 v6, a196
  v_add_f32 v18, v18, v20
  v_mfma_f32_16x16x32_bf16 v[240:243], a[124:127], v[96:99], v[240:243]
  ds_read_b128 a[72:75], v118 offset:40960
  v_exp_f32 v48, v48
  v_add_f32 v24, v24, v22
  v_mfma_f32_16x16x32_bf16 v[80:83], v[112:115], v[96:99], v[80:83]
  v_add_f32 v24, v24, v18
  v_lshlrev_b32 v7, 16, v6
  v_exp_f32 v49, v49
  v_mfma_f32_16x16x32_bf16 v[132:135], a[96:99], v[100:103], v[132:135]
  ds_read_b128 a[76:79], v119 offset:40960
  v_add_f32 v24, v24, v7
  v_mul_f32 v7, v24, v24
  v_exp_f32 v50, v50
  v_mfma_f32_16x16x32_bf16 v[148:151], a[100:103], v[100:103], v[148:151]
  v_fma_f32 v7, v7, s45, v1
  v_mul_f32 v7, v7, v24
  v_mfma_f32_16x16x32_bf16 v[164:167], a[104:107], v[100:103], v[164:167]
  v_exp_f32 v7, v7
  v_cvt_pk_bf16_f32 v104, v48, v49
  v_add_f32 v7, 1.0, v7
  v_mfma_f32_16x16x32_bf16 v[180:183], a[108:111], v[100:103], v[180:183]
  ds_read_b128 a[80:83], v116 offset:45056
  ds_read_b128 a[84:87], v117 offset:45056
  v_rcp_f32 v7, v7
  v_mfma_f32_16x16x32_bf16 v[196:199], a[112:115], v[100:103], v[196:199]
  v_exp_f32 v51, v51
  v_mul_f32 v24, v24, v7
  v_add_f32 v19, v19, v21
  v_mfma_f32_16x16x32_bf16 v[212:215], a[116:119], v[100:103], v[212:215]
  v_add_f32 v25, v25, v23
  v_add_f32 v25, v25, v19
  v_exp_f32 v52, v52
  v_mfma_f32_16x16x32_bf16 v[228:231], a[120:123], v[100:103], v[228:231]
  v_and_b32 v7, 4294901760, v6
  v_add_f32 v25, v25, v7
  v_cvt_pk_bf16_f32 v105, v50, v51
  v_mul_f32 v7, v25, v25
  v_mfma_f32_16x16x32_bf16 v[244:247], a[124:127], v[100:103], v[244:247]
  ds_read_b128 a[88:91], v118 offset:45056
  v_fma_f32 v7, v7, s45, v1
  v_exp_f32 v53, v53
  v_mfma_f32_16x16x32_bf16 v[84:87], v[112:115], v[100:103], v[84:87]
  s_waitcnt lgkmcnt(10)
  ds_read_b128 a[92:95], v119 offset:45056
  v_mul_f32 v7, v7, v25
  v_exp_f32 v7, v7
  v_mfma_f32_16x16x32_bf16 v[32:35], a[64:67], a[0:3], v[64:67]
  s_waitcnt lgkmcnt(10)
  s_add_u32 m0, s21, 65536
  v_add_f32 v7, 1.0, v7
  v_exp_f32 v54, v54
  v_rcp_f32 v7, v7
  v_mfma_f32_16x16x32_bf16 v[32:35], a[68:71], a[16:19], v[32:35]
  s_waitcnt lgkmcnt(5)
  buffer_load_dwordx4 v12, s[12:15], s20 offen lds
  v_mfma_f32_16x16x32_bf16 v[32:35], a[72:75], a[32:35], v[32:35]
  s_waitcnt lgkmcnt(4)
  v_mul_f32 v25, v25, v7
  v_cvt_pk_bf16_f32 v6, v24, v25
  v_cvt_pk_bf16_f32 v106, v52, v53
  v_accvgpr_write_b32 a244, v6
  v_mfma_f32_16x16x32_bf16 v[32:35], a[76:79], a[48:51], v[32:35]
  s_waitcnt lgkmcnt(3)
  ds_read_b64 v[18:19], v27 offset:12288
  ds_read_b64 v[20:21], v27 offset:28672
  v_exp_f32 v55, v55
  v_mfma_f32_16x16x32_bf16 v[36:39], a[80:83], a[0:3], v[64:67]
  s_waitcnt lgkmcnt(4)
  ds_read_b64 v[22:23], v27 offset:45056
  ds_read_b64 v[24:25], v27 offset:61440
  v_exp_f32 v56, v56
  v_mfma_f32_16x16x32_bf16 v[36:39], a[84:87], a[16:19], v[36:39]
  s_waitcnt lgkmcnt(5)
  v_accvgpr_read_b32 v6, a197
  v_add_f32 v28, v28, v30
  v_add_f32 v4, v4, v2
  v_mfma_f32_16x16x32_bf16 v[36:39], a[88:91], a[32:35], v[36:39]
  s_waitcnt lgkmcnt(4)
  v_cvt_pk_bf16_f32 v107, v54, v55
  v_add_f32 v4, v4, v28
  v_lshlrev_b32 v7, 16, v6
  v_mfma_f32_16x16x32_bf16 v[36:39], a[92:95], a[48:51], v[36:39]
  buffer_load_dwordx4 v13, s[12:15], s20 offen offset:1024 lds
  v_mfma_f32_16x16x32_bf16 v[40:43], a[64:67], a[4:7], v[68:71]
  v_exp_f32 v57, v57
  v_add_f32 v4, v4, v7
  v_mul_f32 v7, v4, v4
  v_mfma_f32_16x16x32_bf16 v[40:43], a[68:71], a[20:23], v[40:43]
  v_fma_f32 v7, v7, s45, v1
  v_mul_f32 v7, v7, v4
  v_exp_f32 v58, v58
  v_mfma_f32_16x16x32_bf16 v[40:43], a[72:75], a[36:39], v[40:43]
  v_exp_f32 v7, v7
  s_nop 0
  v_add_f32 v7, 1.0, v7
  v_cvt_pk_bf16_f32 v108, v56, v57
  v_mfma_f32_16x16x32_bf16 v[40:43], a[76:79], a[52:55], v[40:43]
  buffer_load_dwordx4 v12, s[12:15], s20 offen offset:2048 lds
  v_mfma_f32_16x16x32_bf16 v[44:47], a[80:83], a[4:7], v[68:71]
  v_rcp_f32 v7, v7
  s_nop 0
  v_mul_f32 v4, v4, v7
  v_exp_f32 v59, v59
  v_mfma_f32_16x16x32_bf16 v[44:47], a[84:87], a[20:23], v[44:47]
  v_add_f32 v29, v29, v31
  v_add_f32 v5, v5, v3
  v_add_f32 v5, v5, v29
  v_exp_f32 v60, v60
  v_mfma_f32_16x16x32_bf16 v[44:47], a[88:91], a[36:39], v[44:47]
  v_and_b32 v7, 4294901760, v6
  v_add_f32 v5, v5, v7
  v_mul_f32 v7, v5, v5
  v_cvt_pk_bf16_f32 v109, v58, v59
  v_mfma_f32_16x16x32_bf16 v[44:47], a[92:95], a[52:55], v[44:47]
  v_fma_f32 v7, v7, s45, v1
  v_mul_f32 v7, v7, v5
  v_exp_f32 v7, v7
  v_mfma_f32_16x16x32_bf16 v[136:139], a[96:99], v[104:107], v[136:139]
  buffer_load_dwordx4 v13, s[12:15], s20 offen offset:3072 lds
  s_add_u32 s20, s20, 16384
  v_mfma_f32_16x16x32_bf16 v[152:155], a[100:103], v[104:107], v[152:155]
  v_exp_f32 v61, v61
  v_add_f32 v7, 1.0, v7
  v_rcp_f32 v7, v7
  v_mfma_f32_16x16x32_bf16 v[168:171], a[104:107], v[104:107], v[168:171]
  v_exp_f32 v62, v62
  v_mul_f32 v5, v5, v7
  v_cvt_pk_bf16_f32 v6, v4, v5
  v_mfma_f32_16x16x32_bf16 v[184:187], a[108:111], v[104:107], v[184:187]
  ds_read_b64 v[28:29], v27 offset:12296
  ds_read_b64 v[30:31], v27 offset:28680
  v_accvgpr_write_b32 a245, v6
  v_cvt_pk_bf16_f32 v110, v60, v61
  v_mfma_f32_16x16x32_bf16 v[200:203], a[112:115], v[104:107], v[200:203]
  ds_read_b64 v[2:3], v27 offset:45064
  ds_read_b64 v[4:5], v27 offset:61448
  v_exp_f32 v63, v63
  v_mfma_f32_16x16x32_bf16 v[216:219], a[116:119], v[104:107], v[216:219]
  s_waitcnt lgkmcnt(6)
  s_waitcnt vmcnt(18)
  v_accvgpr_read_b32 v6, a198
  v_cvt_pk_bf16_f32 v111, v62, v63
  v_add_f32 v18, v18, v20
  v_mfma_f32_16x16x32_bf16 v[232:235], a[120:123], v[104:107], v[232:235]
  s_waitcnt lgkmcnt(4)
  v_add_f32 v24, v24, v22
  v_add_f32 v24, v24, v18
  v_mfma_f32_16x16x32_bf16 v[248:251], a[124:127], v[104:107], v[248:251]
  v_exp_f32 v32, v32
  v_lshlrev_b32 v7, 16, v6
  v_add_f32 v24, v24, v7
  v_mfma_f32_16x16x32_bf16 v[88:91], v[112:115], v[104:107], v[88:91]
  v_mul_f32 v7, v24, v24
  v_fma_f32 v7, v7, s45, v1
  v_exp_f32 v33, v33
  v_mfma_f32_16x16x32_bf16 v[140:143], a[96:99], v[108:111], v[140:143]
  v_mul_f32 v7, v7, v24
  v_exp_f32 v34, v34
  v_exp_f32 v7, v7
  v_mfma_f32_16x16x32_bf16 v[156:159], a[100:103], v[108:111], v[156:159]
  v_add_f32 v7, 1.0, v7
  v_cvt_pk_bf16_f32 v96, v32, v33
  v_mfma_f32_16x16x32_bf16 v[172:175], a[104:107], v[108:111], v[172:175]
  v_rcp_f32 v7, v7
  s_nop 0
  v_mul_f32 v24, v24, v7
  v_mfma_f32_16x16x32_bf16 v[188:191], a[108:111], v[108:111], v[188:191]
  v_add_f32 v19, v19, v21
  v_add_f32 v25, v25, v23
  v_exp_f32 v35, v35
  v_mfma_f32_16x16x32_bf16 v[204:207], a[112:115], v[108:111], v[204:207]
  ds_read_b64_tr_b16 a[96:97], v120 offset:40960
  v_add_f32 v25, v25, v19
  v_and_b32 v7, 4294901760, v6
  v_mfma_f32_16x16x32_bf16 v[220:223], a[116:119], v[108:111], v[220:223]
  ds_read_b64_tr_b16 a[98:99], v120 offset:45056
  v_add_f32 v25, v25, v7
  v_exp_f32 v36, v36
  v_mfma_f32_16x16x32_bf16 v[236:239], a[120:123], v[108:111], v[236:239]
  ds_read_b64_tr_b16 a[100:101], v121 offset:40960
  v_mul_f32 v7, v25, v25
  v_fma_f32 v7, v7, s45, v1
  v_cvt_pk_bf16_f32 v97, v34, v35
  v_mfma_f32_16x16x32_bf16 v[252:255], a[124:127], v[108:111], v[252:255]
  ds_read_b64_tr_b16 a[102:103], v121 offset:45056
  v_mul_f32 v7, v7, v25
  v_exp_f32 v7, v7
  v_mfma_f32_16x16x32_bf16 v[92:95], v[112:115], v[108:111], v[92:95]
  ds_read_b64_tr_b16 a[104:105], v122 offset:40960
  v_add_f32 v7, 1.0, v7
  v_exp_f32 v37, v37
  v_mfma_f32_16x16x32_bf16 v[48:51], a[64:67], a[8:11], v[72:75]
  v_rcp_f32 v7, v7
  s_nop 0
  v_mul_f32 v25, v25, v7
  v_cvt_pk_bf16_f32 v6, v24, v25
  v_mfma_f32_16x16x32_bf16 v[48:51], a[68:71], a[24:27], v[48:51]
  ds_read_b64_tr_b16 a[106:107], v122 offset:45056
  v_exp_f32 v38, v38
  v_accvgpr_write_b32 a246, v6
  v_mfma_f32_16x16x32_bf16 v[48:51], a[72:75], a[40:43], v[48:51]
  s_waitcnt lgkmcnt(8)
  ds_read_b64_tr_b16 a[108:109], v123 offset:40960
  v_accvgpr_read_b32 v6, a199
  v_cvt_pk_bf16_f32 v98, v36, v37
  v_add_f32 v28, v28, v30
  v_mfma_f32_16x16x32_bf16 v[48:51], a[76:79], a[56:59], v[48:51]
  s_waitcnt lgkmcnt(7)
  ds_read_b64_tr_b16 a[110:111], v123 offset:45056
  v_add_f32 v4, v4, v2
  v_add_f32 v4, v4, v28
  v_exp_f32 v39, v39
  v_mfma_f32_16x16x32_bf16 v[52:55], a[80:83], a[8:11], v[72:75]
  ds_read_b64_tr_b16 a[112:113], v124 offset:40960
  v_lshlrev_b32 v7, 16, v6
  v_add_f32 v4, v4, v7
  v_mul_f32 v7, v4, v4
  v_mfma_f32_16x16x32_bf16 v[52:55], a[84:87], a[24:27], v[52:55]
  ds_read_b64_tr_b16 a[114:115], v124 offset:45056
  v_exp_f32 v40, v40
  v_fma_f32 v7, v7, s45, v1
  v_mfma_f32_16x16x32_bf16 v[52:55], a[88:91], a[40:43], v[52:55]
  v_mul_f32 v7, v7, v4
  v_cvt_pk_bf16_f32 v99, v38, v39
  v_exp_f32 v7, v7
  v_mfma_f32_16x16x32_bf16 v[52:55], a[92:95], a[56:59], v[52:55]
  ds_read_b64_tr_b16 a[116:117], v125 offset:40960
  v_add_f32 v7, 1.0, v7
  v_rcp_f32 v7, v7
  v_mfma_f32_16x16x32_bf16 v[56:59], a[64:67], a[12:15], v[76:79]
  ds_read_b64_tr_b16 a[118:119], v125 offset:45056
  v_mul_f32 v4, v4, v7
  v_exp_f32 v41, v41
  v_mfma_f32_16x16x32_bf16 v[56:59], a[68:71], a[28:31], v[56:59]
  ds_read_b64_tr_b16 a[120:121], v126 offset:40960
  v_add_f32 v29, v29, v31
  v_add_f32 v5, v5, v3
  v_exp_f32 v42, v42
  v_mfma_f32_16x16x32_bf16 v[56:59], a[72:75], a[44:47], v[56:59]
  ds_read_b64_tr_b16 a[122:123], v126 offset:45056
  ds_read_b64_tr_b16 a[124:125], v127 offset:40960
  ds_read_b64_tr_b16 a[126:127], v127 offset:45056
  v_add_f32 v5, v5, v29
  v_mfma_f32_16x16x32_bf16 v[56:59], a[76:79], a[60:63], v[56:59]
  v_and_b32 v7, 4294901760, v6
  v_cvt_pk_bf16_f32 v100, v40, v41
  v_add_f32 v5, v5, v7
  v_mul_f32 v7, v5, v5
  v_mfma_f32_16x16x32_bf16 v[60:63], a[80:83], a[12:15], v[76:79]
  v_fma_f32 v7, v7, s45, v1
  v_mul_f32 v7, v7, v5
  v_exp_f32 v43, v43
  v_mfma_f32_16x16x32_bf16 v[60:63], a[84:87], a[28:31], v[60:63]
  v_exp_f32 v7, v7
  s_nop 0
  v_add_f32 v7, 1.0, v7
  v_exp_f32 v44, v44
  v_mfma_f32_16x16x32_bf16 v[60:63], a[88:91], a[44:47], v[60:63]
  v_rcp_f32 v7, v7
  s_nop 0
  v_mul_f32 v5, v5, v7
  v_cvt_pk_bf16_f32 v6, v4, v5
  v_mfma_f32_16x16x32_bf16 v[60:63], a[92:95], a[60:63], v[60:63]
  v_cvt_pk_bf16_f32 v101, v42, v43
  v_accvgpr_write_b32 a247, v6
  buffer_store_dwordx4 a[244:247], v26, s[60:63], s43 offen offset:1024 sc1
  v_exp_f32 v45, v45
  v_exp_f32 v46, v46
  s_waitcnt vmcnt(10) lgkmcnt(0)
  s_barrier
  v_mfma_f32_16x16x32_bf16 v[128:131], a[96:99], v[96:99], v[128:131]
  ds_read_b128 a[64:67], v116
  v_cvt_pk_bf16_f32 v102, v44, v45
  v_mfma_f32_16x16x32_bf16 v[144:147], a[100:103], v[96:99], v[144:147]
  v_exp_f32 v47, v47
  v_mfma_f32_16x16x32_bf16 v[160:163], a[104:107], v[96:99], v[160:163]
  ds_read_b128 a[68:71], v117
  v_cvt_pk_bf16_f32 v103, v46, v47
  v_mfma_f32_16x16x32_bf16 v[176:179], a[108:111], v[96:99], v[176:179]
  ds_read_b128 a[72:75], v118
  v_mfma_f32_16x16x32_bf16 v[192:195], a[112:115], v[96:99], v[192:195]
  v_exp_f32 v48, v48
  v_mfma_f32_16x16x32_bf16 v[208:211], a[116:119], v[96:99], v[208:211]
  v_exp_f32 v49, v49
  v_mfma_f32_16x16x32_bf16 v[224:227], a[120:123], v[96:99], v[224:227]
  ds_read_b128 a[76:79], v119
  v_mfma_f32_16x16x32_bf16 v[240:243], a[124:127], v[96:99], v[240:243]
  ds_read_b128 a[80:83], v116 offset:4096
  v_lshrrev_b32 v1, 3, v0
  v_mfma_f32_16x16x32_bf16 v[80:83], v[112:115], v[96:99], v[80:83]
  v_exp_f32 v50, v50
  v_mfma_f32_16x16x32_bf16 v[132:135], a[96:99], v[100:103], v[132:135]
  ds_read_b128 a[84:87], v117 offset:4096
  v_cvt_pk_bf16_f32 v104, v48, v49
  v_mfma_f32_16x16x32_bf16 v[148:151], a[100:103], v[100:103], v[148:151]
  v_exp_f32 v51, v51
  v_mfma_f32_16x16x32_bf16 v[164:167], a[104:107], v[100:103], v[164:167]
  v_exp_f32 v52, v52
  v_mfma_f32_16x16x32_bf16 v[180:183], a[108:111], v[100:103], v[180:183]
  v_bfe_u32 v2, v1, 1, 2
  v_cvt_pk_bf16_f32 v105, v50, v51
  v_mfma_f32_16x16x32_bf16 v[196:199], a[112:115], v[100:103], v[196:199]
  ds_read_b128 a[88:91], v118 offset:4096
  v_mfma_f32_16x16x32_bf16 v[212:215], a[116:119], v[100:103], v[212:215]
  v_exp_f32 v53, v53
  v_mfma_f32_16x16x32_bf16 v[228:231], a[120:123], v[100:103], v[228:231]
  v_exp_f32 v54, v54
  v_mfma_f32_16x16x32_bf16 v[244:247], a[124:127], v[100:103], v[244:247]
  ds_read_b128 a[92:95], v119 offset:4096
  v_lshlrev_b32 v2, 1, v2
  v_mfma_f32_16x16x32_bf16 v[84:87], v[112:115], v[100:103], v[84:87]
  s_waitcnt lgkmcnt(7)
  v_cvt_pk_bf16_f32 v106, v52, v53
  v_mfma_f32_16x16x32_bf16 v[32:35], a[64:67], a[0:3], v[64:67]
  s_waitcnt lgkmcnt(6)
  s_add_u32 m0, s21, 32768
  v_exp_f32 v55, v55
  v_mfma_f32_16x16x32_bf16 v[32:35], a[68:71], a[16:19], v[32:35]
  s_waitcnt lgkmcnt(5)
  buffer_load_dwordx4 v8, s[8:11], s20 offen lds
  v_mfma_f32_16x16x32_bf16 v[32:35], a[72:75], a[32:35], v[32:35]
  s_waitcnt lgkmcnt(4)
  v_exp_f32 v56, v56
  v_mfma_f32_16x16x32_bf16 v[32:35], a[76:79], a[48:51], v[32:35]
  s_waitcnt lgkmcnt(3)
  v_and_b32 v3, 7, v0
  v_cvt_pk_bf16_f32 v107, v54, v55
  v_mfma_f32_16x16x32_bf16 v[36:39], a[80:83], a[0:3], v[64:67]
  s_waitcnt lgkmcnt(2)
  v_exp_f32 v57, v57
  v_mfma_f32_16x16x32_bf16 v[36:39], a[84:87], a[16:19], v[36:39]
  s_waitcnt lgkmcnt(1)
  v_exp_f32 v58, v58
  v_mfma_f32_16x16x32_bf16 v[36:39], a[88:91], a[32:35], v[36:39]
  s_waitcnt lgkmcnt(0)
  v_xor_b32 v3, v3, v2
  v_cvt_pk_bf16_f32 v108, v56, v57
  v_mfma_f32_16x16x32_bf16 v[36:39], a[92:95], a[48:51], v[36:39]
  buffer_load_dwordx4 v9, s[8:11], s20 offen offset:1024 lds
  v_mfma_f32_16x16x32_bf16 v[40:43], a[64:67], a[4:7], v[68:71]
  v_exp_f32 v59, v59
  v_mfma_f32_16x16x32_bf16 v[40:43], a[68:71], a[20:23], v[40:43]
  v_exp_f32 v60, v60
  v_mfma_f32_16x16x32_bf16 v[40:43], a[72:75], a[36:39], v[40:43]
  v_lshlrev_b32 v3, 4, v3
  v_cvt_pk_bf16_f32 v109, v58, v59
  v_mfma_f32_16x16x32_bf16 v[40:43], a[76:79], a[52:55], v[40:43]
  buffer_load_dwordx4 v10, s[8:11], s20 offen offset:2048 lds
  v_mfma_f32_16x16x32_bf16 v[44:47], a[80:83], a[4:7], v[68:71]
  v_exp_f32 v61, v61
  v_mfma_f32_16x16x32_bf16 v[44:47], a[84:87], a[20:23], v[44:47]
  v_exp_f32 v62, v62
  v_mfma_f32_16x16x32_bf16 v[44:47], a[88:91], a[36:39], v[44:47]
  s_mov_b32 s43, 4096
  v_cvt_pk_bf16_f32 v110, v60, v61
  v_mul_lo_u32 v1, v1, s43
  v_mfma_f32_16x16x32_bf16 v[44:47], a[92:95], a[52:55], v[44:47]
  v_exp_f32 v63, v63
  v_mfma_f32_16x16x32_bf16 v[136:139], a[96:99], v[104:107], v[136:139]
  buffer_load_dwordx4 v11, s[8:11], s20 offen offset:3072 lds
  v_mfma_f32_16x16x32_bf16 v[152:155], a[100:103], v[104:107], v[152:155]
  v_cvt_pk_bf16_f32 v111, v62, v63
  v_mfma_f32_16x16x32_bf16 v[168:171], a[104:107], v[104:107], v[168:171]
  v_mfma_f32_16x16x32_bf16 v[184:187], a[108:111], v[104:107], v[184:187]
  v_add_u32 v18, v1, v3
  v_mfma_f32_16x16x32_bf16 v[200:203], a[112:115], v[104:107], v[200:203]
  v_exp_f32 v32, v32
  v_mfma_f32_16x16x32_bf16 v[216:219], a[116:119], v[104:107], v[216:219]
  v_exp_f32 v33, v33
  v_mfma_f32_16x16x32_bf16 v[232:235], a[120:123], v[104:107], v[232:235]
  v_exp_f32 v34, v34
  v_mfma_f32_16x16x32_bf16 v[248:251], a[124:127], v[104:107], v[248:251]
  v_cvt_pk_bf16_f32 v96, v32, v33
  v_add_u32 v19, 31744, v18
  v_mfma_f32_16x16x32_bf16 v[88:91], v[112:115], v[104:107], v[88:91]
  v_exp_f32 v35, v35
  v_mfma_f32_16x16x32_bf16 v[140:143], a[96:99], v[108:111], v[140:143]
  v_exp_f32 v36, v36
  v_mfma_f32_16x16x32_bf16 v[156:159], a[100:103], v[108:111], v[156:159]
  ds_read_b64_tr_b16 a[96:97], v120
  ds_read_b64_tr_b16 a[98:99], v120 offset:4096
  v_mfma_f32_16x16x32_bf16 v[172:175], a[104:107], v[108:111], v[172:175]
  ds_read_b64_tr_b16 a[100:101], v121
  v_cvt_pk_bf16_f32 v97, v34, v35
  v_mfma_f32_16x16x32_bf16 v[188:191], a[108:111], v[108:111], v[188:191]
  ds_read_b64_tr_b16 a[102:103], v121 offset:4096
  v_add_u32 v20, 31744, v19
  v_mfma_f32_16x16x32_bf16 v[204:207], a[112:115], v[108:111], v[204:207]
  v_exp_f32 v37, v37
  v_mfma_f32_16x16x32_bf16 v[220:223], a[116:119], v[108:111], v[220:223]
  ds_read_b64_tr_b16 a[104:105], v122
  ds_read_b64_tr_b16 a[106:107], v122 offset:4096
  v_mfma_f32_16x16x32_bf16 v[236:239], a[120:123], v[108:111], v[236:239]
  v_exp_f32 v38, v38
  v_mfma_f32_16x16x32_bf16 v[252:255], a[124:127], v[108:111], v[252:255]
  ds_read_b64_tr_b16 a[108:109], v123
  v_cvt_pk_bf16_f32 v98, v36, v37
  v_mfma_f32_16x16x32_bf16 v[92:95], v[112:115], v[108:111], v[92:95]
  ds_read_b64_tr_b16 a[110:111], v123 offset:4096
  v_add_u32 v21, 31744, v20
  v_mfma_f32_16x16x32_bf16 v[48:51], a[64:67], a[8:11], v[72:75]
  v_exp_f32 v39, v39
  v_mfma_f32_16x16x32_bf16 v[48:51], a[68:71], a[24:27], v[48:51]
  ds_read_b64_tr_b16 a[112:113], v124
  ds_read_b64_tr_b16 a[114:115], v124 offset:4096
  v_mfma_f32_16x16x32_bf16 v[48:51], a[72:75], a[40:43], v[48:51]
  v_exp_f32 v40, v40
  v_mfma_f32_16x16x32_bf16 v[48:51], a[76:79], a[56:59], v[48:51]
  ds_read_b64_tr_b16 a[116:117], v125
  v_cvt_pk_bf16_f32 v99, v38, v39
  v_mfma_f32_16x16x32_bf16 v[52:55], a[80:83], a[8:11], v[72:75]
  ds_read_b64_tr_b16 a[118:119], v125 offset:4096
  v_lshlrev_b32 v22, 4, v0
  v_mfma_f32_16x16x32_bf16 v[52:55], a[84:87], a[24:27], v[52:55]
  v_exp_f32 v41, v41
  v_mfma_f32_16x16x32_bf16 v[52:55], a[88:91], a[40:43], v[52:55]
  ds_read_b64_tr_b16 a[120:121], v126
  ds_read_b64_tr_b16 a[122:123], v126 offset:4096
  v_mfma_f32_16x16x32_bf16 v[52:55], a[92:95], a[56:59], v[52:55]
  v_exp_f32 v42, v42
  v_mfma_f32_16x16x32_bf16 v[56:59], a[64:67], a[12:15], v[76:79]
  ds_read_b64_tr_b16 a[124:125], v127
  v_cvt_pk_bf16_f32 v100, v40, v41
  v_mfma_f32_16x16x32_bf16 v[56:59], a[68:71], a[28:31], v[56:59]
  v_exp_f32 v43, v43
  v_mfma_f32_16x16x32_bf16 v[56:59], a[72:75], a[44:47], v[56:59]
  ds_read_b64_tr_b16 a[126:127], v127 offset:4096
  v_add_u32 v23, 57344, v22
  v_mfma_f32_16x16x32_bf16 v[56:59], a[76:79], a[60:63], v[56:59]
  v_exp_f32 v44, v44
  v_mfma_f32_16x16x32_bf16 v[60:63], a[80:83], a[12:15], v[76:79]
  v_cvt_pk_bf16_f32 v101, v42, v43
  v_add_u32 v24, 57344, v23
  v_mfma_f32_16x16x32_bf16 v[60:63], a[84:87], a[28:31], v[60:63]
  v_exp_f32 v45, v45
  v_mfma_f32_16x16x32_bf16 v[60:63], a[88:91], a[44:47], v[60:63]
  v_exp_f32 v46, v46
  v_mfma_f32_16x16x32_bf16 v[60:63], a[92:95], a[60:63], v[60:63]
  s_waitcnt lgkmcnt(14)
  ds_read_b128 a[64:67], v116 offset:8192
  v_cvt_pk_bf16_f32 v102, v44, v45
  v_mfma_f32_16x16x32_bf16 v[128:131], a[96:99], v[96:99], v[128:131]
  s_waitcnt lgkmcnt(13)
  v_exp_f32 v47, v47
  v_mfma_f32_16x16x32_bf16 v[144:147], a[100:103], v[96:99], v[144:147]
  s_waitcnt lgkmcnt(11)
  ds_read_b128 a[68:71], v117 offset:8192
  v_add_u32 v25, 57344, v24
  v_mfma_f32_16x16x32_bf16 v[160:163], a[104:107], v[96:99], v[160:163]
  s_waitcnt lgkmcnt(10)
  v_cvt_pk_bf16_f32 v103, v46, v47
  v_mfma_f32_16x16x32_bf16 v[176:179], a[108:111], v[96:99], v[176:179]
  s_waitcnt lgkmcnt(8)
  ds_read_b128 a[72:75], v118 offset:8192
  v_mfma_f32_16x16x32_bf16 v[192:195], a[112:115], v[96:99], v[192:195]
  s_waitcnt lgkmcnt(7)
  v_exp_f32 v48, v48
  v_mfma_f32_16x16x32_bf16 v[208:211], a[116:119], v[96:99], v[208:211]
  s_waitcnt lgkmcnt(5)
  s_mul_i32 s39, s24, 448*4096
  s_lshl_b32 s43, s46, 7
  s_add_u32 s39, s39, s43
  s_mul_i32 s36, s47, 4*56
  s_mul_i32 s43, s24, 14
  s_add_u32 s36, s36, s43
  s_lshl_b32 s36, s36, 10
  s_add_u32 s36, s36, 4194304
  s_mov_b32 s38, 0
  s_mov_b32 s37, 0
  v_exp_f32 v49, v49
  v_mfma_f32_16x16x32_bf16 v[224:227], a[120:123], v[96:99], v[224:227]
  s_waitcnt lgkmcnt(3)
  ds_read_b128 a[76:79], v119 offset:8192
  v_mfma_f32_16x16x32_bf16 v[240:243], a[124:127], v[96:99], v[240:243]
  v_exp_f32 v50, v50
  v_mfma_f32_16x16x32_bf16 v[80:83], v[112:115], v[96:99], v[80:83]
  ds_read_b128 a[80:83], v116 offset:12288
  v_cvt_pk_bf16_f32 v104, v48, v49
  v_mfma_f32_16x16x32_bf16 v[132:135], a[96:99], v[100:103], v[132:135]
  v_exp_f32 v51, v51
  v_mfma_f32_16x16x32_bf16 v[148:151], a[100:103], v[100:103], v[148:151]
  v_exp_f32 v52, v52
  v_mfma_f32_16x16x32_bf16 v[164:167], a[104:107], v[100:103], v[164:167]
  ds_read_b128 a[84:87], v117 offset:12288
  v_cvt_pk_bf16_f32 v105, v50, v51
  v_mfma_f32_16x16x32_bf16 v[180:183], a[108:111], v[100:103], v[180:183]
  ds_read_b128 a[88:91], v118 offset:12288
  v_mov_b32 v4, 1
  v_mfma_f32_16x16x32_bf16 v[196:199], a[112:115], v[100:103], v[196:199]
  s_waitcnt vmcnt(4)
  s_lshl_b32 s44, s47, 2
  s_add_u32 s44, s44, s24
  s_lshl_b32 s44, s44, 8
  s_add_u32 s44, s44, 6160384
  v_lshlrev_b32 v5, 25, v0
  buffer_atomic_add v4, v5, s[60:63], s44 offen sc1
  v_mfma_f32_16x16x32_bf16 v[212:215], a[116:119], v[100:103], v[212:215]
  v_exp_f32 v53, v53
  v_mfma_f32_16x16x32_bf16 v[228:231], a[120:123], v[100:103], v[228:231]
  v_exp_f32 v54, v54
  v_mfma_f32_16x16x32_bf16 v[244:247], a[124:127], v[100:103], v[244:247]
  ds_read_b128 a[92:95], v119 offset:12288
  v_cvt_pk_bf16_f32 v106, v52, v53
  v_mfma_f32_16x16x32_bf16 v[84:87], v[112:115], v[100:103], v[84:87]
  s_waitcnt lgkmcnt(7)
  v_exp_f32 v55, v55
  v_mfma_f32_16x16x32_bf16 v[32:35], a[64:67], a[0:3], v[64:67]
  s_waitcnt lgkmcnt(6)
  s_add_u32 m0, s21, 81920
  v_exp_f32 v56, v56
  v_mfma_f32_16x16x32_bf16 v[32:35], a[68:71], a[16:19], v[32:35]
  s_waitcnt lgkmcnt(5)
  buffer_load_dwordx4 v12, s[12:15], s20 offen lds
  v_mfma_f32_16x16x32_bf16 v[32:35], a[72:75], a[32:35], v[32:35]
  s_waitcnt lgkmcnt(4)
  v_cvt_pk_bf16_f32 v107, v54, v55
  v_mfma_f32_16x16x32_bf16 v[32:35], a[76:79], a[48:51], v[32:35]
  s_waitcnt lgkmcnt(3)
  v_exp_f32 v57, v57
  v_mfma_f32_16x16x32_bf16 v[36:39], a[80:83], a[0:3], v[64:67]
  s_waitcnt lgkmcnt(2)
  v_exp_f32 v58, v58
  v_mfma_f32_16x16x32_bf16 v[36:39], a[84:87], a[16:19], v[36:39]
  s_waitcnt lgkmcnt(1)
  v_cvt_pk_bf16_f32 v108, v56, v57
  v_mfma_f32_16x16x32_bf16 v[36:39], a[88:91], a[32:35], v[36:39]
  s_waitcnt lgkmcnt(0)
  v_mfma_f32_16x16x32_bf16 v[36:39], a[92:95], a[48:51], v[36:39]
  buffer_load_dwordx4 v13, s[12:15], s20 offen offset:1024 lds
  v_mfma_f32_16x16x32_bf16 v[40:43], a[64:67], a[4:7], v[68:71]
  v_exp_f32 v59, v59
  v_mfma_f32_16x16x32_bf16 v[40:43], a[68:71], a[20:23], v[40:43]
  v_exp_f32 v60, v60
  v_mfma_f32_16x16x32_bf16 v[40:43], a[72:75], a[36:39], v[40:43]
  v_cvt_pk_bf16_f32 v109, v58, v59
  v_mfma_f32_16x16x32_bf16 v[40:43], a[76:79], a[52:55], v[40:43]
  buffer_load_dwordx4 v12, s[12:15], s20 offen offset:2048 lds
  v_mfma_f32_16x16x32_bf16 v[44:47], a[80:83], a[4:7], v[68:71]
  v_exp_f32 v61, v61
  v_mfma_f32_16x16x32_bf16 v[44:47], a[84:87], a[20:23], v[44:47]
  v_exp_f32 v62, v62
  v_mfma_f32_16x16x32_bf16 v[44:47], a[88:91], a[36:39], v[44:47]
  v_cvt_pk_bf16_f32 v110, v60, v61
  v_mfma_f32_16x16x32_bf16 v[44:47], a[92:95], a[52:55], v[44:47]
  v_exp_f32 v63, v63
  v_mfma_f32_16x16x32_bf16 v[136:139], a[96:99], v[104:107], v[136:139]
  buffer_load_dwordx4 v13, s[12:15], s20 offen offset:3072 lds
  s_add_u32 s20, s20, 16384
  v_mfma_f32_16x16x32_bf16 v[152:155], a[100:103], v[104:107], v[152:155]
  v_cvt_pk_bf16_f32 v111, v62, v63
  v_mfma_f32_16x16x32_bf16 v[168:171], a[104:107], v[104:107], v[168:171]
  v_mfma_f32_16x16x32_bf16 v[184:187], a[108:111], v[104:107], v[184:187]
  v_mfma_f32_16x16x32_bf16 v[200:203], a[112:115], v[104:107], v[200:203]
  v_exp_f32 v32, v32
  v_mfma_f32_16x16x32_bf16 v[216:219], a[116:119], v[104:107], v[216:219]
  v_exp_f32 v33, v33
  v_mfma_f32_16x16x32_bf16 v[232:235], a[120:123], v[104:107], v[232:235]
  v_exp_f32 v34, v34
  v_mfma_f32_16x16x32_bf16 v[248:251], a[124:127], v[104:107], v[248:251]
  v_cvt_pk_bf16_f32 v96, v32, v33
  v_mfma_f32_16x16x32_bf16 v[88:91], v[112:115], v[104:107], v[88:91]
  v_exp_f32 v35, v35
  v_mfma_f32_16x16x32_bf16 v[140:143], a[96:99], v[108:111], v[140:143]
  v_exp_f32 v36, v36
  v_mfma_f32_16x16x32_bf16 v[156:159], a[100:103], v[108:111], v[156:159]
  ds_read_b64_tr_b16 a[96:97], v120 offset:8192
  ds_read_b64_tr_b16 a[98:99], v120 offset:12288
  v_mfma_f32_16x16x32_bf16 v[172:175], a[104:107], v[108:111], v[172:175]
  ds_read_b64_tr_b16 a[100:101], v121 offset:8192
  v_cvt_pk_bf16_f32 v97, v34, v35
  v_mfma_f32_16x16x32_bf16 v[188:191], a[108:111], v[108:111], v[188:191]
  ds_read_b64_tr_b16 a[102:103], v121 offset:12288
  v_mfma_f32_16x16x32_bf16 v[204:207], a[112:115], v[108:111], v[204:207]
  v_exp_f32 v37, v37
  v_mfma_f32_16x16x32_bf16 v[220:223], a[116:119], v[108:111], v[220:223]
  ds_read_b64_tr_b16 a[104:105], v122 offset:8192
  ds_read_b64_tr_b16 a[106:107], v122 offset:12288
  v_mfma_f32_16x16x32_bf16 v[236:239], a[120:123], v[108:111], v[236:239]
  v_exp_f32 v38, v38
  v_mfma_f32_16x16x32_bf16 v[252:255], a[124:127], v[108:111], v[252:255]
  ds_read_b64_tr_b16 a[108:109], v123 offset:8192
  v_cvt_pk_bf16_f32 v98, v36, v37
  v_mfma_f32_16x16x32_bf16 v[92:95], v[112:115], v[108:111], v[92:95]
  ds_read_b64_tr_b16 a[110:111], v123 offset:12288
  ds_read_b64_tr_b16 a[112:113], v124 offset:8192
  v_mfma_f32_16x16x32_bf16 v[48:51], a[64:67], a[8:11], v[72:75]
  v_exp_f32 v39, v39
  v_mfma_f32_16x16x32_bf16 v[48:51], a[68:71], a[24:27], v[48:51]
  v_exp_f32 v40, v40
  v_mfma_f32_16x16x32_bf16 v[48:51], a[72:75], a[40:43], v[48:51]
  ds_read_b64_tr_b16 a[114:115], v124 offset:12288
  v_cvt_pk_bf16_f32 v99, v38, v39
  v_mfma_f32_16x16x32_bf16 v[48:51], a[76:79], a[56:59], v[48:51]
  ds_read_b64_tr_b16 a[116:117], v125 offset:8192
  ds_read_b64_tr_b16 a[118:119], v125 offset:12288
  v_mfma_f32_16x16x32_bf16 v[52:55], a[80:83], a[8:11], v[72:75]
  v_exp_f32 v41, v41
  v_mfma_f32_16x16x32_bf16 v[52:55], a[84:87], a[24:27], v[52:55]
  ds_read_b64_tr_b16 a[120:121], v126 offset:8192
  ds_read_b64_tr_b16 a[122:123], v126 offset:12288
  v_mfma_f32_16x16x32_bf16 v[52:55], a[88:91], a[40:43], v[52:55]
  v_exp_f32 v42, v42
  v_mfma_f32_16x16x32_bf16 v[52:55], a[92:95], a[56:59], v[52:55]
  ds_read_b64_tr_b16 a[124:125], v127 offset:8192
  v_cvt_pk_bf16_f32 v100, v40, v41
  v_mfma_f32_16x16x32_bf16 v[56:59], a[64:67], a[12:15], v[76:79]
  v_exp_f32 v43, v43
  v_mfma_f32_16x16x32_bf16 v[56:59], a[68:71], a[28:31], v[56:59]
  ds_read_b64_tr_b16 a[126:127], v127 offset:12288
  v_mfma_f32_16x16x32_bf16 v[56:59], a[72:75], a[44:47], v[56:59]
  v_exp_f32 v44, v44
  v_mfma_f32_16x16x32_bf16 v[56:59], a[76:79], a[60:63], v[56:59]
  v_cvt_pk_bf16_f32 v101, v42, v43
  v_mfma_f32_16x16x32_bf16 v[60:63], a[80:83], a[12:15], v[76:79]
  v_exp_f32 v45, v45
  v_mfma_f32_16x16x32_bf16 v[60:63], a[84:87], a[28:31], v[60:63]
  v_exp_f32 v46, v46
  v_mfma_f32_16x16x32_bf16 v[60:63], a[88:91], a[44:47], v[60:63]
  v_mfma_f32_16x16x32_bf16 v[60:63], a[92:95], a[60:63], v[60:63]
  s_waitcnt vmcnt(9) lgkmcnt(0)
  s_barrier
  v_mfma_f32_16x16x32_bf16 v[128:131], a[96:99], v[96:99], v[128:131]
  ds_read_b128 a[64:67], v116 offset:16384
  v_cvt_pk_bf16_f32 v102, v44, v45
  v_mfma_f32_16x16x32_bf16 v[144:147], a[100:103], v[96:99], v[144:147]
  v_exp_f32 v47, v47
  v_mfma_f32_16x16x32_bf16 v[160:163], a[104:107], v[96:99], v[160:163]
  ds_read_b128 a[68:71], v117 offset:16384
  v_cvt_pk_bf16_f32 v103, v46, v47
  v_mfma_f32_16x16x32_bf16 v[176:179], a[108:111], v[96:99], v[176:179]
  ds_read_b128 a[72:75], v118 offset:16384
  v_mfma_f32_16x16x32_bf16 v[192:195], a[112:115], v[96:99], v[192:195]
  v_exp_f32 v48, v48
  v_mfma_f32_16x16x32_bf16 v[208:211], a[116:119], v[96:99], v[208:211]
  v_exp_f32 v49, v49
  v_mfma_f32_16x16x32_bf16 v[224:227], a[120:123], v[96:99], v[224:227]
  ds_read_b128 a[76:79], v119 offset:16384
  v_mfma_f32_16x16x32_bf16 v[240:243], a[124:127], v[96:99], v[240:243]
  v_exp_f32 v50, v50
  v_mfma_f32_16x16x32_bf16 v[80:83], v[112:115], v[96:99], v[80:83]
  ds_read_b128 a[80:83], v116 offset:20480
  v_cvt_pk_bf16_f32 v104, v48, v49
  v_mfma_f32_16x16x32_bf16 v[132:135], a[96:99], v[100:103], v[132:135]
  s_add_u32 m0, s21, 0
  v_exp_f32 v51, v51
  v_mfma_f32_16x16x32_bf16 v[148:151], a[100:103], v[100:103], v[148:151]
  buffer_load_dwordx4 v8, s[8:11], s20 offen lds
  v_mfma_f32_16x16x32_bf16 v[164:167], a[104:107], v[100:103], v[164:167]
  v_exp_f32 v52, v52
  v_mfma_f32_16x16x32_bf16 v[180:183], a[108:111], v[100:103], v[180:183]
  ds_read_b128 a[84:87], v117 offset:20480
  v_cvt_pk_bf16_f32 v105, v50, v51
  v_mfma_f32_16x16x32_bf16 v[196:199], a[112:115], v[100:103], v[196:199]
  ds_read_b128 a[88:91], v118 offset:20480
  v_mfma_f32_16x16x32_bf16 v[212:215], a[116:119], v[100:103], v[212:215]
  v_exp_f32 v53, v53
  v_mfma_f32_16x16x32_bf16 v[228:231], a[120:123], v[100:103], v[228:231]
  v_exp_f32 v54, v54
  v_mfma_f32_16x16x32_bf16 v[244:247], a[124:127], v[100:103], v[244:247]
  buffer_load_dwordx4 v9, s[8:11], s20 offen offset:1024 lds
  v_mfma_f32_16x16x32_bf16 v[84:87], v[112:115], v[100:103], v[84:87]
  s_waitcnt lgkmcnt(6)
  ds_read_b128 a[92:95], v119 offset:20480
  v_cvt_pk_bf16_f32 v106, v52, v53
  v_mfma_f32_16x16x32_bf16 v[32:35], a[64:67], a[0:3], v[64:67]
  s_waitcnt lgkmcnt(6)
  v_exp_f32 v55, v55
  v_mfma_f32_16x16x32_bf16 v[32:35], a[68:71], a[16:19], v[32:35]
  s_waitcnt lgkmcnt(5)
  v_exp_f32 v56, v56
  v_mfma_f32_16x16x32_bf16 v[32:35], a[72:75], a[32:35], v[32:35]
  s_waitcnt lgkmcnt(4)
  v_cvt_pk_bf16_f32 v107, v54, v55
  v_mfma_f32_16x16x32_bf16 v[32:35], a[76:79], a[48:51], v[32:35]
  s_waitcnt lgkmcnt(3)
  buffer_load_dwordx4 v10, s[8:11], s20 offen offset:2048 lds
  v_mfma_f32_16x16x32_bf16 v[36:39], a[80:83], a[0:3], v[64:67]
  s_waitcnt lgkmcnt(2)
  v_exp_f32 v57, v57
  v_mfma_f32_16x16x32_bf16 v[36:39], a[84:87], a[16:19], v[36:39]
  s_waitcnt lgkmcnt(1)
  v_exp_f32 v58, v58
  v_mfma_f32_16x16x32_bf16 v[36:39], a[88:91], a[32:35], v[36:39]
  s_waitcnt lgkmcnt(0)
  v_cvt_pk_bf16_f32 v108, v56, v57
  v_mfma_f32_16x16x32_bf16 v[36:39], a[92:95], a[48:51], v[36:39]
  v_exp_f32 v59, v59
  v_mfma_f32_16x16x32_bf16 v[40:43], a[64:67], a[4:7], v[68:71]
  v_exp_f32 v60, v60
  v_mfma_f32_16x16x32_bf16 v[40:43], a[68:71], a[20:23], v[40:43]
  buffer_load_dwordx4 v11, s[8:11], s20 offen offset:3072 lds
  v_mfma_f32_16x16x32_bf16 v[40:43], a[72:75], a[36:39], v[40:43]
  v_cvt_pk_bf16_f32 v109, v58, v59
  v_mfma_f32_16x16x32_bf16 v[40:43], a[76:79], a[52:55], v[40:43]
  v_exp_f32 v61, v61
  v_mfma_f32_16x16x32_bf16 v[44:47], a[80:83], a[4:7], v[68:71]
  v_exp_f32 v62, v62
  v_mfma_f32_16x16x32_bf16 v[44:47], a[84:87], a[20:23], v[44:47]
  v_mfma_f32_16x16x32_bf16 v[44:47], a[88:91], a[36:39], v[44:47]
  v_cvt_pk_bf16_f32 v110, v60, v61
  v_mfma_f32_16x16x32_bf16 v[44:47], a[92:95], a[52:55], v[44:47]
  v_exp_f32 v63, v63
  v_mfma_f32_16x16x32_bf16 v[136:139], a[96:99], v[104:107], v[136:139]
  s_add_u32 m0, s21, 49152
  v_mfma_f32_16x16x32_bf16 v[152:155], a[100:103], v[104:107], v[152:155]
  buffer_load_dwordx4 v12, s[12:15], s20 offen lds
  v_mfma_f32_16x16x32_bf16 v[168:171], a[104:107], v[104:107], v[168:171]
  v_cvt_pk_bf16_f32 v111, v62, v63
  v_mfma_f32_16x16x32_bf16 v[184:187], a[108:111], v[104:107], v[184:187]
  v_mfma_f32_16x16x32_bf16 v[200:203], a[112:115], v[104:107], v[200:203]
  v_exp_f32 v32, v32
  v_mfma_f32_16x16x32_bf16 v[216:219], a[116:119], v[104:107], v[216:219]
  v_exp_f32 v33, v33
  v_mfma_f32_16x16x32_bf16 v[232:235], a[120:123], v[104:107], v[232:235]
  buffer_load_dwordx4 v13, s[12:15], s20 offen offset:1024 lds
  v_mfma_f32_16x16x32_bf16 v[248:251], a[124:127], v[104:107], v[248:251]
  v_exp_f32 v34, v34
  v_mfma_f32_16x16x32_bf16 v[88:91], v[112:115], v[104:107], v[88:91]
  v_cvt_pk_bf16_f32 v96, v32, v33
  v_mfma_f32_16x16x32_bf16 v[140:143], a[96:99], v[108:111], v[140:143]
  v_exp_f32 v35, v35
  v_mfma_f32_16x16x32_bf16 v[156:159], a[100:103], v[108:111], v[156:159]
  ds_read_b64_tr_b16 a[96:97], v120 offset:16384
  ds_read_b64_tr_b16 a[98:99], v120 offset:20480
  v_mfma_f32_16x16x32_bf16 v[172:175], a[104:107], v[108:111], v[172:175]
  v_exp_f32 v36, v36
  v_mfma_f32_16x16x32_bf16 v[188:191], a[108:111], v[108:111], v[188:191]
  buffer_load_dwordx4 v12, s[12:15], s20 offen offset:2048 lds
  v_mfma_f32_16x16x32_bf16 v[204:207], a[112:115], v[108:111], v[204:207]
  ds_read_b64_tr_b16 a[100:101], v121 offset:16384
  v_cvt_pk_bf16_f32 v97, v34, v35
  v_mfma_f32_16x16x32_bf16 v[220:223], a[116:119], v[108:111], v[220:223]
  ds_read_b64_tr_b16 a[102:103], v121 offset:20480
  ds_read_b64_tr_b16 a[104:105], v122 offset:16384
  v_mfma_f32_16x16x32_bf16 v[236:239], a[120:123], v[108:111], v[236:239]
  v_exp_f32 v37, v37
  v_mfma_f32_16x16x32_bf16 v[252:255], a[124:127], v[108:111], v[252:255]
  v_exp_f32 v38, v38
  v_mfma_f32_16x16x32_bf16 v[92:95], v[112:115], v[108:111], v[92:95]
  buffer_load_dwordx4 v13, s[12:15], s20 offen offset:3072 lds
  s_add_u32 s20, s20, 16384
  v_mfma_f32_16x16x32_bf16 v[48:51], a[64:67], a[8:11], v[72:75]
  ds_read_b64_tr_b16 a[106:107], v122 offset:20480
  v_cvt_pk_bf16_f32 v98, v36, v37
  v_mfma_f32_16x16x32_bf16 v[48:51], a[68:71], a[24:27], v[48:51]
  ds_read_b64_tr_b16 a[108:109], v123 offset:16384
  ds_read_b64_tr_b16 a[110:111], v123 offset:20480
  v_mfma_f32_16x16x32_bf16 v[48:51], a[72:75], a[40:43], v[48:51]
  v_exp_f32 v39, v39
  v_mfma_f32_16x16x32_bf16 v[48:51], a[76:79], a[56:59], v[48:51]
  ds_read_b64_tr_b16 a[112:113], v124 offset:16384
  ds_read_b64_tr_b16 a[114:115], v124 offset:20480
  v_mfma_f32_16x16x32_bf16 v[52:55], a[80:83], a[8:11], v[72:75]
  s_mov_b32 m0, s40
  v_exp_f32 v40, v40
  v_mfma_f32_16x16x32_bf16 v[52:55], a[84:87], a[24:27], v[52:55]
  buffer_load_dwordx4 v18, s[52:55], s39 offen lds
  v_mfma_f32_16x16x32_bf16 v[52:55], a[88:91], a[40:43], v[52:55]
  ds_read_b64_tr_b16 a[116:117], v125 offset:16384
  v_cvt_pk_bf16_f32 v99, v38, v39
  v_mfma_f32_16x16x32_bf16 v[52:55], a[92:95], a[56:59], v[52:55]
  ds_read_b64_tr_b16 a[118:119], v125 offset:20480
  ds_read_b64_tr_b16 a[120:121], v126 offset:16384
  v_exp_f32 v41, v41
  v_mfma_f32_16x16x32_bf16 v[56:59], a[64:67], a[12:15], v[76:79]
  v_exp_f32 v42, v42
  v_mfma_f32_16x16x32_bf16 v[56:59], a[68:71], a[28:31], v[56:59]
  buffer_load_dwordx4 v19, s[52:55], s39 offen offset:1024 lds
  v_mfma_f32_16x16x32_bf16 v[56:59], a[72:75], a[44:47], v[56:59]
  ds_read_b64_tr_b16 a[122:123], v126 offset:20480
  ds_read_b64_tr_b16 a[124:125], v127 offset:16384
  v_cvt_pk_bf16_f32 v100, v40, v41
  v_mfma_f32_16x16x32_bf16 v[56:59], a[76:79], a[60:63], v[56:59]
  ds_read_b64_tr_b16 a[126:127], v127 offset:20480
  v_exp_f32 v43, v43
  v_mfma_f32_16x16x32_bf16 v[60:63], a[80:83], a[12:15], v[76:79]
  v_exp_f32 v44, v44
  v_mfma_f32_16x16x32_bf16 v[60:63], a[84:87], a[28:31], v[60:63]
  v_cvt_pk_bf16_f32 v101, v42, v43
  v_mfma_f32_16x16x32_bf16 v[60:63], a[88:91], a[44:47], v[60:63]
  buffer_load_dwordx4 v20, s[52:55], s39 offen offset:2048 lds
  v_mfma_f32_16x16x32_bf16 v[60:63], a[92:95], a[60:63], v[60:63]
  s_waitcnt lgkmcnt(14)
  v_exp_f32 v45, v45
  v_mfma_f32_16x16x32_bf16 v[128:131], a[96:99], v[96:99], v[128:131]
  s_waitcnt lgkmcnt(12)
  v_exp_f32 v46, v46
  v_mfma_f32_16x16x32_bf16 v[144:147], a[100:103], v[96:99], v[144:147]
  s_waitcnt lgkmcnt(10)
  ds_read_b128 a[64:67], v116 offset:24576
  v_cvt_pk_bf16_f32 v102, v44, v45
  v_mfma_f32_16x16x32_bf16 v[160:163], a[104:107], v[96:99], v[160:163]
  s_waitcnt lgkmcnt(9)
  buffer_load_dwordx4 v21, s[52:55], s39 offen offset:3072 lds
  v_mfma_f32_16x16x32_bf16 v[176:179], a[108:111], v[96:99], v[176:179]
  s_waitcnt lgkmcnt(7)
  v_exp_f32 v47, v47
  v_mfma_f32_16x16x32_bf16 v[192:195], a[112:115], v[96:99], v[192:195]
  s_waitcnt lgkmcnt(5)
  ds_read_b128 a[68:71], v117 offset:24576
  v_cvt_pk_bf16_f32 v103, v46, v47
  v_mfma_f32_16x16x32_bf16 v[208:211], a[116:119], v[96:99], v[208:211]
  s_waitcnt lgkmcnt(4)
  s_add_u32 s39, s39, 131072
  v_exp_f32 v48, v48
  v_mfma_f32_16x16x32_bf16 v[224:227], a[120:123], v[96:99], v[224:227]
  s_waitcnt lgkmcnt(2)
  s_add_u32 m0, s40, 4096
  ds_read_b128 a[72:75], v118 offset:24576
  ds_read_b128 a[76:79], v119 offset:24576
  v_mfma_f32_16x16x32_bf16 v[240:243], a[124:127], v[96:99], v[240:243]
  buffer_load_dwordx4 v18, s[52:55], s39 offen lds
  v_mfma_f32_16x16x32_bf16 v[80:83], v[112:115], v[96:99], v[80:83]
  v_exp_f32 v49, v49
  v_mfma_f32_16x16x32_bf16 v[132:135], a[96:99], v[100:103], v[132:135]
  v_exp_f32 v50, v50
  v_mfma_f32_16x16x32_bf16 v[148:151], a[100:103], v[100:103], v[148:151]
  ds_read_b128 a[80:83], v116 offset:28672
  v_cvt_pk_bf16_f32 v104, v48, v49
  v_mfma_f32_16x16x32_bf16 v[164:167], a[104:107], v[100:103], v[164:167]
  buffer_load_dwordx4 v19, s[52:55], s39 offen offset:1024 lds
  v_mfma_f32_16x16x32_bf16 v[180:183], a[108:111], v[100:103], v[180:183]
  v_exp_f32 v51, v51
  v_mfma_f32_16x16x32_bf16 v[196:199], a[112:115], v[100:103], v[196:199]
  v_exp_f32 v52, v52
  v_mfma_f32_16x16x32_bf16 v[212:215], a[116:119], v[100:103], v[212:215]
  ds_read_b128 a[84:87], v117 offset:28672
  v_cvt_pk_bf16_f32 v105, v50, v51
  v_mfma_f32_16x16x32_bf16 v[228:231], a[120:123], v[100:103], v[228:231]
  ds_read_b128 a[88:91], v118 offset:28672
  ds_read_b128 a[92:95], v119 offset:28672
  v_mfma_f32_16x16x32_bf16 v[244:247], a[124:127], v[100:103], v[244:247]
  buffer_load_dwordx4 v20, s[52:55], s39 offen offset:2048 lds
  v_mfma_f32_16x16x32_bf16 v[84:87], v[112:115], v[100:103], v[84:87]
  s_waitcnt lgkmcnt(7)
  v_exp_f32 v53, v53
  v_mfma_f32_16x16x32_bf16 v[32:35], a[64:67], a[0:3], v[64:67]
  s_waitcnt lgkmcnt(6)
  v_exp_f32 v54, v54
  v_mfma_f32_16x16x32_bf16 v[32:35], a[68:71], a[16:19], v[32:35]
  s_waitcnt lgkmcnt(5)
  v_cvt_pk_bf16_f32 v106, v52, v53
  v_mfma_f32_16x16x32_bf16 v[32:35], a[72:75], a[32:35], v[32:35]
  s_waitcnt lgkmcnt(4)
  buffer_load_dwordx4 v21, s[52:55], s39 offen offset:3072 lds
  v_mfma_f32_16x16x32_bf16 v[32:35], a[76:79], a[48:51], v[32:35]
  s_waitcnt lgkmcnt(3)
  v_exp_f32 v55, v55
  v_mfma_f32_16x16x32_bf16 v[36:39], a[80:83], a[0:3], v[64:67]
  s_waitcnt lgkmcnt(2)
  v_exp_f32 v56, v56
  v_mfma_f32_16x16x32_bf16 v[36:39], a[84:87], a[16:19], v[36:39]
  s_waitcnt lgkmcnt(1)
  s_add_u32 s39, s39, 131072
  s_xor_b32 s40, s40, 8192
  v_cvt_pk_bf16_f32 v107, v54, v55
  v_mfma_f32_16x16x32_bf16 v[36:39], a[88:91], a[32:35], v[36:39]
  s_waitcnt lgkmcnt(0)
  s_mov_b32 m0, s40
  v_exp_f32 v57, v57
  v_mfma_f32_16x16x32_bf16 v[36:39], a[92:95], a[48:51], v[36:39]
  buffer_load_dwordx4 v18, s[52:55], s39 offen lds
  v_mfma_f32_16x16x32_bf16 v[40:43], a[64:67], a[4:7], v[68:71]
  v_exp_f32 v58, v58
  v_mfma_f32_16x16x32_bf16 v[40:43], a[68:71], a[20:23], v[40:43]
  v_cvt_pk_bf16_f32 v108, v56, v57
  v_mfma_f32_16x16x32_bf16 v[40:43], a[72:75], a[36:39], v[40:43]
  v_exp_f32 v59, v59
  v_mfma_f32_16x16x32_bf16 v[40:43], a[76:79], a[52:55], v[40:43]
  buffer_load_dwordx4 v19, s[52:55], s39 offen offset:1024 lds
  v_mfma_f32_16x16x32_bf16 v[44:47], a[80:83], a[4:7], v[68:71]
  v_exp_f32 v60, v60
  v_mfma_f32_16x16x32_bf16 v[44:47], a[84:87], a[20:23], v[44:47]
  v_cvt_pk_bf16_f32 v109, v58, v59
  v_mfma_f32_16x16x32_bf16 v[44:47], a[88:91], a[36:39], v[44:47]
  v_exp_f32 v61, v61
  v_mfma_f32_16x16x32_bf16 v[44:47], a[92:95], a[52:55], v[44:47]
  v_exp_f32 v62, v62
  v_mfma_f32_16x16x32_bf16 v[136:139], a[96:99], v[104:107], v[136:139]
  buffer_load_dwordx4 v20, s[52:55], s39 offen offset:2048 lds
  v_mfma_f32_16x16x32_bf16 v[152:155], a[100:103], v[104:107], v[152:155]
  v_cvt_pk_bf16_f32 v110, v60, v61
  v_mfma_f32_16x16x32_bf16 v[168:171], a[104:107], v[104:107], v[168:171]
  v_exp_f32 v63, v63
  v_mfma_f32_16x16x32_bf16 v[184:187], a[108:111], v[104:107], v[184:187]
  v_cvt_pk_bf16_f32 v111, v62, v63
  v_mfma_f32_16x16x32_bf16 v[200:203], a[112:115], v[104:107], v[200:203]
  buffer_load_dwordx4 v21, s[52:55], s39 offen offset:3072 lds
  v_mfma_f32_16x16x32_bf16 v[216:219], a[116:119], v[104:107], v[216:219]
  v_exp_f32 v32, v32
  v_mfma_f32_16x16x32_bf16 v[232:235], a[120:123], v[104:107], v[232:235]
  v_exp_f32 v33, v33
  v_mfma_f32_16x16x32_bf16 v[248:251], a[124:127], v[104:107], v[248:251]
  s_add_u32 s39, s39, 131072
  v_exp_f32 v34, v34
  v_mfma_f32_16x16x32_bf16 v[88:91], v[112:115], v[104:107], v[88:91]
  s_add_u32 m0, s40, 4096
  v_cvt_pk_bf16_f32 v96, v32, v33
  v_mfma_f32_16x16x32_bf16 v[140:143], a[96:99], v[108:111], v[140:143]
  buffer_load_dwordx4 v18, s[52:55], s39 offen lds
  v_mfma_f32_16x16x32_bf16 v[156:159], a[100:103], v[108:111], v[156:159]
  v_exp_f32 v35, v35
  v_mfma_f32_16x16x32_bf16 v[172:175], a[104:107], v[108:111], v[172:175]
  ds_read_b64_tr_b16 a[96:97], v120 offset:24576
  ds_read_b64_tr_b16 a[98:99], v120 offset:28672
  v_mfma_f32_16x16x32_bf16 v[188:191], a[108:111], v[108:111], v[188:191]
  v_exp_f32 v36, v36
  v_mfma_f32_16x16x32_bf16 v[204:207], a[112:115], v[108:111], v[204:207]
  buffer_load_dwordx4 v19, s[52:55], s39 offen offset:1024 lds
  v_mfma_f32_16x16x32_bf16 v[220:223], a[116:119], v[108:111], v[220:223]
  ds_read_b64_tr_b16 a[100:101], v121 offset:24576
  v_cvt_pk_bf16_f32 v97, v34, v35
  v_mfma_f32_16x16x32_bf16 v[236:239], a[120:123], v[108:111], v[236:239]
  ds_read_b64_tr_b16 a[102:103], v121 offset:28672
  ds_read_b64_tr_b16 a[104:105], v122 offset:24576
  v_mfma_f32_16x16x32_bf16 v[252:255], a[124:127], v[108:111], v[252:255]
  v_exp_f32 v37, v37
  v_mfma_f32_16x16x32_bf16 v[92:95], v[112:115], v[108:111], v[92:95]
  v_exp_f32 v38, v38
  v_mfma_f32_16x16x32_bf16 v[48:51], a[64:67], a[8:11], v[72:75]
  buffer_load_dwordx4 v20, s[52:55], s39 offen offset:2048 lds
  v_mfma_f32_16x16x32_bf16 v[48:51], a[68:71], a[24:27], v[48:51]
  ds_read_b64_tr_b16 a[106:107], v122 offset:28672
  ds_read_b64_tr_b16 a[108:109], v123 offset:24576
  v_cvt_pk_bf16_f32 v98, v36, v37
  v_mfma_f32_16x16x32_bf16 v[48:51], a[72:75], a[40:43], v[48:51]
  ds_read_b64_tr_b16 a[110:111], v123 offset:28672
  ds_read_b64_tr_b16 a[112:113], v124 offset:24576
  v_mfma_f32_16x16x32_bf16 v[48:51], a[76:79], a[56:59], v[48:51]
  v_exp_f32 v39, v39
  v_mfma_f32_16x16x32_bf16 v[52:55], a[80:83], a[8:11], v[72:75]
  buffer_load_dwordx4 v21, s[52:55], s39 offen offset:3072 lds
  v_mfma_f32_16x16x32_bf16 v[52:55], a[84:87], a[24:27], v[52:55]
  ds_read_b64_tr_b16 a[114:115], v124 offset:28672
  v_exp_f32 v40, v40
  v_mfma_f32_16x16x32_bf16 v[52:55], a[88:91], a[40:43], v[52:55]
  ds_read_b64_tr_b16 a[116:117], v125 offset:24576
  v_cvt_pk_bf16_f32 v99, v38, v39
  v_mfma_f32_16x16x32_bf16 v[52:55], a[92:95], a[56:59], v[52:55]
  s_add_u32 s39, s39, 131072
  s_xor_b32 s40, s40, 8192
  ds_read_b64_tr_b16 a[118:119], v125 offset:28672
  ds_read_b64_tr_b16 a[120:121], v126 offset:24576
  v_exp_f32 v41, v41
  v_mfma_f32_16x16x32_bf16 v[56:59], a[64:67], a[12:15], v[76:79]
  v_exp_f32 v42, v42
  v_mfma_f32_16x16x32_bf16 v[56:59], a[68:71], a[28:31], v[56:59]
  ds_read_b64_tr_b16 a[122:123], v126 offset:28672
  v_cvt_pk_bf16_f32 v100, v40, v41
  v_mfma_f32_16x16x32_bf16 v[56:59], a[72:75], a[44:47], v[56:59]
  ds_read_b64_tr_b16 a[124:125], v127 offset:24576
  ds_read_b64_tr_b16 a[126:127], v127 offset:28672
  v_mfma_f32_16x16x32_bf16 v[56:59], a[76:79], a[60:63], v[56:59]
  v_exp_f32 v43, v43
  v_mfma_f32_16x16x32_bf16 v[60:63], a[80:83], a[12:15], v[76:79]
  v_exp_f32 v44, v44
  v_mfma_f32_16x16x32_bf16 v[60:63], a[84:87], a[28:31], v[60:63]
  v_cvt_pk_bf16_f32 v101, v42, v43
  v_mfma_f32_16x16x32_bf16 v[60:63], a[88:91], a[44:47], v[60:63]
  v_exp_f32 v45, v45
  v_mfma_f32_16x16x32_bf16 v[60:63], a[92:95], a[60:63], v[60:63]
  v_exp_f32 v46, v46
  s_waitcnt vmcnt(24) lgkmcnt(0)
  s_barrier
  v_mfma_f32_16x16x32_bf16 v[128:131], a[96:99], v[96:99], v[128:131]
  ds_read_b128 a[64:67], v116 offset:32768
  v_cvt_pk_bf16_f32 v102, v44, v45
  v_mfma_f32_16x16x32_bf16 v[144:147], a[100:103], v[96:99], v[144:147]
  v_exp_f32 v47, v47
  v_mfma_f32_16x16x32_bf16 v[160:163], a[104:107], v[96:99], v[160:163]
  ds_read_b128 a[68:71], v117 offset:32768
  v_cvt_pk_bf16_f32 v103, v46, v47
  v_mfma_f32_16x16x32_bf16 v[176:179], a[108:111], v[96:99], v[176:179]
  ds_read_b128 a[72:75], v118 offset:32768
  v_mfma_f32_16x16x32_bf16 v[192:195], a[112:115], v[96:99], v[192:195]
  v_exp_f32 v48, v48
  v_mfma_f32_16x16x32_bf16 v[208:211], a[116:119], v[96:99], v[208:211]
  v_exp_f32 v49, v49
  v_mfma_f32_16x16x32_bf16 v[224:227], a[120:123], v[96:99], v[224:227]
  ds_read_b128 a[76:79], v119 offset:32768
  v_mfma_f32_16x16x32_bf16 v[240:243], a[124:127], v[96:99], v[240:243]
  v_exp_f32 v50, v50
  v_mfma_f32_16x16x32_bf16 v[80:83], v[112:115], v[96:99], v[80:83]
  ds_read_b128 a[80:83], v116 offset:36864
  v_cvt_pk_bf16_f32 v104, v48, v49
  v_mfma_f32_16x16x32_bf16 v[132:135], a[96:99], v[100:103], v[132:135]
  v_exp_f32 v51, v51
  v_mfma_f32_16x16x32_bf16 v[148:151], a[100:103], v[100:103], v[148:151]
  v_exp_f32 v52, v52
  v_mfma_f32_16x16x32_bf16 v[164:167], a[104:107], v[100:103], v[164:167]
  ds_read_b128 a[84:87], v117 offset:36864
  v_cvt_pk_bf16_f32 v105, v50, v51
  v_mfma_f32_16x16x32_bf16 v[180:183], a[108:111], v[100:103], v[180:183]
  ds_read_b128 a[88:91], v118 offset:36864
  v_mfma_f32_16x16x32_bf16 v[196:199], a[112:115], v[100:103], v[196:199]
  v_exp_f32 v53, v53
  v_mfma_f32_16x16x32_bf16 v[212:215], a[116:119], v[100:103], v[212:215]
  v_exp_f32 v54, v54
  v_mfma_f32_16x16x32_bf16 v[228:231], a[120:123], v[100:103], v[228:231]
  ds_read_b128 a[92:95], v119 offset:36864
  v_cvt_pk_bf16_f32 v106, v52, v53
  v_mfma_f32_16x16x32_bf16 v[244:247], a[124:127], v[100:103], v[244:247]
  v_exp_f32 v55, v55
  v_mfma_f32_16x16x32_bf16 v[84:87], v[112:115], v[100:103], v[84:87]
  s_waitcnt lgkmcnt(7)
  v_mfma_f32_16x16x32_bf16 v[32:35], a[64:67], a[0:3], v[64:67]
  s_waitcnt lgkmcnt(6)
  s_add_u32 m0, s21, 16384
  v_exp_f32 v56, v56
  v_mfma_f32_16x16x32_bf16 v[32:35], a[68:71], a[16:19], v[32:35]
  s_waitcnt lgkmcnt(5)
  buffer_load_dwordx4 v8, s[8:11], s20 offen lds
  v_mfma_f32_16x16x32_bf16 v[32:35], a[72:75], a[32:35], v[32:35]
  s_waitcnt lgkmcnt(4)
  v_cvt_pk_bf16_f32 v107, v54, v55
  v_mfma_f32_16x16x32_bf16 v[32:35], a[76:79], a[48:51], v[32:35]
  s_waitcnt lgkmcnt(3)
  v_exp_f32 v57, v57
  v_mfma_f32_16x16x32_bf16 v[36:39], a[80:83], a[0:3], v[64:67]
  s_waitcnt lgkmcnt(2)
  v_exp_f32 v58, v58
  v_mfma_f32_16x16x32_bf16 v[36:39], a[84:87], a[16:19], v[36:39]
  s_waitcnt lgkmcnt(1)
  v_cvt_pk_bf16_f32 v108, v56, v57
  v_mfma_f32_16x16x32_bf16 v[36:39], a[88:91], a[32:35], v[36:39]
  s_waitcnt lgkmcnt(0)
  v_mfma_f32_16x16x32_bf16 v[36:39], a[92:95], a[48:51], v[36:39]
  buffer_load_dwordx4 v9, s[8:11], s20 offen offset:1024 lds
  v_mfma_f32_16x16x32_bf16 v[40:43], a[64:67], a[4:7], v[68:71]
  v_exp_f32 v59, v59
  v_mfma_f32_16x16x32_bf16 v[40:43], a[68:71], a[20:23], v[40:43]
  v_exp_f32 v60, v60
  v_mfma_f32_16x16x32_bf16 v[40:43], a[72:75], a[36:39], v[40:43]
  v_cvt_pk_bf16_f32 v109, v58, v59
  v_mfma_f32_16x16x32_bf16 v[40:43], a[76:79], a[52:55], v[40:43]
  buffer_load_dwordx4 v10, s[8:11], s20 offen offset:2048 lds
  v_mfma_f32_16x16x32_bf16 v[44:47], a[80:83], a[4:7], v[68:71]
  v_exp_f32 v61, v61
  v_mfma_f32_16x16x32_bf16 v[44:47], a[84:87], a[20:23], v[44:47]
  v_exp_f32 v62, v62
  v_mfma_f32_16x16x32_bf16 v[44:47], a[88:91], a[36:39], v[44:47]
  v_cvt_pk_bf16_f32 v110, v60, v61
  v_mfma_f32_16x16x32_bf16 v[44:47], a[92:95], a[52:55], v[44:47]
  v_exp_f32 v63, v63
  v_mfma_f32_16x16x32_bf16 v[136:139], a[96:99], v[104:107], v[136:139]
  buffer_load_dwordx4 v11, s[8:11], s20 offen offset:3072 lds
  v_mfma_f32_16x16x32_bf16 v[152:155], a[100:103], v[104:107], v[152:155]
  v_cvt_pk_bf16_f32 v111, v62, v63
  v_mfma_f32_16x16x32_bf16 v[168:171], a[104:107], v[104:107], v[168:171]
  v_mfma_f32_16x16x32_bf16 v[184:187], a[108:111], v[104:107], v[184:187]
  v_mfma_f32_16x16x32_bf16 v[200:203], a[112:115], v[104:107], v[200:203]
  v_exp_f32 v32, v32
  v_mfma_f32_16x16x32_bf16 v[216:219], a[116:119], v[104:107], v[216:219]
  v_exp_f32 v33, v33
  v_mfma_f32_16x16x32_bf16 v[232:235], a[120:123], v[104:107], v[232:235]
  v_exp_f32 v34, v34
  v_mfma_f32_16x16x32_bf16 v[248:251], a[124:127], v[104:107], v[248:251]
  v_cvt_pk_bf16_f32 v96, v32, v33
  v_mfma_f32_16x16x32_bf16 v[88:91], v[112:115], v[104:107], v[88:91]
  v_exp_f32 v35, v35
  v_mfma_f32_16x16x32_bf16 v[140:143], a[96:99], v[108:111], v[140:143]
  v_exp_f32 v36, v36
  v_mfma_f32_16x16x32_bf16 v[156:159], a[100:103], v[108:111], v[156:159]
  ds_read_b64_tr_b16 a[96:97], v120 offset:32768
  ds_read_b64_tr_b16 a[98:99], v120 offset:36864
  v_mfma_f32_16x16x32_bf16 v[172:175], a[104:107], v[108:111], v[172:175]
  ds_read_b64_tr_b16 a[100:101], v121 offset:32768
  v_cvt_pk_bf16_f32 v97, v34, v35
  v_mfma_f32_16x16x32_bf16 v[188:191], a[108:111], v[108:111], v[188:191]
  ds_read_b64_tr_b16 a[102:103], v121 offset:36864
  v_mfma_f32_16x16x32_bf16 v[204:207], a[112:115], v[108:111], v[204:207]
  v_exp_f32 v37, v37
  v_mfma_f32_16x16x32_bf16 v[220:223], a[116:119], v[108:111], v[220:223]
  ds_read_b64_tr_b16 a[104:105], v122 offset:32768
  ds_read_b64_tr_b16 a[106:107], v122 offset:36864
  v_mfma_f32_16x16x32_bf16 v[236:239], a[120:123], v[108:111], v[236:239]
  v_exp_f32 v38, v38
  v_mfma_f32_16x16x32_bf16 v[252:255], a[124:127], v[108:111], v[252:255]
  ds_read_b64_tr_b16 a[108:109], v123 offset:32768
  v_cvt_pk_bf16_f32 v98, v36, v37
  v_mfma_f32_16x16x32_bf16 v[92:95], v[112:115], v[108:111], v[92:95]
  ds_read_b64_tr_b16 a[110:111], v123 offset:36864
  ds_read_b64_tr_b16 a[112:113], v124 offset:32768
  v_mfma_f32_16x16x32_bf16 v[48:51], a[64:67], a[8:11], v[72:75]
  v_exp_f32 v39, v39
  v_mfma_f32_16x16x32_bf16 v[48:51], a[68:71], a[24:27], v[48:51]
  v_exp_f32 v40, v40
  v_mfma_f32_16x16x32_bf16 v[48:51], a[72:75], a[40:43], v[48:51]
  ds_read_b64_tr_b16 a[114:115], v124 offset:36864
  v_cvt_pk_bf16_f32 v99, v38, v39
  v_mfma_f32_16x16x32_bf16 v[48:51], a[76:79], a[56:59], v[48:51]
  ds_read_b64_tr_b16 a[116:117], v125 offset:32768
  ds_read_b64_tr_b16 a[118:119], v125 offset:36864
  v_mfma_f32_16x16x32_bf16 v[52:55], a[80:83], a[8:11], v[72:75]
  v_exp_f32 v41, v41
  v_mfma_f32_16x16x32_bf16 v[52:55], a[84:87], a[24:27], v[52:55]
  ds_read_b64_tr_b16 a[120:121], v126 offset:32768
  ds_read_b64_tr_b16 a[122:123], v126 offset:36864
  v_mfma_f32_16x16x32_bf16 v[52:55], a[88:91], a[40:43], v[52:55]
  s_lshl_b32 s44, s25, 5
  s_add_u32 s44, s44, s26
  s_lshl_b32 s44, s44, 2
  s_add_u32 s44, s44, s24
  s_lshl_b32 s44, s44, 12
  buffer_load_dwordx4 a[240:243], v22, s[32:35], s44 offen
  v_mfma_f32_16x16x32_bf16 v[52:55], a[92:95], a[56:59], v[52:55]
  v_exp_f32 v42, v42
  v_mfma_f32_16x16x32_bf16 v[56:59], a[64:67], a[12:15], v[76:79]
  ds_read_b64_tr_b16 a[124:125], v127 offset:32768
  v_cvt_pk_bf16_f32 v100, v40, v41
  v_mfma_f32_16x16x32_bf16 v[56:59], a[68:71], a[28:31], v[56:59]
  buffer_load_dwordx4 a[244:247], v22, s[32:35], s44 offen offset:1024
  v_mfma_f32_16x16x32_bf16 v[56:59], a[72:75], a[44:47], v[56:59]
  v_exp_f32 v43, v43
  v_mfma_f32_16x16x32_bf16 v[56:59], a[76:79], a[60:63], v[56:59]
  ds_read_b64_tr_b16 a[126:127], v127 offset:36864
  v_mfma_f32_16x16x32_bf16 v[60:63], a[80:83], a[12:15], v[76:79]
  v_exp_f32 v44, v44
  v_mfma_f32_16x16x32_bf16 v[60:63], a[84:87], a[28:31], v[60:63]
  buffer_load_dwordx4 a[248:251], v22, s[32:35], s44 offen offset:2048
  v_mfma_f32_16x16x32_bf16 v[60:63], a[88:91], a[44:47], v[60:63]
  v_cvt_pk_bf16_f32 v101, v42, v43
  v_mfma_f32_16x16x32_bf16 v[60:63], a[92:95], a[60:63], v[60:63]
  s_waitcnt lgkmcnt(14)
  v_exp_f32 v45, v45
  v_mfma_f32_16x16x32_bf16 v[128:131], a[96:99], v[96:99], v[128:131]
  s_waitcnt lgkmcnt(12)
  v_exp_f32 v46, v46
  v_mfma_f32_16x16x32_bf16 v[144:147], a[100:103], v[96:99], v[144:147]
  s_waitcnt lgkmcnt(10)
  ds_read_b128 a[64:67], v116 offset:40960
  v_cvt_pk_bf16_f32 v102, v44, v45
  v_mfma_f32_16x16x32_bf16 v[160:163], a[104:107], v[96:99], v[160:163]
  s_waitcnt lgkmcnt(9)
  buffer_load_dwordx4 a[252:255], v22, s[32:35], s44 offen offset:3072
  v_mfma_f32_16x16x32_bf16 v[176:179], a[108:111], v[96:99], v[176:179]
  s_waitcnt lgkmcnt(7)
  v_exp_f32 v47, v47
  v_mfma_f32_16x16x32_bf16 v[192:195], a[112:115], v[96:99], v[192:195]
  s_waitcnt lgkmcnt(5)
  ds_read_b128 a[68:71], v117 offset:40960
  v_cvt_pk_bf16_f32 v103, v46, v47
  v_mfma_f32_16x16x32_bf16 v[208:211], a[116:119], v[96:99], v[208:211]
  s_waitcnt lgkmcnt(4)
  v_exp_f32 v48, v48
  v_mfma_f32_16x16x32_bf16 v[224:227], a[120:123], v[96:99], v[224:227]
  s_waitcnt lgkmcnt(2)
  ds_read_b128 a[72:75], v118 offset:40960
  ds_read_b128 a[76:79], v119 offset:40960
  v_mfma_f32_16x16x32_bf16 v[240:243], a[124:127], v[96:99], v[240:243]
  v_exp_f32 v49, v49
  v_mfma_f32_16x16x32_bf16 v[80:83], v[112:115], v[96:99], v[80:83]
  v_exp_f32 v50, v50
  v_mfma_f32_16x16x32_bf16 v[132:135], a[96:99], v[100:103], v[132:135]
  ds_read_b128 a[80:83], v116 offset:45056
  v_cvt_pk_bf16_f32 v104, v48, v49
  v_mfma_f32_16x16x32_bf16 v[148:151], a[100:103], v[100:103], v[148:151]
  v_exp_f32 v51, v51
  v_mfma_f32_16x16x32_bf16 v[164:167], a[104:107], v[100:103], v[164:167]
  v_exp_f32 v52, v52
  v_mfma_f32_16x16x32_bf16 v[180:183], a[108:111], v[100:103], v[180:183]
  ds_read_b128 a[84:87], v117 offset:45056
  v_cvt_pk_bf16_f32 v105, v50, v51
  v_mfma_f32_16x16x32_bf16 v[196:199], a[112:115], v[100:103], v[196:199]
  ds_read_b128 a[88:91], v118 offset:45056
  v_mfma_f32_16x16x32_bf16 v[212:215], a[116:119], v[100:103], v[212:215]
  v_exp_f32 v53, v53
  v_mfma_f32_16x16x32_bf16 v[228:231], a[120:123], v[100:103], v[228:231]
  v_exp_f32 v54, v54
  v_mfma_f32_16x16x32_bf16 v[244:247], a[124:127], v[100:103], v[244:247]
  ds_read_b128 a[92:95], v119 offset:45056
  v_cvt_pk_bf16_f32 v106, v52, v53
  v_mfma_f32_16x16x32_bf16 v[84:87], v[112:115], v[100:103], v[84:87]
  s_waitcnt lgkmcnt(7)
  v_exp_f32 v55, v55
  v_mfma_f32_16x16x32_bf16 v[32:35], a[64:67], a[0:3], v[64:67]
  s_waitcnt lgkmcnt(6)
  s_add_u32 m0, s21, 65536
  v_exp_f32 v56, v56
  v_mfma_f32_16x16x32_bf16 v[32:35], a[68:71], a[16:19], v[32:35]
  s_waitcnt lgkmcnt(5)
  buffer_load_dwordx4 v12, s[12:15], s20 offen lds
  v_mfma_f32_16x16x32_bf16 v[32:35], a[72:75], a[32:35], v[32:35]
  s_waitcnt lgkmcnt(4)
  v_cvt_pk_bf16_f32 v107, v54, v55
  v_mfma_f32_16x16x32_bf16 v[32:35], a[76:79], a[48:51], v[32:35]
  s_waitcnt lgkmcnt(3)
  v_exp_f32 v57, v57
  v_mfma_f32_16x16x32_bf16 v[36:39], a[80:83], a[0:3], v[64:67]
  s_waitcnt lgkmcnt(2)
  v_exp_f32 v58, v58
  v_mfma_f32_16x16x32_bf16 v[36:39], a[84:87], a[16:19], v[36:39]
  s_waitcnt lgkmcnt(1)
  v_cvt_pk_bf16_f32 v108, v56, v57
  v_mfma_f32_16x16x32_bf16 v[36:39], a[88:91], a[32:35], v[36:39]
  s_waitcnt lgkmcnt(0)
  v_mfma_f32_16x16x32_bf16 v[36:39], a[92:95], a[48:51], v[36:39]
  buffer_load_dwordx4 v13, s[12:15], s20 offen offset:1024 lds
  v_mfma_f32_16x16x32_bf16 v[40:43], a[64:67], a[4:7], v[68:71]
  v_exp_f32 v59, v59
  v_mfma_f32_16x16x32_bf16 v[40:43], a[68:71], a[20:23], v[40:43]
  v_exp_f32 v60, v60
  v_mfma_f32_16x16x32_bf16 v[40:43], a[72:75], a[36:39], v[40:43]
  v_cvt_pk_bf16_f32 v109, v58, v59
  v_mfma_f32_16x16x32_bf16 v[40:43], a[76:79], a[52:55], v[40:43]
  buffer_load_dwordx4 v12, s[12:15], s20 offen offset:2048 lds
  v_mfma_f32_16x16x32_bf16 v[44:47], a[80:83], a[4:7], v[68:71]
  v_exp_f32 v61, v61
  v_mfma_f32_16x16x32_bf16 v[44:47], a[84:87], a[20:23], v[44:47]
  v_exp_f32 v62, v62
  v_mfma_f32_16x16x32_bf16 v[44:47], a[88:91], a[36:39], v[44:47]
  v_cvt_pk_bf16_f32 v110, v60, v61
  v_mfma_f32_16x16x32_bf16 v[44:47], a[92:95], a[52:55], v[44:47]
  v_exp_f32 v63, v63
  v_mfma_f32_16x16x32_bf16 v[136:139], a[96:99], v[104:107], v[136:139]
  buffer_load_dwordx4 v13, s[12:15], s20 offen offset:3072 lds
  s_add_u32 s20, s20, 16384
  v_mfma_f32_16x16x32_bf16 v[152:155], a[100:103], v[104:107], v[152:155]
  v_cvt_pk_bf16_f32 v111, v62, v63
  v_mfma_f32_16x16x32_bf16 v[168:171], a[104:107], v[104:107], v[168:171]
  v_mfma_f32_16x16x32_bf16 v[184:187], a[108:111], v[104:107], v[184:187]
  v_mfma_f32_16x16x32_bf16 v[200:203], a[112:115], v[104:107], v[200:203]
  v_exp_f32 v32, v32
  v_mfma_f32_16x16x32_bf16 v[216:219], a[116:119], v[104:107], v[216:219]
  v_exp_f32 v33, v33
  v_mfma_f32_16x16x32_bf16 v[232:235], a[120:123], v[104:107], v[232:235]
  s_lshl_b32 s43, s47, 10
  s_add_u32 s43, s43, 6160384
  v_and_b32 v1, 3, v0
  v_lshlrev_b32 v1, 8, v1
  v_mfma_f32_16x16x32_bf16 v[248:251], a[124:127], v[104:107], v[248:251]
  buffer_load_dword v6, v1, s[16:19], s43 offen sc1
  v_mfma_f32_16x16x32_bf16 v[88:91], v[112:115], v[104:107], v[88:91]
  v_exp_f32 v34, v34
  v_mfma_f32_16x16x32_bf16 v[140:143], a[96:99], v[108:111], v[140:143]
  v_cvt_pk_bf16_f32 v96, v32, v33
  v_mfma_f32_16x16x32_bf16 v[156:159], a[100:103], v[108:111], v[156:159]
  v_exp_f32 v35, v35
  v_mfma_f32_16x16x32_bf16 v[172:175], a[104:107], v[108:111], v[172:175]
  ds_read_b64_tr_b16 a[96:97], v120 offset:40960
  ds_read_b64_tr_b16 a[98:99], v120 offset:45056
  v_mfma_f32_16x16x32_bf16 v[188:191], a[108:111], v[108:111], v[188:191]
  v_exp_f32 v36, v36
  v_mfma_f32_16x16x32_bf16 v[204:207], a[112:115], v[108:111], v[204:207]
  ds_read_b64_tr_b16 a[100:101], v121 offset:40960
  v_cvt_pk_bf16_f32 v97, v34, v35
  v_mfma_f32_16x16x32_bf16 v[220:223], a[116:119], v[108:111], v[220:223]
  ds_read_b64_tr_b16 a[102:103], v121 offset:45056
  ds_read_b64_tr_b16 a[104:105], v122 offset:40960
  v_mfma_f32_16x16x32_bf16 v[236:239], a[120:123], v[108:111], v[236:239]
  v_exp_f32 v37, v37
  v_mfma_f32_16x16x32_bf16 v[252:255], a[124:127], v[108:111], v[252:255]
  v_exp_f32 v38, v38
  v_mfma_f32_16x16x32_bf16 v[92:95], v[112:115], v[108:111], v[92:95]
  ds_read_b64_tr_b16 a[106:107], v122 offset:45056
  ds_read_b64_tr_b16 a[108:109], v123 offset:40960
  v_mfma_f32_16x16x32_bf16 v[48:51], a[64:67], a[8:11], v[72:75]
  ds_read_b64_tr_b16 a[110:111], v123 offset:45056
  v_cvt_pk_bf16_f32 v98, v36, v37
  v_mfma_f32_16x16x32_bf16 v[48:51], a[68:71], a[24:27], v[48:51]
  v_exp_f32 v39, v39
  v_mfma_f32_16x16x32_bf16 v[48:51], a[72:75], a[40:43], v[48:51]
  ds_read_b64_tr_b16 a[112:113], v124 offset:40960
  ds_read_b64_tr_b16 a[114:115], v124 offset:45056
  v_mfma_f32_16x16x32_bf16 v[48:51], a[76:79], a[56:59], v[48:51]
  v_exp_f32 v40, v40
  v_mfma_f32_16x16x32_bf16 v[52:55], a[80:83], a[8:11], v[72:75]
  ds_read_b64_tr_b16 a[116:117], v125 offset:40960
  v_cvt_pk_bf16_f32 v99, v38, v39
  v_mfma_f32_16x16x32_bf16 v[52:55], a[84:87], a[24:27], v[52:55]
  ds_read_b64_tr_b16 a[118:119], v125 offset:45056
  ds_read_b64_tr_b16 a[120:121], v126 offset:40960
  v_mfma_f32_16x16x32_bf16 v[52:55], a[88:91], a[40:43], v[52:55]
  v_exp_f32 v41, v41
  v_mfma_f32_16x16x32_bf16 v[52:55], a[92:95], a[56:59], v[52:55]
  v_exp_f32 v42, v42
  v_mfma_f32_16x16x32_bf16 v[56:59], a[64:67], a[12:15], v[76:79]
  ds_read_b64_tr_b16 a[122:123], v126 offset:45056
  v_cvt_pk_bf16_f32 v100, v40, v41
  v_mfma_f32_16x16x32_bf16 v[56:59], a[68:71], a[28:31], v[56:59]
  ds_read_b64_tr_b16 a[124:125], v127 offset:40960
  ds_read_b64_tr_b16 a[126:127], v127 offset:45056
  v_mfma_f32_16x16x32_bf16 v[56:59], a[72:75], a[44:47], v[56:59]
  v_exp_f32 v43, v43
  v_mfma_f32_16x16x32_bf16 v[56:59], a[76:79], a[60:63], v[56:59]
  v_exp_f32 v44, v44
  v_mfma_f32_16x16x32_bf16 v[60:63], a[80:83], a[12:15], v[76:79]
  v_cvt_pk_bf16_f32 v101, v42, v43
  v_mfma_f32_16x16x32_bf16 v[60:63], a[84:87], a[28:31], v[60:63]
  v_exp_f32 v45, v45
  v_mfma_f32_16x16x32_bf16 v[60:63], a[88:91], a[44:47], v[60:63]
  v_exp_f32 v46, v46
  v_mfma_f32_16x16x32_bf16 v[60:63], a[92:95], a[60:63], v[60:63]
  s_mov_b32 s45, 0
L_k3_poll:
  s_waitcnt vmcnt(0)
  v_cmp_le_u32 vcc, 28, v6
  s_nop 3
  s_cmp_eq_u64 vcc, -1
  s_cbranch_scc1 L_k3_pollok
  s_sleep 4
  buffer_load_dword v6, v1, s[16:19], s43 offen sc1
  s_waitcnt vmcnt(0)
  s_add_u32 s45, s45, 1
  s_cmp_lt_u32 s45, 262144
  s_cbranch_scc1 L_k3_poll
L_k3_pollok:
  s_waitcnt vmcnt(0) lgkmcnt(0)
  s_barrier
  v_mfma_f32_16x16x32_bf16 v[128:131], a[96:99], v[96:99], v[128:131]
  ds_read_b128 a[64:67], v116
  v_cvt_pk_bf16_f32 v102, v44, v45
  v_mfma_f32_16x16x32_bf16 v[144:147], a[100:103], v[96:99], v[144:147]
  v_exp_f32 v47, v47
  v_mfma_f32_16x16x32_bf16 v[160:163], a[104:107], v[96:99], v[160:163]
  ds_read_b128 a[68:71], v117
  v_cvt_pk_bf16_f32 v103, v46, v47
  v_mfma_f32_16x16x32_bf16 v[176:179], a[108:111], v[96:99], v[176:179]
  ds_read_b128 a[72:75], v118
  v_mfma_f32_16x16x32_bf16 v[192:195], a[112:115], v[96:99], v[192:195]
  v_exp_f32 v48, v48
  v_mfma_f32_16x16x32_bf16 v[208:211], a[116:119], v[96:99], v[208:211]
  v_exp_f32 v49, v49
  v_mfma_f32_16x16x32_bf16 v[224:227], a[120:123], v[96:99], v[224:227]
  ds_read_b128 a[76:79], v119
  v_mfma_f32_16x16x32_bf16 v[240:243], a[124:127], v[96:99], v[240:243]
  buffer_load_dwordx4 a[192:195], v22, s[16:19], s36 offen sc1
  v_mfma_f32_16x16x32_bf16 v[80:83], v[112:115], v[96:99], v[80:83]
  v_exp_f32 v50, v50
  v_mfma_f32_16x16x32_bf16 v[132:135], a[96:99], v[100:103], v[132:135]
  ds_read_b128 a[80:83], v116 offset:4096
  v_cvt_pk_bf16_f32 v104, v48, v49
  v_mfma_f32_16x16x32_bf16 v[148:151], a[100:103], v[100:103], v[148:151]
  v_exp_f32 v51, v51
  v_mfma_f32_16x16x32_bf16 v[164:167], a[104:107], v[100:103], v[164:167]
  buffer_load_dwordx4 a[196:199], v23, s[16:19], s36 offen sc1
  v_mfma_f32_16x16x32_bf16 v[180:183], a[108:111], v[100:103], v[180:183]
  v_exp_f32 v52, v52
  v_mfma_f32_16x16x32_bf16 v[196:199], a[112:115], v[100:103], v[196:199]
  ds_read_b128 a[84:87], v117 offset:4096
  v_cvt_pk_bf16_f32 v105, v50, v51
  v_mfma_f32_16x16x32_bf16 v[212:215], a[116:119], v[100:103], v[212:215]
  ds_read_b128 a[88:91], v118 offset:4096
  v_accvgpr_write_b32 a128, 0
  v_mfma_f32_16x16x32_bf16 v[228:231], a[120:123], v[100:103], v[228:231]
  buffer_load_dwordx4 a[200:203], v24, s[16:19], s36 offen sc1
  v_mfma_f32_16x16x32_bf16 v[244:247], a[124:127], v[100:103], v[244:247]
  v_exp_f32 v53, v53
  v_mfma_f32_16x16x32_bf16 v[84:87], v[112:115], v[100:103], v[84:87]
  s_waitcnt lgkmcnt(6)
  v_exp_f32 v54, v54
  v_mfma_f32_16x16x32_bf16 v[32:35], a[64:67], a[0:3], v[64:67]
  s_waitcnt lgkmcnt(5)
  ds_read_b128 a[92:95], v119 offset:4096
  v_accvgpr_write_b32 a129, 0
  v_mfma_f32_16x16x32_bf16 v[32:35], a[68:71], a[16:19], v[32:35]
  s_waitcnt lgkmcnt(5)
  buffer_load_dwordx4 a[204:207], v25, s[16:19], s36 offen sc1
  v_cvt_pk_bf16_f32 v106, v52, v53
  v_mfma_f32_16x16x32_bf16 v[32:35], a[72:75], a[32:35], v[32:35]
  s_waitcnt lgkmcnt(4)
  s_add_u32 m0, s21, 32768
  v_accvgpr_write_b32 a130, 0
  v_accvgpr_write_b32 a131, 0
  v_mfma_f32_16x16x32_bf16 v[32:35], a[76:79], a[48:51], v[32:35]
  s_waitcnt lgkmcnt(3)
  buffer_load_dwordx4 v8, s[8:11], s20 offen lds
  v_mfma_f32_16x16x32_bf16 v[36:39], a[80:83], a[0:3], v[64:67]
  s_waitcnt lgkmcnt(2)
  s_add_u32 s36, s36, 1024
  v_exp_f32 v55, v55
  v_exp_f32 v56, v56
  v_mfma_f32_16x16x32_bf16 v[36:39], a[84:87], a[16:19], v[36:39]
  s_waitcnt lgkmcnt(1)
  buffer_load_dwordx4 a[208:211], v22, s[16:19], s36 offen sc1
  v_accvgpr_write_b32 a132, 0
  v_mfma_f32_16x16x32_bf16 v[36:39], a[88:91], a[32:35], v[36:39]
  s_waitcnt lgkmcnt(0)
  v_cvt_pk_bf16_f32 v107, v54, v55
  v_accvgpr_write_b32 a133, 0
  v_mfma_f32_16x16x32_bf16 v[36:39], a[92:95], a[48:51], v[36:39]
  buffer_load_dwordx4 v9, s[8:11], s20 offen offset:1024 lds
  v_mfma_f32_16x16x32_bf16 v[40:43], a[64:67], a[4:7], v[68:71]
  v_exp_f32 v57, v57
  v_exp_f32 v58, v58
  v_mfma_f32_16x16x32_bf16 v[40:43], a[68:71], a[20:23], v[40:43]
  v_accvgpr_write_b32 a134, 0
  v_cvt_pk_bf16_f32 v108, v56, v57
  v_mfma_f32_16x16x32_bf16 v[40:43], a[72:75], a[36:39], v[40:43]
  buffer_load_dwordx4 a[212:215], v23, s[16:19], s36 offen sc1
  v_mfma_f32_16x16x32_bf16 v[40:43], a[76:79], a[52:55], v[40:43]
  v_accvgpr_write_b32 a135, 0
  v_accvgpr_write_b32 a136, 0
  v_exp_f32 v59, v59
  v_mfma_f32_16x16x32_bf16 v[44:47], a[80:83], a[4:7], v[68:71]
  buffer_load_dwordx4 v10, s[8:11], s20 offen offset:2048 lds
  v_mfma_f32_16x16x32_bf16 v[44:47], a[84:87], a[20:23], v[44:47]
  v_exp_f32 v60, v60
  v_mfma_f32_16x16x32_bf16 v[44:47], a[88:91], a[36:39], v[44:47]
  buffer_load_dwordx4 a[216:219], v24, s[16:19], s36 offen sc1
  v_cvt_pk_bf16_f32 v109, v58, v59
  v_mfma_f32_16x16x32_bf16 v[44:47], a[92:95], a[52:55], v[44:47]
  v_accvgpr_write_b32 a137, 0
  v_accvgpr_write_b32 a138, 0
  v_exp_f32 v61, v61
  v_mfma_f32_16x16x32_bf16 v[136:139], a[96:99], v[104:107], v[136:139]
  buffer_load_dwordx4 v11, s[8:11], s20 offen offset:3072 lds
  v_mfma_f32_16x16x32_bf16 v[152:155], a[100:103], v[104:107], v[152:155]
  v_exp_f32 v62, v62
  v_mfma_f32_16x16x32_bf16 v[168:171], a[104:107], v[104:107], v[168:171]
  buffer_load_dwordx4 a[220:223], v25, s[16:19], s36 offen sc1
  v_accvgpr_write_b32 a139, 0
  v_mfma_f32_16x16x32_bf16 v[184:187], a[108:111], v[104:107], v[184:187]
  v_cvt_pk_bf16_f32 v110, v60, v61
  v_accvgpr_write_b32 a140, 0
  v_mfma_f32_16x16x32_bf16 v[200:203], a[112:115], v[104:107], v[200:203]
  v_exp_f32 v63, v63
  v_mfma_f32_16x16x32_bf16 v[216:219], a[116:119], v[104:107], v[216:219]
  s_add_u32 s36, s36, 1024
  v_cvt_pk_bf16_f32 v111, v62, v63
  v_accvgpr_write_b32 a141, 0
  v_mfma_f32_16x16x32_bf16 v[232:235], a[120:123], v[104:107], v[232:235]
  v_exp_f32 v32, v32
  v_mfma_f32_16x16x32_bf16 v[248:251], a[124:127], v[104:107], v[248:251]
  v_accvgpr_write_b32 a142, 0
  v_accvgpr_write_b32 a143, 0
  v_mfma_f32_16x16x32_bf16 v[88:91], v[112:115], v[104:107], v[88:91]
  v_exp_f32 v33, v33
  v_mfma_f32_16x16x32_bf16 v[140:143], a[96:99], v[108:111], v[140:143]
  v_exp_f32 v34, v34
  v_mfma_f32_16x16x32_bf16 v[156:159], a[100:103], v[108:111], v[156:159]
  v_cvt_pk_bf16_f32 v96, v32, v33
  v_accvgpr_write_b32 a144, 0
  v_mfma_f32_16x16x32_bf16 v[172:175], a[104:107], v[108:111], v[172:175]
  v_exp_f32 v35, v35
  v_mfma_f32_16x16x32_bf16 v[188:191], a[108:111], v[108:111], v[188:191]
  ds_read_b64_tr_b16 a[96:97], v120
  v_accvgpr_write_b32 a145, 0
  v_mfma_f32_16x16x32_bf16 v[204:207], a[112:115], v[108:111], v[204:207]
  v_exp_f32 v36, v36
  v_mfma_f32_16x16x32_bf16 v[220:223], a[116:119], v[108:111], v[220:223]
  ds_read_b64_tr_b16 a[98:99], v120 offset:4096
  v_accvgpr_write_b32 a146, 0
  v_mfma_f32_16x16x32_bf16 v[236:239], a[120:123], v[108:111], v[236:239]
  ds_read_b64_tr_b16 a[100:101], v121
  v_cvt_pk_bf16_f32 v97, v34, v35
  v_mfma_f32_16x16x32_bf16 v[252:255], a[124:127], v[108:111], v[252:255]
  ds_read_b64_tr_b16 a[102:103], v121 offset:4096
  v_accvgpr_write_b32 a147, 0
  v_exp_f32 v37, v37
  v_mfma_f32_16x16x32_bf16 v[92:95], v[112:115], v[108:111], v[92:95]
  ds_read_b64_tr_b16 a[104:105], v122
  ds_read_b64_tr_b16 a[106:107], v122 offset:4096
  v_mfma_f32_16x16x32_bf16 v[48:51], a[64:67], a[8:11], v[72:75]
  v_exp_f32 v38, v38
  v_accvgpr_write_b32 a148, 0
  v_mfma_f32_16x16x32_bf16 v[48:51], a[68:71], a[24:27], v[48:51]
  ds_read_b64_tr_b16 a[108:109], v123
  v_cvt_pk_bf16_f32 v98, v36, v37
  v_mfma_f32_16x16x32_bf16 v[48:51], a[72:75], a[40:43], v[48:51]
  ds_read_b64_tr_b16 a[110:111], v123 offset:4096
  v_accvgpr_write_b32 a149, 0
  v_mfma_f32_16x16x32_bf16 v[48:51], a[76:79], a[56:59], v[48:51]
  v_exp_f32 v39, v39
  v_mfma_f32_16x16x32_bf16 v[52:55], a[80:83], a[8:11], v[72:75]
  ds_read_b64_tr_b16 a[112:113], v124
  v_accvgpr_write_b32 a150, 0
  v_exp_f32 v40, v40
  v_mfma_f32_16x16x32_bf16 v[52:55], a[84:87], a[24:27], v[52:55]
  ds_read_b64_tr_b16 a[114:115], v124 offset:4096
  v_cvt_pk_bf16_f32 v99, v38, v39
  v_mfma_f32_16x16x32_bf16 v[52:55], a[88:91], a[40:43], v[52:55]
  ds_read_b64_tr_b16 a[116:117], v125
  v_accvgpr_write_b32 a151, 0
  v_mfma_f32_16x16x32_bf16 v[52:55], a[92:95], a[56:59], v[52:55]
  ds_read_b64_tr_b16 a[118:119], v125 offset:4096
  v_accvgpr_write_b32 a152, 0
  v_exp_f32 v41, v41
  v_mfma_f32_16x16x32_bf16 v[56:59], a[64:67], a[12:15], v[76:79]
  ds_read_b64_tr_b16 a[120:121], v126
  ds_read_b64_tr_b16 a[122:123], v126 offset:4096
  v_exp_f32 v42, v42
  v_mfma_f32_16x16x32_bf16 v[56:59], a[68:71], a[28:31], v[56:59]
  v_accvgpr_write_b32 a153, 0
  v_cvt_pk_bf16_f32 v100, v40, v41
  v_mfma_f32_16x16x32_bf16 v[56:59], a[72:75], a[44:47], v[56:59]
  ds_read_b64_tr_b16 a[124:125], v127
  v_accvgpr_write_b32 a154, 0
  v_mfma_f32_16x16x32_bf16 v[56:59], a[76:79], a[60:63], v[56:59]
  ds_read_b64_tr_b16 a[126:127], v127 offset:4096
  v_exp_f32 v43, v43
  v_mfma_f32_16x16x32_bf16 v[60:63], a[80:83], a[12:15], v[76:79]
  v_exp_f32 v44, v44
  v_mfma_f32_16x16x32_bf16 v[60:63], a[84:87], a[28:31], v[60:63]
  v_accvgpr_write_b32 a155, 0
  v_cvt_pk_bf16_f32 v101, v42, v43
  v_mfma_f32_16x16x32_bf16 v[60:63], a[88:91], a[44:47], v[60:63]
  v_accvgpr_write_b32 a156, 0
  v_accvgpr_write_b32 a157, 0
  v_mfma_f32_16x16x32_bf16 v[60:63], a[92:95], a[60:63], v[60:63]
  s_waitcnt lgkmcnt(14)
  v_exp_f32 v45, v45
  v_mfma_f32_16x16x32_bf16 v[128:131], a[96:99], v[96:99], v[128:131]
  s_waitcnt lgkmcnt(12)
  v_exp_f32 v46, v46
  v_mfma_f32_16x16x32_bf16 v[144:147], a[100:103], v[96:99], v[144:147]
  s_waitcnt lgkmcnt(10)
  v_cvt_pk_bf16_f32 v102, v44, v45
  v_accvgpr_write_b32 a158, 0
  v_mfma_f32_16x16x32_bf16 v[160:163], a[104:107], v[96:99], v[160:163]
  s_waitcnt lgkmcnt(8)
  ds_read_b128 a[64:67], v116 offset:8192
  v_accvgpr_write_b32 a159, 0
  v_mfma_f32_16x16x32_bf16 v[176:179], a[108:111], v[96:99], v[176:179]
  s_waitcnt lgkmcnt(7)
  v_exp_f32 v47, v47
  v_mfma_f32_16x16x32_bf16 v[192:195], a[112:115], v[96:99], v[192:195]
  s_waitcnt lgkmcnt(5)
  ds_read_b128 a[68:71], v117 offset:8192
  v_cvt_pk_bf16_f32 v103, v46, v47
  v_mfma_f32_16x16x32_bf16 v[208:211], a[116:119], v[96:99], v[208:211]
  s_waitcnt lgkmcnt(4)
  ds_read_b128 a[72:75], v118 offset:8192
  v_accvgpr_write_b32 a160, 0
  v_mfma_f32_16x16x32_bf16 v[224:227], a[120:123], v[96:99], v[224:227]
  s_waitcnt lgkmcnt(3)
  v_exp_f32 v48, v48
  v_mfma_f32_16x16x32_bf16 v[240:243], a[124:127], v[96:99], v[240:243]
  ds_read_b128 a[76:79], v119 offset:8192
  v_accvgpr_write_b32 a161, 0
  v_mfma_f32_16x16x32_bf16 v[80:83], v[112:115], v[96:99], v[80:83]
  v_exp_f32 v49, v49
  v_mfma_f32_16x16x32_bf16 v[132:135], a[96:99], v[100:103], v[132:135]
  v_exp_f32 v50, v50
  v_mfma_f32_16x16x32_bf16 v[148:151], a[100:103], v[100:103], v[148:151]
  v_accvgpr_write_b32 a162, 0
  v_cvt_pk_bf16_f32 v104, v48, v49
  v_mfma_f32_16x16x32_bf16 v[164:167], a[104:107], v[100:103], v[164:167]
  ds_read_b128 a[80:83], v116 offset:12288
  v_accvgpr_write_b32 a163, 0
  v_mfma_f32_16x16x32_bf16 v[180:183], a[108:111], v[100:103], v[180:183]
  v_exp_f32 v51, v51
  v_mfma_f32_16x16x32_bf16 v[196:199], a[112:115], v[100:103], v[196:199]
  ds_read_b128 a[84:87], v117 offset:12288
  v_accvgpr_write_b32 a164, 0
  v_mfma_f32_16x16x32_bf16 v[212:215], a[116:119], v[100:103], v[212:215]
  v_exp_f32 v52, v52
  v_mfma_f32_16x16x32_bf16 v[228:231], a[120:123], v[100:103], v[228:231]
  v_accvgpr_write_b32 a165, 0
  v_cvt_pk_bf16_f32 v105, v50, v51
  v_mfma_f32_16x16x32_bf16 v[244:247], a[124:127], v[100:103], v[244:247]
  ds_read_b128 a[88:91], v118 offset:12288
  v_accvgpr_write_b32 a166, 0
  v_exp_f32 v53, v53
  v_mfma_f32_16x16x32_bf16 v[84:87], v[112:115], v[100:103], v[84:87]
  s_waitcnt lgkmcnt(6)
  v_exp_f32 v54, v54
  v_mfma_f32_16x16x32_bf16 v[32:35], a[64:67], a[0:3], v[64:67]
  s_waitcnt lgkmcnt(5)
  s_add_u32 m0, s21, 81920
  ds_read_b128 a[92:95], v119 offset:12288
  v_accvgpr_write_b32 a167, 0
  v_mfma_f32_16x16x32_bf16 v[32:35], a[68:71], a[16:19], v[32:35]
  s_waitcnt lgkmcnt(5)
  buffer_load_dwordx4 v12, s[12:15], s20 offen lds
  v_mfma_f32_16x16x32_bf16 v[32:35], a[72:75], a[32:35], v[32:35]
  s_waitcnt lgkmcnt(4)
  v_cvt_pk_bf16_f32 v106, v52, v53
  v_accvgpr_write_b32 a168, 0
  v_mfma_f32_16x16x32_bf16 v[32:35], a[76:79], a[48:51], v[32:35]
  s_waitcnt lgkmcnt(3)
  v_exp_f32 v55, v55
  v_mfma_f32_16x16x32_bf16 v[36:39], a[80:83], a[0:3], v[64:67]
  s_waitcnt lgkmcnt(2)
  v_exp_f32 v56, v56
  v_accvgpr_write_b32 a169, 0
  v_mfma_f32_16x16x32_bf16 v[36:39], a[84:87], a[16:19], v[36:39]
  s_waitcnt lgkmcnt(1)
  v_cvt_pk_bf16_f32 v107, v54, v55
  v_accvgpr_write_b32 a170, 0
  v_mfma_f32_16x16x32_bf16 v[36:39], a[88:91], a[32:35], v[36:39]
  s_waitcnt lgkmcnt(0)
  v_exp_f32 v57, v57
  v_mfma_f32_16x16x32_bf16 v[36:39], a[92:95], a[48:51], v[36:39]
  buffer_load_dwordx4 v13, s[12:15], s20 offen offset:1024 lds
  v_mfma_f32_16x16x32_bf16 v[40:43], a[64:67], a[4:7], v[68:71]
  v_accvgpr_write_b32 a171, 0
  v_accvgpr_write_b32 a172, 0
  v_exp_f32 v58, v58
  v_mfma_f32_16x16x32_bf16 v[40:43], a[68:71], a[20:23], v[40:43]
  v_cvt_pk_bf16_f32 v108, v56, v57
  v_accvgpr_write_b32 a173, 0
  v_mfma_f32_16x16x32_bf16 v[40:43], a[72:75], a[36:39], v[40:43]
  v_exp_f32 v59, v59
  v_mfma_f32_16x16x32_bf16 v[40:43], a[76:79], a[52:55], v[40:43]
  buffer_load_dwordx4 v12, s[12:15], s20 offen offset:2048 lds
  v_mfma_f32_16x16x32_bf16 v[44:47], a[80:83], a[4:7], v[68:71]
  v_exp_f32 v60, v60
  v_mfma_f32_16x16x32_bf16 v[44:47], a[84:87], a[20:23], v[44:47]
  v_accvgpr_write_b32 a174, 0
  v_cvt_pk_bf16_f32 v109, v58, v59
  v_mfma_f32_16x16x32_bf16 v[44:47], a[88:91], a[36:39], v[44:47]
  v_accvgpr_write_b32 a175, 0
  v_accvgpr_write_b32 a176, 0
  v_mfma_f32_16x16x32_bf16 v[44:47], a[92:95], a[52:55], v[44:47]
  v_exp_f32 v61, v61
  v_mfma_f32_16x16x32_bf16 v[136:139], a[96:99], v[104:107], v[136:139]
  buffer_load_dwordx4 v13, s[12:15], s20 offen offset:3072 lds
  s_add_u32 s20, s20, 16384
  v_mfma_f32_16x16x32_bf16 v[152:155], a[100:103], v[104:107], v[152:155]
  v_exp_f32 v62, v62
  v_mfma_f32_16x16x32_bf16 v[168:171], a[104:107], v[104:107], v[168:171]
  v_cvt_pk_bf16_f32 v110, v60, v61
  v_accvgpr_write_b32 a177, 0
  v_mfma_f32_16x16x32_bf16 v[184:187], a[108:111], v[104:107], v[184:187]
  v_exp_f32 v63, v63
  v_mfma_f32_16x16x32_bf16 v[200:203], a[112:115], v[104:107], v[200:203]
  v_accvgpr_write_b32 a178, 0
  v_cvt_pk_bf16_f32 v111, v62, v63
  v_mfma_f32_16x16x32_bf16 v[216:219], a[116:119], v[104:107], v[216:219]
  v_accvgpr_write_b32 a179, 0
  v_accvgpr_write_b32 a180, 0
  v_mfma_f32_16x16x32_bf16 v[232:235], a[120:123], v[104:107], v[232:235]
  v_exp_f32 v32, v32
  v_mfma_f32_16x16x32_bf16 v[248:251], a[124:127], v[104:107], v[248:251]
  v_exp_f32 v33, v33
  v_mfma_f32_16x16x32_bf16 v[88:91], v[112:115], v[104:107], v[88:91]
  v_exp_f32 v34, v34
  v_mfma_f32_16x16x32_bf16 v[140:143], a[96:99], v[108:111], v[140:143]
  v_accvgpr_write_b32 a181, 0
  v_cvt_pk_bf16_f32 v96, v32, v33
  v_mfma_f32_16x16x32_bf16 v[156:159], a[100:103], v[108:111], v[156:159]
  ds_read_b64_tr_b16 a[96:97], v120 offset:8192
  v_accvgpr_write_b32 a182, 0
  v_mfma_f32_16x16x32_bf16 v[172:175], a[104:107], v[108:111], v[172:175]
  v_exp_f32 v35, v35
  v_mfma_f32_16x16x32_bf16 v[188:191], a[108:111], v[108:111], v[188:191]
  ds_read_b64_tr_b16 a[98:99], v120 offset:12288
  v_accvgpr_write_b32 a183, 0
  v_mfma_f32_16x16x32_bf16 v[204:207], a[112:115], v[108:111], v[204:207]
  v_exp_f32 v36, v36
  v_mfma_f32_16x16x32_bf16 v[220:223], a[116:119], v[108:111], v[220:223]
  ds_read_b64_tr_b16 a[100:101], v121 offset:8192
  v_cvt_pk_bf16_f32 v97, v34, v35
  v_mfma_f32_16x16x32_bf16 v[236:239], a[120:123], v[108:111], v[236:239]
  ds_read_b64_tr_b16 a[102:103], v121 offset:12288
  v_accvgpr_write_b32 a184, 0
  v_mfma_f32_16x16x32_bf16 v[252:255], a[124:127], v[108:111], v[252:255]
  v_exp_f32 v37, v37
  v_mfma_f32_16x16x32_bf16 v[92:95], v[112:115], v[108:111], v[92:95]
  ds_read_b64_tr_b16 a[104:105], v122 offset:8192
  v_accvgpr_write_b32 a185, 0
  v_mfma_f32_16x16x32_bf16 v[48:51], a[64:67], a[8:11], v[72:75]
  ds_read_b64_tr_b16 a[106:107], v122 offset:12288
  v_exp_f32 v38, v38
  v_mfma_f32_16x16x32_bf16 v[48:51], a[68:71], a[24:27], v[48:51]
  ds_read_b64_tr_b16 a[108:109], v123 offset:8192
  v_accvgpr_write_b32 a186, 0
  v_cvt_pk_bf16_f32 v98, v36, v37
  v_mfma_f32_16x16x32_bf16 v[48:51], a[72:75], a[40:43], v[48:51]
  ds_read_b64_tr_b16 a[110:111], v123 offset:12288
  v_accvgpr_write_b32 a187, 0
  v_mfma_f32_16x16x32_bf16 v[48:51], a[76:79], a[56:59], v[48:51]
  v_exp_f32 v39, v39
  v_mfma_f32_16x16x32_bf16 v[52:55], a[80:83], a[8:11], v[72:75]
  ds_read_b64_tr_b16 a[112:113], v124 offset:8192
  v_accvgpr_write_b32 a188, 0
  v_exp_f32 v40, v40
  v_mfma_f32_16x16x32_bf16 v[52:55], a[84:87], a[24:27], v[52:55]
  ds_read_b64_tr_b16 a[114:115], v124 offset:12288
  v_cvt_pk_bf16_f32 v99, v38, v39
  v_mfma_f32_16x16x32_bf16 v[52:55], a[88:91], a[40:43], v[52:55]
  ds_read_b64_tr_b16 a[116:117], v125 offset:8192
  v_accvgpr_write_b32 a189, 0
  v_mfma_f32_16x16x32_bf16 v[52:55], a[92:95], a[56:59], v[52:55]
  ds_read_b64_tr_b16 a[118:119], v125 offset:12288
  ds_read_b64_tr_b16 a[120:121], v126 offset:8192
  v_exp_f32 v41, v41
  v_mfma_f32_16x16x32_bf16 v[56:59], a[64:67], a[12:15], v[76:79]
  ds_read_b64_tr_b16 a[122:123], v126 offset:12288
  v_accvgpr_write_b32 a190, 0
  v_mfma_f32_16x16x32_bf16 v[56:59], a[68:71], a[28:31], v[56:59]
  v_exp_f32 v42, v42
  v_mfma_f32_16x16x32_bf16 v[56:59], a[72:75], a[44:47], v[56:59]
  ds_read_b64_tr_b16 a[124:125], v127 offset:8192
  ds_read_b64_tr_b16 a[126:127], v127 offset:12288
  v_accvgpr_write_b32 a191, 0
  v_cvt_pk_bf16_f32 v100, v40, v41
  v_mfma_f32_16x16x32_bf16 v[56:59], a[76:79], a[60:63], v[56:59]
  v_exp_f32 v43, v43
  v_mfma_f32_16x16x32_bf16 v[60:63], a[80:83], a[12:15], v[76:79]
  v_exp_f32 v44, v44
  v_mfma_f32_16x16x32_bf16 v[60:63], a[84:87], a[28:31], v[60:63]
  v_cvt_pk_bf16_f32 v101, v42, v43
  v_mfma_f32_16x16x32_bf16 v[60:63], a[88:91], a[44:47], v[60:63]
  v_exp_f32 v45, v45
  v_mfma_f32_16x16x32_bf16 v[60:63], a[92:95], a[60:63], v[60:63]
  v_exp_f32 v46, v46
  s_waitcnt vmcnt(16) lgkmcnt(0)
  s_barrier
  s_mov_b32 s4, 2
L_k3_loopB:
  v_mfma_f32_16x16x32_bf16 v[128:131], a[96:99], v[96:99], v[128:131]
  ds_read_b128 a[64:67], v116 offset:16384
  v_cvt_pk_bf16_f32 v102, v44, v45
  v_mfma_f32_16x16x32_bf16 v[144:147], a[100:103], v[96:99], v[144:147]
  v_exp_f32 v47, v47
  v_mfma_f32_16x16x32_bf16 v[160:163], a[104:107], v[96:99], v[160:163]
  ds_read_b128 a[68:71], v117 offset:16384
  v_cvt_pk_bf16_f32 v103, v46, v47
  v_mfma_f32_16x16x32_bf16 v[176:179], a[108:111], v[96:99], v[176:179]
  ds_read_b128 a[72:75], v118 offset:16384
  v_mfma_f32_16x16x32_bf16 v[192:195], a[112:115], v[96:99], v[192:195]
  ds_read_b64_tr_b16 a[224:225], v14
  v_mfma_f32_16x16x32_bf16 v[208:211], a[116:119], v[96:99], v[208:211]
  v_exp_f32 v48, v48
  v_mfma_f32_16x16x32_bf16 v[224:227], a[120:123], v[96:99], v[224:227]
  v_exp_f32 v49, v49
  v_mfma_f32_16x16x32_bf16 v[240:243], a[124:127], v[96:99], v[240:243]
  ds_read_b128 a[76:79], v119 offset:16384
  ds_read_b64_tr_b16 a[226:227], v14 offset:2048
  v_mfma_f32_16x16x32_bf16 v[80:83], v[112:115], v[96:99], v[80:83]
  v_exp_f32 v50, v50
  v_mfma_f32_16x16x32_bf16 v[132:135], a[96:99], v[100:103], v[132:135]
  ds_read_b128 a[80:83], v116 offset:20480
  v_cvt_pk_bf16_f32 v104, v48, v49
  v_mfma_f32_16x16x32_bf16 v[148:151], a[100:103], v[100:103], v[148:151]
  v_exp_f32 v51, v51
  v_mfma_f32_16x16x32_bf16 v[164:167], a[104:107], v[100:103], v[164:167]
  ds_read_b64_tr_b16 a[228:229], v15
  ds_read_b128 a[84:87], v117 offset:20480
  v_mfma_f32_16x16x32_bf16 v[180:183], a[108:111], v[100:103], v[180:183]
  s_add_u32 m0, s21, 0
  v_exp_f32 v52, v52
  v_mfma_f32_16x16x32_bf16 v[196:199], a[112:115], v[100:103], v[196:199]
  buffer_load_dwordx4 v8, s[8:11], s20 offen lds
  v_mfma_f32_16x16x32_bf16 v[212:215], a[116:119], v[100:103], v[212:215]
  ds_read_b128 a[88:91], v118 offset:20480
  v_cvt_pk_bf16_f32 v105, v50, v51
  v_mfma_f32_16x16x32_bf16 v[228:231], a[120:123], v[100:103], v[228:231]
  v_exp_f32 v53, v53
  v_mfma_f32_16x16x32_bf16 v[244:247], a[124:127], v[100:103], v[244:247]
  ds_read_b64_tr_b16 a[230:231], v15 offset:2048
  ds_read_b128 a[92:95], v119 offset:20480
  v_mfma_f32_16x16x32_bf16 v[84:87], v[112:115], v[100:103], v[84:87]
  s_waitcnt lgkmcnt(11)
  v_exp_f32 v54, v54
  v_mfma_f32_16x16x32_bf16 v[32:35], a[64:67], a[0:3], v[64:67]
  s_waitcnt lgkmcnt(10)
  ds_read_b64_tr_b16 a[232:233], v16
  v_cvt_pk_bf16_f32 v106, v52, v53
  v_mfma_f32_16x16x32_bf16 v[32:35], a[68:71], a[16:19], v[32:35]
  s_waitcnt lgkmcnt(10)
  v_exp_f32 v55, v55
  v_mfma_f32_16x16x32_bf16 v[32:35], a[72:75], a[32:35], v[32:35]
  s_waitcnt lgkmcnt(8)
  buffer_load_dwordx4 v9, s[8:11], s20 offen offset:1024 lds
  v_mfma_f32_16x16x32_bf16 v[32:35], a[76:79], a[48:51], v[32:35]
  s_waitcnt lgkmcnt(6)
  v_exp_f32 v56, v56
  v_mfma_f32_16x16x32_bf16 v[36:39], a[80:83], a[0:3], v[64:67]
  s_waitcnt lgkmcnt(4)
  ds_read_b64_tr_b16 a[234:235], v16 offset:2048
  v_cvt_pk_bf16_f32 v107, v54, v55
  v_mfma_f32_16x16x32_bf16 v[36:39], a[84:87], a[16:19], v[36:39]
  s_waitcnt lgkmcnt(4)
  v_exp_f32 v57, v57
  v_mfma_f32_16x16x32_bf16 v[36:39], a[88:91], a[32:35], v[36:39]
  s_waitcnt lgkmcnt(2)
  v_exp_f32 v58, v58
  v_mfma_f32_16x16x32_bf16 v[36:39], a[92:95], a[48:51], v[36:39]
  ds_read_b64_tr_b16 a[236:237], v17
  v_cvt_pk_bf16_f32 v108, v56, v57
  v_mfma_f32_16x16x32_bf16 v[40:43], a[64:67], a[4:7], v[68:71]
  buffer_load_dwordx4 v10, s[8:11], s20 offen offset:2048 lds
  v_mfma_f32_16x16x32_bf16 v[40:43], a[68:71], a[20:23], v[40:43]
  v_exp_f32 v59, v59
  v_mfma_f32_16x16x32_bf16 v[40:43], a[72:75], a[36:39], v[40:43]
  v_exp_f32 v60, v60
  v_mfma_f32_16x16x32_bf16 v[40:43], a[76:79], a[52:55], v[40:43]
  ds_read_b64_tr_b16 a[238:239], v17 offset:2048
  v_cvt_pk_bf16_f32 v109, v58, v59
  v_mfma_f32_16x16x32_bf16 v[44:47], a[80:83], a[4:7], v[68:71]
  v_exp_f32 v61, v61
  v_mfma_f32_16x16x32_bf16 v[44:47], a[84:87], a[20:23], v[44:47]
  ds_read_b64_tr_b16 a[240:241], v14 offset:4096
  v_mfma_f32_16x16x32_bf16 v[44:47], a[88:91], a[36:39], v[44:47]
  v_exp_f32 v62, v62
  v_mfma_f32_16x16x32_bf16 v[44:47], a[92:95], a[52:55], v[44:47]
  buffer_load_dwordx4 v11, s[8:11], s20 offen offset:3072 lds
  v_mfma_f32_16x16x32_bf16 v[136:139], a[96:99], v[104:107], v[136:139]
  ds_read_b64_tr_b16 a[242:243], v14 offset:6144
  v_cvt_pk_bf16_f32 v110, v60, v61
  v_mfma_f32_16x16x32_bf16 v[152:155], a[100:103], v[104:107], v[152:155]
  v_exp_f32 v63, v63
  v_mfma_f32_16x16x32_bf16 v[168:171], a[104:107], v[104:107], v[168:171]
  v_cvt_pk_bf16_f32 v111, v62, v63
  v_mfma_f32_16x16x32_bf16 v[184:187], a[108:111], v[104:107], v[184:187]
  ds_read_b64_tr_b16 a[244:245], v15 offset:4096
  v_mfma_f32_16x16x32_bf16 v[200:203], a[112:115], v[104:107], v[200:203]
  v_exp_f32 v32, v32
  v_mfma_f32_16x16x32_bf16 v[216:219], a[116:119], v[104:107], v[216:219]
  v_exp_f32 v33, v33
  v_mfma_f32_16x16x32_bf16 v[232:235], a[120:123], v[104:107], v[232:235]
  v_exp_f32 v34, v34
  v_mfma_f32_16x16x32_bf16 v[248:251], a[124:127], v[104:107], v[248:251]
  ds_read_b64_tr_b16 a[246:247], v15 offset:6144
  v_cvt_pk_bf16_f32 v96, v32, v33
  v_mfma_f32_16x16x32_bf16 v[88:91], v[112:115], v[104:107], v[88:91]
  s_add_u32 m0, s21, 49152
  v_exp_f32 v35, v35
  v_mfma_f32_16x16x32_bf16 v[140:143], a[96:99], v[108:111], v[140:143]
  buffer_load_dwordx4 v12, s[12:15], s20 offen lds
  v_mfma_f32_16x16x32_bf16 v[156:159], a[100:103], v[108:111], v[156:159]
  ds_read_b64_tr_b16 a[96:97], v120 offset:16384
  ds_read_b64_tr_b16 a[98:99], v120 offset:20480
  v_mfma_f32_16x16x32_bf16 v[172:175], a[104:107], v[108:111], v[172:175]
  v_exp_f32 v36, v36
  v_mfma_f32_16x16x32_bf16 v[188:191], a[108:111], v[108:111], v[188:191]
  ds_read_b64_tr_b16 a[248:249], v16 offset:4096
  v_cvt_pk_bf16_f32 v97, v34, v35
  v_mfma_f32_16x16x32_bf16 v[204:207], a[112:115], v[108:111], v[204:207]
  v_exp_f32 v37, v37
  v_mfma_f32_16x16x32_bf16 v[220:223], a[116:119], v[108:111], v[220:223]
  ds_read_b64_tr_b16 a[100:101], v121 offset:16384
  ds_read_b64_tr_b16 a[250:251], v16 offset:6144
  v_mfma_f32_16x16x32_bf16 v[236:239], a[120:123], v[108:111], v[236:239]
  v_exp_f32 v38, v38
  v_mfma_f32_16x16x32_bf16 v[252:255], a[124:127], v[108:111], v[252:255]
  buffer_load_dwordx4 v13, s[12:15], s20 offen offset:1024 lds
  v_mfma_f32_16x16x32_bf16 v[92:95], v[112:115], v[108:111], v[92:95]
  ds_read_b64_tr_b16 a[102:103], v121 offset:20480
  v_cvt_pk_bf16_f32 v98, v36, v37
  v_mfma_f32_16x16x32_bf16 v[48:51], a[64:67], a[8:11], v[72:75]
  v_exp_f32 v39, v39
  v_mfma_f32_16x16x32_bf16 v[48:51], a[68:71], a[24:27], v[48:51]
  ds_read_b64_tr_b16 a[104:105], v122 offset:16384
  ds_read_b64_tr_b16 a[252:253], v17 offset:4096
  v_mfma_f32_16x16x32_bf16 v[48:51], a[72:75], a[40:43], v[48:51]
  v_exp_f32 v40, v40
  v_mfma_f32_16x16x32_bf16 v[48:51], a[76:79], a[56:59], v[48:51]
  ds_read_b64_tr_b16 a[106:107], v122 offset:20480
  v_cvt_pk_bf16_f32 v99, v38, v39
  v_mfma_f32_16x16x32_bf16 v[52:55], a[80:83], a[8:11], v[72:75]
  v_exp_f32 v41, v41
  v_mfma_f32_16x16x32_bf16 v[52:55], a[84:87], a[24:27], v[52:55]
  buffer_load_dwordx4 v12, s[12:15], s20 offen offset:2048 lds
  v_mfma_f32_16x16x32_bf16 v[52:55], a[88:91], a[40:43], v[52:55]
  ds_read_b64_tr_b16 a[108:109], v123 offset:16384
  ds_read_b64_tr_b16 a[254:255], v17 offset:6144
  v_mfma_f32_16x16x32_bf16 v[52:55], a[92:95], a[56:59], v[52:55]
  v_exp_f32 v42, v42
  v_mfma_f32_16x16x32_bf16 v[56:59], a[64:67], a[12:15], v[76:79]
  ds_read_b64_tr_b16 a[110:111], v123 offset:20480
  v_cvt_pk_bf16_f32 v100, v40, v41
  v_mfma_f32_16x16x32_bf16 v[56:59], a[68:71], a[28:31], v[56:59]
  v_exp_f32 v43, v43
  v_mfma_f32_16x16x32_bf16 v[56:59], a[72:75], a[44:47], v[56:59]
  ds_read_b64_tr_b16 a[112:113], v124 offset:16384
  ds_read_b64_tr_b16 a[114:115], v124 offset:20480
  v_mfma_f32_16x16x32_bf16 v[56:59], a[76:79], a[60:63], v[56:59]
  buffer_load_dwordx4 v13, s[12:15], s20 offen offset:3072 lds
  s_add_u32 s20, s20, 16384
  v_mfma_f32_16x16x32_bf16 v[60:63], a[80:83], a[12:15], v[76:79]
  v_exp_f32 v44, v44
  v_mfma_f32_16x16x32_bf16 v[60:63], a[84:87], a[28:31], v[60:63]
  ds_read_b64_tr_b16 a[116:117], v125 offset:16384
  v_cvt_pk_bf16_f32 v101, v42, v43
  v_mfma_f32_16x16x32_bf16 v[60:63], a[88:91], a[44:47], v[60:63]
  v_exp_f32 v45, v45
  v_mfma_f32_16x16x32_bf16 v[60:63], a[92:95], a[60:63], v[60:63]
  s_waitcnt vmcnt(15)
  v_exp_f32 v46, v46
  v_mfma_f32_16x16x32_bf16 a[128:131], a[192:195], a[224:227], a[128:131]
  ds_read_b64_tr_b16 a[118:119], v125 offset:20480
  v_cvt_pk_bf16_f32 v102, v44, v45
  v_mfma_f32_16x16x32_bf16 a[132:135], a[192:195], a[228:231], a[132:135]
  s_waitcnt lgkmcnt(15)
  v_exp_f32 v47, v47
  v_mfma_f32_16x16x32_bf16 a[136:139], a[192:195], a[232:235], a[136:139]
  ds_read_b64_tr_b16 a[120:121], v126 offset:16384
  v_cvt_pk_bf16_f32 v103, v46, v47
  v_mfma_f32_16x16x32_bf16 a[140:143], a[192:195], a[236:239], a[140:143]
  s_waitcnt vmcnt(14)
  ds_read_b64_tr_b16 a[122:123], v126 offset:20480
  v_mfma_f32_16x16x32_bf16 a[144:147], a[196:199], a[224:227], a[144:147]
  v_exp_f32 v48, v48
  v_mfma_f32_16x16x32_bf16 a[148:151], a[196:199], a[228:231], a[148:151]
  ds_read_b64_tr_b16 a[124:125], v127 offset:16384
  v_mfma_f32_16x16x32_bf16 a[152:155], a[196:199], a[232:235], a[152:155]
  s_cmp_gt_u32 s38, 4
  s_cselect_b32 s37, 0x30000, 0
  s_add_u32 s38, s38, 1
  s_max_u32 s5, s40, s37
  s_mov_b32 m0, s5
  v_exp_f32 v49, v49
  v_mfma_f32_16x16x32_bf16 a[156:159], a[196:199], a[236:239], a[156:159]
  s_waitcnt vmcnt(13)
  s_waitcnt lgkmcnt(8)
  buffer_load_dwordx4 v18, s[52:55], s39 offen lds
  v_mfma_f32_16x16x32_bf16 a[160:163], a[200:203], a[224:227], a[160:163]
  v_xor_b32 v14, 8192, v14
  v_xor_b32 v15, 8192, v15
  v_mfma_f32_16x16x32_bf16 a[164:167], a[200:203], a[228:231], a[164:167]
  v_xor_b32 v16, 8192, v16
  v_xor_b32 v17, 8192, v17
  v_mfma_f32_16x16x32_bf16 a[168:171], a[200:203], a[232:235], a[168:171]
  ds_read_b64_tr_b16 a[126:127], v127 offset:20480
  v_mfma_f32_16x16x32_bf16 a[172:175], a[200:203], a[236:239], a[172:175]
  s_waitcnt vmcnt(13)
  v_exp_f32 v50, v50
  v_mfma_f32_16x16x32_bf16 a[176:179], a[204:207], a[224:227], a[176:179]
  v_cvt_pk_bf16_f32 v104, v48, v49
  v_mfma_f32_16x16x32_bf16 a[180:183], a[204:207], a[228:231], a[180:183]
  v_exp_f32 v51, v51
  v_mfma_f32_16x16x32_bf16 a[184:187], a[204:207], a[232:235], a[184:187]
  buffer_load_dwordx4 v19, s[52:55], s39 offen offset:1024 lds
  v_mfma_f32_16x16x32_bf16 a[188:191], a[204:207], a[236:239], a[188:191]
  v_exp_f32 v52, v52
  v_mfma_f32_16x16x32_bf16 v[128:131], a[96:99], v[96:99], v[128:131]
  ds_read_b128 a[64:67], v116 offset:24576
  v_cvt_pk_bf16_f32 v105, v50, v51
  v_mfma_f32_16x16x32_bf16 v[144:147], a[100:103], v[96:99], v[144:147]
  ds_read_b128 a[68:71], v117 offset:24576
  v_mfma_f32_16x16x32_bf16 v[160:163], a[104:107], v[96:99], v[160:163]
  s_waitcnt lgkmcnt(10)
  v_exp_f32 v53, v53
  v_mfma_f32_16x16x32_bf16 v[176:179], a[108:111], v[96:99], v[176:179]
  s_waitcnt lgkmcnt(8)
  ds_read_b128 a[72:75], v118 offset:24576
  v_mfma_f32_16x16x32_bf16 v[192:195], a[112:115], v[96:99], v[192:195]
  s_waitcnt lgkmcnt(7)
  v_exp_f32 v54, v54
  v_mfma_f32_16x16x32_bf16 v[208:211], a[116:119], v[96:99], v[208:211]
  s_waitcnt lgkmcnt(5)
  buffer_load_dwordx4 v20, s[52:55], s39 offen offset:2048 lds
  v_mfma_f32_16x16x32_bf16 v[224:227], a[120:123], v[96:99], v[224:227]
  s_waitcnt lgkmcnt(3)
  ds_read_b128 a[76:79], v119 offset:24576
  v_cvt_pk_bf16_f32 v106, v52, v53
  v_mfma_f32_16x16x32_bf16 v[240:243], a[124:127], v[96:99], v[240:243]
  v_exp_f32 v55, v55
  v_mfma_f32_16x16x32_bf16 v[80:83], v[112:115], v[96:99], v[80:83]
  ds_read_b128 a[80:83], v116 offset:28672
  v_mfma_f32_16x16x32_bf16 v[132:135], a[96:99], v[100:103], v[132:135]
  v_exp_f32 v56, v56
  v_mfma_f32_16x16x32_bf16 v[148:151], a[100:103], v[100:103], v[148:151]
  ds_read_b128 a[84:87], v117 offset:28672
  v_mfma_f32_16x16x32_bf16 v[164:167], a[104:107], v[100:103], v[164:167]
  v_cvt_pk_bf16_f32 v107, v54, v55
  v_mfma_f32_16x16x32_bf16 v[180:183], a[108:111], v[100:103], v[180:183]
  buffer_load_dwordx4 v21, s[52:55], s39 offen offset:3072 lds
  v_mfma_f32_16x16x32_bf16 v[196:199], a[112:115], v[100:103], v[196:199]
  ds_read_b128 a[88:91], v118 offset:28672
  v_mfma_f32_16x16x32_bf16 v[212:215], a[116:119], v[100:103], v[212:215]
  v_exp_f32 v57, v57
  v_mfma_f32_16x16x32_bf16 v[228:231], a[120:123], v[100:103], v[228:231]
  ds_read_b128 a[92:95], v119 offset:28672
  v_mfma_f32_16x16x32_bf16 v[244:247], a[124:127], v[100:103], v[244:247]
  v_exp_f32 v58, v58
  v_mfma_f32_16x16x32_bf16 v[84:87], v[112:115], v[100:103], v[84:87]
  s_waitcnt lgkmcnt(7)
  s_add_u32 s39, s39, 131072
  v_cvt_pk_bf16_f32 v108, v56, v57
  v_mfma_f32_16x16x32_bf16 v[32:35], a[64:67], a[0:3], v[64:67]
  s_waitcnt lgkmcnt(6)
  s_add_u32 m0, s5, 4096
  v_mfma_f32_16x16x32_bf16 v[32:35], a[68:71], a[16:19], v[32:35]
  s_waitcnt lgkmcnt(5)
  buffer_load_dwordx4 v18, s[52:55], s39 offen lds
  v_mfma_f32_16x16x32_bf16 v[32:35], a[72:75], a[32:35], v[32:35]
  s_waitcnt lgkmcnt(4)
  v_exp_f32 v59, v59
  v_mfma_f32_16x16x32_bf16 v[32:35], a[76:79], a[48:51], v[32:35]
  s_waitcnt lgkmcnt(3)
  v_exp_f32 v60, v60
  v_mfma_f32_16x16x32_bf16 v[36:39], a[80:83], a[0:3], v[64:67]
  s_waitcnt lgkmcnt(2)
  v_mfma_f32_16x16x32_bf16 v[36:39], a[84:87], a[16:19], v[36:39]
  s_waitcnt lgkmcnt(1)
  v_mfma_f32_16x16x32_bf16 v[36:39], a[88:91], a[32:35], v[36:39]
  s_waitcnt lgkmcnt(0)
  v_cvt_pk_bf16_f32 v109, v58, v59
  v_mfma_f32_16x16x32_bf16 v[36:39], a[92:95], a[48:51], v[36:39]
  v_mfma_f32_16x16x32_bf16 v[40:43], a[64:67], a[4:7], v[68:71]
  buffer_load_dwordx4 v19, s[52:55], s39 offen offset:1024 lds
  v_mfma_f32_16x16x32_bf16 v[40:43], a[68:71], a[20:23], v[40:43]
  v_exp_f32 v61, v61
  v_mfma_f32_16x16x32_bf16 v[40:43], a[72:75], a[36:39], v[40:43]
  v_exp_f32 v62, v62
  v_mfma_f32_16x16x32_bf16 v[40:43], a[76:79], a[52:55], v[40:43]
  v_mfma_f32_16x16x32_bf16 v[44:47], a[80:83], a[4:7], v[68:71]
  v_cvt_pk_bf16_f32 v110, v60, v61
  v_mfma_f32_16x16x32_bf16 v[44:47], a[84:87], a[20:23], v[44:47]
  v_mfma_f32_16x16x32_bf16 v[44:47], a[88:91], a[36:39], v[44:47]
  v_exp_f32 v63, v63
  v_mfma_f32_16x16x32_bf16 v[44:47], a[92:95], a[52:55], v[44:47]
  s_waitcnt vmcnt(17)
  buffer_load_dwordx4 v20, s[52:55], s39 offen offset:2048 lds
  v_mfma_f32_16x16x32_bf16 a[128:131], a[208:211], a[240:243], a[128:131]
  v_cvt_pk_bf16_f32 v111, v62, v63
  v_mfma_f32_16x16x32_bf16 a[132:135], a[208:211], a[244:247], a[132:135]
  v_mfma_f32_16x16x32_bf16 a[136:139], a[208:211], a[248:251], a[136:139]
  v_mfma_f32_16x16x32_bf16 a[140:143], a[208:211], a[252:255], a[140:143]
  s_waitcnt vmcnt(17)
  v_mfma_f32_16x16x32_bf16 a[144:147], a[212:215], a[240:243], a[144:147]
  v_exp_f32 v32, v32
  v_mfma_f32_16x16x32_bf16 a[148:151], a[212:215], a[244:247], a[148:151]
  v_exp_f32 v33, v33
  v_mfma_f32_16x16x32_bf16 a[152:155], a[212:215], a[248:251], a[152:155]
  buffer_load_dwordx4 v21, s[52:55], s39 offen offset:3072 lds
  v_mfma_f32_16x16x32_bf16 a[156:159], a[212:215], a[252:255], a[156:159]
  s_waitcnt vmcnt(17)
  v_exp_f32 v34, v34
  v_mfma_f32_16x16x32_bf16 a[160:163], a[216:219], a[240:243], a[160:163]
  v_mfma_f32_16x16x32_bf16 a[164:167], a[216:219], a[244:247], a[164:167]
  v_cvt_pk_bf16_f32 v96, v32, v33
  v_mfma_f32_16x16x32_bf16 a[168:171], a[216:219], a[248:251], a[168:171]
  v_mfma_f32_16x16x32_bf16 a[172:175], a[216:219], a[252:255], a[172:175]
  s_waitcnt vmcnt(16)
  s_add_u32 s39, s39, 131072
  v_exp_f32 v35, v35
  v_mfma_f32_16x16x32_bf16 a[176:179], a[220:223], a[240:243], a[176:179]
  v_mfma_f32_16x16x32_bf16 a[180:183], a[220:223], a[244:247], a[180:183]
  v_exp_f32 v36, v36
  v_mfma_f32_16x16x32_bf16 a[184:187], a[220:223], a[248:251], a[184:187]
  v_mfma_f32_16x16x32_bf16 a[188:191], a[220:223], a[252:255], a[188:191]
  v_cvt_pk_bf16_f32 v97, v34, v35
  v_mfma_f32_16x16x32_bf16 v[136:139], a[96:99], v[104:107], v[136:139]
  v_mfma_f32_16x16x32_bf16 v[152:155], a[100:103], v[104:107], v[152:155]
  v_exp_f32 v37, v37
  v_mfma_f32_16x16x32_bf16 v[168:171], a[104:107], v[104:107], v[168:171]
  v_mfma_f32_16x16x32_bf16 v[184:187], a[108:111], v[104:107], v[184:187]
  buffer_load_dwordx4 a[192:195], v22, s[16:19], s36 offen sc1
  v_mfma_f32_16x16x32_bf16 v[200:203], a[112:115], v[104:107], v[200:203]
  v_exp_f32 v38, v38
  v_mfma_f32_16x16x32_bf16 v[216:219], a[116:119], v[104:107], v[216:219]
  v_mfma_f32_16x16x32_bf16 v[232:235], a[120:123], v[104:107], v[232:235]
  v_cvt_pk_bf16_f32 v98, v36, v37
  v_mfma_f32_16x16x32_bf16 v[248:251], a[124:127], v[104:107], v[248:251]
  buffer_load_dwordx4 a[196:199], v23, s[16:19], s36 offen sc1
  v_mfma_f32_16x16x32_bf16 v[88:91], v[112:115], v[104:107], v[88:91]
  v_exp_f32 v39, v39
  v_mfma_f32_16x16x32_bf16 v[140:143], a[96:99], v[108:111], v[140:143]
  v_mfma_f32_16x16x32_bf16 v[156:159], a[100:103], v[108:111], v[156:159]
  buffer_load_dwordx4 a[200:203], v24, s[16:19], s36 offen sc1
  v_mfma_f32_16x16x32_bf16 v[172:175], a[104:107], v[108:111], v[172:175]
  ds_read_b64_tr_b16 a[96:97], v120 offset:24576
  ds_read_b64_tr_b16 a[98:99], v120 offset:28672
  v_mfma_f32_16x16x32_bf16 v[188:191], a[108:111], v[108:111], v[188:191]
  v_exp_f32 v40, v40
  v_mfma_f32_16x16x32_bf16 v[204:207], a[112:115], v[108:111], v[204:207]
  buffer_load_dwordx4 a[204:207], v25, s[16:19], s36 offen sc1
  v_mfma_f32_16x16x32_bf16 v[220:223], a[116:119], v[108:111], v[220:223]
  ds_read_b64_tr_b16 a[100:101], v121 offset:24576
  ds_read_b64_tr_b16 a[102:103], v121 offset:28672
  v_mfma_f32_16x16x32_bf16 v[236:239], a[120:123], v[108:111], v[236:239]
  s_add_u32 s36, s36, 1024
  ds_read_b64_tr_b16 a[104:105], v122 offset:24576
  v_cvt_pk_bf16_f32 v99, v38, v39
  v_mfma_f32_16x16x32_bf16 v[252:255], a[124:127], v[108:111], v[252:255]
  ds_read_b64_tr_b16 a[106:107], v122 offset:28672
  ds_read_b64_tr_b16 a[108:109], v123 offset:24576
  v_mfma_f32_16x16x32_bf16 v[92:95], v[112:115], v[108:111], v[92:95]
  buffer_load_dwordx4 a[208:211], v22, s[16:19], s36 offen sc1
  v_mfma_f32_16x16x32_bf16 v[48:51], a[64:67], a[8:11], v[72:75]
  v_exp_f32 v41, v41
  v_mfma_f32_16x16x32_bf16 v[48:51], a[68:71], a[24:27], v[48:51]
  ds_read_b64_tr_b16 a[110:111], v123 offset:28672
  ds_read_b64_tr_b16 a[112:113], v124 offset:24576
  v_mfma_f32_16x16x32_bf16 v[48:51], a[72:75], a[40:43], v[48:51]
  buffer_load_dwordx4 a[212:215], v23, s[16:19], s36 offen sc1
  v_mfma_f32_16x16x32_bf16 v[48:51], a[76:79], a[56:59], v[48:51]
  v_exp_f32 v42, v42
  v_mfma_f32_16x16x32_bf16 v[52:55], a[80:83], a[8:11], v[72:75]
  ds_read_b64_tr_b16 a[114:115], v124 offset:28672
  v_cvt_pk_bf16_f32 v100, v40, v41
  v_mfma_f32_16x16x32_bf16 v[52:55], a[84:87], a[24:27], v[52:55]
  buffer_load_dwordx4 a[216:219], v24, s[16:19], s36 offen sc1
  v_mfma_f32_16x16x32_bf16 v[52:55], a[88:91], a[40:43], v[52:55]
  ds_read_b64_tr_b16 a[116:117], v125 offset:24576
  ds_read_b64_tr_b16 a[118:119], v125 offset:28672
  v_mfma_f32_16x16x32_bf16 v[52:55], a[92:95], a[56:59], v[52:55]
  v_exp_f32 v43, v43
  v_mfma_f32_16x16x32_bf16 v[56:59], a[64:67], a[12:15], v[76:79]
  ds_read_b64_tr_b16 a[120:121], v126 offset:24576
  ds_read_b64_tr_b16 a[122:123], v126 offset:28672
  v_mfma_f32_16x16x32_bf16 v[56:59], a[68:71], a[28:31], v[56:59]
  buffer_load_dwordx4 a[220:223], v25, s[16:19], s36 offen sc1
  v_mfma_f32_16x16x32_bf16 v[56:59], a[72:75], a[44:47], v[56:59]
  ds_read_b64_tr_b16 a[124:125], v127 offset:24576
  ds_read_b64_tr_b16 a[126:127], v127 offset:28672
  v_exp_f32 v44, v44
  v_mfma_f32_16x16x32_bf16 v[56:59], a[76:79], a[60:63], v[56:59]
  s_add_u32 s36, s36, 1024
  v_cvt_pk_bf16_f32 v101, v42, v43
  v_mfma_f32_16x16x32_bf16 v[60:63], a[80:83], a[12:15], v[76:79]
  v_exp_f32 v45, v45
  v_mfma_f32_16x16x32_bf16 v[60:63], a[84:87], a[28:31], v[60:63]
  v_exp_f32 v46, v46
  v_mfma_f32_16x16x32_bf16 v[60:63], a[88:91], a[44:47], v[60:63]
  v_mfma_f32_16x16x32_bf16 v[60:63], a[92:95], a[60:63], v[60:63]
  s_xor_b32 s40, s40, 8192
  s_waitcnt vmcnt(24) lgkmcnt(0)
  s_barrier
  v_mfma_f32_16x16x32_bf16 v[128:131], a[96:99], v[96:99], v[128:131]
  ds_read_b128 a[64:67], v116 offset:32768
  v_cvt_pk_bf16_f32 v102, v44, v45
  v_mfma_f32_16x16x32_bf16 v[144:147], a[100:103], v[96:99], v[144:147]
  v_exp_f32 v47, v47
  v_mfma_f32_16x16x32_bf16 v[160:163], a[104:107], v[96:99], v[160:163]
  ds_read_b128 a[68:71], v117 offset:32768
  v_cvt_pk_bf16_f32 v103, v46, v47
  v_mfma_f32_16x16x32_bf16 v[176:179], a[108:111], v[96:99], v[176:179]
  ds_read_b128 a[72:75], v118 offset:32768
  v_mfma_f32_16x16x32_bf16 v[192:195], a[112:115], v[96:99], v[192:195]
  ds_read_b64_tr_b16 a[224:225], v14
  v_mfma_f32_16x16x32_bf16 v[208:211], a[116:119], v[96:99], v[208:211]
  v_exp_f32 v48, v48
  v_mfma_f32_16x16x32_bf16 v[224:227], a[120:123], v[96:99], v[224:227]
  v_exp_f32 v49, v49
  v_mfma_f32_16x16x32_bf16 v[240:243], a[124:127], v[96:99], v[240:243]
  ds_read_b128 a[76:79], v119 offset:32768
  ds_read_b64_tr_b16 a[226:227], v14 offset:2048
  v_mfma_f32_16x16x32_bf16 v[80:83], v[112:115], v[96:99], v[80:83]
  v_exp_f32 v50, v50
  v_mfma_f32_16x16x32_bf16 v[132:135], a[96:99], v[100:103], v[132:135]
  ds_read_b128 a[80:83], v116 offset:36864
  v_cvt_pk_bf16_f32 v104, v48, v49
  v_mfma_f32_16x16x32_bf16 v[148:151], a[100:103], v[100:103], v[148:151]
  v_exp_f32 v51, v51
  v_mfma_f32_16x16x32_bf16 v[164:167], a[104:107], v[100:103], v[164:167]
  ds_read_b64_tr_b16 a[228:229], v15
  ds_read_b128 a[84:87], v117 offset:36864
  v_mfma_f32_16x16x32_bf16 v[180:183], a[108:111], v[100:103], v[180:183]
  s_add_u32 m0, s21, 16384
  v_exp_f32 v52, v52
  v_mfma_f32_16x16x32_bf16 v[196:199], a[112:115], v[100:103], v[196:199]
  buffer_load_dwordx4 v8, s[8:11], s20 offen lds
  v_mfma_f32_16x16x32_bf16 v[212:215], a[116:119], v[100:103], v[212:215]
  ds_read_b128 a[88:91], v118 offset:36864
  v_cvt_pk_bf16_f32 v105, v50, v51
  v_mfma_f32_16x16x32_bf16 v[228:231], a[120:123], v[100:103], v[228:231]
  v_exp_f32 v53, v53
  v_mfma_f32_16x16x32_bf16 v[244:247], a[124:127], v[100:103], v[244:247]
  ds_read_b64_tr_b16 a[230:231], v15 offset:2048
  ds_read_b128 a[92:95], v119 offset:36864
  v_mfma_f32_16x16x32_bf16 v[84:87], v[112:115], v[100:103], v[84:87]
  s_waitcnt lgkmcnt(11)
  v_exp_f32 v54, v54
  v_mfma_f32_16x16x32_bf16 v[32:35], a[64:67], a[0:3], v[64:67]
  s_waitcnt lgkmcnt(10)
  ds_read_b64_tr_b16 a[232:233], v16
  v_cvt_pk_bf16_f32 v106, v52, v53
  v_mfma_f32_16x16x32_bf16 v[32:35], a[68:71], a[16:19], v[32:35]
  s_waitcnt lgkmcnt(10)
  v_exp_f32 v55, v55
  v_mfma_f32_16x16x32_bf16 v[32:35], a[72:75], a[32:35], v[32:35]
  s_waitcnt lgkmcnt(8)
  buffer_load_dwordx4 v9, s[8:11], s20 offen offset:1024 lds
  v_mfma_f32_16x16x32_bf16 v[32:35], a[76:79], a[48:51], v[32:35]
  s_waitcnt lgkmcnt(6)
  v_exp_f32 v56, v56
  v_mfma_f32_16x16x32_bf16 v[36:39], a[80:83], a[0:3], v[64:67]
  s_waitcnt lgkmcnt(4)
  ds_read_b64_tr_b16 a[234:235], v16 offset:2048
  v_cvt_pk_bf16_f32 v107, v54, v55
  v_mfma_f32_16x16x32_bf16 v[36:39], a[84:87], a[16:19], v[36:39]
  s_waitcnt lgkmcnt(4)
  v_exp_f32 v57, v57
  v_mfma_f32_16x16x32_bf16 v[36:39], a[88:91], a[32:35], v[36:39]
  s_waitcnt lgkmcnt(2)
  v_exp_f32 v58, v58
  v_mfma_f32_16x16x32_bf16 v[36:39], a[92:95], a[48:51], v[36:39]
  ds_read_b64_tr_b16 a[236:237], v17
  v_cvt_pk_bf16_f32 v108, v56, v57
  v_mfma_f32_16x16x32_bf16 v[40:43], a[64:67], a[4:7], v[68:71]
  buffer_load_dwordx4 v10, s[8:11], s20 offen offset:2048 lds
  v_mfma_f32_16x16x32_bf16 v[40:43], a[68:71], a[20:23], v[40:43]
  v_exp_f32 v59, v59
  v_mfma_f32_16x16x32_bf16 v[40:43], a[72:75], a[36:39], v[40:43]
  v_exp_f32 v60, v60
  v_mfma_f32_16x16x32_bf16 v[40:43], a[76:79], a[52:55], v[40:43]
  ds_read_b64_tr_b16 a[238:239], v17 offset:2048
  v_cvt_pk_bf16_f32 v109, v58, v59
  v_mfma_f32_16x16x32_bf16 v[44:47], a[80:83], a[4:7], v[68:71]
  v_exp_f32 v61, v61
  v_mfma_f32_16x16x32_bf16 v[44:47], a[84:87], a[20:23], v[44:47]
  ds_read_b64_tr_b16 a[240:241], v14 offset:4096
  v_mfma_f32_16x16x32_bf16 v[44:47], a[88:91], a[36:39], v[44:47]
  v_exp_f32 v62, v62
  v_mfma_f32_16x16x32_bf16 v[44:47], a[92:95], a[52:55], v[44:47]
  buffer_load_dwordx4 v11, s[8:11], s20 offen offset:3072 lds
  v_mfma_f32_16x16x32_bf16 v[136:139], a[96:99], v[104:107], v[136:139]
  ds_read_b64_tr_b16 a[242:243], v14 offset:6144
  v_cvt_pk_bf16_f32 v110, v60, v61
  v_mfma_f32_16x16x32_bf16 v[152:155], a[100:103], v[104:107], v[152:155]
  v_exp_f32 v63, v63
  v_mfma_f32_16x16x32_bf16 v[168:171], a[104:107], v[104:107], v[168:171]
  v_cvt_pk_bf16_f32 v111, v62, v63
  v_mfma_f32_16x16x32_bf16 v[184:187], a[108:111], v[104:107], v[184:187]
  ds_read_b64_tr_b16 a[244:245], v15 offset:4096
  v_mfma_f32_16x16x32_bf16 v[200:203], a[112:115], v[104:107], v[200:203]
  v_exp_f32 v32, v32
  v_mfma_f32_16x16x32_bf16 v[216:219], a[116:119], v[104:107], v[216:219]
  v_exp_f32 v33, v33
  v_mfma_f32_16x16x32_bf16 v[232:235], a[120:123], v[104:107], v[232:235]
  v_exp_f32 v34, v34
  v_mfma_f32_16x16x32_bf16 v[248:251], a[124:127], v[104:107], v[248:251]
  ds_read_b64_tr_b16 a[246:247], v15 offset:6144
  v_cvt_pk_bf16_f32 v96, v32, v33
  v_mfma_f32_16x16x32_bf16 v[88:91], v[112:115], v[104:107], v[88:91]
  s_add_u32 m0, s21, 65536
  v_exp_f32 v35, v35
  v_mfma_f32_16x16x32_bf16 v[140:143], a[96:99], v[108:111], v[140:143]
  buffer_load_dwordx4 v12, s[12:15], s20 offen lds
  v_mfma_f32_16x16x32_bf16 v[156:159], a[100:103], v[108:111], v[156:159]
  ds_read_b64_tr_b16 a[96:97], v120 offset:32768
  ds_read_b64_tr_b16 a[98:99], v120 offset:36864
  v_mfma_f32_16x16x32_bf16 v[172:175], a[104:107], v[108:111], v[172:175]
  v_exp_f32 v36, v36
  v_mfma_f32_16x16x32_bf16 v[188:191], a[108:111], v[108:111], v[188:191]
  ds_read_b64_tr_b16 a[248:249], v16 offset:4096
  v_cvt_pk_bf16_f32 v97, v34, v35
  v_mfma_f32_16x16x32_bf16 v[204:207], a[112:115], v[108:111], v[204:207]
  v_exp_f32 v37, v37
  v_mfma_f32_16x16x32_bf16 v[220:223], a[116:119], v[108:111], v[220:223]
  ds_read_b64_tr_b16 a[100:101], v121 offset:32768
  ds_read_b64_tr_b16 a[250:251], v16 offset:6144
  v_mfma_f32_16x16x32_bf16 v[236:239], a[120:123], v[108:111], v[236:239]
  v_exp_f32 v38, v38
  v_mfma_f32_16x16x32_bf16 v[252:255], a[124:127], v[108:111], v[252:255]
  buffer_load_dwordx4 v13, s[12:15], s20 offen offset:1024 lds
  v_mfma_f32_16x16x32_bf16 v[92:95], v[112:115], v[108:111], v[92:95]
  ds_read_b64_tr_b16 a[102:103], v121 offset:36864
  v_cvt_pk_bf16_f32 v98, v36, v37
  v_mfma_f32_16x16x32_bf16 v[48:51], a[64:67], a[8:11], v[72:75]
  v_exp_f32 v39, v39
  v_mfma_f32_16x16x32_bf16 v[48:51], a[68:71], a[24:27], v[48:51]
  ds_read_b64_tr_b16 a[104:105], v122 offset:32768
  ds_read_b64_tr_b16 a[252:253], v17 offset:4096
  v_mfma_f32_16x16x32_bf16 v[48:51], a[72:75], a[40:43], v[48:51]
  v_exp_f32 v40, v40
  v_mfma_f32_16x16x32_bf16 v[48:51], a[76:79], a[56:59], v[48:51]
  ds_read_b64_tr_b16 a[106:107], v122 offset:36864
  v_cvt_pk_bf16_f32 v99, v38, v39
  v_mfma_f32_16x16x32_bf16 v[52:55], a[80:83], a[8:11], v[72:75]
  v_exp_f32 v41, v41
  v_mfma_f32_16x16x32_bf16 v[52:55], a[84:87], a[24:27], v[52:55]
  buffer_load_dwordx4 v12, s[12:15], s20 offen offset:2048 lds
  v_mfma_f32_16x16x32_bf16 v[52:55], a[88:91], a[40:43], v[52:55]
  ds_read_b64_tr_b16 a[108:109], v123 offset:32768
  ds_read_b64_tr_b16 a[254:255], v17 offset:6144
  v_mfma_f32_16x16x32_bf16 v[52:55], a[92:95], a[56:59], v[52:55]
  v_exp_f32 v42, v42
  v_mfma_f32_16x16x32_bf16 v[56:59], a[64:67], a[12:15], v[76:79]
  ds_read_b64_tr_b16 a[110:111], v123 offset:36864
  v_cvt_pk_bf16_f32 v100, v40, v41
  v_mfma_f32_16x16x32_bf16 v[56:59], a[68:71], a[28:31], v[56:59]
  v_exp_f32 v43, v43
  v_mfma_f32_16x16x32_bf16 v[56:59], a[72:75], a[44:47], v[56:59]
  ds_read_b64_tr_b16 a[112:113], v124 offset:32768
  ds_read_b64_tr_b16 a[114:115], v124 offset:36864
  v_mfma_f32_16x16x32_bf16 v[56:59], a[76:79], a[60:63], v[56:59]
  buffer_load_dwordx4 v13, s[12:15], s20 offen offset:3072 lds
  s_add_u32 s20, s20, 16384
  v_mfma_f32_16x16x32_bf16 v[60:63], a[80:83], a[12:15], v[76:79]
  v_exp_f32 v44, v44
  v_mfma_f32_16x16x32_bf16 v[60:63], a[84:87], a[28:31], v[60:63]
  ds_read_b64_tr_b16 a[116:117], v125 offset:32768
  v_cvt_pk_bf16_f32 v101, v42, v43
  v_mfma_f32_16x16x32_bf16 v[60:63], a[88:91], a[44:47], v[60:63]
  v_exp_f32 v45, v45
  v_mfma_f32_16x16x32_bf16 v[60:63], a[92:95], a[60:63], v[60:63]
  s_waitcnt vmcnt(15)
  v_exp_f32 v46, v46
  v_mfma_f32_16x16x32_bf16 a[128:131], a[192:195], a[224:227], a[128:131]
  ds_read_b64_tr_b16 a[118:119], v125 offset:36864
  v_cvt_pk_bf16_f32 v102, v44, v45
  v_mfma_f32_16x16x32_bf16 a[132:135], a[192:195], a[228:231], a[132:135]
  s_waitcnt lgkmcnt(15)
  v_exp_f32 v47, v47
  v_mfma_f32_16x16x32_bf16 a[136:139], a[192:195], a[232:235], a[136:139]
  ds_read_b64_tr_b16 a[120:121], v126 offset:32768
  v_cvt_pk_bf16_f32 v103, v46, v47
  v_mfma_f32_16x16x32_bf16 a[140:143], a[192:195], a[236:239], a[140:143]
  s_waitcnt vmcnt(14)
  ds_read_b64_tr_b16 a[122:123], v126 offset:36864
  v_mfma_f32_16x16x32_bf16 a[144:147], a[196:199], a[224:227], a[144:147]
  v_exp_f32 v48, v48
  v_mfma_f32_16x16x32_bf16 a[148:151], a[196:199], a[228:231], a[148:151]
  ds_read_b64_tr_b16 a[124:125], v127 offset:32768
  v_mfma_f32_16x16x32_bf16 a[152:155], a[196:199], a[232:235], a[152:155]
  s_cmp_gt_u32 s38, 4
  s_cselect_b32 s37, 0x30000, 0
  s_add_u32 s38, s38, 1
  s_max_u32 s5, s40, s37
  s_mov_b32 m0, s5
  v_exp_f32 v49, v49
  v_mfma_f32_16x16x32_bf16 a[156:159], a[196:199], a[236:239], a[156:159]
  s_waitcnt vmcnt(13)
  s_waitcnt lgkmcnt(8)
  buffer_load_dwordx4 v18, s[52:55], s39 offen lds
  v_mfma_f32_16x16x32_bf16 a[160:163], a[200:203], a[224:227], a[160:163]
  v_xor_b32 v14, 8192, v14
  v_xor_b32 v15, 8192, v15
  v_mfma_f32_16x16x32_bf16 a[164:167], a[200:203], a[228:231], a[164:167]
  v_xor_b32 v16, 8192, v16
  v_xor_b32 v17, 8192, v17
  v_mfma_f32_16x16x32_bf16 a[168:171], a[200:203], a[232:235], a[168:171]
  ds_read_b64_tr_b16 a[126:127], v127 offset:36864
  v_mfma_f32_16x16x32_bf16 a[172:175], a[200:203], a[236:239], a[172:175]
  s_waitcnt vmcnt(13)
  v_exp_f32 v50, v50
  v_mfma_f32_16x16x32_bf16 a[176:179], a[204:207], a[224:227], a[176:179]
  v_cvt_pk_bf16_f32 v104, v48, v49
  v_mfma_f32_16x16x32_bf16 a[180:183], a[204:207], a[228:231], a[180:183]
  v_exp_f32 v51, v51
  v_mfma_f32_16x16x32_bf16 a[184:187], a[204:207], a[232:235], a[184:187]
  buffer_load_dwordx4 v19, s[52:55], s39 offen offset:1024 lds
  v_mfma_f32_16x16x32_bf16 a[188:191], a[204:207], a[236:239], a[188:191]
  v_exp_f32 v52, v52
  v_mfma_f32_16x16x32_bf16 v[128:131], a[96:99], v[96:99], v[128:131]
  ds_read_b128 a[64:67], v116 offset:40960
  v_cvt_pk_bf16_f32 v105, v50, v51
  v_mfma_f32_16x16x32_bf16 v[144:147], a[100:103], v[96:99], v[144:147]
  ds_read_b128 a[68:71], v117 offset:40960
  v_mfma_f32_16x16x32_bf16 v[160:163], a[104:107], v[96:99], v[160:163]
  s_waitcnt lgkmcnt(10)
  v_exp_f32 v53, v53
  v_mfma_f32_16x16x32_bf16 v[176:179], a[108:111], v[96:99], v[176:179]
  s_waitcnt lgkmcnt(8)
  ds_read_b128 a[72:75], v118 offset:40960
  v_mfma_f32_16x16x32_bf16 v[192:195], a[112:115], v[96:99], v[192:195]
  s_waitcnt lgkmcnt(7)
  v_exp_f32 v54, v54
  v_mfma_f32_16x16x32_bf16 v[208:211], a[116:119], v[96:99], v[208:211]
  s_waitcnt lgkmcnt(5)
  buffer_load_dwordx4 v20, s[52:55], s39 offen offset:2048 lds
  v_mfma_f32_16x16x32_bf16 v[224:227], a[120:123], v[96:99], v[224:227]
  s_waitcnt lgkmcnt(3)
  ds_read_b128 a[76:79], v119 offset:40960
  v_cvt_pk_bf16_f32 v106, v52, v53
  v_mfma_f32_16x16x32_bf16 v[240:243], a[124:127], v[96:99], v[240:243]
  v_exp_f32 v55, v55
  v_mfma_f32_16x16x32_bf16 v[80:83], v[112:115], v[96:99], v[80:83]
  ds_read_b128 a[80:83], v116 offset:45056
  v_mfma_f32_16x16x32_bf16 v[132:135], a[96:99], v[100:103], v[132:135]
  v_exp_f32 v56, v56
  v_mfma_f32_16x16x32_bf16 v[148:151], a[100:103], v[100:103], v[148:151]
  ds_read_b128 a[84:87], v117 offset:45056
  v_mfma_f32_16x16x32_bf16 v[164:167], a[104:107], v[100:103], v[164:167]
  v_cvt_pk_bf16_f32 v107, v54, v55
  v_mfma_f32_16x16x32_bf16 v[180:183], a[108:111], v[100:103], v[180:183]
  buffer_load_dwordx4 v21, s[52:55], s39 offen offset:3072 lds
  v_mfma_f32_16x16x32_bf16 v[196:199], a[112:115], v[100:103], v[196:199]
  ds_read_b128 a[88:91], v118 offset:45056
  v_mfma_f32_16x16x32_bf16 v[212:215], a[116:119], v[100:103], v[212:215]
  v_exp_f32 v57, v57
  v_mfma_f32_16x16x32_bf16 v[228:231], a[120:123], v[100:103], v[228:231]
  ds_read_b128 a[92:95], v119 offset:45056
  v_mfma_f32_16x16x32_bf16 v[244:247], a[124:127], v[100:103], v[244:247]
  v_exp_f32 v58, v58
  v_mfma_f32_16x16x32_bf16 v[84:87], v[112:115], v[100:103], v[84:87]
  s_waitcnt lgkmcnt(7)
  s_add_u32 s39, s39, 131072
  v_cvt_pk_bf16_f32 v108, v56, v57
  v_mfma_f32_16x16x32_bf16 v[32:35], a[64:67], a[0:3], v[64:67]
  s_waitcnt lgkmcnt(6)
  s_add_u32 m0, s5, 4096
  v_mfma_f32_16x16x32_bf16 v[32:35], a[68:71], a[16:19], v[32:35]
  s_waitcnt lgkmcnt(5)
  buffer_load_dwordx4 v18, s[52:55], s39 offen lds
  v_mfma_f32_16x16x32_bf16 v[32:35], a[72:75], a[32:35], v[32:35]
  s_waitcnt lgkmcnt(4)
  v_exp_f32 v59, v59
  v_mfma_f32_16x16x32_bf16 v[32:35], a[76:79], a[48:51], v[32:35]
  s_waitcnt lgkmcnt(3)
  v_exp_f32 v60, v60
  v_mfma_f32_16x16x32_bf16 v[36:39], a[80:83], a[0:3], v[64:67]
  s_waitcnt lgkmcnt(2)
  v_mfma_f32_16x16x32_bf16 v[36:39], a[84:87], a[16:19], v[36:39]
  s_waitcnt lgkmcnt(1)
  v_mfma_f32_16x16x32_bf16 v[36:39], a[88:91], a[32:35], v[36:39]
  s_waitcnt lgkmcnt(0)
  v_cvt_pk_bf16_f32 v109, v58, v59
  v_mfma_f32_16x16x32_bf16 v[36:39], a[92:95], a[48:51], v[36:39]
  v_mfma_f32_16x16x32_bf16 v[40:43], a[64:67], a[4:7], v[68:71]
  buffer_load_dwordx4 v19, s[52:55], s39 offen offset:1024 lds
  v_mfma_f32_16x16x32_bf16 v[40:43], a[68:71], a[20:23], v[40:43]
  v_exp_f32 v61, v61
  v_mfma_f32_16x16x32_bf16 v[40:43], a[72:75], a[36:39], v[40:43]
  v_exp_f32 v62, v62
  v_mfma_f32_16x16x32_bf16 v[40:43], a[76:79], a[52:55], v[40:43]
  v_mfma_f32_16x16x32_bf16 v[44:47], a[80:83], a[4:7], v[68:71]
  v_cvt_pk_bf16_f32 v110, v60, v61
  v_mfma_f32_16x16x32_bf16 v[44:47], a[84:87], a[20:23], v[44:47]
  v_mfma_f32_16x16x32_bf16 v[44:47], a[88:91], a[36:39], v[44:47]
  v_exp_f32 v63, v63
  v_mfma_f32_16x16x32_bf16 v[44:47], a[92:95], a[52:55], v[44:47]
  s_waitcnt vmcnt(17)
  buffer_load_dwordx4 v20, s[52:55], s39 offen offset:2048 lds
  v_mfma_f32_16x16x32_bf16 a[128:131], a[208:211], a[240:243], a[128:131]
  v_cvt_pk_bf16_f32 v111, v62, v63
  v_mfma_f32_16x16x32_bf16 a[132:135], a[208:211], a[244:247], a[132:135]
  v_mfma_f32_16x16x32_bf16 a[136:139], a[208:211], a[248:251], a[136:139]
  v_mfma_f32_16x16x32_bf16 a[140:143], a[208:211], a[252:255], a[140:143]
  s_waitcnt vmcnt(17)
  v_mfma_f32_16x16x32_bf16 a[144:147], a[212:215], a[240:243], a[144:147]
  v_exp_f32 v32, v32
  v_mfma_f32_16x16x32_bf16 a[148:151], a[212:215], a[244:247], a[148:151]
  v_exp_f32 v33, v33
  v_mfma_f32_16x16x32_bf16 a[152:155], a[212:215], a[248:251], a[152:155]
  buffer_load_dwordx4 v21, s[52:55], s39 offen offset:3072 lds
  v_mfma_f32_16x16x32_bf16 a[156:159], a[212:215], a[252:255], a[156:159]
  s_waitcnt vmcnt(17)
  v_exp_f32 v34, v34
  v_mfma_f32_16x16x32_bf16 a[160:163], a[216:219], a[240:243], a[160:163]
  v_mfma_f32_16x16x32_bf16 a[164:167], a[216:219], a[244:247], a[164:167]
  v_cvt_pk_bf16_f32 v96, v32, v33
  v_mfma_f32_16x16x32_bf16 a[168:171], a[216:219], a[248:251], a[168:171]
  v_mfma_f32_16x16x32_bf16 a[172:175], a[216:219], a[252:255], a[172:175]
  s_waitcnt vmcnt(16)
  s_add_u32 s39, s39, 131072
  v_exp_f32 v35, v35
  v_mfma_f32_16x16x32_bf16 a[176:179], a[220:223], a[240:243], a[176:179]
  v_mfma_f32_16x16x32_bf16 a[180:183], a[220:223], a[244:247], a[180:183]
  v_exp_f32 v36, v36
  v_mfma_f32_16x16x32_bf16 a[184:187], a[220:223], a[248:251], a[184:187]
  v_mfma_f32_16x16x32_bf16 a[188:191], a[220:223], a[252:255], a[188:191]
  v_cvt_pk_bf16_f32 v97, v34, v35
  v_mfma_f32_16x16x32_bf16 v[136:139], a[96:99], v[104:107], v[136:139]
  v_mfma_f32_16x16x32_bf16 v[152:155], a[100:103], v[104:107], v[152:155]
  v_exp_f32 v37, v37
  v_mfma_f32_16x16x32_bf16 v[168:171], a[104:107], v[104:107], v[168:171]
  v_mfma_f32_16x16x32_bf16 v[184:187], a[108:111], v[104:107], v[184:187]
  buffer_load_dwordx4 a[192:195], v22, s[16:19], s36 offen sc1
  v_mfma_f32_16x16x32_bf16 v[200:203], a[112:115], v[104:107], v[200:203]
  v_exp_f32 v38, v38
  v_mfma_f32_16x16x32_bf16 v[216:219], a[116:119], v[104:107], v[216:219]
  v_mfma_f32_16x16x32_bf16 v[232:235], a[120:123], v[104:107], v[232:235]
  v_cvt_pk_bf16_f32 v98, v36, v37
  v_mfma_f32_16x16x32_bf16 v[248:251], a[124:127], v[104:107], v[248:251]
  buffer_load_dwordx4 a[196:199], v23, s[16:19], s36 offen sc1
  v_mfma_f32_16x16x32_bf16 v[88:91], v[112:115], v[104:107], v[88:91]
  v_exp_f32 v39, v39
  v_mfma_f32_16x16x32_bf16 v[140:143], a[96:99], v[108:111], v[140:143]
  v_mfma_f32_16x16x32_bf16 v[156:159], a[100:103], v[108:111], v[156:159]
  buffer_load_dwordx4 a[200:203], v24, s[16:19], s36 offen sc1
  v_mfma_f32_16x16x32_bf16 v[172:175], a[104:107], v[108:111], v[172:175]
  ds_read_b64_tr_b16 a[96:97], v120 offset:40960
  ds_read_b64_tr_b16 a[98:99], v120 offset:45056
  v_mfma_f32_16x16x32_bf16 v[188:191], a[108:111], v[108:111], v[188:191]
  v_exp_f32 v40, v40
  v_mfma_f32_16x16x32_bf16 v[204:207], a[112:115], v[108:111], v[204:207]
  buffer_load_dwordx4 a[204:207], v25, s[16:19], s36 offen sc1
  v_mfma_f32_16x16x32_bf16 v[220:223], a[116:119], v[108:111], v[220:223]
  ds_read_b64_tr_b16 a[100:101], v121 offset:40960
  ds_read_b64_tr_b16 a[102:103], v121 offset:45056
  v_mfma_f32_16x16x32_bf16 v[236:239], a[120:123], v[108:111], v[236:239]
  s_add_u32 s36, s36, 1024
  ds_read_b64_tr_b16 a[104:105], v122 offset:40960
  v_cvt_pk_bf16_f32 v99, v38, v39
  v_mfma_f32_16x16x32_bf16 v[252:255], a[124:127], v[108:111], v[252:255]
  ds_read_b64_tr_b16 a[106:107], v122 offset:45056
  ds_read_b64_tr_b16 a[108:109], v123 offset:40960
  v_mfma_f32_16x16x32_bf16 v[92:95], v[112:115], v[108:111], v[92:95]
  buffer_load_dwordx4 a[208:211], v22, s[16:19], s36 offen sc1
  v_mfma_f32_16x16x32_bf16 v[48:51], a[64:67], a[8:11], v[72:75]
  v_exp_f32 v41, v41
  v_mfma_f32_16x16x32_bf16 v[48:51], a[68:71], a[24:27], v[48:51]
  ds_read_b64_tr_b16 a[110:111], v123 offset:45056
  ds_read_b64_tr_b16 a[112:113], v124 offset:40960
  v_mfma_f32_16x16x32_bf16 v[48:51], a[72:75], a[40:43], v[48:51]
  buffer_load_dwordx4 a[212:215], v23, s[16:19], s36 offen sc1
  v_mfma_f32_16x16x32_bf16 v[48:51], a[76:79], a[56:59], v[48:51]
  v_exp_f32 v42, v42
  v_mfma_f32_16x16x32_bf16 v[52:55], a[80:83], a[8:11], v[72:75]
  ds_read_b64_tr_b16 a[114:115], v124 offset:45056
  v_cvt_pk_bf16_f32 v100, v40, v41
  v_mfma_f32_16x16x32_bf16 v[52:55], a[84:87], a[24:27], v[52:55]
  buffer_load_dwordx4 a[216:219], v24, s[16:19], s36 offen sc1
  v_mfma_f32_16x16x32_bf16 v[52:55], a[88:91], a[40:43], v[52:55]
  ds_read_b64_tr_b16 a[116:117], v125 offset:40960
  ds_read_b64_tr_b16 a[118:119], v125 offset:45056
  v_mfma_f32_16x16x32_bf16 v[52:55], a[92:95], a[56:59], v[52:55]
  v_exp_f32 v43, v43
  v_mfma_f32_16x16x32_bf16 v[56:59], a[64:67], a[12:15], v[76:79]
  ds_read_b64_tr_b16 a[120:121], v126 offset:40960
  ds_read_b64_tr_b16 a[122:123], v126 offset:45056
  v_mfma_f32_16x16x32_bf16 v[56:59], a[68:71], a[28:31], v[56:59]
  buffer_load_dwordx4 a[220:223], v25, s[16:19], s36 offen sc1
  v_mfma_f32_16x16x32_bf16 v[56:59], a[72:75], a[44:47], v[56:59]
  ds_read_b64_tr_b16 a[124:125], v127 offset:40960
  ds_read_b64_tr_b16 a[126:127], v127 offset:45056
  v_exp_f32 v44, v44
  v_mfma_f32_16x16x32_bf16 v[56:59], a[76:79], a[60:63], v[56:59]
  s_add_u32 s36, s36, 1024
  v_cvt_pk_bf16_f32 v101, v42, v43
  v_mfma_f32_16x16x32_bf16 v[60:63], a[80:83], a[12:15], v[76:79]
  v_exp_f32 v45, v45
  v_mfma_f32_16x16x32_bf16 v[60:63], a[84:87], a[28:31], v[60:63]
  v_exp_f32 v46, v46
  v_mfma_f32_16x16x32_bf16 v[60:63], a[88:91], a[44:47], v[60:63]
  v_mfma_f32_16x16x32_bf16 v[60:63], a[92:95], a[60:63], v[60:63]
  s_xor_b32 s40, s40, 8192
  s_waitcnt vmcnt(24) lgkmcnt(0)
  s_barrier
  v_mfma_f32_16x16x32_bf16 v[128:131], a[96:99], v[96:99], v[128:131]
  ds_read_b128 a[64:67], v116
  v_cvt_pk_bf16_f32 v102, v44, v45
  v_mfma_f32_16x16x32_bf16 v[144:147], a[100:103], v[96:99], v[144:147]
  v_exp_f32 v47, v47
  v_mfma_f32_16x16x32_bf16 v[160:163], a[104:107], v[96:99], v[160:163]
  ds_read_b128 a[68:71], v117
  v_cvt_pk_bf16_f32 v103, v46, v47
  v_mfma_f32_16x16x32_bf16 v[176:179], a[108:111], v[96:99], v[176:179]
  ds_read_b128 a[72:75], v118
  v_mfma_f32_16x16x32_bf16 v[192:195], a[112:115], v[96:99], v[192:195]
  ds_read_b64_tr_b16 a[224:225], v14
  v_mfma_f32_16x16x32_bf16 v[208:211], a[116:119], v[96:99], v[208:211]
  v_exp_f32 v48, v48
  v_mfma_f32_16x16x32_bf16 v[224:227], a[120:123], v[96:99], v[224:227]
  v_exp_f32 v49, v49
  v_mfma_f32_16x16x32_bf16 v[240:243], a[124:127], v[96:99], v[240:243]
  ds_read_b128 a[76:79], v119
  ds_read_b64_tr_b16 a[226:227], v14 offset:2048
  v_mfma_f32_16x16x32_bf16 v[80:83], v[112:115], v[96:99], v[80:83]
  v_exp_f32 v50, v50
  v_mfma_f32_16x16x32_bf16 v[132:135], a[96:99], v[100:103], v[132:135]
  ds_read_b128 a[80:83], v116 offset:4096
  v_cvt_pk_bf16_f32 v104, v48, v49
  v_mfma_f32_16x16x32_bf16 v[148:151], a[100:103], v[100:103], v[148:151]
  v_exp_f32 v51, v51
  v_mfma_f32_16x16x32_bf16 v[164:167], a[104:107], v[100:103], v[164:167]
  ds_read_b64_tr_b16 a[228:229], v15
  ds_read_b128 a[84:87], v117 offset:4096
  v_mfma_f32_16x16x32_bf16 v[180:183], a[108:111], v[100:103], v[180:183]
  s_add_u32 m0, s21, 32768
  v_exp_f32 v52, v52
  v_mfma_f32_16x16x32_bf16 v[196:199], a[112:115], v[100:103], v[196:199]
  buffer_load_dwordx4 v8, s[8:11], s20 offen lds
  v_mfma_f32_16x16x32_bf16 v[212:215], a[116:119], v[100:103], v[212:215]
  ds_read_b128 a[88:91], v118 offset:4096
  v_cvt_pk_bf16_f32 v105, v50, v51
  v_mfma_f32_16x16x32_bf16 v[228:231], a[120:123], v[100:103], v[228:231]
  v_exp_f32 v53, v53
  v_mfma_f32_16x16x32_bf16 v[244:247], a[124:127], v[100:103], v[244:247]
  ds_read_b64_tr_b16 a[230:231], v15 offset:2048
  ds_read_b128 a[92:95], v119 offset:4096
  v_mfma_f32_16x16x32_bf16 v[84:87], v[112:115], v[100:103], v[84:87]
  s_waitcnt lgkmcnt(11)
  v_exp_f32 v54, v54
  v_mfma_f32_16x16x32_bf16 v[32:35], a[64:67], a[0:3], v[64:67]
  s_waitcnt lgkmcnt(10)
  ds_read_b64_tr_b16 a[232:233], v16
  v_cvt_pk_bf16_f32 v106, v52, v53
  v_mfma_f32_16x16x32_bf16 v[32:35], a[68:71], a[16:19], v[32:35]
  s_waitcnt lgkmcnt(10)
  v_exp_f32 v55, v55
  v_mfma_f32_16x16x32_bf16 v[32:35], a[72:75], a[32:35], v[32:35]
  s_waitcnt lgkmcnt(8)
  buffer_load_dwordx4 v9, s[8:11], s20 offen offset:1024 lds
  v_mfma_f32_16x16x32_bf16 v[32:35], a[76:79], a[48:51], v[32:35]
  s_waitcnt lgkmcnt(6)
  v_exp_f32 v56, v56
  v_mfma_f32_16x16x32_bf16 v[36:39], a[80:83], a[0:3], v[64:67]
  s_waitcnt lgkmcnt(4)
  ds_read_b64_tr_b16 a[234:235], v16 offset:2048
  v_cvt_pk_bf16_f32 v107, v54, v55
  v_mfma_f32_16x16x32_bf16 v[36:39], a[84:87], a[16:19], v[36:39]
  s_waitcnt lgkmcnt(4)
  v_exp_f32 v57, v57
  v_mfma_f32_16x16x32_bf16 v[36:39], a[88:91], a[32:35], v[36:39]
  s_waitcnt lgkmcnt(2)
  v_exp_f32 v58, v58
  v_mfma_f32_16x16x32_bf16 v[36:39], a[92:95], a[48:51], v[36:39]
  ds_read_b64_tr_b16 a[236:237], v17
  v_cvt_pk_bf16_f32 v108, v56, v57
  v_mfma_f32_16x16x32_bf16 v[40:43], a[64:67], a[4:7], v[68:71]
  buffer_load_dwordx4 v10, s[8:11], s20 offen offset:2048 lds
  v_mfma_f32_16x16x32_bf16 v[40:43], a[68:71], a[20:23], v[40:43]
  v_exp_f32 v59, v59
  v_mfma_f32_16x16x32_bf16 v[40:43], a[72:75], a[36:39], v[40:43]
  v_exp_f32 v60, v60
  v_mfma_f32_16x16x32_bf16 v[40:43], a[76:79], a[52:55], v[40:43]
  ds_read_b64_tr_b16 a[238:239], v17 offset:2048
  v_cvt_pk_bf16_f32 v109, v58, v59
  v_mfma_f32_16x16x32_bf16 v[44:47], a[80:83], a[4:7], v[68:71]
  v_exp_f32 v61, v61
  v_mfma_f32_16x16x32_bf16 v[44:47], a[84:87], a[20:23], v[44:47]
  ds_read_b64_tr_b16 a[240:241], v14 offset:4096
  v_mfma_f32_16x16x32_bf16 v[44:47], a[88:91], a[36:39], v[44:47]
  v_exp_f32 v62, v62
  v_mfma_f32_16x16x32_bf16 v[44:47], a[92:95], a[52:55], v[44:47]
  buffer_load_dwordx4 v11, s[8:11], s20 offen offset:3072 lds
  v_mfma_f32_16x16x32_bf16 v[136:139], a[96:99], v[104:107], v[136:139]
  ds_read_b64_tr_b16 a[242:243], v14 offset:6144
  v_cvt_pk_bf16_f32 v110, v60, v61
  v_mfma_f32_16x16x32_bf16 v[152:155], a[100:103], v[104:107], v[152:155]
  v_exp_f32 v63, v63
  v_mfma_f32_16x16x32_bf16 v[168:171], a[104:107], v[104:107], v[168:171]
  v_cvt_pk_bf16_f32 v111, v62, v63
  v_mfma_f32_16x16x32_bf16 v[184:187], a[108:111], v[104:107], v[184:187]
  ds_read_b64_tr_b16 a[244:245], v15 offset:4096
  v_mfma_f32_16x16x32_bf16 v[200:203], a[112:115], v[104:107], v[200:203]
  v_exp_f32 v32, v32
  v_mfma_f32_16x16x32_bf16 v[216:219], a[116:119], v[104:107], v[216:219]
  v_exp_f32 v33, v33
  v_mfma_f32_16x16x32_bf16 v[232:235], a[120:123], v[104:107], v[232:235]
  v_exp_f32 v34, v34
  v_mfma_f32_16x16x32_bf16 v[248:251], a[124:127], v[104:107], v[248:251]
  ds_read_b64_tr_b16 a[246:247], v15 offset:6144
  v_cvt_pk_bf16_f32 v96, v32, v33
  v_mfma_f32_16x16x32_bf16 v[88:91], v[112:115], v[104:107], v[88:91]
  s_add_u32 m0, s21, 81920
  v_exp_f32 v35, v35
  v_mfma_f32_16x16x32_bf16 v[140:143], a[96:99], v[108:111], v[140:143]
  buffer_load_dwordx4 v12, s[12:15], s20 offen lds
  v_mfma_f32_16x16x32_bf16 v[156:159], a[100:103], v[108:111], v[156:159]
  ds_read_b64_tr_b16 a[96:97], v120
  ds_read_b64_tr_b16 a[98:99], v120 offset:4096
  v_mfma_f32_16x16x32_bf16 v[172:175], a[104:107], v[108:111], v[172:175]
  v_exp_f32 v36, v36
  v_mfma_f32_16x16x32_bf16 v[188:191], a[108:111], v[108:111], v[188:191]
  ds_read_b64_tr_b16 a[248:249], v16 offset:4096
  v_cvt_pk_bf16_f32 v97, v34, v35
  v_mfma_f32_16x16x32_bf16 v[204:207], a[112:115], v[108:111], v[204:207]
  v_exp_f32 v37, v37
  v_mfma_f32_16x16x32_bf16 v[220:223], a[116:119], v[108:111], v[220:223]
  ds_read_b64_tr_b16 a[100:101], v121
  ds_read_b64_tr_b16 a[250:251], v16 offset:6144
  v_mfma_f32_16x16x32_bf16 v[236:239], a[120:123], v[108:111], v[236:239]
  v_exp_f32 v38, v38
  v_mfma_f32_16x16x32_bf16 v[252:255], a[124:127], v[108:111], v[252:255]
  buffer_load_dwordx4 v13, s[12:15], s20 offen offset:1024 lds
  v_mfma_f32_16x16x32_bf16 v[92:95], v[112:115], v[108:111], v[92:95]
  ds_read_b64_tr_b16 a[102:103], v121 offset:4096
  v_cvt_pk_bf16_f32 v98, v36, v37
  v_mfma_f32_16x16x32_bf16 v[48:51], a[64:67], a[8:11], v[72:75]
  v_exp_f32 v39, v39
  v_mfma_f32_16x16x32_bf16 v[48:51], a[68:71], a[24:27], v[48:51]
  ds_read_b64_tr_b16 a[104:105], v122
  ds_read_b64_tr_b16 a[252:253], v17 offset:4096
  v_mfma_f32_16x16x32_bf16 v[48:51], a[72:75], a[40:43], v[48:51]
  v_exp_f32 v40, v40
  v_mfma_f32_16x16x32_bf16 v[48:51], a[76:79], a[56:59], v[48:51]
  ds_read_b64_tr_b16 a[106:107], v122 offset:4096
  v_cvt_pk_bf16_f32 v99, v38, v39
  v_mfma_f32_16x16x32_bf16 v[52:55], a[80:83], a[8:11], v[72:75]
  v_exp_f32 v41, v41
  v_mfma_f32_16x16x32_bf16 v[52:55], a[84:87], a[24:27], v[52:55]
  buffer_load_dwordx4 v12, s[12:15], s20 offen offset:2048 lds
  v_mfma_f32_16x16x32_bf16 v[52:55], a[88:91], a[40:43], v[52:55]
  ds_read_b64_tr_b16 a[108:109], v123
  ds_read_b64_tr_b16 a[254:255], v17 offset:6144
  v_mfma_f32_16x16x32_bf16 v[52:55], a[92:95], a[56:59], v[52:55]
  v_exp_f32 v42, v42
  v_mfma_f32_16x16x32_bf16 v[56:59], a[64:67], a[12:15], v[76:79]
  ds_read_b64_tr_b16 a[110:111], v123 offset:4096
  v_cvt_pk_bf16_f32 v100, v40, v41
  v_mfma_f32_16x16x32_bf16 v[56:59], a[68:71], a[28:31], v[56:59]
  v_exp_f32 v43, v43
  v_mfma_f32_16x16x32_bf16 v[56:59], a[72:75], a[44:47], v[56:59]
  ds_read_b64_tr_b16 a[112:113], v124
  ds_read_b64_tr_b16 a[114:115], v124 offset:4096
  v_mfma_f32_16x16x32_bf16 v[56:59], a[76:79], a[60:63], v[56:59]
  buffer_load_dwordx4 v13, s[12:15], s20 offen offset:3072 lds
  s_add_u32 s20, s20, 16384
  v_mfma_f32_16x16x32_bf16 v[60:63], a[80:83], a[12:15], v[76:79]
  v_exp_f32 v44, v44
  v_mfma_f32_16x16x32_bf16 v[60:63], a[84:87], a[28:31], v[60:63]
  ds_read_b64_tr_b16 a[116:117], v125
  v_cvt_pk_bf16_f32 v101, v42, v43
  v_mfma_f32_16x16x32_bf16 v[60:63], a[88:91], a[44:47], v[60:63]
  v_exp_f32 v45, v45
  v_mfma_f32_16x16x32_bf16 v[60:63], a[92:95], a[60:63], v[60:63]
  s_waitcnt vmcnt(15)
  v_exp_f32 v46, v46
  v_mfma_f32_16x16x32_bf16 a[128:131], a[192:195], a[224:227], a[128:131]
  ds_read_b64_tr_b16 a[118:119], v125 offset:4096
  v_cvt_pk_bf16_f32 v102, v44, v45
  v_mfma_f32_16x16x32_bf16 a[132:135], a[192:195], a[228:231], a[132:135]
  s_waitcnt lgkmcnt(15)
  v_exp_f32 v47, v47
  v_mfma_f32_16x16x32_bf16 a[136:139], a[192:195], a[232:235], a[136:139]
  ds_read_b64_tr_b16 a[120:121], v126
  v_cvt_pk_bf16_f32 v103, v46, v47
  v_mfma_f32_16x16x32_bf16 a[140:143], a[192:195], a[236:239], a[140:143]
  s_waitcnt vmcnt(14)
  ds_read_b64_tr_b16 a[122:123], v126 offset:4096
  v_mfma_f32_16x16x32_bf16 a[144:147], a[196:199], a[224:227], a[144:147]
  v_exp_f32 v48, v48
  v_mfma_f32_16x16x32_bf16 a[148:151], a[196:199], a[228:231], a[148:151]
  ds_read_b64_tr_b16 a[124:125], v127
  v_mfma_f32_16x16x32_bf16 a[152:155], a[196:199], a[232:235], a[152:155]
  s_cmp_gt_u32 s38, 4
  s_cselect_b32 s37, 0x30000, 0
  s_add_u32 s38, s38, 1
  s_max_u32 s5, s40, s37
  s_mov_b32 m0, s5
  v_exp_f32 v49, v49
  v_mfma_f32_16x16x32_bf16 a[156:159], a[196:199], a[236:239], a[156:159]
  s_waitcnt vmcnt(13)
  s_waitcnt lgkmcnt(8)
  buffer_load_dwordx4 v18, s[52:55], s39 offen lds
  v_mfma_f32_16x16x32_bf16 a[160:163], a[200:203], a[224:227], a[160:163]
  v_xor_b32 v14, 8192, v14
  v_xor_b32 v15, 8192, v15
  v_mfma_f32_16x16x32_bf16 a[164:167], a[200:203], a[228:231], a[164:167]
  v_xor_b32 v16, 8192, v16
  v_xor_b32 v17, 8192, v17
  v_mfma_f32_16x16x32_bf16 a[168:171], a[200:203], a[232:235], a[168:171]
  ds_read_b64_tr_b16 a[126:127], v127 offset:4096
  v_mfma_f32_16x16x32_bf16 a[172:175], a[200:203], a[236:239], a[172:175]
  s_waitcnt vmcnt(13)
  v_exp_f32 v50, v50
  v_mfma_f32_16x16x32_bf16 a[176:179], a[204:207], a[224:227], a[176:179]
  v_cvt_pk_bf16_f32 v104, v48, v49
  v_mfma_f32_16x16x32_bf16 a[180:183], a[204:207], a[228:231], a[180:183]
  v_exp_f32 v51, v51
  v_mfma_f32_16x16x32_bf16 a[184:187], a[204:207], a[232:235], a[184:187]
  buffer_load_dwordx4 v19, s[52:55], s39 offen offset:1024 lds
  v_mfma_f32_16x16x32_bf16 a[188:191], a[204:207], a[236:239], a[188:191]
  v_exp_f32 v52, v52
  v_mfma_f32_16x16x32_bf16 v[128:131], a[96:99], v[96:99], v[128:131]
  ds_read_b128 a[64:67], v116 offset:8192
  v_cvt_pk_bf16_f32 v105, v50, v51
  v_mfma_f32_16x16x32_bf16 v[144:147], a[100:103], v[96:99], v[144:147]
  ds_read_b128 a[68:71], v117 offset:8192
  v_mfma_f32_16x16x32_bf16 v[160:163], a[104:107], v[96:99], v[160:163]
  s_waitcnt lgkmcnt(10)
  v_exp_f32 v53, v53
  v_mfma_f32_16x16x32_bf16 v[176:179], a[108:111], v[96:99], v[176:179]
  s_waitcnt lgkmcnt(8)
  ds_read_b128 a[72:75], v118 offset:8192
  v_mfma_f32_16x16x32_bf16 v[192:195], a[112:115], v[96:99], v[192:195]
  s_waitcnt lgkmcnt(7)
  v_exp_f32 v54, v54
  v_mfma_f32_16x16x32_bf16 v[208:211], a[116:119], v[96:99], v[208:211]
  s_waitcnt lgkmcnt(5)
  buffer_load_dwordx4 v20, s[52:55], s39 offen offset:2048 lds
  v_mfma_f32_16x16x32_bf16 v[224:227], a[120:123], v[96:99], v[224:227]
  s_waitcnt lgkmcnt(3)
  ds_read_b128 a[76:79], v119 offset:8192
  v_cvt_pk_bf16_f32 v106, v52, v53
  v_mfma_f32_16x16x32_bf16 v[240:243], a[124:127], v[96:99], v[240:243]
  v_exp_f32 v55, v55
  v_mfma_f32_16x16x32_bf16 v[80:83], v[112:115], v[96:99], v[80:83]
  ds_read_b128 a[80:83], v116 offset:12288
  v_mfma_f32_16x16x32_bf16 v[132:135], a[96:99], v[100:103], v[132:135]
  v_exp_f32 v56, v56
  v_mfma_f32_16x16x32_bf16 v[148:151], a[100:103], v[100:103], v[148:151]
  ds_read_b128 a[84:87], v117 offset:12288
  v_mfma_f32_16x16x32_bf16 v[164:167], a[104:107], v[100:103], v[164:167]
  v_cvt_pk_bf16_f32 v107, v54, v55
  v_mfma_f32_16x16x32_bf16 v[180:183], a[108:111], v[100:103], v[180:183]
  buffer_load_dwordx4 v21, s[52:55], s39 offen offset:3072 lds
  v_mfma_f32_16x16x32_bf16 v[196:199], a[112:115], v[100:103], v[196:199]
  ds_read_b128 a[88:91], v118 offset:12288
  v_mfma_f32_16x16x32_bf16 v[212:215], a[116:119], v[100:103], v[212:215]
  v_exp_f32 v57, v57
  v_mfma_f32_16x16x32_bf16 v[228:231], a[120:123], v[100:103], v[228:231]
  ds_read_b128 a[92:95], v119 offset:12288
  v_mfma_f32_16x16x32_bf16 v[244:247], a[124:127], v[100:103], v[244:247]
  v_exp_f32 v58, v58
  v_mfma_f32_16x16x32_bf16 v[84:87], v[112:115], v[100:103], v[84:87]
  s_waitcnt lgkmcnt(7)
  s_add_u32 s39, s39, 131072
  v_cvt_pk_bf16_f32 v108, v56, v57
  v_mfma_f32_16x16x32_bf16 v[32:35], a[64:67], a[0:3], v[64:67]
  s_waitcnt lgkmcnt(6)
  s_add_u32 m0, s5, 4096
  v_mfma_f32_16x16x32_bf16 v[32:35], a[68:71], a[16:19], v[32:35]
  s_waitcnt lgkmcnt(5)
  buffer_load_dwordx4 v18, s[52:55], s39 offen lds
  v_mfma_f32_16x16x32_bf16 v[32:35], a[72:75], a[32:35], v[32:35]
  s_waitcnt lgkmcnt(4)
  v_exp_f32 v59, v59
  v_mfma_f32_16x16x32_bf16 v[32:35], a[76:79], a[48:51], v[32:35]
  s_waitcnt lgkmcnt(3)
  v_exp_f32 v60, v60
  v_mfma_f32_16x16x32_bf16 v[36:39], a[80:83], a[0:3], v[64:67]
  s_waitcnt lgkmcnt(2)
  v_mfma_f32_16x16x32_bf16 v[36:39], a[84:87], a[16:19], v[36:39]
  s_waitcnt lgkmcnt(1)
  v_mfma_f32_16x16x32_bf16 v[36:39], a[88:91], a[32:35], v[36:39]
  s_waitcnt lgkmcnt(0)
  v_cvt_pk_bf16_f32 v109, v58, v59
  v_mfma_f32_16x16x32_bf16 v[36:39], a[92:95], a[48:51], v[36:39]
  v_mfma_f32_16x16x32_bf16 v[40:43], a[64:67], a[4:7], v[68:71]
  buffer_load_dwordx4 v19, s[52:55], s39 offen offset:1024 lds
  v_mfma_f32_16x16x32_bf16 v[40:43], a[68:71], a[20:23], v[40:43]
  v_exp_f32 v61, v61
  v_mfma_f32_16x16x32_bf16 v[40:43], a[72:75], a[36:39], v[40:43]
  v_exp_f32 v62, v62
  v_mfma_f32_16x16x32_bf16 v[40:43], a[76:79], a[52:55], v[40:43]
  v_mfma_f32_16x16x32_bf16 v[44:47], a[80:83], a[4:7], v[68:71]
  v_cvt_pk_bf16_f32 v110, v60, v61
  v_mfma_f32_16x16x32_bf16 v[44:47], a[84:87], a[20:23], v[44:47]
  v_mfma_f32_16x16x32_bf16 v[44:47], a[88:91], a[36:39], v[44:47]
  v_exp_f32 v63, v63
  v_mfma_f32_16x16x32_bf16 v[44:47], a[92:95], a[52:55], v[44:47]
  s_waitcnt vmcnt(17)
  buffer_load_dwordx4 v20, s[52:55], s39 offen offset:2048 lds
  v_mfma_f32_16x16x32_bf16 a[128:131], a[208:211], a[240:243], a[128:131]
  v_cvt_pk_bf16_f32 v111, v62, v63
  v_mfma_f32_16x16x32_bf16 a[132:135], a[208:211], a[244:247], a[132:135]
  v_mfma_f32_16x16x32_bf16 a[136:139], a[208:211], a[248:251], a[136:139]
  v_mfma_f32_16x16x32_bf16 a[140:143], a[208:211], a[252:255], a[140:143]
  s_waitcnt vmcnt(17)
  v_mfma_f32_16x16x32_bf16 a[144:147], a[212:215], a[240:243], a[144:147]
  v_exp_f32 v32, v32
  v_mfma_f32_16x16x32_bf16 a[148:151], a[212:215], a[244:247], a[148:151]
  v_exp_f32 v33, v33
  v_mfma_f32_16x16x32_bf16 a[152:155], a[212:215], a[248:251], a[152:155]
  buffer_load_dwordx4 v21, s[52:55], s39 offen offset:3072 lds
  v_mfma_f32_16x16x32_bf16 a[156:159], a[212:215], a[252:255], a[156:159]
  s_waitcnt vmcnt(17)
  v_exp_f32 v34, v34
  v_mfma_f32_16x16x32_bf16 a[160:163], a[216:219], a[240:243], a[160:163]
  v_mfma_f32_16x16x32_bf16 a[164:167], a[216:219], a[244:247], a[164:167]
  v_cvt_pk_bf16_f32 v96, v32, v33
  v_mfma_f32_16x16x32_bf16 a[168:171], a[216:219], a[248:251], a[168:171]
  v_mfma_f32_16x16x32_bf16 a[172:175], a[216:219], a[252:255], a[172:175]
  s_waitcnt vmcnt(16)
  s_add_u32 s39, s39, 131072
  v_exp_f32 v35, v35
  v_mfma_f32_16x16x32_bf16 a[176:179], a[220:223], a[240:243], a[176:179]
  v_mfma_f32_16x16x32_bf16 a[180:183], a[220:223], a[244:247], a[180:183]
  v_exp_f32 v36, v36
  v_mfma_f32_16x16x32_bf16 a[184:187], a[220:223], a[248:251], a[184:187]
  v_mfma_f32_16x16x32_bf16 a[188:191], a[220:223], a[252:255], a[188:191]
  v_cvt_pk_bf16_f32 v97, v34, v35
  v_mfma_f32_16x16x32_bf16 v[136:139], a[96:99], v[104:107], v[136:139]
  v_mfma_f32_16x16x32_bf16 v[152:155], a[100:103], v[104:107], v[152:155]
  v_exp_f32 v37, v37
  v_mfma_f32_16x16x32_bf16 v[168:171], a[104:107], v[104:107], v[168:171]
  v_mfma_f32_16x16x32_bf16 v[184:187], a[108:111], v[104:107], v[184:187]
  buffer_load_dwordx4 a[192:195], v22, s[16:19], s36 offen sc1
  v_mfma_f32_16x16x32_bf16 v[200:203], a[112:115], v[104:107], v[200:203]
  v_exp_f32 v38, v38
  v_mfma_f32_16x16x32_bf16 v[216:219], a[116:119], v[104:107], v[216:219]
  v_mfma_f32_16x16x32_bf16 v[232:235], a[120:123], v[104:107], v[232:235]
  v_cvt_pk_bf16_f32 v98, v36, v37
  v_mfma_f32_16x16x32_bf16 v[248:251], a[124:127], v[104:107], v[248:251]
  buffer_load_dwordx4 a[196:199], v23, s[16:19], s36 offen sc1
  v_mfma_f32_16x16x32_bf16 v[88:91], v[112:115], v[104:107], v[88:91]
  v_exp_f32 v39, v39
  v_mfma_f32_16x16x32_bf16 v[140:143], a[96:99], v[108:111], v[140:143]
  v_mfma_f32_16x16x32_bf16 v[156:159], a[100:103], v[108:111], v[156:159]
  buffer_load_dwordx4 a[200:203], v24, s[16:19], s36 offen sc1
  v_mfma_f32_16x16x32_bf16 v[172:175], a[104:107], v[108:111], v[172:175]
  ds_read_b64_tr_b16 a[96:97], v120 offset:8192
  ds_read_b64_tr_b16 a[98:99], v120 offset:12288
  v_mfma_f32_16x16x32_bf16 v[188:191], a[108:111], v[108:111], v[188:191]
  v_exp_f32 v40, v40
  v_mfma_f32_16x16x32_bf16 v[204:207], a[112:115], v[108:111], v[204:207]
  buffer_load_dwordx4 a[204:207], v25, s[16:19], s36 offen sc1
  v_mfma_f32_16x16x32_bf16 v[220:223], a[116:119], v[108:111], v[220:223]
  ds_read_b64_tr_b16 a[100:101], v121 offset:8192
  ds_read_b64_tr_b16 a[102:103], v121 offset:12288
  v_mfma_f32_16x16x32_bf16 v[236:239], a[120:123], v[108:111], v[236:239]
  s_add_u32 s36, s36, 1024
  ds_read_b64_tr_b16 a[104:105], v122 offset:8192
  v_cvt_pk_bf16_f32 v99, v38, v39
  v_mfma_f32_16x16x32_bf16 v[252:255], a[124:127], v[108:111], v[252:255]
  ds_read_b64_tr_b16 a[106:107], v122 offset:12288
  ds_read_b64_tr_b16 a[108:109], v123 offset:8192
  v_mfma_f32_16x16x32_bf16 v[92:95], v[112:115], v[108:111], v[92:95]
  buffer_load_dwordx4 a[208:211], v22, s[16:19], s36 offen sc1
  v_mfma_f32_16x16x32_bf16 v[48:51], a[64:67], a[8:11], v[72:75]
  v_exp_f32 v41, v41
  v_mfma_f32_16x16x32_bf16 v[48:51], a[68:71], a[24:27], v[48:51]
  ds_read_b64_tr_b16 a[110:111], v123 offset:12288
  ds_read_b64_tr_b16 a[112:113], v124 offset:8192
  v_mfma_f32_16x16x32_bf16 v[48:51], a[72:75], a[40:43], v[48:51]
  buffer_load_dwordx4 a[212:215], v23, s[16:19], s36 offen sc1
  v_mfma_f32_16x16x32_bf16 v[48:51], a[76:79], a[56:59], v[48:51]
  v_exp_f32 v42, v42
  v_mfma_f32_16x16x32_bf16 v[52:55], a[80:83], a[8:11], v[72:75]
  ds_read_b64_tr_b16 a[114:115], v124 offset:12288
  v_cvt_pk_bf16_f32 v100, v40, v41
  v_mfma_f32_16x16x32_bf16 v[52:55], a[84:87], a[24:27], v[52:55]
  buffer_load_dwordx4 a[216:219], v24, s[16:19], s36 offen sc1
  v_mfma_f32_16x16x32_bf16 v[52:55], a[88:91], a[40:43], v[52:55]
  ds_read_b64_tr_b16 a[116:117], v125 offset:8192
  ds_read_b64_tr_b16 a[118:119], v125 offset:12288
  v_mfma_f32_16x16x32_bf16 v[52:55], a[92:95], a[56:59], v[52:55]
  v_exp_f32 v43, v43
  v_mfma_f32_16x16x32_bf16 v[56:59], a[64:67], a[12:15], v[76:79]
  ds_read_b64_tr_b16 a[120:121], v126 offset:8192
  ds_read_b64_tr_b16 a[122:123], v126 offset:12288
  v_mfma_f32_16x16x32_bf16 v[56:59], a[68:71], a[28:31], v[56:59]
  buffer_load_dwordx4 a[220:223], v25, s[16:19], s36 offen sc1
  v_mfma_f32_16x16x32_bf16 v[56:59], a[72:75], a[44:47], v[56:59]
  ds_read_b64_tr_b16 a[124:125], v127 offset:8192
  ds_read_b64_tr_b16 a[126:127], v127 offset:12288
  v_exp_f32 v44, v44
  v_mfma_f32_16x16x32_bf16 v[56:59], a[76:79], a[60:63], v[56:59]
  s_add_u32 s36, s36, 1024
  v_cvt_pk_bf16_f32 v101, v42, v43
  v_mfma_f32_16x16x32_bf16 v[60:63], a[80:83], a[12:15], v[76:79]
  v_exp_f32 v45, v45
  v_mfma_f32_16x16x32_bf16 v[60:63], a[84:87], a[28:31], v[60:63]
  v_exp_f32 v46, v46
  v_mfma_f32_16x16x32_bf16 v[60:63], a[88:91], a[44:47], v[60:63]
  v_mfma_f32_16x16x32_bf16 v[60:63], a[92:95], a[60:63], v[60:63]
  s_xor_b32 s40, s40, 8192
  s_waitcnt vmcnt(24) lgkmcnt(0)
  s_barrier
  s_sub_u32 s4, s4, 1
  s_cmp_lg_u32 s4, 0
  s_cbranch_scc1 L_k3_loopB
  v_mfma_f32_16x16x32_bf16 v[128:131], a[96:99], v[96:99], v[128:131]
  ds_read_b128 a[64:67], v116 offset:16384
  v_cvt_pk_bf16_f32 v102, v44, v45
  v_mfma_f32_16x16x32_bf16 v[144:147], a[100:103], v[96:99], v[144:147]
  v_exp_f32 v47, v47
  v_mfma_f32_16x16x32_bf16 v[160:163], a[104:107], v[96:99], v[160:163]
  ds_read_b128 a[68:71], v117 offset:16384
  v_cvt_pk_bf16_f32 v103, v46, v47
  v_mfma_f32_16x16x32_bf16 v[176:179], a[108:111], v[96:99], v[176:179]
  ds_read_b128 a[72:75], v118 offset:16384
  v_mfma_f32_16x16x32_bf16 v[192:195], a[112:115], v[96:99], v[192:195]
  ds_read_b64_tr_b16 a[224:225], v14
  v_mfma_f32_16x16x32_bf16 v[208:211], a[116:119], v[96:99], v[208:211]
  v_exp_f32 v48, v48
  v_mfma_f32_16x16x32_bf16 v[224:227], a[120:123], v[96:99], v[224:227]
  v_exp_f32 v49, v49
  v_mfma_f32_16x16x32_bf16 v[240:243], a[124:127], v[96:99], v[240:243]
  ds_read_b128 a[76:79], v119 offset:16384
  ds_read_b64_tr_b16 a[226:227], v14 offset:2048
  v_mfma_f32_16x16x32_bf16 v[80:83], v[112:115], v[96:99], v[80:83]
  v_exp_f32 v50, v50
  v_mfma_f32_16x16x32_bf16 v[132:135], a[96:99], v[100:103], v[132:135]
  ds_read_b128 a[80:83], v116 offset:20480
  v_cvt_pk_bf16_f32 v104, v48, v49
  v_mfma_f32_16x16x32_bf16 v[148:151], a[100:103], v[100:103], v[148:151]
  v_exp_f32 v51, v51
  v_mfma_f32_16x16x32_bf16 v[164:167], a[104:107], v[100:103], v[164:167]
  ds_read_b64_tr_b16 a[228:229], v15
  ds_read_b128 a[84:87], v117 offset:20480
  v_mfma_f32_16x16x32_bf16 v[180:183], a[108:111], v[100:103], v[180:183]
  v_exp_f32 v52, v52
  v_mfma_f32_16x16x32_bf16 v[196:199], a[112:115], v[100:103], v[196:199]
  ds_read_b128 a[88:91], v118 offset:20480
  v_cvt_pk_bf16_f32 v105, v50, v51
  v_mfma_f32_16x16x32_bf16 v[212:215], a[116:119], v[100:103], v[212:215]
  v_exp_f32 v53, v53
  v_mfma_f32_16x16x32_bf16 v[228:231], a[120:123], v[100:103], v[228:231]
  ds_read_b64_tr_b16 a[230:231], v15 offset:2048
  ds_read_b128 a[92:95], v119 offset:20480
  v_mfma_f32_16x16x32_bf16 v[244:247], a[124:127], v[100:103], v[244:247]
  v_exp_f32 v54, v54
  v_mfma_f32_16x16x32_bf16 v[84:87], v[112:115], v[100:103], v[84:87]
  s_waitcnt lgkmcnt(11)
  ds_read_b64_tr_b16 a[232:233], v16
  v_cvt_pk_bf16_f32 v106, v52, v53
  v_mfma_f32_16x16x32_bf16 v[32:35], a[64:67], a[0:3], v[64:67]
  s_waitcnt lgkmcnt(11)
  v_exp_f32 v55, v55
  v_mfma_f32_16x16x32_bf16 v[32:35], a[68:71], a[16:19], v[32:35]
  s_waitcnt lgkmcnt(10)
  v_exp_f32 v56, v56
  v_mfma_f32_16x16x32_bf16 v[32:35], a[72:75], a[32:35], v[32:35]
  s_waitcnt lgkmcnt(8)
  ds_read_b64_tr_b16 a[234:235], v16 offset:2048
  v_cvt_pk_bf16_f32 v107, v54, v55
  v_mfma_f32_16x16x32_bf16 v[32:35], a[76:79], a[48:51], v[32:35]
  s_waitcnt lgkmcnt(7)
  v_exp_f32 v57, v57
  v_mfma_f32_16x16x32_bf16 v[36:39], a[80:83], a[0:3], v[64:67]
  s_waitcnt lgkmcnt(5)
  v_exp_f32 v58, v58
  v_mfma_f32_16x16x32_bf16 v[36:39], a[84:87], a[16:19], v[36:39]
  s_waitcnt lgkmcnt(4)
  s_add_u32 m0, s21, 0
  ds_read_b64_tr_b16 a[236:237], v17
  v_cvt_pk_bf16_f32 v108, v56, v57
  v_mfma_f32_16x16x32_bf16 v[36:39], a[88:91], a[32:35], v[36:39]
  s_waitcnt lgkmcnt(3)
  buffer_load_dwordx4 v8, s[8:11], s20 offen lds
  v_mfma_f32_16x16x32_bf16 v[36:39], a[92:95], a[48:51], v[36:39]
  v_exp_f32 v59, v59
  v_mfma_f32_16x16x32_bf16 v[40:43], a[64:67], a[4:7], v[68:71]
  v_exp_f32 v60, v60
  v_mfma_f32_16x16x32_bf16 v[40:43], a[68:71], a[20:23], v[40:43]
  ds_read_b64_tr_b16 a[238:239], v17 offset:2048
  v_mfma_f32_16x16x32_bf16 v[40:43], a[72:75], a[36:39], v[40:43]
  v_cvt_pk_bf16_f32 v109, v58, v59
  v_mfma_f32_16x16x32_bf16 v[40:43], a[76:79], a[52:55], v[40:43]
  v_exp_f32 v61, v61
  v_mfma_f32_16x16x32_bf16 v[44:47], a[80:83], a[4:7], v[68:71]
  buffer_load_dwordx4 v9, s[8:11], s20 offen offset:1024 lds
  v_mfma_f32_16x16x32_bf16 v[44:47], a[84:87], a[20:23], v[44:47]
  ds_read_b64_tr_b16 a[240:241], v14 offset:4096
  v_mfma_f32_16x16x32_bf16 v[44:47], a[88:91], a[36:39], v[44:47]
  v_exp_f32 v62, v62
  v_mfma_f32_16x16x32_bf16 v[44:47], a[92:95], a[52:55], v[44:47]
  ds_read_b64_tr_b16 a[242:243], v14 offset:6144
  v_cvt_pk_bf16_f32 v110, v60, v61
  v_mfma_f32_16x16x32_bf16 v[136:139], a[96:99], v[104:107], v[136:139]
  v_exp_f32 v63, v63
  v_mfma_f32_16x16x32_bf16 v[152:155], a[100:103], v[104:107], v[152:155]
  v_cvt_pk_bf16_f32 v111, v62, v63
  v_mfma_f32_16x16x32_bf16 v[168:171], a[104:107], v[104:107], v[168:171]
  buffer_load_dwordx4 v10, s[8:11], s20 offen offset:2048 lds
  v_mfma_f32_16x16x32_bf16 v[184:187], a[108:111], v[104:107], v[184:187]
  ds_read_b64_tr_b16 a[244:245], v15 offset:4096
  v_mfma_f32_16x16x32_bf16 v[200:203], a[112:115], v[104:107], v[200:203]
  v_exp_f32 v32, v32
  v_mfma_f32_16x16x32_bf16 v[216:219], a[116:119], v[104:107], v[216:219]
  v_exp_f32 v33, v33
  v_mfma_f32_16x16x32_bf16 v[232:235], a[120:123], v[104:107], v[232:235]
  v_exp_f32 v34, v34
  v_mfma_f32_16x16x32_bf16 v[248:251], a[124:127], v[104:107], v[248:251]
  ds_read_b64_tr_b16 a[246:247], v15 offset:6144
  v_cvt_pk_bf16_f32 v96, v32, v33
  v_mfma_f32_16x16x32_bf16 v[88:91], v[112:115], v[104:107], v[88:91]
  buffer_load_dwordx4 v11, s[8:11], s20 offen offset:3072 lds
  v_mfma_f32_16x16x32_bf16 v[140:143], a[96:99], v[108:111], v[140:143]
  v_exp_f32 v35, v35
  v_mfma_f32_16x16x32_bf16 v[156:159], a[100:103], v[108:111], v[156:159]
  ds_read_b64_tr_b16 a[96:97], v120 offset:16384
  ds_read_b64_tr_b16 a[98:99], v120 offset:20480
  v_mfma_f32_16x16x32_bf16 v[172:175], a[104:107], v[108:111], v[172:175]
  v_exp_f32 v36, v36
  v_mfma_f32_16x16x32_bf16 v[188:191], a[108:111], v[108:111], v[188:191]
  ds_read_b64_tr_b16 a[248:249], v16 offset:4096
  v_cvt_pk_bf16_f32 v97, v34, v35
  v_mfma_f32_16x16x32_bf16 v[204:207], a[112:115], v[108:111], v[204:207]
  v_exp_f32 v37, v37
  v_mfma_f32_16x16x32_bf16 v[220:223], a[116:119], v[108:111], v[220:223]
  ds_read_b64_tr_b16 a[100:101], v121 offset:16384
  ds_read_b64_tr_b16 a[250:251], v16 offset:6144
  v_mfma_f32_16x16x32_bf16 v[236:239], a[120:123], v[108:111], v[236:239]
  v_exp_f32 v38, v38
  v_mfma_f32_16x16x32_bf16 v[252:255], a[124:127], v[108:111], v[252:255]
  ds_read_b64_tr_b16 a[102:103], v121 offset:20480
  v_cvt_pk_bf16_f32 v98, v36, v37
  v_mfma_f32_16x16x32_bf16 v[92:95], v[112:115], v[108:111], v[92:95]
  v_exp_f32 v39, v39
  v_mfma_f32_16x16x32_bf16 v[48:51], a[64:67], a[8:11], v[72:75]
  ds_read_b64_tr_b16 a[104:105], v122 offset:16384
  ds_read_b64_tr_b16 a[252:253], v17 offset:4096
  v_mfma_f32_16x16x32_bf16 v[48:51], a[68:71], a[24:27], v[48:51]
  v_exp_f32 v40, v40
  v_mfma_f32_16x16x32_bf16 v[48:51], a[72:75], a[40:43], v[48:51]
  ds_read_b64_tr_b16 a[106:107], v122 offset:20480
  v_cvt_pk_bf16_f32 v99, v38, v39
  v_mfma_f32_16x16x32_bf16 v[48:51], a[76:79], a[56:59], v[48:51]
  v_exp_f32 v41, v41
  v_mfma_f32_16x16x32_bf16 v[52:55], a[80:83], a[8:11], v[72:75]
  ds_read_b64_tr_b16 a[108:109], v123 offset:16384
  ds_read_b64_tr_b16 a[254:255], v17 offset:6144
  v_mfma_f32_16x16x32_bf16 v[52:55], a[84:87], a[24:27], v[52:55]
  v_exp_f32 v42, v42
  v_mfma_f32_16x16x32_bf16 v[52:55], a[88:91], a[40:43], v[52:55]
  ds_read_b64_tr_b16 a[110:111], v123 offset:20480
  v_cvt_pk_bf16_f32 v100, v40, v41
  v_mfma_f32_16x16x32_bf16 v[52:55], a[92:95], a[56:59], v[52:55]
  v_exp_f32 v43, v43
  v_mfma_f32_16x16x32_bf16 v[56:59], a[64:67], a[12:15], v[76:79]
  ds_read_b64_tr_b16 a[112:113], v124 offset:16384
  v_mfma_f32_16x16x32_bf16 v[56:59], a[68:71], a[28:31], v[56:59]
  v_exp_f32 v44, v44
  v_mfma_f32_16x16x32_bf16 v[56:59], a[72:75], a[44:47], v[56:59]
  ds_read_b64_tr_b16 a[114:115], v124 offset:20480
  v_cvt_pk_bf16_f32 v101, v42, v43
  v_mfma_f32_16x16x32_bf16 v[56:59], a[76:79], a[60:63], v[56:59]
  v_exp_f32 v45, v45
  v_mfma_f32_16x16x32_bf16 v[60:63], a[80:83], a[12:15], v[76:79]
  ds_read_b64_tr_b16 a[116:117], v125 offset:16384
  v_mfma_f32_16x16x32_bf16 v[60:63], a[84:87], a[28:31], v[60:63]
  v_exp_f32 v46, v46
  v_mfma_f32_16x16x32_bf16 v[60:63], a[88:91], a[44:47], v[60:63]
  ds_read_b64_tr_b16 a[118:119], v125 offset:20480
  v_cvt_pk_bf16_f32 v102, v44, v45
  v_mfma_f32_16x16x32_bf16 v[60:63], a[92:95], a[60:63], v[60:63]
  s_waitcnt vmcnt(11)
  v_exp_f32 v47, v47
  v_mfma_f32_16x16x32_bf16 a[128:131], a[192:195], a[224:227], a[128:131]
  ds_read_b64_tr_b16 a[120:121], v126 offset:16384
  v_mfma_f32_16x16x32_bf16 a[132:135], a[192:195], a[228:231], a[132:135]
  s_waitcnt lgkmcnt(15)
  v_cvt_pk_bf16_f32 v103, v46, v47
  v_mfma_f32_16x16x32_bf16 a[136:139], a[192:195], a[232:235], a[136:139]
  ds_read_b64_tr_b16 a[122:123], v126 offset:20480
  v_mfma_f32_16x16x32_bf16 a[140:143], a[192:195], a[236:239], a[140:143]
  s_waitcnt vmcnt(10)
  v_mfma_f32_16x16x32_bf16 a[144:147], a[196:199], a[224:227], a[144:147]
  v_exp_f32 v48, v48
  v_mfma_f32_16x16x32_bf16 a[148:151], a[196:199], a[228:231], a[148:151]
  ds_read_b64_tr_b16 a[124:125], v127 offset:16384
  v_mfma_f32_16x16x32_bf16 a[152:155], a[196:199], a[232:235], a[152:155]
  v_exp_f32 v49, v49
  v_mfma_f32_16x16x32_bf16 a[156:159], a[196:199], a[236:239], a[156:159]
  s_waitcnt vmcnt(9)
  v_xor_b32 v14, 8192, v14
  v_xor_b32 v15, 8192, v15
  v_mfma_f32_16x16x32_bf16 a[160:163], a[200:203], a[224:227], a[160:163]
  v_xor_b32 v16, 8192, v16
  v_xor_b32 v17, 8192, v17
  v_mfma_f32_16x16x32_bf16 a[164:167], a[200:203], a[228:231], a[164:167]
  ds_read_b64_tr_b16 a[126:127], v127 offset:20480
  v_mfma_f32_16x16x32_bf16 a[168:171], a[200:203], a[232:235], a[168:171]
  v_exp_f32 v50, v50
  v_mfma_f32_16x16x32_bf16 a[172:175], a[200:203], a[236:239], a[172:175]
  s_waitcnt vmcnt(8)
  v_cvt_pk_bf16_f32 v104, v48, v49
  v_mfma_f32_16x16x32_bf16 a[176:179], a[204:207], a[224:227], a[176:179]
  v_exp_f32 v51, v51
  v_mfma_f32_16x16x32_bf16 a[180:183], a[204:207], a[228:231], a[180:183]
  v_exp_f32 v52, v52
  v_mfma_f32_16x16x32_bf16 a[184:187], a[204:207], a[232:235], a[184:187]
  ds_read_b128 a[64:67], v116 offset:24576
  v_mfma_f32_16x16x32_bf16 a[188:191], a[204:207], a[236:239], a[188:191]
  v_cvt_pk_bf16_f32 v105, v50, v51
  v_mfma_f32_16x16x32_bf16 v[128:131], a[96:99], v[96:99], v[128:131]
  s_waitcnt lgkmcnt(15)
  ds_read_b128 a[68:71], v117 offset:24576
  v_mfma_f32_16x16x32_bf16 v[144:147], a[100:103], v[96:99], v[144:147]
  s_waitcnt lgkmcnt(13)
  v_exp_f32 v53, v53
  v_mfma_f32_16x16x32_bf16 v[160:163], a[104:107], v[96:99], v[160:163]
  s_waitcnt lgkmcnt(10)
  v_mfma_f32_16x16x32_bf16 v[176:179], a[108:111], v[96:99], v[176:179]
  s_waitcnt lgkmcnt(8)
  ds_read_b128 a[72:75], v118 offset:24576
  v_mfma_f32_16x16x32_bf16 v[192:195], a[112:115], v[96:99], v[192:195]
  s_waitcnt lgkmcnt(7)
  v_exp_f32 v54, v54
  v_mfma_f32_16x16x32_bf16 v[208:211], a[116:119], v[96:99], v[208:211]
  s_waitcnt lgkmcnt(5)
  ds_read_b128 a[76:79], v119 offset:24576
  v_cvt_pk_bf16_f32 v106, v52, v53
  v_mfma_f32_16x16x32_bf16 v[224:227], a[120:123], v[96:99], v[224:227]
  s_waitcnt lgkmcnt(4)
  v_mfma_f32_16x16x32_bf16 v[240:243], a[124:127], v[96:99], v[240:243]
  v_exp_f32 v55, v55
  v_mfma_f32_16x16x32_bf16 v[80:83], v[112:115], v[96:99], v[80:83]
  ds_read_b128 a[80:83], v116 offset:28672
  v_mfma_f32_16x16x32_bf16 v[132:135], a[96:99], v[100:103], v[132:135]
  v_exp_f32 v56, v56
  v_mfma_f32_16x16x32_bf16 v[148:151], a[100:103], v[100:103], v[148:151]
  ds_read_b128 a[84:87], v117 offset:28672
  v_mfma_f32_16x16x32_bf16 v[164:167], a[104:107], v[100:103], v[164:167]
  v_cvt_pk_bf16_f32 v107, v54, v55
  v_mfma_f32_16x16x32_bf16 v[180:183], a[108:111], v[100:103], v[180:183]
  ds_read_b128 a[88:91], v118 offset:28672
  v_mfma_f32_16x16x32_bf16 v[196:199], a[112:115], v[100:103], v[196:199]
  v_exp_f32 v57, v57
  v_mfma_f32_16x16x32_bf16 v[212:215], a[116:119], v[100:103], v[212:215]
  ds_read_b128 a[92:95], v119 offset:28672
  v_mfma_f32_16x16x32_bf16 v[228:231], a[120:123], v[100:103], v[228:231]
  v_exp_f32 v58, v58
  v_mfma_f32_16x16x32_bf16 v[244:247], a[124:127], v[100:103], v[244:247]
  v_mfma_f32_16x16x32_bf16 v[84:87], v[112:115], v[100:103], v[84:87]
  s_waitcnt lgkmcnt(7)
  v_cvt_pk_bf16_f32 v108, v56, v57
  v_mfma_f32_16x16x32_bf16 v[32:35], a[64:67], a[0:3], v[64:67]
  s_waitcnt lgkmcnt(6)
  v_mfma_f32_16x16x32_bf16 v[32:35], a[68:71], a[16:19], v[32:35]
  s_waitcnt lgkmcnt(5)
  v_exp_f32 v59, v59
  v_mfma_f32_16x16x32_bf16 v[32:35], a[72:75], a[32:35], v[32:35]
  s_waitcnt lgkmcnt(4)
  v_mfma_f32_16x16x32_bf16 v[32:35], a[76:79], a[48:51], v[32:35]
  s_waitcnt lgkmcnt(3)
  v_exp_f32 v60, v60
  v_mfma_f32_16x16x32_bf16 v[36:39], a[80:83], a[0:3], v[64:67]
  s_waitcnt lgkmcnt(2)
  v_mfma_f32_16x16x32_bf16 v[36:39], a[84:87], a[16:19], v[36:39]
  s_waitcnt lgkmcnt(1)
  s_add_u32 m0, s21, 49152
  v_mfma_f32_16x16x32_bf16 v[36:39], a[88:91], a[32:35], v[36:39]
  s_waitcnt lgkmcnt(0)
  buffer_load_dwordx4 v12, s[12:15], s20 offen lds
  v_mfma_f32_16x16x32_bf16 v[36:39], a[92:95], a[48:51], v[36:39]
  v_cvt_pk_bf16_f32 v109, v58, v59
  v_mfma_f32_16x16x32_bf16 v[40:43], a[64:67], a[4:7], v[68:71]
  v_exp_f32 v61, v61
  v_mfma_f32_16x16x32_bf16 v[40:43], a[68:71], a[20:23], v[40:43]
  v_mfma_f32_16x16x32_bf16 v[40:43], a[72:75], a[36:39], v[40:43]
  v_exp_f32 v62, v62
  v_mfma_f32_16x16x32_bf16 v[40:43], a[76:79], a[52:55], v[40:43]
  v_mfma_f32_16x16x32_bf16 v[44:47], a[80:83], a[4:7], v[68:71]
  buffer_load_dwordx4 v13, s[12:15], s20 offen offset:1024 lds
  v_mfma_f32_16x16x32_bf16 v[44:47], a[84:87], a[20:23], v[44:47]
  v_cvt_pk_bf16_f32 v110, v60, v61
  v_mfma_f32_16x16x32_bf16 v[44:47], a[88:91], a[36:39], v[44:47]
  v_exp_f32 v63, v63
  v_mfma_f32_16x16x32_bf16 v[44:47], a[92:95], a[52:55], v[44:47]
  s_waitcnt vmcnt(9)
  v_mfma_f32_16x16x32_bf16 a[128:131], a[208:211], a[240:243], a[128:131]
  v_cvt_pk_bf16_f32 v111, v62, v63
  v_mfma_f32_16x16x32_bf16 a[132:135], a[208:211], a[244:247], a[132:135]
  v_mfma_f32_16x16x32_bf16 a[136:139], a[208:211], a[248:251], a[136:139]
  buffer_load_dwordx4 v12, s[12:15], s20 offen offset:2048 lds
  v_mfma_f32_16x16x32_bf16 a[140:143], a[208:211], a[252:255], a[140:143]
  s_waitcnt vmcnt(9)
  v_mfma_f32_16x16x32_bf16 a[144:147], a[212:215], a[240:243], a[144:147]
  v_exp_f32 v32, v32
  v_mfma_f32_16x16x32_bf16 a[148:151], a[212:215], a[244:247], a[148:151]
  v_exp_f32 v33, v33
  v_mfma_f32_16x16x32_bf16 a[152:155], a[212:215], a[248:251], a[152:155]
  v_exp_f32 v34, v34
  v_mfma_f32_16x16x32_bf16 a[156:159], a[212:215], a[252:255], a[156:159]
  s_waitcnt vmcnt(8)
  v_mfma_f32_16x16x32_bf16 a[160:163], a[216:219], a[240:243], a[160:163]
  buffer_load_dwordx4 v13, s[12:15], s20 offen offset:3072 lds
  s_add_u32 s20, s20, 16384
  v_mfma_f32_16x16x32_bf16 a[164:167], a[216:219], a[244:247], a[164:167]
  v_cvt_pk_bf16_f32 v96, v32, v33
  v_mfma_f32_16x16x32_bf16 a[168:171], a[216:219], a[248:251], a[168:171]
  v_mfma_f32_16x16x32_bf16 a[172:175], a[216:219], a[252:255], a[172:175]
  s_waitcnt vmcnt(8)
  v_exp_f32 v35, v35
  v_mfma_f32_16x16x32_bf16 a[176:179], a[220:223], a[240:243], a[176:179]
  v_mfma_f32_16x16x32_bf16 a[180:183], a[220:223], a[244:247], a[180:183]
  v_exp_f32 v36, v36
  v_mfma_f32_16x16x32_bf16 a[184:187], a[220:223], a[248:251], a[184:187]
  v_mfma_f32_16x16x32_bf16 a[188:191], a[220:223], a[252:255], a[188:191]
  v_cvt_pk_bf16_f32 v97, v34, v35
  v_mfma_f32_16x16x32_bf16 v[136:139], a[96:99], v[104:107], v[136:139]
  v_mfma_f32_16x16x32_bf16 v[152:155], a[100:103], v[104:107], v[152:155]
  v_exp_f32 v37, v37
  v_mfma_f32_16x16x32_bf16 v[168:171], a[104:107], v[104:107], v[168:171]
  v_mfma_f32_16x16x32_bf16 v[184:187], a[108:111], v[104:107], v[184:187]
  v_mfma_f32_16x16x32_bf16 v[200:203], a[112:115], v[104:107], v[200:203]
  v_exp_f32 v38, v38
  v_mfma_f32_16x16x32_bf16 v[216:219], a[116:119], v[104:107], v[216:219]
  v_mfma_f32_16x16x32_bf16 v[232:235], a[120:123], v[104:107], v[232:235]
  v_cvt_pk_bf16_f32 v98, v36, v37
  v_mfma_f32_16x16x32_bf16 v[248:251], a[124:127], v[104:107], v[248:251]
  v_mfma_f32_16x16x32_bf16 v[88:91], v[112:115], v[104:107], v[88:91]
  v_exp_f32 v39, v39
  v_mfma_f32_16x16x32_bf16 v[140:143], a[96:99], v[108:111], v[140:143]
  v_mfma_f32_16x16x32_bf16 v[156:159], a[100:103], v[108:111], v[156:159]
  ds_read_b64_tr_b16 a[96:97], v120 offset:24576
  ds_read_b64_tr_b16 a[98:99], v120 offset:28672
  v_mfma_f32_16x16x32_bf16 v[172:175], a[104:107], v[108:111], v[172:175]
  v_exp_f32 v40, v40
  v_mfma_f32_16x16x32_bf16 v[188:191], a[108:111], v[108:111], v[188:191]
  ds_read_b64_tr_b16 a[100:101], v121 offset:24576
  ds_read_b64_tr_b16 a[102:103], v121 offset:28672
  v_mfma_f32_16x16x32_bf16 v[204:207], a[112:115], v[108:111], v[204:207]
  ds_read_b64_tr_b16 a[104:105], v122 offset:24576
  v_cvt_pk_bf16_f32 v99, v38, v39
  v_mfma_f32_16x16x32_bf16 v[220:223], a[116:119], v[108:111], v[220:223]
  ds_read_b64_tr_b16 a[106:107], v122 offset:28672
  v_mfma_f32_16x16x32_bf16 v[236:239], a[120:123], v[108:111], v[236:239]
  v_exp_f32 v41, v41
  v_mfma_f32_16x16x32_bf16 v[252:255], a[124:127], v[108:111], v[252:255]
  ds_read_b64_tr_b16 a[108:109], v123 offset:24576
  ds_read_b64_tr_b16 a[110:111], v123 offset:28672
  v_mfma_f32_16x16x32_bf16 v[92:95], v[112:115], v[108:111], v[92:95]
  v_exp_f32 v42, v42
  v_mfma_f32_16x16x32_bf16 v[48:51], a[64:67], a[8:11], v[72:75]
  ds_read_b64_tr_b16 a[112:113], v124 offset:24576
  ds_read_b64_tr_b16 a[114:115], v124 offset:28672
  v_mfma_f32_16x16x32_bf16 v[48:51], a[68:71], a[24:27], v[48:51]
  ds_read_b64_tr_b16 a[116:117], v125 offset:24576
  v_cvt_pk_bf16_f32 v100, v40, v41
  v_mfma_f32_16x16x32_bf16 v[48:51], a[72:75], a[40:43], v[48:51]
  ds_read_b64_tr_b16 a[118:119], v125 offset:28672
  v_mfma_f32_16x16x32_bf16 v[48:51], a[76:79], a[56:59], v[48:51]
  v_exp_f32 v43, v43
  v_mfma_f32_16x16x32_bf16 v[52:55], a[80:83], a[8:11], v[72:75]
  ds_read_b64_tr_b16 a[120:121], v126 offset:24576
  v_mfma_f32_16x16x32_bf16 v[52:55], a[84:87], a[24:27], v[52:55]
  ds_read_b64_tr_b16 a[122:123], v126 offset:28672
  v_mfma_f32_16x16x32_bf16 v[52:55], a[88:91], a[40:43], v[52:55]
  v_exp_f32 v44, v44
  v_mfma_f32_16x16x32_bf16 v[52:55], a[92:95], a[56:59], v[52:55]
  ds_read_b64_tr_b16 a[124:125], v127 offset:24576
  ds_read_b64_tr_b16 a[126:127], v127 offset:28672
  v_mfma_f32_16x16x32_bf16 v[56:59], a[64:67], a[12:15], v[76:79]
  v_cvt_pk_bf16_f32 v101, v42, v43
  v_mfma_f32_16x16x32_bf16 v[56:59], a[68:71], a[28:31], v[56:59]
  v_mfma_f32_16x16x32_bf16 v[56:59], a[72:75], a[44:47], v[56:59]
  v_exp_f32 v45, v45
  v_mfma_f32_16x16x32_bf16 v[56:59], a[76:79], a[60:63], v[56:59]
  v_mfma_f32_16x16x32_bf16 v[60:63], a[80:83], a[12:15], v[76:79]
  v_exp_f32 v46, v46
  v_mfma_f32_16x16x32_bf16 v[60:63], a[84:87], a[28:31], v[60:63]
  v_mfma_f32_16x16x32_bf16 v[60:63], a[88:91], a[44:47], v[60:63]
  v_mfma_f32_16x16x32_bf16 v[60:63], a[92:95], a[60:63], v[60:63]
  s_xor_b32 s40, s40, 8192
  s_waitcnt vmcnt(8) lgkmcnt(0)
  s_barrier
  s_mov_b32 s28, s98
  s_mov_b32 s29, s99
  s_mov_b32 s30, 4096
  s_mov_b32 s31, 131072
  v_mfma_f32_16x16x32_bf16 v[128:131], a[96:99], v[96:99], v[128:131]
  ds_read_b128 a[64:67], v116 offset:32768
  v_cvt_pk_bf16_f32 v102, v44, v45
  v_mfma_f32_16x16x32_bf16 v[144:147], a[100:103], v[96:99], v[144:147]
  v_exp_f32 v47, v47
  v_mfma_f32_16x16x32_bf16 v[160:163], a[104:107], v[96:99], v[160:163]
  ds_read_b128 a[68:71], v117 offset:32768
  v_cvt_pk_bf16_f32 v103, v46, v47
  v_mfma_f32_16x16x32_bf16 v[176:179], a[108:111], v[96:99], v[176:179]
  ds_read_b128 a[72:75], v118 offset:32768
  v_mfma_f32_16x16x32_bf16 v[192:195], a[112:115], v[96:99], v[192:195]
  v_exp_f32 v48, v48
  v_mfma_f32_16x16x32_bf16 v[208:211], a[116:119], v[96:99], v[208:211]
  v_exp_f32 v49, v49
  v_mfma_f32_16x16x32_bf16 v[224:227], a[120:123], v[96:99], v[224:227]
  ds_read_b128 a[76:79], v119 offset:32768
  v_mfma_f32_16x16x32_bf16 v[240:243], a[124:127], v[96:99], v[240:243]
  s_lshl_b32 s44, s46, 6
  s_lshl_b32 s45, s24, 4
  s_add_u32 s44, s44, s45
  v_and_b32 v1, 15, v0
  v_add_u32 v1, s44, v1
  v_mfma_f32_16x16x32_bf16 v[80:83], v[112:115], v[96:99], v[80:83]
  v_exp_f32 v50, v50
  v_mfma_f32_16x16x32_bf16 v[132:135], a[96:99], v[100:103], v[132:135]
  ds_read_b128 a[80:83], v116 offset:36864
  v_cvt_pk_bf16_f32 v104, v48, v49
  v_mfma_f32_16x16x32_bf16 v[148:151], a[100:103], v[100:103], v[148:151]
  v_exp_f32 v51, v51
  v_mfma_f32_16x16x32_bf16 v[164:167], a[104:107], v[100:103], v[164:167]
  ds_read_b128 a[84:87], v117 offset:36864
  v_lshlrev_b32 v1, 1, v1
  v_mfma_f32_16x16x32_bf16 v[180:183], a[108:111], v[100:103], v[180:183]
  buffer_load_ushort v1, v1, s[28:31], 0 offen
  v_mfma_f32_16x16x32_bf16 v[196:199], a[112:115], v[100:103], v[196:199]
  v_exp_f32 v52, v52
  v_mfma_f32_16x16x32_bf16 v[212:215], a[116:119], v[100:103], v[212:215]
  ds_read_b128 a[88:91], v118 offset:36864
  v_cvt_pk_bf16_f32 v105, v50, v51
  v_mfma_f32_16x16x32_bf16 v[228:231], a[120:123], v[100:103], v[228:231]
  ds_read_b128 a[92:95], v119 offset:36864
  v_lshlrev_b32 v27, 4, v0
  v_mfma_f32_16x16x32_bf16 v[244:247], a[124:127], v[100:103], v[244:247]
  v_exp_f32 v53, v53
  v_mfma_f32_16x16x32_bf16 v[84:87], v[112:115], v[100:103], v[84:87]
  s_waitcnt lgkmcnt(7)
  v_exp_f32 v54, v54
  v_mfma_f32_16x16x32_bf16 v[32:35], a[64:67], a[0:3], v[64:67]
  s_waitcnt lgkmcnt(6)
  s_add_u32 m0, s21, 16384
  v_cvt_pk_bf16_f32 v106, v52, v53
  v_add_u32 v26, s27, v27
  v_mfma_f32_16x16x32_bf16 v[32:35], a[68:71], a[16:19], v[32:35]
  s_waitcnt lgkmcnt(5)
  buffer_load_dwordx4 v8, s[8:11], s20 offen lds
  v_mfma_f32_16x16x32_bf16 v[32:35], a[72:75], a[32:35], v[32:35]
  s_waitcnt lgkmcnt(4)
  v_exp_f32 v55, v55
  v_mfma_f32_16x16x32_bf16 v[32:35], a[76:79], a[48:51], v[32:35]
  s_waitcnt lgkmcnt(3)
  v_exp_f32 v56, v56
  v_mfma_f32_16x16x32_bf16 v[36:39], a[80:83], a[0:3], v[64:67]
  s_waitcnt lgkmcnt(2)
  ds_write_b128 v26, a[128:131]
  v_cvt_pk_bf16_f32 v107, v54, v55
  v_mfma_f32_16x16x32_bf16 v[36:39], a[84:87], a[16:19], v[36:39]
  s_waitcnt lgkmcnt(2)
  v_exp_f32 v57, v57
  v_mfma_f32_16x16x32_bf16 v[36:39], a[88:91], a[32:35], v[36:39]
  s_waitcnt lgkmcnt(1)
  v_exp_f32 v58, v58
  v_mfma_f32_16x16x32_bf16 v[36:39], a[92:95], a[48:51], v[36:39]
  buffer_load_dwordx4 v9, s[8:11], s20 offen offset:1024 lds
  v_mfma_f32_16x16x32_bf16 v[40:43], a[64:67], a[4:7], v[68:71]
  ds_write_b128 v26, a[132:135] offset:1024
  v_cvt_pk_bf16_f32 v108, v56, v57
  v_mfma_f32_16x16x32_bf16 v[40:43], a[68:71], a[20:23], v[40:43]
  v_exp_f32 v59, v59
  v_mfma_f32_16x16x32_bf16 v[40:43], a[72:75], a[36:39], v[40:43]
  v_exp_f32 v60, v60
  v_mfma_f32_16x16x32_bf16 v[40:43], a[76:79], a[52:55], v[40:43]
  buffer_load_dwordx4 v10, s[8:11], s20 offen offset:2048 lds
  v_mfma_f32_16x16x32_bf16 v[44:47], a[80:83], a[4:7], v[68:71]
  ds_write_b128 v26, a[136:139] offset:2048
  v_cvt_pk_bf16_f32 v109, v58, v59
  v_mfma_f32_16x16x32_bf16 v[44:47], a[84:87], a[20:23], v[44:47]
  v_exp_f32 v61, v61
  v_mfma_f32_16x16x32_bf16 v[44:47], a[88:91], a[36:39], v[44:47]
  v_exp_f32 v62, v62
  v_mfma_f32_16x16x32_bf16 v[44:47], a[92:95], a[52:55], v[44:47]
  ds_write_b128 v26, a[140:143] offset:3072
  v_cvt_pk_bf16_f32 v110, v60, v61
  v_mfma_f32_16x16x32_bf16 v[136:139], a[96:99], v[104:107], v[136:139]
  buffer_load_dwordx4 v11, s[8:11], s20 offen offset:3072 lds
  v_mfma_f32_16x16x32_bf16 v[152:155], a[100:103], v[104:107], v[152:155]
  v_exp_f32 v63, v63
  v_mfma_f32_16x16x32_bf16 v[168:171], a[104:107], v[104:107], v[168:171]
  v_cvt_pk_bf16_f32 v111, v62, v63
  v_mfma_f32_16x16x32_bf16 v[184:187], a[108:111], v[104:107], v[184:187]
  ds_write_b128 v26, a[144:147] offset:4096
  v_mfma_f32_16x16x32_bf16 v[200:203], a[112:115], v[104:107], v[200:203]
  v_exp_f32 v32, v32
  v_mfma_f32_16x16x32_bf16 v[216:219], a[116:119], v[104:107], v[216:219]
  v_exp_f32 v33, v33
  v_mfma_f32_16x16x32_bf16 v[232:235], a[120:123], v[104:107], v[232:235]
  v_exp_f32 v34, v34
  v_mfma_f32_16x16x32_bf16 v[248:251], a[124:127], v[104:107], v[248:251]
  v_cvt_pk_bf16_f32 v96, v32, v33
  v_mfma_f32_16x16x32_bf16 v[88:91], v[112:115], v[104:107], v[88:91]
  ds_write_b128 v26, a[148:151] offset:5120
  v_mfma_f32_16x16x32_bf16 v[140:143], a[96:99], v[108:111], v[140:143]
  v_exp_f32 v35, v35
  v_mfma_f32_16x16x32_bf16 v[156:159], a[100:103], v[108:111], v[156:159]
  ds_read_b64_tr_b16 a[96:97], v120 offset:32768
  ds_read_b64_tr_b16 a[98:99], v120 offset:36864
  v_mfma_f32_16x16x32_bf16 v[172:175], a[104:107], v[108:111], v[172:175]
  v_exp_f32 v36, v36
  v_mfma_f32_16x16x32_bf16 v[188:191], a[108:111], v[108:111], v[188:191]
  ds_read_b64_tr_b16 a[100:101], v121 offset:32768
  v_cvt_pk_bf16_f32 v97, v34, v35
  v_mfma_f32_16x16x32_bf16 v[204:207], a[112:115], v[108:111], v[204:207]
  ds_read_b64_tr_b16 a[102:103], v121 offset:36864
  ds_write_b128 v26, a[152:155] offset:6144
  v_mfma_f32_16x16x32_bf16 v[220:223], a[116:119], v[108:111], v[220:223]
  v_exp_f32 v37, v37
  v_mfma_f32_16x16x32_bf16 v[236:239], a[120:123], v[108:111], v[236:239]
  ds_read_b64_tr_b16 a[104:105], v122 offset:32768
  ds_read_b64_tr_b16 a[106:107], v122 offset:36864
  v_mfma_f32_16x16x32_bf16 v[252:255], a[124:127], v[108:111], v[252:255]
  v_exp_f32 v38, v38
  v_mfma_f32_16x16x32_bf16 v[92:95], v[112:115], v[108:111], v[92:95]
  ds_read_b64_tr_b16 a[108:109], v123 offset:32768
  v_cvt_pk_bf16_f32 v98, v36, v37
  v_mfma_f32_16x16x32_bf16 v[48:51], a[64:67], a[8:11], v[72:75]
  ds_read_b64_tr_b16 a[110:111], v123 offset:36864
  ds_write_b128 v26, a[156:159] offset:7168
  v_mfma_f32_16x16x32_bf16 v[48:51], a[68:71], a[24:27], v[48:51]
  v_exp_f32 v39, v39
  v_mfma_f32_16x16x32_bf16 v[48:51], a[72:75], a[40:43], v[48:51]
  ds_read_b64_tr_b16 a[112:113], v124 offset:32768
  ds_read_b64_tr_b16 a[114:115], v124 offset:36864
  v_mfma_f32_16x16x32_bf16 v[48:51], a[76:79], a[56:59], v[48:51]
  v_exp_f32 v40, v40
  v_mfma_f32_16x16x32_bf16 v[52:55], a[80:83], a[8:11], v[72:75]
  ds_read_b64_tr_b16 a[116:117], v125 offset:32768
  v_cvt_pk_bf16_f32 v99, v38, v39
  v_mfma_f32_16x16x32_bf16 v[52:55], a[84:87], a[24:27], v[52:55]
  ds_read_b64_tr_b16 a[118:119], v125 offset:36864
  ds_write_b128 v26, a[160:163] offset:8192
  v_mfma_f32_16x16x32_bf16 v[52:55], a[88:91], a[40:43], v[52:55]
  v_exp_f32 v41, v41
  v_mfma_f32_16x16x32_bf16 v[52:55], a[92:95], a[56:59], v[52:55]
  ds_read_b64_tr_b16 a[120:121], v126 offset:32768
  ds_read_b64_tr_b16 a[122:123], v126 offset:36864
  v_mfma_f32_16x16x32_bf16 v[56:59], a[64:67], a[12:15], v[76:79]
  v_exp_f32 v42, v42
  v_mfma_f32_16x16x32_bf16 v[56:59], a[68:71], a[28:31], v[56:59]
  ds_read_b64_tr_b16 a[124:125], v127 offset:32768
  v_cvt_pk_bf16_f32 v100, v40, v41
  v_mfma_f32_16x16x32_bf16 v[56:59], a[72:75], a[44:47], v[56:59]
  v_exp_f32 v43, v43
  v_mfma_f32_16x16x32_bf16 v[56:59], a[76:79], a[60:63], v[56:59]
  ds_write_b128 v26, a[164:167] offset:9216
  ds_read_b64_tr_b16 a[126:127], v127 offset:36864
  v_mfma_f32_16x16x32_bf16 v[60:63], a[80:83], a[12:15], v[76:79]
  v_exp_f32 v44, v44
  v_mfma_f32_16x16x32_bf16 v[60:63], a[84:87], a[28:31], v[60:63]
  ds_write_b128 v26, a[168:171] offset:10240
  v_cvt_pk_bf16_f32 v101, v42, v43
  v_mfma_f32_16x16x32_bf16 v[60:63], a[88:91], a[44:47], v[60:63]
  v_exp_f32 v45, v45
  v_mfma_f32_16x16x32_bf16 v[60:63], a[92:95], a[60:63], v[60:63]
  s_waitcnt lgkmcnt(15)
  v_exp_f32 v46, v46
  v_mfma_f32_16x16x32_bf16 v[128:131], a[96:99], v[96:99], v[128:131]
  ds_read_b128 a[64:67], v116 offset:40960
  v_cvt_pk_bf16_f32 v102, v44, v45
  v_mfma_f32_16x16x32_bf16 v[144:147], a[100:103], v[96:99], v[144:147]
  s_waitcnt lgkmcnt(15)
  v_exp_f32 v47, v47
  v_mfma_f32_16x16x32_bf16 v[160:163], a[104:107], v[96:99], v[160:163]
  s_waitcnt lgkmcnt(13)
  ds_write_b128 v26, a[172:175] offset:11264
  ds_read_b128 a[68:71], v117 offset:40960
  v_mfma_f32_16x16x32_bf16 v[176:179], a[108:111], v[96:99], v[176:179]
  s_waitcnt lgkmcnt(12)
  ds_read_b128 a[72:75], v118 offset:40960
  v_cvt_pk_bf16_f32 v103, v46, v47
  v_mfma_f32_16x16x32_bf16 v[192:195], a[112:115], v[96:99], v[192:195]
  s_waitcnt lgkmcnt(11)
  v_exp_f32 v48, v48
  v_mfma_f32_16x16x32_bf16 v[208:211], a[116:119], v[96:99], v[208:211]
  s_waitcnt lgkmcnt(8)
  v_exp_f32 v49, v49
  v_mfma_f32_16x16x32_bf16 v[224:227], a[120:123], v[96:99], v[224:227]
  s_waitcnt lgkmcnt(5)
  ds_write_b128 v26, a[176:179] offset:12288
  ds_read_b128 a[76:79], v119 offset:40960
  v_mfma_f32_16x16x32_bf16 v[240:243], a[124:127], v[96:99], v[240:243]
  v_exp_f32 v50, v50
  v_mfma_f32_16x16x32_bf16 v[80:83], v[112:115], v[96:99], v[80:83]
  ds_read_b128 a[80:83], v116 offset:45056
  v_cvt_pk_bf16_f32 v104, v48, v49
  v_mfma_f32_16x16x32_bf16 v[132:135], a[96:99], v[100:103], v[132:135]
  v_exp_f32 v51, v51
  v_mfma_f32_16x16x32_bf16 v[148:151], a[100:103], v[100:103], v[148:151]
  ds_write_b128 v26, a[180:183] offset:13312
  ds_read_b128 a[84:87], v117 offset:45056
  v_mfma_f32_16x16x32_bf16 v[164:167], a[104:107], v[100:103], v[164:167]
  v_exp_f32 v52, v52
  v_mfma_f32_16x16x32_bf16 v[180:183], a[108:111], v[100:103], v[180:183]
  ds_read_b128 a[88:91], v118 offset:45056
  v_cvt_pk_bf16_f32 v105, v50, v51
  v_mfma_f32_16x16x32_bf16 v[196:199], a[112:115], v[100:103], v[196:199]
  v_exp_f32 v53, v53
  v_mfma_f32_16x16x32_bf16 v[212:215], a[116:119], v[100:103], v[212:215]
  ds_write_b128 v26, a[184:187] offset:14336
  ds_read_b128 a[92:95], v119 offset:45056
  v_mfma_f32_16x16x32_bf16 v[228:231], a[120:123], v[100:103], v[228:231]
  v_exp_f32 v54, v54
  v_mfma_f32_16x16x32_bf16 v[244:247], a[124:127], v[100:103], v[244:247]
  v_cvt_pk_bf16_f32 v106, v52, v53
  v_mfma_f32_16x16x32_bf16 v[84:87], v[112:115], v[100:103], v[84:87]
  s_waitcnt lgkmcnt(11)
  v_exp_f32 v55, v55
  v_mfma_f32_16x16x32_bf16 v[32:35], a[64:67], a[0:3], v[64:67]
  s_waitcnt lgkmcnt(9)
  s_add_u32 m0, s21, 65536
  ds_write_b128 v26, a[188:191] offset:15360
  v_mfma_f32_16x16x32_bf16 v[32:35], a[68:71], a[16:19], v[32:35]
  s_waitcnt lgkmcnt(9)
  buffer_load_dwordx4 v12, s[12:15], s20 offen lds
  v_mfma_f32_16x16x32_bf16 v[32:35], a[72:75], a[32:35], v[32:35]
  s_waitcnt lgkmcnt(7)
  v_exp_f32 v56, v56
  v_mfma_f32_16x16x32_bf16 v[32:35], a[76:79], a[48:51], v[32:35]
  s_waitcnt lgkmcnt(6)
  s_lshl_b32 s43, s24, 10
  s_add_u32 s43, s43, 98304
  v_cvt_pk_bf16_f32 v107, v54, v55
  v_add_u32 v27, s43, v27
  v_mfma_f32_16x16x32_bf16 v[36:39], a[80:83], a[0:3], v[64:67]
  s_waitcnt lgkmcnt(4)
  v_exp_f32 v57, v57
  v_mfma_f32_16x16x32_bf16 v[36:39], a[84:87], a[16:19], v[36:39]
  s_waitcnt lgkmcnt(3)
  v_exp_f32 v58, v58
  v_mfma_f32_16x16x32_bf16 v[36:39], a[88:91], a[32:35], v[36:39]
  s_waitcnt lgkmcnt(1)
  v_cvt_pk_bf16_f32 v108, v56, v57
  v_mfma_f32_16x16x32_bf16 v[36:39], a[92:95], a[48:51], v[36:39]
  buffer_load_dwordx4 v13, s[12:15], s20 offen offset:1024 lds
  v_mfma_f32_16x16x32_bf16 v[40:43], a[64:67], a[4:7], v[68:71]
  v_exp_f32 v59, v59
  v_mfma_f32_16x16x32_bf16 v[40:43], a[68:71], a[20:23], v[40:43]
  v_exp_f32 v60, v60
  v_mfma_f32_16x16x32_bf16 v[40:43], a[72:75], a[36:39], v[40:43]
  v_cvt_pk_bf16_f32 v109, v58, v59
  v_mfma_f32_16x16x32_bf16 v[40:43], a[76:79], a[52:55], v[40:43]
  buffer_load_dwordx4 v12, s[12:15], s20 offen offset:2048 lds
  v_mfma_f32_16x16x32_bf16 v[44:47], a[80:83], a[4:7], v[68:71]
  v_exp_f32 v61, v61
  v_mfma_f32_16x16x32_bf16 v[44:47], a[84:87], a[20:23], v[44:47]
  v_exp_f32 v62, v62
  v_mfma_f32_16x16x32_bf16 v[44:47], a[88:91], a[36:39], v[44:47]
  v_cvt_pk_bf16_f32 v110, v60, v61
  v_mfma_f32_16x16x32_bf16 v[44:47], a[92:95], a[52:55], v[44:47]
  v_exp_f32 v63, v63
  v_mfma_f32_16x16x32_bf16 v[136:139], a[96:99], v[104:107], v[136:139]
  buffer_load_dwordx4 v13, s[12:15], s20 offen offset:3072 lds
  s_add_u32 s20, s20, 16384
  v_mfma_f32_16x16x32_bf16 v[152:155], a[100:103], v[104:107], v[152:155]
  v_cvt_pk_bf16_f32 v111, v62, v63
  v_mfma_f32_16x16x32_bf16 v[168:171], a[104:107], v[104:107], v[168:171]
  v_mfma_f32_16x16x32_bf16 v[184:187], a[108:111], v[104:107], v[184:187]
  v_mfma_f32_16x16x32_bf16 v[200:203], a[112:115], v[104:107], v[200:203]
  v_exp_f32 v32, v32
  v_mfma_f32_16x16x32_bf16 v[216:219], a[116:119], v[104:107], v[216:219]
  v_exp_f32 v33, v33
  v_mfma_f32_16x16x32_bf16 v[232:235], a[120:123], v[104:107], v[232:235]
  v_exp_f32 v34, v34
  v_mfma_f32_16x16x32_bf16 v[248:251], a[124:127], v[104:107], v[248:251]
  v_cvt_pk_bf16_f32 v96, v32, v33
  v_mfma_f32_16x16x32_bf16 v[88:91], v[112:115], v[104:107], v[88:91]
  v_exp_f32 v35, v35
  v_mfma_f32_16x16x32_bf16 v[140:143], a[96:99], v[108:111], v[140:143]
  v_exp_f32 v36, v36
  v_mfma_f32_16x16x32_bf16 v[156:159], a[100:103], v[108:111], v[156:159]
  ds_read_b64_tr_b16 a[96:97], v120 offset:40960
  ds_read_b64_tr_b16 a[98:99], v120 offset:45056
  v_mfma_f32_16x16x32_bf16 v[172:175], a[104:107], v[108:111], v[172:175]
  ds_read_b64_tr_b16 a[100:101], v121 offset:40960
  v_cvt_pk_bf16_f32 v97, v34, v35
  v_mfma_f32_16x16x32_bf16 v[188:191], a[108:111], v[108:111], v[188:191]
  ds_read_b64_tr_b16 a[102:103], v121 offset:45056
  v_mfma_f32_16x16x32_bf16 v[204:207], a[112:115], v[108:111], v[204:207]
  v_exp_f32 v37, v37
  v_mfma_f32_16x16x32_bf16 v[220:223], a[116:119], v[108:111], v[220:223]
  ds_read_b64_tr_b16 a[104:105], v122 offset:40960
  ds_read_b64_tr_b16 a[106:107], v122 offset:45056
  v_mfma_f32_16x16x32_bf16 v[236:239], a[120:123], v[108:111], v[236:239]
  v_exp_f32 v38, v38
  v_mfma_f32_16x16x32_bf16 v[252:255], a[124:127], v[108:111], v[252:255]
  ds_read_b64_tr_b16 a[108:109], v123 offset:40960
  v_cvt_pk_bf16_f32 v98, v36, v37
  v_mfma_f32_16x16x32_bf16 v[92:95], v[112:115], v[108:111], v[92:95]
  ds_read_b64_tr_b16 a[110:111], v123 offset:45056
  ds_read_b64_tr_b16 a[112:113], v124 offset:40960
  v_mfma_f32_16x16x32_bf16 v[48:51], a[64:67], a[8:11], v[72:75]
  v_exp_f32 v39, v39
  v_mfma_f32_16x16x32_bf16 v[48:51], a[68:71], a[24:27], v[48:51]
  v_exp_f32 v40, v40
  v_mfma_f32_16x16x32_bf16 v[48:51], a[72:75], a[40:43], v[48:51]
  ds_read_b64_tr_b16 a[114:115], v124 offset:45056
  v_cvt_pk_bf16_f32 v99, v38, v39
  v_mfma_f32_16x16x32_bf16 v[48:51], a[76:79], a[56:59], v[48:51]
  ds_read_b64_tr_b16 a[116:117], v125 offset:40960
  ds_read_b64_tr_b16 a[118:119], v125 offset:45056
  v_mfma_f32_16x16x32_bf16 v[52:55], a[80:83], a[8:11], v[72:75]
  v_exp_f32 v41, v41
  v_mfma_f32_16x16x32_bf16 v[52:55], a[84:87], a[24:27], v[52:55]
  ds_read_b64_tr_b16 a[120:121], v126 offset:40960
  ds_read_b64_tr_b16 a[122:123], v126 offset:45056
  v_mfma_f32_16x16x32_bf16 v[52:55], a[88:91], a[40:43], v[52:55]
  v_exp_f32 v42, v42
  v_mfma_f32_16x16x32_bf16 v[52:55], a[92:95], a[56:59], v[52:55]
  ds_read_b64_tr_b16 a[124:125], v127 offset:40960
  v_cvt_pk_bf16_f32 v100, v40, v41
  v_mfma_f32_16x16x32_bf16 v[56:59], a[64:67], a[12:15], v[76:79]
  v_exp_f32 v43, v43
  v_mfma_f32_16x16x32_bf16 v[56:59], a[68:71], a[28:31], v[56:59]
  ds_read_b64_tr_b16 a[126:127], v127 offset:45056
  v_mfma_f32_16x16x32_bf16 v[56:59], a[72:75], a[44:47], v[56:59]
  v_exp_f32 v44, v44
  v_mfma_f32_16x16x32_bf16 v[56:59], a[76:79], a[60:63], v[56:59]
  v_cvt_pk_bf16_f32 v101, v42, v43
  v_mfma_f32_16x16x32_bf16 v[60:63], a[80:83], a[12:15], v[76:79]
  v_exp_f32 v45, v45
  v_mfma_f32_16x16x32_bf16 v[60:63], a[84:87], a[28:31], v[60:63]
  v_exp_f32 v46, v46
  v_mfma_f32_16x16x32_bf16 v[60:63], a[88:91], a[44:47], v[60:63]
  v_mfma_f32_16x16x32_bf16 v[60:63], a[92:95], a[60:63], v[60:63]
  s_waitcnt vmcnt(9) lgkmcnt(0)
  s_barrier
  v_mfma_f32_16x16x32_bf16 v[128:131], a[96:99], v[96:99], v[128:131]
  s_mov_b32 s44, 0xbfb8aa3b
  ds_read_b128 a[64:67], v116
  v_cvt_pk_bf16_f32 v102, v44, v45
  v_mfma_f32_16x16x32_bf16 v[144:147], a[100:103], v[96:99], v[144:147]
  s_waitcnt vmcnt(8)
  s_lshr_b32 s43, s47, 1
  s_lshl_b32 s45, s46, 2
  s_add_u32 s43, s43, s45
  s_lshl_b32 s43, s43, 2
  s_and_b32 s45, s47, 1
  s_lshl_b32 s45, s45, 1
  s_add_u32 s43, s43, s45
  s_lshl_b32 s43, s43, 2
  s_add_u32 s43, s43, s24
  s_lshl_b32 s43, s43, 10
  s_add_u32 s43, s43, 6291456
  v_lshlrev_b32 v1, 16, v1
  v_lshlrev_b32 v26, 4, v0
  v_mfma_f32_16x16x32_bf16 v[160:163], a[104:107], v[96:99], v[160:163]
  v_exp_f32 v47, v47
  v_mfma_f32_16x16x32_bf16 v[176:179], a[108:111], v[96:99], v[176:179]
  ds_read_b64 v[18:19], v27
  ds_read_b64 v[20:21], v27 offset:16384
  v_mfma_f32_16x16x32_bf16 v[192:195], a[112:115], v[96:99], v[192:195]
  ds_read_b128 a[68:71], v117
  v_cvt_pk_bf16_f32 v103, v46, v47
  v_mfma_f32_16x16x32_bf16 v[208:211], a[116:119], v[96:99], v[208:211]
  ds_read_b64 v[22:23], v27 offset:32768
  ds_read_b64 v[24:25], v27 offset:49152
  v_mfma_f32_16x16x32_bf16 v[224:227], a[120:123], v[96:99], v[224:227]
  v_exp_f32 v48, v48
  v_mfma_f32_16x16x32_bf16 v[240:243], a[124:127], v[96:99], v[240:243]
  ds_read_b64 v[28:29], v27 offset:8
  ds_read_b128 a[72:75], v118
  ds_read_b64 v[30:31], v27 offset:16392
  v_mfma_f32_16x16x32_bf16 v[80:83], v[112:115], v[96:99], v[80:83]
  ds_read_b64 v[2:3], v27 offset:32776
  v_exp_f32 v49, v49
  v_mfma_f32_16x16x32_bf16 v[132:135], a[96:99], v[100:103], v[132:135]
  s_waitcnt lgkmcnt(7)
  ds_read_b64 v[4:5], v27 offset:49160
  ds_read_b128 a[76:79], v119
  v_add_f32 v18, v18, v20
  v_exp_f32 v50, v50
  v_mfma_f32_16x16x32_bf16 v[148:151], a[100:103], v[100:103], v[148:151]
  s_waitcnt lgkmcnt(6)
  v_add_f32 v24, v24, v22
  v_add_f32 v24, v24, v18
  v_mfma_f32_16x16x32_bf16 v[164:167], a[104:107], v[100:103], v[164:167]
  v_cvt_pk_bf16_f32 v104, v48, v49
  v_add_f32 v24, v24, v1
  v_mfma_f32_16x16x32_bf16 v[180:183], a[108:111], v[100:103], v[180:183]
  ds_read_b128 a[80:83], v116 offset:4096
  v_mul_f32 v7, s44, v24
  v_exp_f32 v51, v51
  v_mfma_f32_16x16x32_bf16 v[196:199], a[112:115], v[100:103], v[196:199]
  v_exp_f32 v7, v7
  s_nop 0
  v_add_f32 v7, 1.0, v7
  v_mfma_f32_16x16x32_bf16 v[212:215], a[116:119], v[100:103], v[212:215]
  ds_read_b128 a[84:87], v117 offset:4096
  v_exp_f32 v52, v52
  v_rcp_f32 v7, v7
  v_mfma_f32_16x16x32_bf16 v[228:231], a[120:123], v[100:103], v[228:231]
  v_mul_f32 v24, v24, v7
  v_cvt_pk_bf16_f32 v105, v50, v51
  v_add_f32 v19, v19, v21
  v_mfma_f32_16x16x32_bf16 v[244:247], a[124:127], v[100:103], v[244:247]
  ds_read_b128 a[88:91], v118 offset:4096
  v_add_f32 v25, v25, v23
  v_exp_f32 v53, v53
  v_mfma_f32_16x16x32_bf16 v[84:87], v[112:115], v[100:103], v[84:87]
  v_add_f32 v25, v25, v19
  v_add_f32 v25, v25, v1
  v_mfma_f32_16x16x32_bf16 v[32:35], a[64:67], a[0:3], v[64:67]
  ds_read_b128 a[92:95], v119 offset:4096
  v_exp_f32 v54, v54
  v_mul_f32 v7, s44, v25
  v_mfma_f32_16x16x32_bf16 v[32:35], a[68:71], a[16:19], v[32:35]
  s_waitcnt lgkmcnt(8)
  v_exp_f32 v7, v7
  v_cvt_pk_bf16_f32 v106, v52, v53
  v_mfma_f32_16x16x32_bf16 v[32:35], a[72:75], a[32:35], v[32:35]
  s_waitcnt lgkmcnt(4)
  v_add_f32 v7, 1.0, v7
  v_rcp_f32 v7, v7
  v_mfma_f32_16x16x32_bf16 v[32:35], a[76:79], a[48:51], v[32:35]
  s_waitcnt lgkmcnt(3)
  v_exp_f32 v55, v55
  v_mul_f32 v25, v25, v7
  v_mfma_f32_16x16x32_bf16 v[36:39], a[80:83], a[0:3], v[64:67]
  s_waitcnt lgkmcnt(2)
  v_cvt_pk_bf16_f32 v6, v24, v25
  v_accvgpr_write_b32 a240, v6
  v_exp_f32 v56, v56
  v_mfma_f32_16x16x32_bf16 v[36:39], a[84:87], a[16:19], v[36:39]
  s_waitcnt lgkmcnt(1)
  ds_read_b64 v[18:19], v27 offset:4096
  v_cvt_pk_bf16_f32 v107, v54, v55
  v_mfma_f32_16x16x32_bf16 v[36:39], a[88:91], a[32:35], v[36:39]
  s_waitcnt lgkmcnt(1)
  ds_read_b64 v[20:21], v27 offset:20480
  ds_read_b64 v[22:23], v27 offset:36864
  v_mfma_f32_16x16x32_bf16 v[36:39], a[92:95], a[48:51], v[36:39]
  ds_read_b64 v[24:25], v27 offset:53248
  v_exp_f32 v57, v57
  v_mfma_f32_16x16x32_bf16 v[40:43], a[64:67], a[4:7], v[68:71]
  v_add_f32 v28, v28, v30
  v_add_f32 v4, v4, v2
  v_exp_f32 v58, v58
  v_mfma_f32_16x16x32_bf16 v[40:43], a[68:71], a[20:23], v[40:43]
  v_add_f32 v4, v4, v28
  v_add_f32 v4, v4, v1
  v_mfma_f32_16x16x32_bf16 v[40:43], a[72:75], a[36:39], v[40:43]
  v_cvt_pk_bf16_f32 v108, v56, v57
  v_mul_f32 v7, s44, v4
  v_mfma_f32_16x16x32_bf16 v[40:43], a[76:79], a[52:55], v[40:43]
  v_exp_f32 v7, v7
  v_exp_f32 v59, v59
  v_mfma_f32_16x16x32_bf16 v[44:47], a[80:83], a[4:7], v[68:71]
  v_add_f32 v7, 1.0, v7
  v_rcp_f32 v7, v7
  v_mfma_f32_16x16x32_bf16 v[44:47], a[84:87], a[20:23], v[44:47]
  v_exp_f32 v60, v60
  v_mul_f32 v4, v4, v7
  v_mfma_f32_16x16x32_bf16 v[44:47], a[88:91], a[36:39], v[44:47]
  v_add_f32 v29, v29, v31
  v_cvt_pk_bf16_f32 v109, v58, v59
  v_add_f32 v5, v5, v3
  v_mfma_f32_16x16x32_bf16 v[44:47], a[92:95], a[52:55], v[44:47]
  v_add_f32 v5, v5, v29
  v_add_f32 v5, v5, v1
  v_exp_f32 v61, v61
  v_mfma_f32_16x16x32_bf16 v[136:139], a[96:99], v[104:107], v[136:139]
  v_mul_f32 v7, s44, v5
  v_mfma_f32_16x16x32_bf16 v[152:155], a[100:103], v[104:107], v[152:155]
  v_exp_f32 v62, v62
  v_exp_f32 v7, v7
  v_mfma_f32_16x16x32_bf16 v[168:171], a[104:107], v[104:107], v[168:171]
  v_add_f32 v7, 1.0, v7
  v_cvt_pk_bf16_f32 v110, v60, v61
  v_mfma_f32_16x16x32_bf16 v[184:187], a[108:111], v[104:107], v[184:187]
  v_rcp_f32 v7, v7
  s_nop 0
  v_mul_f32 v5, v5, v7
  v_mfma_f32_16x16x32_bf16 v[200:203], a[112:115], v[104:107], v[200:203]
  v_exp_f32 v63, v63
  v_cvt_pk_bf16_f32 v6, v4, v5
  v_mfma_f32_16x16x32_bf16 v[216:219], a[116:119], v[104:107], v[216:219]
  ds_read_b64 v[28:29], v27 offset:4104
  v_accvgpr_write_b32 a241, v6
  v_cvt_pk_bf16_f32 v111, v62, v63
  v_mfma_f32_16x16x32_bf16 v[232:235], a[120:123], v[104:107], v[232:235]
  ds_read_b64 v[30:31], v27 offset:20488
  ds_read_b64 v[2:3], v27 offset:36872
  v_mfma_f32_16x16x32_bf16 v[248:251], a[124:127], v[104:107], v[248:251]
  ds_read_b64 v[4:5], v27 offset:53256
  v_exp_f32 v32, v32
  v_mfma_f32_16x16x32_bf16 v[88:91], v[112:115], v[104:107], v[88:91]
  s_waitcnt lgkmcnt(6)
  v_exp_f32 v33, v33
  v_add_f32 v18, v18, v20
  v_mfma_f32_16x16x32_bf16 v[140:143], a[96:99], v[108:111], v[140:143]
  s_waitcnt lgkmcnt(4)
  v_add_f32 v24, v24, v22
  v_add_f32 v24, v24, v18
  v_exp_f32 v34, v34
  v_mfma_f32_16x16x32_bf16 v[156:159], a[100:103], v[108:111], v[156:159]
  v_add_f32 v24, v24, v1
  v_mul_f32 v7, s44, v24
  v_mfma_f32_16x16x32_bf16 v[172:175], a[104:107], v[108:111], v[172:175]
  ds_read_b64_tr_b16 a[96:97], v120
  v_cvt_pk_bf16_f32 v96, v32, v33
  v_exp_f32 v7, v7
  v_mfma_f32_16x16x32_bf16 v[188:191], a[108:111], v[108:111], v[188:191]
  ds_read_b64_tr_b16 a[98:99], v120 offset:4096
  v_add_f32 v7, 1.0, v7
  v_exp_f32 v35, v35
  v_mfma_f32_16x16x32_bf16 v[204:207], a[112:115], v[108:111], v[204:207]
  v_rcp_f32 v7, v7
  s_nop 0
  v_mul_f32 v24, v24, v7
  v_mfma_f32_16x16x32_bf16 v[220:223], a[116:119], v[108:111], v[220:223]
  v_exp_f32 v36, v36
  v_add_f32 v19, v19, v21
  v_mfma_f32_16x16x32_bf16 v[236:239], a[120:123], v[108:111], v[236:239]
  ds_read_b64_tr_b16 a[100:101], v121
  v_add_f32 v25, v25, v23
  v_cvt_pk_bf16_f32 v97, v34, v35
  v_add_f32 v25, v25, v19
  v_mfma_f32_16x16x32_bf16 v[252:255], a[124:127], v[108:111], v[252:255]
  ds_read_b64_tr_b16 a[102:103], v121 offset:4096
  v_add_f32 v25, v25, v1
  v_exp_f32 v37, v37
  v_mfma_f32_16x16x32_bf16 v[92:95], v[112:115], v[108:111], v[92:95]
  ds_read_b64_tr_b16 a[104:105], v122
  v_mul_f32 v7, s44, v25
  v_exp_f32 v7, v7
  v_mfma_f32_16x16x32_bf16 v[48:51], a[64:67], a[8:11], v[72:75]
  ds_read_b64_tr_b16 a[106:107], v122 offset:4096
  v_exp_f32 v38, v38
  v_add_f32 v7, 1.0, v7
  v_mfma_f32_16x16x32_bf16 v[48:51], a[68:71], a[24:27], v[48:51]
  ds_read_b64_tr_b16 a[108:109], v123
  v_rcp_f32 v7, v7
  v_cvt_pk_bf16_f32 v98, v36, v37
  v_mfma_f32_16x16x32_bf16 v[48:51], a[72:75], a[40:43], v[48:51]
  ds_read_b64_tr_b16 a[110:111], v123 offset:4096
  v_mul_f32 v25, v25, v7
  v_cvt_pk_bf16_f32 v6, v24, v25
  v_mfma_f32_16x16x32_bf16 v[48:51], a[76:79], a[56:59], v[48:51]
  v_exp_f32 v39, v39
  v_accvgpr_write_b32 a242, v6
  v_mfma_f32_16x16x32_bf16 v[52:55], a[80:83], a[8:11], v[72:75]
  ds_read_b64_tr_b16 a[112:113], v124
  ds_read_b64 v[18:19], v27 offset:8192
  v_exp_f32 v40, v40
  v_mfma_f32_16x16x32_bf16 v[52:55], a[84:87], a[24:27], v[52:55]
  ds_read_b64 v[20:21], v27 offset:24576
  ds_read_b64_tr_b16 a[114:115], v124 offset:4096
  ds_read_b64 v[22:23], v27 offset:40960
  v_mfma_f32_16x16x32_bf16 v[52:55], a[88:91], a[40:43], v[52:55]
  s_waitcnt lgkmcnt(15)
  ds_read_b64 v[24:25], v27 offset:57344
  ds_read_b64_tr_b16 a[116:117], v125
  v_cvt_pk_bf16_f32 v99, v38, v39
  v_add_f32 v28, v28, v30
  v_mfma_f32_16x16x32_bf16 v[52:55], a[92:95], a[56:59], v[52:55]
  s_waitcnt lgkmcnt(15)
  ds_read_b64_tr_b16 a[118:119], v125 offset:4096
  v_add_f32 v4, v4, v2
  v_exp_f32 v41, v41
  v_mfma_f32_16x16x32_bf16 v[56:59], a[64:67], a[12:15], v[76:79]
  ds_read_b64_tr_b16 a[120:121], v126
  v_add_f32 v4, v4, v28
  v_add_f32 v4, v4, v1
  v_exp_f32 v42, v42
  v_mfma_f32_16x16x32_bf16 v[56:59], a[68:71], a[28:31], v[56:59]
  ds_read_b64_tr_b16 a[122:123], v126 offset:4096
  v_mul_f32 v7, s44, v4
  v_mfma_f32_16x16x32_bf16 v[56:59], a[72:75], a[44:47], v[56:59]
  ds_read_b64_tr_b16 a[124:125], v127
  v_exp_f32 v7, v7
  v_cvt_pk_bf16_f32 v100, v40, v41
  v_mfma_f32_16x16x32_bf16 v[56:59], a[76:79], a[60:63], v[56:59]
  ds_read_b64_tr_b16 a[126:127], v127 offset:4096
  v_add_f32 v7, 1.0, v7
  v_rcp_f32 v7, v7
  v_mfma_f32_16x16x32_bf16 v[60:63], a[80:83], a[12:15], v[76:79]
  v_exp_f32 v43, v43
  v_mul_f32 v4, v4, v7
  v_add_f32 v29, v29, v31
  v_mfma_f32_16x16x32_bf16 v[60:63], a[84:87], a[28:31], v[60:63]
  v_exp_f32 v44, v44
  v_add_f32 v5, v5, v3
  v_mfma_f32_16x16x32_bf16 v[60:63], a[88:91], a[44:47], v[60:63]
  v_add_f32 v5, v5, v29
  v_cvt_pk_bf16_f32 v101, v42, v43
  v_add_f32 v5, v5, v1
  v_mfma_f32_16x16x32_bf16 v[60:63], a[92:95], a[60:63], v[60:63]
  s_waitcnt lgkmcnt(15)
  ds_read_b128 a[64:67], v116 offset:8192
  v_mul_f32 v7, s44, v5
  v_exp_f32 v45, v45
  v_mfma_f32_16x16x32_bf16 v[128:131], a[96:99], v[96:99], v[128:131]
  v_exp_f32 v7, v7
  s_nop 0
  v_add_f32 v7, 1.0, v7
  v_mfma_f32_16x16x32_bf16 v[144:147], a[100:103], v[96:99], v[144:147]
  s_waitcnt lgkmcnt(15)
  v_exp_f32 v46, v46
  v_rcp_f32 v7, v7
  v_mfma_f32_16x16x32_bf16 v[160:163], a[104:107], v[96:99], v[160:163]
  s_waitcnt lgkmcnt(13)
  v_mul_f32 v5, v5, v7
  v_cvt_pk_bf16_f32 v102, v44, v45
  v_mfma_f32_16x16x32_bf16 v[176:179], a[108:111], v[96:99], v[176:179]
  s_waitcnt lgkmcnt(9)
  v_cvt_pk_bf16_f32 v6, v4, v5
  v_accvgpr_write_b32 a243, v6
  v_mfma_f32_16x16x32_bf16 v[192:195], a[112:115], v[96:99], v[192:195]
  s_waitcnt lgkmcnt(5)
  buffer_store_dwordx4 a[240:243], v26, s[16:19], s43 offen sc1
  s_add_u32 s43, s43, 4096
  v_exp_f32 v47, v47
  v_mfma_f32_16x16x32_bf16 v[208:211], a[116:119], v[96:99], v[208:211]
  s_waitcnt lgkmcnt(3)
  ds_read_b64 v[28:29], v27 offset:8200
  ds_read_b128 a[68:71], v117 offset:8192
  ds_read_b64 v[30:31], v27 offset:24584
  v_cvt_pk_bf16_f32 v103, v46, v47
  v_mfma_f32_16x16x32_bf16 v[224:227], a[120:123], v[96:99], v[224:227]
  s_waitcnt lgkmcnt(4)
  ds_read_b64 v[2:3], v27 offset:40968
  ds_read_b64 v[4:5], v27 offset:57352
  v_mfma_f32_16x16x32_bf16 v[240:243], a[124:127], v[96:99], v[240:243]
  ds_read_b128 a[72:75], v118 offset:8192
  v_exp_f32 v48, v48
  v_add_f32 v18, v18, v20
  v_mfma_f32_16x16x32_bf16 v[80:83], v[112:115], v[96:99], v[80:83]
  v_exp_f32 v49, v49
  v_add_f32 v24, v24, v22
  v_mfma_f32_16x16x32_bf16 v[132:135], a[96:99], v[100:103], v[132:135]
  ds_read_b128 a[76:79], v119 offset:8192
  v_add_f32 v24, v24, v18
  v_add_f32 v24, v24, v1
  v_exp_f32 v50, v50
  v_mfma_f32_16x16x32_bf16 v[148:151], a[100:103], v[100:103], v[148:151]
  v_mul_f32 v7, s44, v24
  v_cvt_pk_bf16_f32 v104, v48, v49
  v_mfma_f32_16x16x32_bf16 v[164:167], a[104:107], v[100:103], v[164:167]
  v_exp_f32 v7, v7
  s_nop 0
  v_add_f32 v7, 1.0, v7
  v_mfma_f32_16x16x32_bf16 v[180:183], a[108:111], v[100:103], v[180:183]
  ds_read_b128 a[80:83], v116 offset:12288
  ds_read_b128 a[84:87], v117 offset:12288
  v_rcp_f32 v7, v7
  v_mfma_f32_16x16x32_bf16 v[196:199], a[112:115], v[100:103], v[196:199]
  v_exp_f32 v51, v51
  v_mul_f32 v24, v24, v7
  v_add_f32 v19, v19, v21
  v_mfma_f32_16x16x32_bf16 v[212:215], a[116:119], v[100:103], v[212:215]
  v_exp_f32 v52, v52
  v_add_f32 v25, v25, v23
  v_mfma_f32_16x16x32_bf16 v[228:231], a[120:123], v[100:103], v[228:231]
  v_add_f32 v25, v25, v19
  v_cvt_pk_bf16_f32 v105, v50, v51
  v_add_f32 v25, v25, v1
  v_mfma_f32_16x16x32_bf16 v[244:247], a[124:127], v[100:103], v[244:247]
  ds_read_b128 a[88:91], v118 offset:12288
  v_mul_f32 v7, s44, v25
  v_exp_f32 v53, v53
  v_mfma_f32_16x16x32_bf16 v[84:87], v[112:115], v[100:103], v[84:87]
  s_waitcnt lgkmcnt(10)
  v_exp_f32 v7, v7
  s_nop 0
  v_add_f32 v7, 1.0, v7
  v_mfma_f32_16x16x32_bf16 v[32:35], a[64:67], a[0:3], v[64:67]
  s_waitcnt lgkmcnt(8)
  v_exp_f32 v54, v54
  v_rcp_f32 v7, v7
  v_mfma_f32_16x16x32_bf16 v[32:35], a[68:71], a[16:19], v[32:35]
  s_waitcnt lgkmcnt(4)
  ds_read_b128 a[92:95], v119 offset:12288
  v_mul_f32 v25, v25, v7
  v_cvt_pk_bf16_f32 v106, v52, v53
  v_mfma_f32_16x16x32_bf16 v[32:35], a[72:75], a[32:35], v[32:35]
  s_waitcnt lgkmcnt(4)
  v_cvt_pk_bf16_f32 v6, v24, v25
  v_accvgpr_write_b32 a244, v6
  v_mfma_f32_16x16x32_bf16 v[32:35], a[76:79], a[48:51], v[32:35]
  s_waitcnt lgkmcnt(3)
  ds_read_b64 v[18:19], v27 offset:12288
  v_exp_f32 v55, v55
  v_mfma_f32_16x16x32_bf16 v[36:39], a[80:83], a[0:3], v[64:67]
  s_waitcnt lgkmcnt(3)
  ds_read_b64 v[20:21], v27 offset:28672
  ds_read_b64 v[22:23], v27 offset:45056
  v_exp_f32 v56, v56
  v_mfma_f32_16x16x32_bf16 v[36:39], a[84:87], a[16:19], v[36:39]
  s_waitcnt lgkmcnt(4)
  ds_read_b64 v[24:25], v27 offset:61440
  v_cvt_pk_bf16_f32 v107, v54, v55
  v_mfma_f32_16x16x32_bf16 v[36:39], a[88:91], a[32:35], v[36:39]
  s_waitcnt lgkmcnt(4)
  v_add_f32 v28, v28, v30
  v_add_f32 v4, v4, v2
  v_mfma_f32_16x16x32_bf16 v[36:39], a[92:95], a[48:51], v[36:39]
  v_exp_f32 v57, v57
  v_add_f32 v4, v4, v28
  v_mfma_f32_16x16x32_bf16 v[40:43], a[64:67], a[4:7], v[68:71]
  v_add_f32 v4, v4, v1
  v_mul_f32 v7, s44, v4
  v_exp_f32 v58, v58
  v_mfma_f32_16x16x32_bf16 v[40:43], a[68:71], a[20:23], v[40:43]
  v_exp_f32 v7, v7
  v_mfma_f32_16x16x32_bf16 v[40:43], a[72:75], a[36:39], v[40:43]
  v_add_f32 v7, 1.0, v7
  v_cvt_pk_bf16_f32 v108, v56, v57
  v_rcp_f32 v7, v7
  v_mfma_f32_16x16x32_bf16 v[40:43], a[76:79], a[52:55], v[40:43]
  v_mul_f32 v4, v4, v7
  v_add_f32 v29, v29, v31
  v_exp_f32 v59, v59
  v_mfma_f32_16x16x32_bf16 v[44:47], a[80:83], a[4:7], v[68:71]
  v_add_f32 v5, v5, v3
  v_add_f32 v5, v5, v29
  v_mfma_f32_16x16x32_bf16 v[44:47], a[84:87], a[20:23], v[44:47]
  v_exp_f32 v60, v60
  v_mfma_f32_16x16x32_bf16 v[44:47], a[88:91], a[36:39], v[44:47]
  v_add_f32 v5, v5, v1
  v_cvt_pk_bf16_f32 v109, v58, v59
  v_mul_f32 v7, s44, v5
  v_mfma_f32_16x16x32_bf16 v[44:47], a[92:95], a[52:55], v[44:47]
  v_exp_f32 v7, v7
  v_exp_f32 v61, v61
  v_mfma_f32_16x16x32_bf16 v[136:139], a[96:99], v[104:107], v[136:139]
  v_add_f32 v7, 1.0, v7
  v_rcp_f32 v7, v7
  v_mfma_f32_16x16x32_bf16 v[152:155], a[100:103], v[104:107], v[152:155]
  v_exp_f32 v62, v62
  v_mul_f32 v5, v5, v7
  v_mfma_f32_16x16x32_bf16 v[168:171], a[104:107], v[104:107], v[168:171]
  v_cvt_pk_bf16_f32 v6, v4, v5
  v_cvt_pk_bf16_f32 v110, v60, v61
  v_mfma_f32_16x16x32_bf16 v[184:187], a[108:111], v[104:107], v[184:187]
  ds_read_b64 v[28:29], v27 offset:12296
  v_accvgpr_write_b32 a245, v6
  v_mfma_f32_16x16x32_bf16 v[200:203], a[112:115], v[104:107], v[200:203]
  ds_read_b64 v[30:31], v27 offset:28680
  v_exp_f32 v63, v63
  v_mfma_f32_16x16x32_bf16 v[216:219], a[116:119], v[104:107], v[216:219]
  ds_read_b64 v[2:3], v27 offset:45064
  ds_read_b64 v[4:5], v27 offset:61448
  v_cvt_pk_bf16_f32 v111, v62, v63
  v_mfma_f32_16x16x32_bf16 v[232:235], a[120:123], v[104:107], v[232:235]
  s_waitcnt lgkmcnt(4)
  s_waitcnt lgkmcnt(6)
  v_add_f32 v18, v18, v20
  v_add_f32 v24, v24, v22
  v_mfma_f32_16x16x32_bf16 v[248:251], a[124:127], v[104:107], v[248:251]
  v_exp_f32 v32, v32
  v_add_f32 v24, v24, v18
  v_mfma_f32_16x16x32_bf16 v[88:91], v[112:115], v[104:107], v[88:91]
  v_exp_f32 v33, v33
  v_add_f32 v24, v24, v1
  v_mfma_f32_16x16x32_bf16 v[140:143], a[96:99], v[108:111], v[140:143]
  v_mul_f32 v7, s44, v24
  v_exp_f32 v7, v7
  v_exp_f32 v34, v34
  v_mfma_f32_16x16x32_bf16 v[156:159], a[100:103], v[108:111], v[156:159]
  v_add_f32 v7, 1.0, v7
  v_cvt_pk_bf16_f32 v96, v32, v33
  v_mfma_f32_16x16x32_bf16 v[172:175], a[104:107], v[108:111], v[172:175]
  v_rcp_f32 v7, v7
  s_nop 0
  v_mul_f32 v24, v24, v7
  v_mfma_f32_16x16x32_bf16 v[188:191], a[108:111], v[108:111], v[188:191]
  ds_read_b64_tr_b16 a[96:97], v120 offset:8192
  v_add_f32 v19, v19, v21
  v_exp_f32 v35, v35
  v_mfma_f32_16x16x32_bf16 v[204:207], a[112:115], v[108:111], v[204:207]
  v_add_f32 v25, v25, v23
  v_add_f32 v25, v25, v19
  v_mfma_f32_16x16x32_bf16 v[220:223], a[116:119], v[108:111], v[220:223]
  ds_read_b64_tr_b16 a[98:99], v120 offset:12288
  v_add_f32 v25, v25, v1
  v_exp_f32 v36, v36
  v_mfma_f32_16x16x32_bf16 v[236:239], a[120:123], v[108:111], v[236:239]
  ds_read_b64_tr_b16 a[100:101], v121 offset:8192
  v_mul_f32 v7, s44, v25
  v_cvt_pk_bf16_f32 v97, v34, v35
  v_exp_f32 v7, v7
  v_mfma_f32_16x16x32_bf16 v[252:255], a[124:127], v[108:111], v[252:255]
  ds_read_b64_tr_b16 a[102:103], v121 offset:12288
  v_add_f32 v7, 1.0, v7
  v_mfma_f32_16x16x32_bf16 v[92:95], v[112:115], v[108:111], v[92:95]
  v_exp_f32 v37, v37
  v_rcp_f32 v7, v7
  v_mfma_f32_16x16x32_bf16 v[48:51], a[64:67], a[8:11], v[72:75]
  ds_read_b64_tr_b16 a[104:105], v122 offset:8192
  v_mul_f32 v25, v25, v7
  v_exp_f32 v38, v38
  v_mfma_f32_16x16x32_bf16 v[48:51], a[68:71], a[24:27], v[48:51]
  ds_read_b64_tr_b16 a[106:107], v122 offset:12288
  ds_read_b64_tr_b16 a[108:109], v123 offset:8192
  v_cvt_pk_bf16_f32 v6, v24, v25
  v_accvgpr_write_b32 a246, v6
  v_mfma_f32_16x16x32_bf16 v[48:51], a[72:75], a[40:43], v[48:51]
  s_waitcnt lgkmcnt(7)
  s_waitcnt lgkmcnt(9)
  ds_read_b64_tr_b16 a[110:111], v123 offset:12288
  v_cvt_pk_bf16_f32 v98, v36, v37
  v_add_f32 v28, v28, v30
  v_add_f32 v4, v4, v2
  v_mfma_f32_16x16x32_bf16 v[48:51], a[76:79], a[56:59], v[48:51]
  v_exp_f32 v39, v39
  v_add_f32 v4, v4, v28
  v_mfma_f32_16x16x32_bf16 v[52:55], a[80:83], a[8:11], v[72:75]
  ds_read_b64_tr_b16 a[112:113], v124 offset:8192
  v_add_f32 v4, v4, v1
  v_exp_f32 v40, v40
  v_mfma_f32_16x16x32_bf16 v[52:55], a[84:87], a[24:27], v[52:55]
  ds_read_b64_tr_b16 a[114:115], v124 offset:12288
  v_mul_f32 v7, s44, v4
  v_exp_f32 v7, v7
  v_mfma_f32_16x16x32_bf16 v[52:55], a[88:91], a[40:43], v[52:55]
  ds_read_b64_tr_b16 a[116:117], v125 offset:8192
  v_add_f32 v7, 1.0, v7
  v_cvt_pk_bf16_f32 v99, v38, v39
  v_rcp_f32 v7, v7
  v_mfma_f32_16x16x32_bf16 v[52:55], a[92:95], a[56:59], v[52:55]
  ds_read_b64_tr_b16 a[118:119], v125 offset:12288
  v_mul_f32 v4, v4, v7
  v_exp_f32 v41, v41
  v_mfma_f32_16x16x32_bf16 v[56:59], a[64:67], a[12:15], v[76:79]
  ds_read_b64_tr_b16 a[120:121], v126 offset:8192
  v_add_f32 v29, v29, v31
  v_add_f32 v5, v5, v3
  v_mfma_f32_16x16x32_bf16 v[56:59], a[68:71], a[28:31], v[56:59]
  ds_read_b64_tr_b16 a[122:123], v126 offset:12288
  v_exp_f32 v42, v42
  v_add_f32 v5, v5, v29
  v_mfma_f32_16x16x32_bf16 v[56:59], a[72:75], a[44:47], v[56:59]
  ds_read_b64_tr_b16 a[124:125], v127 offset:8192
  ds_read_b64_tr_b16 a[126:127], v127 offset:12288
  v_add_f32 v5, v5, v1
  v_cvt_pk_bf16_f32 v100, v40, v41
  v_mfma_f32_16x16x32_bf16 v[56:59], a[76:79], a[60:63], v[56:59]
  v_mul_f32 v7, s44, v5
  v_exp_f32 v7, v7
  v_exp_f32 v43, v43
  v_mfma_f32_16x16x32_bf16 v[60:63], a[80:83], a[12:15], v[76:79]
  v_add_f32 v7, 1.0, v7
  v_rcp_f32 v7, v7
  v_mfma_f32_16x16x32_bf16 v[60:63], a[84:87], a[28:31], v[60:63]
  v_exp_f32 v44, v44
  v_mul_f32 v5, v5, v7
  v_mfma_f32_16x16x32_bf16 v[60:63], a[88:91], a[44:47], v[60:63]
  v_cvt_pk_bf16_f32 v6, v4, v5
  v_cvt_pk_bf16_f32 v101, v42, v43
  v_accvgpr_write_b32 a247, v6
  v_mfma_f32_16x16x32_bf16 v[60:63], a[92:95], a[60:63], v[60:63]
  buffer_store_dwordx4 a[244:247], v26, s[16:19], s43 offen sc1
  s_add_u32 s43, s43, 4096
  v_exp_f32 v45, v45
  v_exp_f32 v46, v46
  s_waitcnt vmcnt(2) lgkmcnt(0)
  s_barrier
  v_mfma_f32_16x16x32_bf16 v[128:131], a[96:99], v[96:99], v[128:131]
  ds_read_b128 a[64:67], v116 offset:16384
  v_cvt_pk_bf16_f32 v102, v44, v45
  v_mfma_f32_16x16x32_bf16 v[144:147], a[100:103], v[96:99], v[144:147]
  v_exp_f32 v47, v47
  v_mfma_f32_16x16x32_bf16 v[160:163], a[104:107], v[96:99], v[160:163]
  ds_read_b128 a[68:71], v117 offset:16384
  v_cvt_pk_bf16_f32 v103, v46, v47
  v_mfma_f32_16x16x32_bf16 v[176:179], a[108:111], v[96:99], v[176:179]
  v_lshrrev_b32 v1, 4, v0
  v_and_b32 v2, 7, v0
  v_mfma_f32_16x16x32_bf16 v[192:195], a[112:115], v[96:99], v[192:195]
  s_lshl_b32 s3, s26, 16
  s_add_u32 s3, s3, 8388608
  s_mov_b32 s43, 1024
  v_lshlrev_b32 v2, 21, v2
  v_and_b32 v2, 15, v0
  v_mfma_f32_16x16x32_bf16 v[208:211], a[116:119], v[96:99], v[208:211]
  buffer_load_dword a201, v2, s[16:19], s3 offen sc1
  s_lshl_b32 s3, s26, 16
  s_add_u32 s3, s3, 6291456
  v_mov_b32 v3, 0
  v_mfma_f32_16x16x32_bf16 v[224:227], a[120:123], v[96:99], v[224:227]
  v_exp_f32 v48, v48
  v_mfma_f32_16x16x32_bf16 v[240:243], a[124:127], v[96:99], v[240:243]
  s_mov_b32 s48, s100
  s_mov_b32 s49, s101
  s_mov_b32 s50, 2097152
  s_mov_b32 s51, 131072
  buffer_load_dword a202, v3, s[16:19], s3 offen sc1
  s_lshl_b32 s3, s26, 16
  v_add_u32 v3, 0, v1
  v_mfma_f32_16x16x32_bf16 v[80:83], v[112:115], v[96:99], v[80:83]
  ds_read_b128 a[72:75], v118 offset:16384
  v_lshlrev_b32 v3, 1, v3
  v_exp_f32 v49, v49
  v_mfma_f32_16x16x32_bf16 v[132:135], a[96:99], v[100:103], v[132:135]
  buffer_load_dword a203, v3, s[48:51], s3 offen
  v_xor_b32 v3, v3, v2
  v_mfma_f32_16x16x32_bf16 v[148:151], a[100:103], v[100:103], v[148:151]
  ds_read_b128 a[76:79], v119 offset:16384
  v_lshlrev_b32 v3, 4, v3
  v_exp_f32 v50, v50
  v_mfma_f32_16x16x32_bf16 v[164:167], a[104:107], v[100:103], v[164:167]
  v_mul_lo_u32 v14, v1, s43
  v_cvt_pk_bf16_f32 v104, v48, v49
  v_add_u32 v14, v14, v3
  v_mfma_f32_16x16x32_bf16 v[180:183], a[108:111], v[100:103], v[180:183]
  ds_read_b128 a[80:83], v116 offset:20480
  v_add_u32 v3, 4, v1
  v_exp_f32 v51, v51
  v_mfma_f32_16x16x32_bf16 v[196:199], a[112:115], v[100:103], v[196:199]
  v_lshlrev_b32 v3, 1, v3
  v_xor_b32 v3, v3, v2
  v_mfma_f32_16x16x32_bf16 v[212:215], a[116:119], v[100:103], v[212:215]
  ds_read_b128 a[84:87], v117 offset:20480
  v_exp_f32 v52, v52
  v_mfma_f32_16x16x32_bf16 v[228:231], a[120:123], v[100:103], v[228:231]
  v_lshlrev_b32 v3, 4, v3
  v_cvt_pk_bf16_f32 v105, v50, v51
  v_mul_lo_u32 v15, v1, s43
  v_mfma_f32_16x16x32_bf16 v[244:247], a[124:127], v[100:103], v[244:247]
  ds_read_b128 a[88:91], v118 offset:20480
  v_add_u32 v15, v15, v3
  v_exp_f32 v53, v53
  v_mfma_f32_16x16x32_bf16 v[84:87], v[112:115], v[100:103], v[84:87]
  s_waitcnt lgkmcnt(6)
  v_add_u32 v15, 3072, v15
  v_add_u32 v3, 0, v1
  v_mfma_f32_16x16x32_bf16 v[32:35], a[64:67], a[0:3], v[64:67]
  s_waitcnt lgkmcnt(5)
  ds_read_b128 a[92:95], v119 offset:20480
  v_exp_f32 v54, v54
  v_mfma_f32_16x16x32_bf16 v[32:35], a[68:71], a[16:19], v[32:35]
  s_waitcnt lgkmcnt(5)
  v_lshlrev_b32 v3, 1, v3
  v_cvt_pk_bf16_f32 v106, v52, v53
  v_mfma_f32_16x16x32_bf16 v[32:35], a[72:75], a[32:35], v[32:35]
  s_waitcnt lgkmcnt(4)
  v_xor_b32 v3, v3, v2
  v_lshlrev_b32 v3, 4, v3
  v_mfma_f32_16x16x32_bf16 v[32:35], a[76:79], a[48:51], v[32:35]
  s_waitcnt lgkmcnt(3)
  v_exp_f32 v55, v55
  v_mul_lo_u32 v16, v1, s43
  v_mfma_f32_16x16x32_bf16 v[36:39], a[80:83], a[0:3], v[64:67]
  s_waitcnt lgkmcnt(2)
  v_exp_f32 v56, v56
  v_add_u32 v16, v16, v3
  v_mfma_f32_16x16x32_bf16 v[36:39], a[84:87], a[16:19], v[36:39]
  s_waitcnt lgkmcnt(1)
  v_add_u32 v16, 6144, v16
  v_cvt_pk_bf16_f32 v107, v54, v55
  v_mfma_f32_16x16x32_bf16 v[36:39], a[88:91], a[32:35], v[36:39]
  s_waitcnt lgkmcnt(0)
  v_add_u32 v3, 4, v1
  v_lshlrev_b32 v3, 1, v3
  v_mfma_f32_16x16x32_bf16 v[36:39], a[92:95], a[48:51], v[36:39]
  v_exp_f32 v57, v57
  v_xor_b32 v3, v3, v2
  v_mfma_f32_16x16x32_bf16 v[40:43], a[64:67], a[4:7], v[68:71]
  v_lshlrev_b32 v3, 4, v3
  v_mul_lo_u32 v17, v1, s43
  v_exp_f32 v58, v58
  v_mfma_f32_16x16x32_bf16 v[40:43], a[68:71], a[20:23], v[40:43]
  v_cvt_pk_bf16_f32 v108, v56, v57
  v_add_u32 v17, v17, v3
  v_mfma_f32_16x16x32_bf16 v[40:43], a[72:75], a[36:39], v[40:43]
  s_lshl_b32 s42, s25, 19
  s_lshl_b32 s43, s24, 8
  s_add_u32 s42, s42, s43
  s_lshl_b32 s7, s24, 13
  s_add_u32 s7, s7, 65536
  v_add_u32 v17, 9216, v17
  v_mfma_f32_16x16x32_bf16 v[40:43], a[76:79], a[52:55], v[40:43]
  v_exp_f32 v59, v59
  v_mfma_f32_16x16x32_bf16 v[44:47], a[80:83], a[4:7], v[68:71]
  v_exp_f32 v60, v60
  v_mfma_f32_16x16x32_bf16 v[44:47], a[84:87], a[20:23], v[44:47]
  v_cvt_pk_bf16_f32 v109, v58, v59
  v_mfma_f32_16x16x32_bf16 v[44:47], a[88:91], a[36:39], v[44:47]
  v_exp_f32 v61, v61
  v_mfma_f32_16x16x32_bf16 v[44:47], a[92:95], a[52:55], v[44:47]
  s_add_u32 m0, s27, 0
  v_exp_f32 v62, v62
  v_mfma_f32_16x16x32_bf16 v[136:139], a[96:99], v[104:107], v[136:139]
  buffer_load_dwordx4 v14, s[32:35], s42 offen lds
  v_mfma_f32_16x16x32_bf16 v[152:155], a[100:103], v[104:107], v[152:155]
  v_cvt_pk_bf16_f32 v110, v60, v61
  v_mfma_f32_16x16x32_bf16 v[168:171], a[104:107], v[104:107], v[168:171]
  v_exp_f32 v63, v63
  v_mfma_f32_16x16x32_bf16 v[184:187], a[108:111], v[104:107], v[184:187]
  v_cvt_pk_bf16_f32 v111, v62, v63
  v_mfma_f32_16x16x32_bf16 v[200:203], a[112:115], v[104:107], v[200:203]
  v_exp_f32 v32, v32
  v_mfma_f32_16x16x32_bf16 v[216:219], a[116:119], v[104:107], v[216:219]
  buffer_load_dwordx4 v15, s[32:35], s42 offen offset:1024 lds
  v_mfma_f32_16x16x32_bf16 v[232:235], a[120:123], v[104:107], v[232:235]
  v_exp_f32 v33, v33
  v_mfma_f32_16x16x32_bf16 v[248:251], a[124:127], v[104:107], v[248:251]
  v_exp_f32 v34, v34
  v_mfma_f32_16x16x32_bf16 v[88:91], v[112:115], v[104:107], v[88:91]
  v_cvt_pk_bf16_f32 v96, v32, v33
  v_mfma_f32_16x16x32_bf16 v[140:143], a[96:99], v[108:111], v[140:143]
  v_exp_f32 v35, v35
  v_mfma_f32_16x16x32_bf16 v[156:159], a[100:103], v[108:111], v[156:159]
  ds_read_b64_tr_b16 a[96:97], v120 offset:16384
  ds_read_b64_tr_b16 a[98:99], v120 offset:20480
  v_mfma_f32_16x16x32_bf16 v[172:175], a[104:107], v[108:111], v[172:175]
  buffer_load_dwordx4 v16, s[32:35], s42 offen offset:2048 lds
  v_mfma_f32_16x16x32_bf16 v[188:191], a[108:111], v[108:111], v[188:191]
  v_exp_f32 v36, v36
  v_mfma_f32_16x16x32_bf16 v[204:207], a[112:115], v[108:111], v[204:207]
  ds_read_b64_tr_b16 a[100:101], v121 offset:16384
  v_cvt_pk_bf16_f32 v97, v34, v35
  v_mfma_f32_16x16x32_bf16 v[220:223], a[116:119], v[108:111], v[220:223]
  ds_read_b64_tr_b16 a[102:103], v121 offset:20480
  ds_read_b64_tr_b16 a[104:105], v122 offset:16384
  v_mfma_f32_16x16x32_bf16 v[236:239], a[120:123], v[108:111], v[236:239]
  v_exp_f32 v37, v37
  v_mfma_f32_16x16x32_bf16 v[252:255], a[124:127], v[108:111], v[252:255]
  v_exp_f32 v38, v38
  v_mfma_f32_16x16x32_bf16 v[92:95], v[112:115], v[108:111], v[92:95]
  buffer_load_dwordx4 v17, s[32:35], s42 offen offset:3072 lds
  v_mfma_f32_16x16x32_bf16 v[48:51], a[64:67], a[8:11], v[72:75]
  ds_read_b64_tr_b16 a[106:107], v122 offset:20480
  v_cvt_pk_bf16_f32 v98, v36, v37
  v_mfma_f32_16x16x32_bf16 v[48:51], a[68:71], a[24:27], v[48:51]
  ds_read_b64_tr_b16 a[108:109], v123 offset:16384
  ds_read_b64_tr_b16 a[110:111], v123 offset:20480
  v_mfma_f32_16x16x32_bf16 v[48:51], a[72:75], a[40:43], v[48:51]
  v_exp_f32 v39, v39
  v_mfma_f32_16x16x32_bf16 v[48:51], a[76:79], a[56:59], v[48:51]
  ds_read_b64_tr_b16 a[112:113], v124 offset:16384
  ds_read_b64_tr_b16 a[114:115], v124 offset:20480
  v_mfma_f32_16x16x32_bf16 v[52:55], a[80:83], a[8:11], v[72:75]
  s_add_u32 s42, s42, 16384
  s_add_u32 m0, s27, 4096
  v_exp_f32 v40, v40
  v_mfma_f32_16x16x32_bf16 v[52:55], a[84:87], a[24:27], v[52:55]
  buffer_load_dwordx4 v14, s[32:35], s42 offen lds
  v_mfma_f32_16x16x32_bf16 v[52:55], a[88:91], a[40:43], v[52:55]
  ds_read_b64_tr_b16 a[116:117], v125 offset:16384
  v_cvt_pk_bf16_f32 v99, v38, v39
  v_mfma_f32_16x16x32_bf16 v[52:55], a[92:95], a[56:59], v[52:55]
  ds_read_b64_tr_b16 a[118:119], v125 offset:20480
  ds_read_b64_tr_b16 a[120:121], v126 offset:16384
  v_exp_f32 v41, v41
  v_mfma_f32_16x16x32_bf16 v[56:59], a[64:67], a[12:15], v[76:79]
  v_exp_f32 v42, v42
  v_mfma_f32_16x16x32_bf16 v[56:59], a[68:71], a[28:31], v[56:59]
  ds_read_b64_tr_b16 a[122:123], v126 offset:20480
  v_cvt_pk_bf16_f32 v100, v40, v41
  v_mfma_f32_16x16x32_bf16 v[56:59], a[72:75], a[44:47], v[56:59]
  ds_read_b64_tr_b16 a[124:125], v127 offset:16384
  ds_read_b64_tr_b16 a[126:127], v127 offset:20480
  v_mfma_f32_16x16x32_bf16 v[56:59], a[76:79], a[60:63], v[56:59]
  buffer_load_dwordx4 v15, s[32:35], s42 offen offset:1024 lds
  v_mfma_f32_16x16x32_bf16 v[60:63], a[80:83], a[12:15], v[76:79]
  v_exp_f32 v43, v43
  v_mfma_f32_16x16x32_bf16 v[60:63], a[84:87], a[28:31], v[60:63]
  v_exp_f32 v44, v44
  v_mfma_f32_16x16x32_bf16 v[60:63], a[88:91], a[44:47], v[60:63]
  v_cvt_pk_bf16_f32 v101, v42, v43
  v_mfma_f32_16x16x32_bf16 v[60:63], a[92:95], a[60:63], v[60:63]
  s_waitcnt lgkmcnt(14)
  v_exp_f32 v45, v45
  v_mfma_f32_16x16x32_bf16 v[128:131], a[96:99], v[96:99], v[128:131]
  s_waitcnt lgkmcnt(12)
  v_exp_f32 v46, v46
  v_mfma_f32_16x16x32_bf16 v[144:147], a[100:103], v[96:99], v[144:147]
  s_waitcnt lgkmcnt(10)
  buffer_load_dwordx4 v16, s[32:35], s42 offen offset:2048 lds
  v_mfma_f32_16x16x32_bf16 v[160:163], a[104:107], v[96:99], v[160:163]
  s_waitcnt lgkmcnt(8)
  ds_read_b128 a[64:67], v116 offset:24576
  v_cvt_pk_bf16_f32 v102, v44, v45
  v_mfma_f32_16x16x32_bf16 v[176:179], a[108:111], v[96:99], v[176:179]
  s_waitcnt lgkmcnt(7)
  v_exp_f32 v47, v47
  v_mfma_f32_16x16x32_bf16 v[192:195], a[112:115], v[96:99], v[192:195]
  s_waitcnt lgkmcnt(5)
  ds_read_b128 a[68:71], v117 offset:24576
  v_cvt_pk_bf16_f32 v103, v46, v47
  v_mfma_f32_16x16x32_bf16 v[208:211], a[116:119], v[96:99], v[208:211]
  s_waitcnt lgkmcnt(4)
  v_exp_f32 v48, v48
  v_mfma_f32_16x16x32_bf16 v[224:227], a[120:123], v[96:99], v[224:227]
  s_waitcnt lgkmcnt(2)
  ds_read_b128 a[72:75], v118 offset:24576
  ds_read_b128 a[76:79], v119 offset:24576
  v_mfma_f32_16x16x32_bf16 v[240:243], a[124:127], v[96:99], v[240:243]
  buffer_load_dwordx4 v17, s[32:35], s42 offen offset:3072 lds
  v_mfma_f32_16x16x32_bf16 v[80:83], v[112:115], v[96:99], v[80:83]
  v_exp_f32 v49, v49
  v_mfma_f32_16x16x32_bf16 v[132:135], a[96:99], v[100:103], v[132:135]
  v_exp_f32 v50, v50
  v_mfma_f32_16x16x32_bf16 v[148:151], a[100:103], v[100:103], v[148:151]
  ds_read_b128 a[80:83], v116 offset:28672
  v_cvt_pk_bf16_f32 v104, v48, v49
  v_mfma_f32_16x16x32_bf16 v[164:167], a[104:107], v[100:103], v[164:167]
  v_exp_f32 v51, v51
  v_mfma_f32_16x16x32_bf16 v[180:183], a[108:111], v[100:103], v[180:183]
  s_add_u32 s42, s42, 16384
  s_add_u32 m0, s27, 8192
  v_exp_f32 v52, v52
  v_mfma_f32_16x16x32_bf16 v[196:199], a[112:115], v[100:103], v[196:199]
  buffer_load_dwordx4 v14, s[32:35], s42 offen lds
  v_mfma_f32_16x16x32_bf16 v[212:215], a[116:119], v[100:103], v[212:215]
  ds_read_b128 a[84:87], v117 offset:28672
  v_cvt_pk_bf16_f32 v105, v50, v51
  v_mfma_f32_16x16x32_bf16 v[228:231], a[120:123], v[100:103], v[228:231]
  ds_read_b128 a[88:91], v118 offset:28672
  ds_read_b128 a[92:95], v119 offset:28672
  v_mfma_f32_16x16x32_bf16 v[244:247], a[124:127], v[100:103], v[244:247]
  v_exp_f32 v53, v53
  v_mfma_f32_16x16x32_bf16 v[84:87], v[112:115], v[100:103], v[84:87]
  s_waitcnt lgkmcnt(7)
  v_exp_f32 v54, v54
  v_mfma_f32_16x16x32_bf16 v[32:35], a[64:67], a[0:3], v[64:67]
  s_waitcnt lgkmcnt(6)
  v_cvt_pk_bf16_f32 v106, v52, v53
  v_mfma_f32_16x16x32_bf16 v[32:35], a[68:71], a[16:19], v[32:35]
  s_waitcnt lgkmcnt(5)
  buffer_load_dwordx4 v15, s[32:35], s42 offen offset:1024 lds
  v_mfma_f32_16x16x32_bf16 v[32:35], a[72:75], a[32:35], v[32:35]
  s_waitcnt lgkmcnt(4)
  v_exp_f32 v55, v55
  v_mfma_f32_16x16x32_bf16 v[32:35], a[76:79], a[48:51], v[32:35]
  s_waitcnt lgkmcnt(3)
  v_exp_f32 v56, v56
  v_mfma_f32_16x16x32_bf16 v[36:39], a[80:83], a[0:3], v[64:67]
  s_waitcnt lgkmcnt(2)
  v_cvt_pk_bf16_f32 v107, v54, v55
  v_mfma_f32_16x16x32_bf16 v[36:39], a[84:87], a[16:19], v[36:39]
  s_waitcnt lgkmcnt(1)
  v_exp_f32 v57, v57
  v_mfma_f32_16x16x32_bf16 v[36:39], a[88:91], a[32:35], v[36:39]
  s_waitcnt lgkmcnt(0)
  v_exp_f32 v58, v58
  v_mfma_f32_16x16x32_bf16 v[36:39], a[92:95], a[48:51], v[36:39]
  buffer_load_dwordx4 v16, s[32:35], s42 offen offset:2048 lds
  v_mfma_f32_16x16x32_bf16 v[40:43], a[64:67], a[4:7], v[68:71]
  v_cvt_pk_bf16_f32 v108, v56, v57
  v_mfma_f32_16x16x32_bf16 v[40:43], a[68:71], a[20:23], v[40:43]
  v_exp_f32 v59, v59
  v_mfma_f32_16x16x32_bf16 v[40:43], a[72:75], a[36:39], v[40:43]
  v_exp_f32 v60, v60
  v_mfma_f32_16x16x32_bf16 v[40:43], a[76:79], a[52:55], v[40:43]
  v_cvt_pk_bf16_f32 v109, v58, v59
  v_mfma_f32_16x16x32_bf16 v[44:47], a[80:83], a[4:7], v[68:71]
  v_exp_f32 v61, v61
  v_mfma_f32_16x16x32_bf16 v[44:47], a[84:87], a[20:23], v[44:47]
  buffer_load_dwordx4 v17, s[32:35], s42 offen offset:3072 lds
  v_mfma_f32_16x16x32_bf16 v[44:47], a[88:91], a[36:39], v[44:47]
  v_exp_f32 v62, v62
  v_mfma_f32_16x16x32_bf16 v[44:47], a[92:95], a[52:55], v[44:47]
  v_cvt_pk_bf16_f32 v110, v60, v61
  v_mfma_f32_16x16x32_bf16 v[136:139], a[96:99], v[104:107], v[136:139]
  v_exp_f32 v63, v63
  v_mfma_f32_16x16x32_bf16 v[152:155], a[100:103], v[104:107], v[152:155]
  s_add_u32 s42, s42, 16384
  v_cvt_pk_bf16_f32 v111, v62, v63
  v_mfma_f32_16x16x32_bf16 v[168:171], a[104:107], v[104:107], v[168:171]
  s_add_u32 m0, s27, 12288
  v_mfma_f32_16x16x32_bf16 v[184:187], a[108:111], v[104:107], v[184:187]
  buffer_load_dwordx4 v14, s[32:35], s42 offen lds
  v_mfma_f32_16x16x32_bf16 v[200:203], a[112:115], v[104:107], v[200:203]
  v_exp_f32 v32, v32
  v_mfma_f32_16x16x32_bf16 v[216:219], a[116:119], v[104:107], v[216:219]
  v_exp_f32 v33, v33
  v_mfma_f32_16x16x32_bf16 v[232:235], a[120:123], v[104:107], v[232:235]
  v_exp_f32 v34, v34
  v_mfma_f32_16x16x32_bf16 v[248:251], a[124:127], v[104:107], v[248:251]
  v_cvt_pk_bf16_f32 v96, v32, v33
  v_mfma_f32_16x16x32_bf16 v[88:91], v[112:115], v[104:107], v[88:91]
  v_exp_f32 v35, v35
  v_mfma_f32_16x16x32_bf16 v[140:143], a[96:99], v[108:111], v[140:143]
  buffer_load_dwordx4 v15, s[32:35], s42 offen offset:1024 lds
  v_mfma_f32_16x16x32_bf16 v[156:159], a[100:103], v[108:111], v[156:159]
  ds_read_b64_tr_b16 a[96:97], v120 offset:24576
  ds_read_b64_tr_b16 a[98:99], v120 offset:28672
  v_mfma_f32_16x16x32_bf16 v[172:175], a[104:107], v[108:111], v[172:175]
  v_exp_f32 v36, v36
  v_mfma_f32_16x16x32_bf16 v[188:191], a[108:111], v[108:111], v[188:191]
  ds_read_b64_tr_b16 a[100:101], v121 offset:24576
  v_cvt_pk_bf16_f32 v97, v34, v35
  v_mfma_f32_16x16x32_bf16 v[204:207], a[112:115], v[108:111], v[204:207]
  ds_read_b64_tr_b16 a[102:103], v121 offset:28672
  ds_read_b64_tr_b16 a[104:105], v122 offset:24576
  v_mfma_f32_16x16x32_bf16 v[220:223], a[116:119], v[108:111], v[220:223]
  v_exp_f32 v37, v37
  v_mfma_f32_16x16x32_bf16 v[236:239], a[120:123], v[108:111], v[236:239]
  buffer_load_dwordx4 v16, s[32:35], s42 offen offset:2048 lds
  v_mfma_f32_16x16x32_bf16 v[252:255], a[124:127], v[108:111], v[252:255]
  v_exp_f32 v38, v38
  v_mfma_f32_16x16x32_bf16 v[92:95], v[112:115], v[108:111], v[92:95]
  ds_read_b64_tr_b16 a[106:107], v122 offset:28672
  ds_read_b64_tr_b16 a[108:109], v123 offset:24576
  v_mfma_f32_16x16x32_bf16 v[48:51], a[64:67], a[8:11], v[72:75]
  ds_read_b64_tr_b16 a[110:111], v123 offset:28672
  v_cvt_pk_bf16_f32 v98, v36, v37
  v_mfma_f32_16x16x32_bf16 v[48:51], a[68:71], a[24:27], v[48:51]
  v_exp_f32 v39, v39
  v_mfma_f32_16x16x32_bf16 v[48:51], a[72:75], a[40:43], v[48:51]
  ds_read_b64_tr_b16 a[112:113], v124 offset:24576
  ds_read_b64_tr_b16 a[114:115], v124 offset:28672
  v_mfma_f32_16x16x32_bf16 v[48:51], a[76:79], a[56:59], v[48:51]
  buffer_load_dwordx4 v17, s[32:35], s42 offen offset:3072 lds
  v_mfma_f32_16x16x32_bf16 v[52:55], a[80:83], a[8:11], v[72:75]
  v_exp_f32 v40, v40
  v_mfma_f32_16x16x32_bf16 v[52:55], a[84:87], a[24:27], v[52:55]
  ds_read_b64_tr_b16 a[116:117], v125 offset:24576
  v_cvt_pk_bf16_f32 v99, v38, v39
  v_mfma_f32_16x16x32_bf16 v[52:55], a[88:91], a[40:43], v[52:55]
  ds_read_b64_tr_b16 a[118:119], v125 offset:28672
  ds_read_b64_tr_b16 a[120:121], v126 offset:24576
  v_mfma_f32_16x16x32_bf16 v[52:55], a[92:95], a[56:59], v[52:55]
  s_add_u32 s42, s42, 16384
  v_exp_f32 v41, v41
  v_mfma_f32_16x16x32_bf16 v[56:59], a[64:67], a[12:15], v[76:79]
  v_exp_f32 v42, v42
  v_mfma_f32_16x16x32_bf16 v[56:59], a[68:71], a[28:31], v[56:59]
  ds_read_b64_tr_b16 a[122:123], v126 offset:28672
  v_cvt_pk_bf16_f32 v100, v40, v41
  v_mfma_f32_16x16x32_bf16 v[56:59], a[72:75], a[44:47], v[56:59]
  ds_read_b64_tr_b16 a[124:125], v127 offset:24576
  ds_read_b64_tr_b16 a[126:127], v127 offset:28672
  v_mfma_f32_16x16x32_bf16 v[56:59], a[76:79], a[60:63], v[56:59]
  v_exp_f32 v43, v43
  v_mfma_f32_16x16x32_bf16 v[60:63], a[80:83], a[12:15], v[76:79]
  v_exp_f32 v44, v44
  v_mfma_f32_16x16x32_bf16 v[60:63], a[84:87], a[28:31], v[60:63]
  v_cvt_pk_bf16_f32 v101, v42, v43
  v_mfma_f32_16x16x32_bf16 v[60:63], a[88:91], a[44:47], v[60:63]
  v_exp_f32 v45, v45
  v_mfma_f32_16x16x32_bf16 v[60:63], a[92:95], a[60:63], v[60:63]
  v_exp_f32 v46, v46
  s_waitcnt vmcnt(19) lgkmcnt(0)
  s_barrier
  s_mov_b32 s6, 0
  v_mov_b32 v4, 1
  v_lshlrev_b32 v5, 25, v0
  s_add_u32 s44, s46, 32
  s_lshl_b32 s44, s44, 8
  s_add_u32 s44, s44, 6160384
  s_cmp_eq_u32 s24, 0
  s_cselect_b32 s44, s44, 33554432
  buffer_atomic_add v4, v5, s[16:19], s44 offen sc1
  s_load_dwordx2 s[96:97], s[0:1], 0
  s_load_dwordx2 s[98:99], s[0:1], 80
  s_add_u32 m0, s7, 0
  s_nop 0
  buffer_load_dwordx4 v14, s[32:35], s42 offen lds
  buffer_load_dwordx4 v15, s[32:35], s42 offen offset:1024 lds
  buffer_load_dwordx4 v16, s[32:35], s42 offen offset:2048 lds
  buffer_load_dwordx4 v17, s[32:35], s42 offen offset:3072 lds
  s_add_u32 s42, s42, 16384
  s_add_u32 m0, s7, 4096
  s_nop 0
  buffer_load_dwordx4 v14, s[32:35], s42 offen lds
  buffer_load_dwordx4 v15, s[32:35], s42 offen offset:1024 lds
  buffer_load_dwordx4 v16, s[32:35], s42 offen offset:2048 lds
  buffer_load_dwordx4 v17, s[32:35], s42 offen offset:3072 lds
  s_add_u32 s42, s42, 16384
  v_mfma_f32_16x16x32_bf16 v[128:131], a[96:99], v[96:99], v[128:131]
  v_cvt_pk_bf16_f32 v102, v44, v45
  v_mfma_f32_16x16x32_bf16 v[144:147], a[100:103], v[96:99], v[144:147]
  v_exp_f32 v47, v47
  v_mfma_f32_16x16x32_bf16 v[160:163], a[104:107], v[96:99], v[160:163]
  v_cvt_pk_bf16_f32 v103, v46, v47
  v_mfma_f32_16x16x32_bf16 v[176:179], a[108:111], v[96:99], v[176:179]
  v_mfma_f32_16x16x32_bf16 v[192:195], a[112:115], v[96:99], v[192:195]
  v_exp_f32 v48, v48
  v_mfma_f32_16x16x32_bf16 v[208:211], a[116:119], v[96:99], v[208:211]
  v_exp_f32 v49, v49
  v_mfma_f32_16x16x32_bf16 v[224:227], a[120:123], v[96:99], v[224:227]
  v_exp_f32 v50, v50
  v_mfma_f32_16x16x32_bf16 v[240:243], a[124:127], v[96:99], v[240:243]
  v_cvt_pk_bf16_f32 v104, v48, v49
  v_mfma_f32_16x16x32_bf16 v[80:83], v[112:115], v[96:99], v[80:83]
  v_exp_f32 v51, v51
  v_mfma_f32_16x16x32_bf16 v[132:135], a[96:99], v[100:103], v[132:135]
  v_exp_f32 v52, v52
  v_mfma_f32_16x16x32_bf16 v[148:151], a[100:103], v[100:103], v[148:151]
  v_mfma_f32_16x16x32_bf16 v[164:167], a[104:107], v[100:103], v[164:167]
  v_cvt_pk_bf16_f32 v105, v50, v51
  v_mfma_f32_16x16x32_bf16 v[180:183], a[108:111], v[100:103], v[180:183]
  v_exp_f32 v53, v53
  v_mfma_f32_16x16x32_bf16 v[196:199], a[112:115], v[100:103], v[196:199]
  v_exp_f32 v54, v54
  v_mfma_f32_16x16x32_bf16 v[212:215], a[116:119], v[100:103], v[212:215]
  v_mfma_f32_16x16x32_bf16 v[228:231], a[120:123], v[100:103], v[228:231]
  v_cvt_pk_bf16_f32 v106, v52, v53
  v_mfma_f32_16x16x32_bf16 v[244:247], a[124:127], v[100:103], v[244:247]
  v_exp_f32 v55, v55
  v_mfma_f32_16x16x32_bf16 v[84:87], v[112:115], v[100:103], v[84:87]
  v_exp_f32 v56, v56
  v_cvt_pk_bf16_f32 v107, v54, v55
  v_exp_f32 v57, v57
  v_exp_f32 v58, v58
  v_cvt_pk_bf16_f32 v108, v56, v57
  v_exp_f32 v59, v59
  v_exp_f32 v60, v60
  v_cvt_pk_bf16_f32 v109, v58, v59
  v_exp_f32 v61, v61
  v_exp_f32 v62, v62
  v_cvt_pk_bf16_f32 v110, v60, v61
  v_exp_f32 v63, v63
  v_mfma_f32_16x16x32_bf16 v[136:139], a[96:99], v[104:107], v[136:139]
  v_mfma_f32_16x16x32_bf16 v[152:155], a[100:103], v[104:107], v[152:155]
  v_cvt_pk_bf16_f32 v111, v62, v63
  v_mfma_f32_16x16x32_bf16 v[168:171], a[104:107], v[104:107], v[168:171]
  v_mfma_f32_16x16x32_bf16 v[184:187], a[108:111], v[104:107], v[184:187]
  v_mfma_f32_16x16x32_bf16 v[200:203], a[112:115], v[104:107], v[200:203]
  v_mfma_f32_16x16x32_bf16 v[216:219], a[116:119], v[104:107], v[216:219]
  v_mfma_f32_16x16x32_bf16 v[232:235], a[120:123], v[104:107], v[232:235]
  v_mfma_f32_16x16x32_bf16 v[248:251], a[124:127], v[104:107], v[248:251]
  v_mfma_f32_16x16x32_bf16 v[88:91], v[112:115], v[104:107], v[88:91]
  v_mfma_f32_16x16x32_bf16 v[140:143], a[96:99], v[108:111], v[140:143]
  v_mfma_f32_16x16x32_bf16 v[156:159], a[100:103], v[108:111], v[156:159]
  v_mfma_f32_16x16x32_bf16 v[172:175], a[104:107], v[108:111], v[172:175]
  v_mfma_f32_16x16x32_bf16 v[188:191], a[108:111], v[108:111], v[188:191]
  v_mfma_f32_16x16x32_bf16 v[204:207], a[112:115], v[108:111], v[204:207]
  v_mfma_f32_16x16x32_bf16 v[220:223], a[116:119], v[108:111], v[220:223]
  v_mfma_f32_16x16x32_bf16 v[236:239], a[120:123], v[108:111], v[236:239]
  v_mfma_f32_16x16x32_bf16 v[252:255], a[124:127], v[108:111], v[252:255]
  v_mfma_f32_16x16x32_bf16 v[92:95], v[112:115], v[108:111], v[92:95]
L_k3_norm:
  s_nop 7
  v_mov_b32 v6, s27
  v_lshrrev_b32 v1, 4, v0
  v_bfe_u32 v2, v0, 2, 2
  v_and_b32 v3, 1, v1
  v_lshl_add_u32 v3, v3, 2, v2
  v_lshlrev_b32 v3, 1, v3
  v_mul_u32_u24 v4, 4, v1
  v_add_u32 v4, v4, v2
  v_lshlrev_b32 v4, 8, v4
  v_and_b32 v5, 1, v0
  v_lshl_add_u32 v4, v5, 3, v4
  v_add_u32 v4, v6, v4
  v_bfe_u32 v5, v0, 1, 1
  v_add_u32 v1, 0, v5
  v_xor_b32 v1, v1, v3
  v_lshl_add_u32 v64, v1, 4, v4
  v_add_u32 v1, 2, v5
  v_xor_b32 v1, v1, v3
  v_lshl_add_u32 v65, v1, 4, v4
  v_add_u32 v1, 4, v5
  v_xor_b32 v1, v1, v3
  v_lshl_add_u32 v66, v1, 4, v4
  v_add_u32 v1, 6, v5
  v_xor_b32 v1, v1, v3
  v_lshl_add_u32 v67, v1, 4, v4
  v_add_u32 v1, 8, v5
  v_xor_b32 v1, v1, v3
  v_lshl_add_u32 v68, v1, 4, v4
  v_add_u32 v1, 10, v5
  v_xor_b32 v1, v1, v3
  v_lshl_add_u32 v69, v1, 4, v4
  v_add_u32 v1, 12, v5
  v_xor_b32 v1, v1, v3
  v_lshl_add_u32 v70, v1, 4, v4
  v_add_u32 v1, 14, v5
  v_xor_b32 v1, v1, v3
  v_lshl_add_u32 v71, v1, 4, v4
  v_mov_b32 v6, s7
  v_lshrrev_b32 v1, 4, v0
  v_bfe_u32 v2, v0, 2, 2
  v_and_b32 v3, 1, v1
  v_lshl_add_u32 v3, v3, 2, v2
  v_lshlrev_b32 v3, 1, v3
  v_mul_u32_u24 v4, 4, v1
  v_add_u32 v4, v4, v2
  v_lshlrev_b32 v4, 8, v4
  v_and_b32 v5, 1, v0
  v_lshl_add_u32 v4, v5, 3, v4
  v_add_u32 v4, v6, v4
  v_bfe_u32 v5, v0, 1, 1
  v_add_u32 v1, 0, v5
  v_xor_b32 v1, v1, v3
  v_lshl_add_u32 v72, v1, 4, v4
  v_add_u32 v1, 2, v5
  v_xor_b32 v1, v1, v3
  v_lshl_add_u32 v73, v1, 4, v4
  v_add_u32 v1, 4, v5
  v_xor_b32 v1, v1, v3
  v_lshl_add_u32 v74, v1, 4, v4
  v_add_u32 v1, 6, v5
  v_xor_b32 v1, v1, v3
  v_lshl_add_u32 v75, v1, 4, v4
  v_add_u32 v1, 8, v5
  v_xor_b32 v1, v1, v3
  v_lshl_add_u32 v76, v1, 4, v4
  v_add_u32 v1, 10, v5
  v_xor_b32 v1, v1, v3
  v_lshl_add_u32 v77, v1, 4, v4
  v_add_u32 v1, 12, v5
  v_xor_b32 v1, v1, v3
  v_lshl_add_u32 v78, v1, 4, v4
  v_add_u32 v1, 14, v5
  v_xor_b32 v1, v1, v3
  v_lshl_add_u32 v79, v1, 4, v4
  v_rcp_f32 v24, v80
  v_rcp_f32 v25, v84
  v_rcp_f32 v26, v88
  v_rcp_f32 v27, v92
  v_lshlrev_b32 v7, 4, v0
  s_lshl_b32 s43, s24, 14
  v_add_u32 v22, s43, v7
  v_mov_b32 v23, v7
  v_mul_f32 v128, v128, v24
  v_mul_f32 v144, v144, v24
  v_mul_f32 v129, v129, v24
  v_mul_f32 v145, v145, v24
  v_mul_f32 v130, v130, v24
  v_mul_f32 v146, v146, v24
  v_mul_f32 v131, v131, v24
  v_mul_f32 v147, v147, v24
  v_max3_f32 v28, |v128|, |v129|, |v130|
  v_max3_f32 v28, |v131|, |v144|, v28
  v_max3_f32 v28, |v145|, |v146|, v28
  v_max_f32 v28, |v147|, v28
  v_cvt_pk_bf16_f32 v48, v128, v129
  v_cvt_pk_bf16_f32 v49, v130, v131
  v_cvt_pk_bf16_f32 v50, v144, v145
  v_cvt_pk_bf16_f32 v51, v146, v147
  ds_write_b128 v22, v[48:51]
  v_mul_f32 v132, v132, v25
  v_mul_f32 v148, v148, v25
  v_mul_f32 v133, v133, v25
  v_mul_f32 v149, v149, v25
  v_mul_f32 v134, v134, v25
  v_mul_f32 v150, v150, v25
  v_mul_f32 v135, v135, v25
  v_mul_f32 v151, v151, v25
  v_max3_f32 v29, |v132|, |v133|, |v134|
  v_max3_f32 v29, |v135|, |v148|, v29
  v_max3_f32 v29, |v149|, |v150|, v29
  v_max_f32 v29, |v151|, v29
  v_cvt_pk_bf16_f32 v52, v132, v133
  v_cvt_pk_bf16_f32 v53, v134, v135
  v_cvt_pk_bf16_f32 v54, v148, v149
  v_cvt_pk_bf16_f32 v55, v150, v151
  ds_write_b128 v22, v[52:55] offset:1024
  v_mul_f32 v136, v136, v26
  v_mul_f32 v152, v152, v26
  v_mul_f32 v137, v137, v26
  v_mul_f32 v153, v153, v26
  v_mul_f32 v138, v138, v26
  v_mul_f32 v154, v154, v26
  v_mul_f32 v139, v139, v26
  v_mul_f32 v155, v155, v26
  v_max3_f32 v30, |v136|, |v137|, |v138|
  v_max3_f32 v30, |v139|, |v152|, v30
  v_max3_f32 v30, |v153|, |v154|, v30
  v_max_f32 v30, |v155|, v30
  v_cvt_pk_bf16_f32 v56, v136, v137
  v_cvt_pk_bf16_f32 v57, v138, v139
  v_cvt_pk_bf16_f32 v58, v152, v153
  v_cvt_pk_bf16_f32 v59, v154, v155
  ds_write_b128 v22, v[56:59] offset:2048
  v_mul_f32 v140, v140, v27
  v_mul_f32 v156, v156, v27
  v_mul_f32 v141, v141, v27
  v_mul_f32 v157, v157, v27
  v_mul_f32 v142, v142, v27
  v_mul_f32 v158, v158, v27
  v_mul_f32 v143, v143, v27
  v_mul_f32 v159, v159, v27
  v_max3_f32 v31, |v140|, |v141|, |v142|
  v_max3_f32 v31, |v143|, |v156|, v31
  v_max3_f32 v31, |v157|, |v158|, v31
  v_max_f32 v31, |v159|, v31
  v_cvt_pk_bf16_f32 v60, v140, v141
  v_cvt_pk_bf16_f32 v61, v142, v143
  v_cvt_pk_bf16_f32 v62, v156, v157
  v_cvt_pk_bf16_f32 v63, v158, v159
  ds_write_b128 v22, v[60:63] offset:3072
  v_mul_f32 v160, v160, v24
  v_mul_f32 v176, v176, v24
  v_mul_f32 v161, v161, v24
  v_mul_f32 v177, v177, v24
  v_mul_f32 v162, v162, v24
  v_mul_f32 v178, v178, v24
  v_mul_f32 v163, v163, v24
  v_mul_f32 v179, v179, v24
  v_max3_f32 v28, |v160|, |v161|, v28
  v_max_f32 v28, |v162|, v28
  v_max3_f32 v28, |v163|, |v176|, v28
  v_max3_f32 v28, |v177|, |v178|, v28
  v_max_f32 v28, |v179|, v28
  v_cvt_pk_bf16_f32 v48, v160, v161
  v_cvt_pk_bf16_f32 v49, v162, v163
  v_cvt_pk_bf16_f32 v50, v176, v177
  v_cvt_pk_bf16_f32 v51, v178, v179
  ds_write_b128 v22, v[48:51] offset:4096
  v_mul_f32 v164, v164, v25
  v_mul_f32 v180, v180, v25
  v_mul_f32 v165, v165, v25
  v_mul_f32 v181, v181, v25
  v_mul_f32 v166, v166, v25
  v_mul_f32 v182, v182, v25
  v_mul_f32 v167, v167, v25
  v_mul_f32 v183, v183, v25
  v_max3_f32 v29, |v164|, |v165|, v29
  v_max_f32 v29, |v166|, v29
  v_max3_f32 v29, |v167|, |v180|, v29
  v_max3_f32 v29, |v181|, |v182|, v29
  v_max_f32 v29, |v183|, v29
  v_cvt_pk_bf16_f32 v52, v164, v165
  v_cvt_pk_bf16_f32 v53, v166, v167
  v_cvt_pk_bf16_f32 v54, v180, v181
  v_cvt_pk_bf16_f32 v55, v182, v183
  ds_write_b128 v22, v[52:55] offset:5120
  v_mul_f32 v168, v168, v26
  v_mul_f32 v184, v184, v26
  v_mul_f32 v169, v169, v26
  v_mul_f32 v185, v185, v26
  v_mul_f32 v170, v170, v26
  v_mul_f32 v186, v186, v26
  v_mul_f32 v171, v171, v26
  v_mul_f32 v187, v187, v26
  v_max3_f32 v30, |v168|, |v169|, v30
  v_max_f32 v30, |v170|, v30
  v_max3_f32 v30, |v171|, |v184|, v30
  v_max3_f32 v30, |v185|, |v186|, v30
  v_max_f32 v30, |v187|, v30
  v_cvt_pk_bf16_f32 v56, v168, v169
  v_cvt_pk_bf16_f32 v57, v170, v171
  v_cvt_pk_bf16_f32 v58, v184, v185
  v_cvt_pk_bf16_f32 v59, v186, v187
  ds_write_b128 v22, v[56:59] offset:6144
  v_mul_f32 v172, v172, v27
  v_mul_f32 v188, v188, v27
  v_mul_f32 v173, v173, v27
  v_mul_f32 v189, v189, v27
  v_mul_f32 v174, v174, v27
  v_mul_f32 v190, v190, v27
  v_mul_f32 v175, v175, v27
  v_mul_f32 v191, v191, v27
  v_max3_f32 v31, |v172|, |v173|, v31
  v_max_f32 v31, |v174|, v31
  v_max3_f32 v31, |v175|, |v188|, v31
  v_max3_f32 v31, |v189|, |v190|, v31
  v_max_f32 v31, |v191|, v31
  v_cvt_pk_bf16_f32 v60, v172, v173
  v_cvt_pk_bf16_f32 v61, v174, v175
  v_cvt_pk_bf16_f32 v62, v188, v189
  v_cvt_pk_bf16_f32 v63, v190, v191
  ds_write_b128 v22, v[60:63] offset:7168
  v_mul_f32 v192, v192, v24
  v_mul_f32 v208, v208, v24
  v_mul_f32 v193, v193, v24
  v_mul_f32 v209, v209, v24
  v_mul_f32 v194, v194, v24
  v_mul_f32 v210, v210, v24
  v_mul_f32 v195, v195, v24
  v_mul_f32 v211, v211, v24
  v_max3_f32 v28, |v192|, |v193|, v28
  v_max_f32 v28, |v194|, v28
  v_max3_f32 v28, |v195|, |v208|, v28
  v_max3_f32 v28, |v209|, |v210|, v28
  v_max_f32 v28, |v211|, v28
  v_cvt_pk_bf16_f32 v48, v192, v193
  v_cvt_pk_bf16_f32 v49, v194, v195
  v_cvt_pk_bf16_f32 v50, v208, v209
  v_cvt_pk_bf16_f32 v51, v210, v211
  ds_write_b128 v22, v[48:51] offset:8192
  v_mul_f32 v196, v196, v25
  v_mul_f32 v212, v212, v25
  v_mul_f32 v197, v197, v25
  v_mul_f32 v213, v213, v25
  v_mul_f32 v198, v198, v25
  v_mul_f32 v214, v214, v25
  v_mul_f32 v199, v199, v25
  v_mul_f32 v215, v215, v25
  v_max3_f32 v29, |v196|, |v197|, v29
  v_max_f32 v29, |v198|, v29
  v_max3_f32 v29, |v199|, |v212|, v29
  v_max3_f32 v29, |v213|, |v214|, v29
  v_max_f32 v29, |v215|, v29
  v_cvt_pk_bf16_f32 v52, v196, v197
  v_cvt_pk_bf16_f32 v53, v198, v199
  v_cvt_pk_bf16_f32 v54, v212, v213
  v_cvt_pk_bf16_f32 v55, v214, v215
  ds_write_b128 v22, v[52:55] offset:9216
  v_mul_f32 v200, v200, v26
  v_mul_f32 v216, v216, v26
  v_mul_f32 v201, v201, v26
  v_mul_f32 v217, v217, v26
  v_mul_f32 v202, v202, v26
  v_mul_f32 v218, v218, v26
  v_mul_f32 v203, v203, v26
  v_mul_f32 v219, v219, v26
  v_max3_f32 v30, |v200|, |v201|, v30
  v_max_f32 v30, |v202|, v30
  v_max3_f32 v30, |v203|, |v216|, v30
  v_max3_f32 v30, |v217|, |v218|, v30
  v_max_f32 v30, |v219|, v30
  v_cvt_pk_bf16_f32 v56, v200, v201
  v_cvt_pk_bf16_f32 v57, v202, v203
  v_cvt_pk_bf16_f32 v58, v216, v217
  v_cvt_pk_bf16_f32 v59, v218, v219
  ds_write_b128 v22, v[56:59] offset:10240
  v_mul_f32 v204, v204, v27
  v_mul_f32 v220, v220, v27
  v_mul_f32 v205, v205, v27
  v_mul_f32 v221, v221, v27
  v_mul_f32 v206, v206, v27
  v_mul_f32 v222, v222, v27
  v_mul_f32 v207, v207, v27
  v_mul_f32 v223, v223, v27
  v_max3_f32 v31, |v204|, |v205|, v31
  v_max_f32 v31, |v206|, v31
  v_max3_f32 v31, |v207|, |v220|, v31
  v_max3_f32 v31, |v221|, |v222|, v31
  v_max_f32 v31, |v223|, v31
  v_cvt_pk_bf16_f32 v60, v204, v205
  v_cvt_pk_bf16_f32 v61, v206, v207
  v_cvt_pk_bf16_f32 v62, v220, v221
  v_cvt_pk_bf16_f32 v63, v222, v223
  ds_write_b128 v22, v[60:63] offset:11264
  v_mul_f32 v224, v224, v24
  v_mul_f32 v240, v240, v24
  v_mul_f32 v225, v225, v24
  v_mul_f32 v241, v241, v24
  v_mul_f32 v226, v226, v24
  v_mul_f32 v242, v242, v24
  v_mul_f32 v227, v227, v24
  v_mul_f32 v243, v243, v24
  v_max3_f32 v28, |v224|, |v225|, v28
  v_max_f32 v28, |v226|, v28
  v_max3_f32 v28, |v227|, |v240|, v28
  v_max3_f32 v28, |v241|, |v242|, v28
  v_max_f32 v28, |v243|, v28
  v_cvt_pk_bf16_f32 v48, v224, v225
  v_cvt_pk_bf16_f32 v49, v226, v227
  v_cvt_pk_bf16_f32 v50, v240, v241
  v_cvt_pk_bf16_f32 v51, v242, v243
  ds_write_b128 v22, v[48:51] offset:12288
  v_mul_f32 v228, v228, v25
  v_mul_f32 v244, v244, v25
  v_mul_f32 v229, v229, v25
  v_mul_f32 v245, v245, v25
  v_mul_f32 v230, v230, v25
  v_mul_f32 v246, v246, v25
  v_mul_f32 v231, v231, v25
  v_mul_f32 v247, v247, v25
  v_max3_f32 v29, |v228|, |v229|, v29
  v_max_f32 v29, |v230|, v29
  v_max3_f32 v29, |v231|, |v244|, v29
  v_max3_f32 v29, |v245|, |v246|, v29
  v_max_f32 v29, |v247|, v29
  v_cvt_pk_bf16_f32 v52, v228, v229
  v_cvt_pk_bf16_f32 v53, v230, v231
  v_cvt_pk_bf16_f32 v54, v244, v245
  v_cvt_pk_bf16_f32 v55, v246, v247
  ds_write_b128 v22, v[52:55] offset:13312
  v_mul_f32 v232, v232, v26
  v_mul_f32 v248, v248, v26
  v_mul_f32 v233, v233, v26
  v_mul_f32 v249, v249, v26
  v_mul_f32 v234, v234, v26
  v_mul_f32 v250, v250, v26
  v_mul_f32 v235, v235, v26
  v_mul_f32 v251, v251, v26
  v_max3_f32 v30, |v232|, |v233|, v30
  v_max_f32 v30, |v234|, v30
  v_max3_f32 v30, |v235|, |v248|, v30
  v_max3_f32 v30, |v249|, |v250|, v30
  v_max_f32 v30, |v251|, v30
  v_cvt_pk_bf16_f32 v56, v232, v233
  v_cvt_pk_bf16_f32 v57, v234, v235
  v_cvt_pk_bf16_f32 v58, v248, v249
  v_cvt_pk_bf16_f32 v59, v250, v251
  ds_write_b128 v22, v[56:59] offset:14336
  v_mul_f32 v236, v236, v27
  v_mul_f32 v252, v252, v27
  v_mul_f32 v237, v237, v27
  v_mul_f32 v253, v253, v27
  v_mul_f32 v238, v238, v27
  v_mul_f32 v254, v254, v27
  v_mul_f32 v239, v239, v27
  v_mul_f32 v255, v255, v27
  v_max3_f32 v31, |v236|, |v237|, v31
  v_max_f32 v31, |v238|, v31
  v_max3_f32 v31, |v239|, |v252|, v31
  v_max3_f32 v31, |v253|, |v254|, v31
  v_max_f32 v31, |v255|, v31
  v_cvt_pk_bf16_f32 v60, v236, v237
  v_cvt_pk_bf16_f32 v61, v238, v239
  v_cvt_pk_bf16_f32 v62, v252, v253
  v_cvt_pk_bf16_f32 v63, v254, v255
  ds_write_b128 v22, v[60:63] offset:15360
  s_waitcnt lgkmcnt(0)
  s_barrier
  s_lshl_b32 s3, s25, 5
  s_add_u32 s3, s3, s26
  s_lshl_b32 s3, s3, 2
  s_add_u32 s3, s3, s24
  s_lshl_b32 s3, s3, 14
  s_add_u32 s3, s3, 8388608
  ds_read_b128 a[128:131], v23
  ds_read_b128 a[132:135], v23 offset:1024
  ds_read_b128 a[136:139], v23 offset:2048
  ds_read_b128 a[140:143], v23 offset:3072
  s_waitcnt vmcnt(17)
  ds_read_b64_tr_b16 a[64:65], v64
  ds_read_b64_tr_b16 a[66:67], v64 offset:4096
  ds_read_b64_tr_b16 a[68:69], v65
  ds_read_b64_tr_b16 a[70:71], v65 offset:4096
  ds_read_b64_tr_b16 a[72:73], v66
  ds_read_b64_tr_b16 a[74:75], v66 offset:4096
  ds_read_b64_tr_b16 a[76:77], v67
  ds_read_b64_tr_b16 a[78:79], v67 offset:4096
  ds_read_b64_tr_b16 a[80:81], v68
  ds_read_b64_tr_b16 a[82:83], v68 offset:4096
  ds_read_b64_tr_b16 a[84:85], v69
  ds_read_b64_tr_b16 a[86:87], v69 offset:4096
  ds_read_b64_tr_b16 a[88:89], v70
  ds_read_b64_tr_b16 a[90:91], v70 offset:4096
  ds_read_b64_tr_b16 a[92:93], v71
  ds_read_b64_tr_b16 a[94:95], v71 offset:4096
  s_waitcnt lgkmcnt(14)
  v_mfma_f32_16x16x32_bf16 v[128:131], a[64:67], a[128:131], 0
  ds_read_b128 a[144:147], v23 offset:4096
  ds_read_b128 a[148:151], v23 offset:5120
  v_mfma_f32_16x16x32_bf16 v[132:135], a[64:67], a[132:135], 0
  ds_read_b128 a[152:155], v23 offset:6144
  ds_read_b128 a[156:159], v23 offset:7168
  v_mfma_f32_16x16x32_bf16 v[136:139], a[64:67], a[136:139], 0
  s_waitcnt vmcnt(9)
  s_add_u32 m0, s27, 0
  ds_read_b64_tr_b16 a[96:97], v64 offset:8192
  ds_read_b64_tr_b16 a[98:99], v64 offset:12288
  v_mfma_f32_16x16x32_bf16 v[140:143], a[64:67], a[140:143], 0
  s_waitcnt lgkmcnt(6)
  buffer_load_dwordx4 v14, s[32:35], s42 offen lds
  v_mfma_f32_16x16x32_bf16 v[144:147], a[68:71], a[128:131], 0
  ds_read_b64_tr_b16 a[100:101], v65 offset:8192
  ds_read_b64_tr_b16 a[102:103], v65 offset:12288
  v_mfma_f32_16x16x32_bf16 v[148:151], a[68:71], a[132:135], 0
  buffer_load_dwordx4 v15, s[32:35], s42 offen offset:1024 lds
  v_mfma_f32_16x16x32_bf16 v[152:155], a[68:71], a[136:139], 0
  ds_read_b64_tr_b16 a[104:105], v66 offset:8192
  ds_read_b64_tr_b16 a[106:107], v66 offset:12288
  v_mfma_f32_16x16x32_bf16 v[156:159], a[68:71], a[140:143], 0
  buffer_load_dwordx4 v16, s[32:35], s42 offen offset:2048 lds
  v_mfma_f32_16x16x32_bf16 v[160:163], a[72:75], a[128:131], 0
  ds_read_b64_tr_b16 a[108:109], v67 offset:8192
  ds_read_b64_tr_b16 a[110:111], v67 offset:12288
  v_mfma_f32_16x16x32_bf16 v[164:167], a[72:75], a[132:135], 0
  buffer_load_dwordx4 v17, s[32:35], s42 offen offset:3072 lds
  v_mfma_f32_16x16x32_bf16 v[168:171], a[72:75], a[136:139], 0
  s_add_u32 s42, s42, 16384
  s_add_u32 m0, s27, 4096
  ds_read_b64_tr_b16 a[112:113], v68 offset:8192
  ds_read_b64_tr_b16 a[114:115], v68 offset:12288
  v_mfma_f32_16x16x32_bf16 v[172:175], a[72:75], a[140:143], 0
  buffer_load_dwordx4 v14, s[32:35], s42 offen lds
  v_mfma_f32_16x16x32_bf16 v[176:179], a[76:79], a[128:131], 0
  ds_read_b64_tr_b16 a[116:117], v69 offset:8192
  ds_read_b64_tr_b16 a[118:119], v69 offset:12288
  v_mfma_f32_16x16x32_bf16 v[180:183], a[76:79], a[132:135], 0
  buffer_load_dwordx4 v15, s[32:35], s42 offen offset:1024 lds
  v_mfma_f32_16x16x32_bf16 v[184:187], a[76:79], a[136:139], 0
  ds_read_b64_tr_b16 a[120:121], v70 offset:8192
  ds_read_b64_tr_b16 a[122:123], v70 offset:12288
  v_mfma_f32_16x16x32_bf16 v[188:191], a[76:79], a[140:143], 0
  buffer_load_dwordx4 v16, s[32:35], s42 offen offset:2048 lds
  v_mfma_f32_16x16x32_bf16 v[192:195], a[80:83], a[128:131], 0
  ds_read_b64_tr_b16 a[124:125], v71 offset:8192
  ds_read_b64_tr_b16 a[126:127], v71 offset:12288
  v_mfma_f32_16x16x32_bf16 v[196:199], a[80:83], a[132:135], 0
  buffer_load_dwordx4 v17, s[32:35], s42 offen offset:3072 lds
  v_mfma_f32_16x16x32_bf16 v[200:203], a[80:83], a[136:139], 0
  s_add_u32 s42, s42, 16384
  v_mfma_f32_16x16x32_bf16 v[204:207], a[80:83], a[140:143], 0
  v_mfma_f32_16x16x32_bf16 v[208:211], a[84:87], a[128:131], 0
  v_mfma_f32_16x16x32_bf16 v[212:215], a[84:87], a[132:135], 0
  v_mfma_f32_16x16x32_bf16 v[216:219], a[84:87], a[136:139], 0
  v_mfma_f32_16x16x32_bf16 v[220:223], a[84:87], a[140:143], 0
  v_mfma_f32_16x16x32_bf16 v[224:227], a[88:91], a[128:131], 0
  v_mfma_f32_16x16x32_bf16 v[228:231], a[88:91], a[132:135], 0
  v_mfma_f32_16x16x32_bf16 v[232:235], a[88:91], a[136:139], 0
  v_mfma_f32_16x16x32_bf16 v[236:239], a[88:91], a[140:143], 0
  v_mfma_f32_16x16x32_bf16 v[240:243], a[92:95], a[128:131], 0
  v_mfma_f32_16x16x32_bf16 v[244:247], a[92:95], a[132:135], 0
  v_mfma_f32_16x16x32_bf16 v[248:251], a[92:95], a[136:139], 0
  v_mfma_f32_16x16x32_bf16 v[252:255], a[92:95], a[140:143], 0
  s_waitcnt lgkmcnt(14)
  v_mfma_f32_16x16x32_bf16 v[128:131], a[96:99], a[144:147], v[128:131]
  ds_read_b128 a[128:131], v23 offset:8192
  ds_read_b128 a[132:135], v23 offset:9216
  v_mfma_f32_16x16x32_bf16 v[132:135], a[96:99], a[148:151], v[132:135]
  ds_read_b128 a[136:139], v23 offset:10240
  ds_read_b128 a[140:143], v23 offset:11264
  v_mfma_f32_16x16x32_bf16 v[136:139], a[96:99], a[152:155], v[136:139]
  s_waitcnt vmcnt(8)
  s_add_u32 m0, s27, 8192
  ds_read_b64_tr_b16 a[64:65], v72
  ds_read_b64_tr_b16 a[66:67], v72 offset:4096
  v_mfma_f32_16x16x32_bf16 v[140:143], a[96:99], a[156:159], v[140:143]
  s_waitcnt lgkmcnt(6)
  buffer_load_dwordx4 v14, s[32:35], s42 offen lds
  v_mfma_f32_16x16x32_bf16 v[144:147], a[100:103], a[144:147], v[144:147]
  ds_read_b64_tr_b16 a[68:69], v73
  ds_read_b64_tr_b16 a[70:71], v73 offset:4096
  v_mfma_f32_16x16x32_bf16 v[148:151], a[100:103], a[148:151], v[148:151]
  buffer_load_dwordx4 v15, s[32:35], s42 offen offset:1024 lds
  v_mfma_f32_16x16x32_bf16 v[152:155], a[100:103], a[152:155], v[152:155]
  ds_read_b64_tr_b16 a[72:73], v74
  ds_read_b64_tr_b16 a[74:75], v74 offset:4096
  v_mfma_f32_16x16x32_bf16 v[156:159], a[100:103], a[156:159], v[156:159]
  buffer_load_dwordx4 v16, s[32:35], s42 offen offset:2048 lds
  v_mfma_f32_16x16x32_bf16 v[160:163], a[104:107], a[144:147], v[160:163]
  ds_read_b64_tr_b16 a[76:77], v75
  ds_read_b64_tr_b16 a[78:79], v75 offset:4096
  v_mfma_f32_16x16x32_bf16 v[164:167], a[104:107], a[148:151], v[164:167]
  buffer_load_dwordx4 v17, s[32:35], s42 offen offset:3072 lds
  v_mfma_f32_16x16x32_bf16 v[168:171], a[104:107], a[152:155], v[168:171]
  s_add_u32 s42, s42, 16384
  s_add_u32 m0, s27, 12288
  ds_read_b64_tr_b16 a[80:81], v76
  ds_read_b64_tr_b16 a[82:83], v76 offset:4096
  v_mfma_f32_16x16x32_bf16 v[172:175], a[104:107], a[156:159], v[172:175]
  buffer_load_dwordx4 v14, s[32:35], s42 offen lds
  v_mfma_f32_16x16x32_bf16 v[176:179], a[108:111], a[144:147], v[176:179]
  ds_read_b64_tr_b16 a[84:85], v77
  ds_read_b64_tr_b16 a[86:87], v77 offset:4096
  v_mfma_f32_16x16x32_bf16 v[180:183], a[108:111], a[148:151], v[180:183]
  buffer_load_dwordx4 v15, s[32:35], s42 offen offset:1024 lds
  v_mfma_f32_16x16x32_bf16 v[184:187], a[108:111], a[152:155], v[184:187]
  ds_read_b64_tr_b16 a[88:89], v78
  ds_read_b64_tr_b16 a[90:91], v78 offset:4096
  v_mfma_f32_16x16x32_bf16 v[188:191], a[108:111], a[156:159], v[188:191]
  buffer_load_dwordx4 v16, s[32:35], s42 offen offset:2048 lds
  v_mfma_f32_16x16x32_bf16 v[192:195], a[112:115], a[144:147], v[192:195]
  ds_read_b64_tr_b16 a[92:93], v79
  ds_read_b64_tr_b16 a[94:95], v79 offset:4096
  v_mfma_f32_16x16x32_bf16 v[196:199], a[112:115], a[148:151], v[196:199]
  buffer_load_dwordx4 v17, s[32:35], s42 offen offset:3072 lds
  v_mfma_f32_16x16x32_bf16 v[200:203], a[112:115], a[152:155], v[200:203]
  s_add_u32 s42, s42, 16384
  v_mfma_f32_16x16x32_bf16 v[204:207], a[112:115], a[156:159], v[204:207]
  v_mfma_f32_16x16x32_bf16 v[208:211], a[116:119], a[144:147], v[208:211]
  v_mfma_f32_16x16x32_bf16 v[212:215], a[116:119], a[148:151], v[212:215]
  v_mfma_f32_16x16x32_bf16 v[216:219], a[116:119], a[152:155], v[216:219]
  v_mfma_f32_16x16x32_bf16 v[220:223], a[116:119], a[156:159], v[220:223]
  v_mfma_f32_16x16x32_bf16 v[224:227], a[120:123], a[144:147], v[224:227]
  v_mfma_f32_16x16x32_bf16 v[228:231], a[120:123], a[148:151], v[228:231]
  v_mfma_f32_16x16x32_bf16 v[232:235], a[120:123], a[152:155], v[232:235]
  v_mfma_f32_16x16x32_bf16 v[236:239], a[120:123], a[156:159], v[236:239]
  v_mfma_f32_16x16x32_bf16 v[240:243], a[124:127], a[144:147], v[240:243]
  v_mfma_f32_16x16x32_bf16 v[244:247], a[124:127], a[148:151], v[244:247]
  v_mfma_f32_16x16x32_bf16 v[248:251], a[124:127], a[152:155], v[248:251]
  v_mfma_f32_16x16x32_bf16 v[252:255], a[124:127], a[156:159], v[252:255]
  s_waitcnt lgkmcnt(14)
  v_mfma_f32_16x16x32_bf16 v[128:131], a[64:67], a[128:131], v[128:131]
  ds_read_b128 a[144:147], v23 offset:12288
  ds_read_b128 a[148:151], v23 offset:13312
  v_mfma_f32_16x16x32_bf16 v[132:135], a[64:67], a[132:135], v[132:135]
  ds_read_b128 a[152:155], v23 offset:14336
  ds_read_b128 a[156:159], v23 offset:15360
  v_mfma_f32_16x16x32_bf16 v[136:139], a[64:67], a[136:139], v[136:139]
  s_waitcnt vmcnt(8)
  s_add_u32 m0, s7, 0
  ds_read_b64_tr_b16 a[96:97], v64
  ds_read_b64_tr_b16 a[98:99], v64 offset:4096
  v_mfma_f32_16x16x32_bf16 v[140:143], a[64:67], a[140:143], v[140:143]
  s_waitcnt lgkmcnt(6)
  buffer_load_dwordx4 v14, s[32:35], s42 offen lds
  v_mfma_f32_16x16x32_bf16 v[144:147], a[68:71], a[128:131], v[144:147]
  ds_read_b64_tr_b16 a[100:101], v65
  ds_read_b64_tr_b16 a[102:103], v65 offset:4096
  v_mfma_f32_16x16x32_bf16 v[148:151], a[68:71], a[132:135], v[148:151]
  buffer_load_dwordx4 v15, s[32:35], s42 offen offset:1024 lds
  v_mfma_f32_16x16x32_bf16 v[152:155], a[68:71], a[136:139], v[152:155]
  ds_read_b64_tr_b16 a[104:105], v66
  ds_read_b64_tr_b16 a[106:107], v66 offset:4096
  v_mfma_f32_16x16x32_bf16 v[156:159], a[68:71], a[140:143], v[156:159]
  buffer_load_dwordx4 v16, s[32:35], s42 offen offset:2048 lds
  v_mfma_f32_16x16x32_bf16 v[160:163], a[72:75], a[128:131], v[160:163]
  ds_read_b64_tr_b16 a[108:109], v67
  ds_read_b64_tr_b16 a[110:111], v67 offset:4096
  v_mfma_f32_16x16x32_bf16 v[164:167], a[72:75], a[132:135], v[164:167]
  buffer_load_dwordx4 v17, s[32:35], s42 offen offset:3072 lds
  v_mfma_f32_16x16x32_bf16 v[168:171], a[72:75], a[136:139], v[168:171]
  s_add_u32 s42, s42, 16384
  s_add_u32 m0, s7, 4096
  ds_read_b64_tr_b16 a[112:113], v68
  ds_read_b64_tr_b16 a[114:115], v68 offset:4096
  v_mfma_f32_16x16x32_bf16 v[172:175], a[72:75], a[140:143], v[172:175]
  buffer_load_dwordx4 v14, s[32:35], s42 offen lds
  v_mfma_f32_16x16x32_bf16 v[176:179], a[76:79], a[128:131], v[176:179]
  ds_read_b64_tr_b16 a[116:117], v69
  ds_read_b64_tr_b16 a[118:119], v69 offset:4096
  v_mfma_f32_16x16x32_bf16 v[180:183], a[76:79], a[132:135], v[180:183]
  buffer_load_dwordx4 v15, s[32:35], s42 offen offset:1024 lds
  v_mfma_f32_16x16x32_bf16 v[184:187], a[76:79], a[136:139], v[184:187]
  ds_read_b64_tr_b16 a[120:121], v70
  ds_read_b64_tr_b16 a[122:123], v70 offset:4096
  v_mfma_f32_16x16x32_bf16 v[188:191], a[76:79], a[140:143], v[188:191]
  buffer_load_dwordx4 v16, s[32:35], s42 offen offset:2048 lds
  v_mfma_f32_16x16x32_bf16 v[192:195], a[80:83], a[128:131], v[192:195]
  ds_read_b64_tr_b16 a[124:125], v71
  ds_read_b64_tr_b16 a[126:127], v71 offset:4096
  v_mfma_f32_16x16x32_bf16 v[196:199], a[80:83], a[132:135], v[196:199]
  buffer_load_dwordx4 v17, s[32:35], s42 offen offset:3072 lds
  v_mfma_f32_16x16x32_bf16 v[200:203], a[80:83], a[136:139], v[200:203]
  s_add_u32 s42, s42, 16384
  v_mfma_f32_16x16x32_bf16 v[204:207], a[80:83], a[140:143], v[204:207]
  v_mfma_f32_16x16x32_bf16 v[208:211], a[84:87], a[128:131], v[208:211]
  v_mfma_f32_16x16x32_bf16 v[212:215], a[84:87], a[132:135], v[212:215]
  v_mfma_f32_16x16x32_bf16 v[216:219], a[84:87], a[136:139], v[216:219]
  v_mfma_f32_16x16x32_bf16 v[220:223], a[84:87], a[140:143], v[220:223]
  v_mfma_f32_16x16x32_bf16 v[224:227], a[88:91], a[128:131], v[224:227]
  v_mfma_f32_16x16x32_bf16 v[228:231], a[88:91], a[132:135], v[228:231]
  v_mfma_f32_16x16x32_bf16 v[232:235], a[88:91], a[136:139], v[232:235]
  v_mfma_f32_16x16x32_bf16 v[236:239], a[88:91], a[140:143], v[236:239]
  v_mfma_f32_16x16x32_bf16 v[240:243], a[92:95], a[128:131], v[240:243]
  v_mfma_f32_16x16x32_bf16 v[244:247], a[92:95], a[132:135], v[244:247]
  v_mfma_f32_16x16x32_bf16 v[248:251], a[92:95], a[136:139], v[248:251]
  v_mfma_f32_16x16x32_bf16 v[252:255], a[92:95], a[140:143], v[252:255]
  s_waitcnt lgkmcnt(14)
  v_mfma_f32_16x16x32_bf16 v[128:131], a[96:99], a[144:147], v[128:131]
  ds_read_b128 a[128:131], v23 offset:16384
  ds_read_b128 a[132:135], v23 offset:17408
  v_mfma_f32_16x16x32_bf16 v[132:135], a[96:99], a[148:151], v[132:135]
  ds_read_b128 a[136:139], v23 offset:18432
  ds_read_b128 a[140:143], v23 offset:19456
  v_mfma_f32_16x16x32_bf16 v[136:139], a[96:99], a[152:155], v[136:139]
  s_waitcnt vmcnt(8)
  s_add_u32 m0, s27, 0
  ds_read_b64_tr_b16 a[64:65], v64 offset:8192
  ds_read_b64_tr_b16 a[66:67], v64 offset:12288
  v_mfma_f32_16x16x32_bf16 v[140:143], a[96:99], a[156:159], v[140:143]
  s_waitcnt lgkmcnt(6)
  buffer_load_dwordx4 v14, s[32:35], s42 offen lds
  v_mfma_f32_16x16x32_bf16 v[144:147], a[100:103], a[144:147], v[144:147]
  ds_read_b64_tr_b16 a[68:69], v65 offset:8192
  ds_read_b64_tr_b16 a[70:71], v65 offset:12288
  v_mfma_f32_16x16x32_bf16 v[148:151], a[100:103], a[148:151], v[148:151]
  buffer_load_dwordx4 v15, s[32:35], s42 offen offset:1024 lds
  v_mfma_f32_16x16x32_bf16 v[152:155], a[100:103], a[152:155], v[152:155]
  ds_read_b64_tr_b16 a[72:73], v66 offset:8192
  ds_read_b64_tr_b16 a[74:75], v66 offset:12288
  v_mfma_f32_16x16x32_bf16 v[156:159], a[100:103], a[156:159], v[156:159]
  buffer_load_dwordx4 v16, s[32:35], s42 offen offset:2048 lds
  v_mfma_f32_16x16x32_bf16 v[160:163], a[104:107], a[144:147], v[160:163]
  ds_read_b64_tr_b16 a[76:77], v67 offset:8192
  ds_read_b64_tr_b16 a[78:79], v67 offset:12288
  v_mfma_f32_16x16x32_bf16 v[164:167], a[104:107], a[148:151], v[164:167]
  buffer_load_dwordx4 v17, s[32:35], s42 offen offset:3072 lds
  v_mfma_f32_16x16x32_bf16 v[168:171], a[104:107], a[152:155], v[168:171]
  s_add_u32 s42, s42, 16384
  s_add_u32 m0, s27, 4096
  ds_read_b64_tr_b16 a[80:81], v68 offset:8192
  ds_read_b64_tr_b16 a[82:83], v68 offset:12288
  v_mfma_f32_16x16x32_bf16 v[172:175], a[104:107], a[156:159], v[172:175]
  buffer_load_dwordx4 v14, s[32:35], s42 offen lds
  v_mfma_f32_16x16x32_bf16 v[176:179], a[108:111], a[144:147], v[176:179]
  ds_read_b64_tr_b16 a[84:85], v69 offset:8192
  ds_read_b64_tr_b16 a[86:87], v69 offset:12288
  v_mfma_f32_16x16x32_bf16 v[180:183], a[108:111], a[148:151], v[180:183]
  buffer_load_dwordx4 v15, s[32:35], s42 offen offset:1024 lds
  v_mfma_f32_16x16x32_bf16 v[184:187], a[108:111], a[152:155], v[184:187]
  ds_read_b64_tr_b16 a[88:89], v70 offset:8192
  ds_read_b64_tr_b16 a[90:91], v70 offset:12288
  v_mfma_f32_16x16x32_bf16 v[188:191], a[108:111], a[156:159], v[188:191]
  buffer_load_dwordx4 v16, s[32:35], s42 offen offset:2048 lds
  v_mfma_f32_16x16x32_bf16 v[192:195], a[112:115], a[144:147], v[192:195]
  ds_read_b64_tr_b16 a[92:93], v71 offset:8192
  ds_read_b64_tr_b16 a[94:95], v71 offset:12288
  v_mfma_f32_16x16x32_bf16 v[196:199], a[112:115], a[148:151], v[196:199]
  buffer_load_dwordx4 v17, s[32:35], s42 offen offset:3072 lds
  v_mfma_f32_16x16x32_bf16 v[200:203], a[112:115], a[152:155], v[200:203]
  s_add_u32 s42, s42, 16384
  v_mfma_f32_16x16x32_bf16 v[204:207], a[112:115], a[156:159], v[204:207]
  v_mfma_f32_16x16x32_bf16 v[208:211], a[116:119], a[144:147], v[208:211]
  v_mfma_f32_16x16x32_bf16 v[212:215], a[116:119], a[148:151], v[212:215]
  v_mfma_f32_16x16x32_bf16 v[216:219], a[116:119], a[152:155], v[216:219]
  v_mfma_f32_16x16x32_bf16 v[220:223], a[116:119], a[156:159], v[220:223]
  v_mfma_f32_16x16x32_bf16 v[224:227], a[120:123], a[144:147], v[224:227]
  v_mfma_f32_16x16x32_bf16 v[228:231], a[120:123], a[148:151], v[228:231]
  v_mfma_f32_16x16x32_bf16 v[232:235], a[120:123], a[152:155], v[232:235]
  v_mfma_f32_16x16x32_bf16 v[236:239], a[120:123], a[156:159], v[236:239]
  v_mfma_f32_16x16x32_bf16 v[240:243], a[124:127], a[144:147], v[240:243]
  v_mfma_f32_16x16x32_bf16 v[244:247], a[124:127], a[148:151], v[244:247]
  v_mfma_f32_16x16x32_bf16 v[248:251], a[124:127], a[152:155], v[248:251]
  v_mfma_f32_16x16x32_bf16 v[252:255], a[124:127], a[156:159], v[252:255]
  s_waitcnt lgkmcnt(14)
  v_mfma_f32_16x16x32_bf16 v[128:131], a[64:67], a[128:131], v[128:131]
  ds_read_b128 a[144:147], v23 offset:20480
  ds_read_b128 a[148:151], v23 offset:21504
  v_mfma_f32_16x16x32_bf16 v[132:135], a[64:67], a[132:135], v[132:135]
  ds_read_b128 a[152:155], v23 offset:22528
  ds_read_b128 a[156:159], v23 offset:23552
  v_mfma_f32_16x16x32_bf16 v[136:139], a[64:67], a[136:139], v[136:139]
  s_waitcnt vmcnt(8)
  s_add_u32 m0, s27, 8192
  ds_read_b64_tr_b16 a[96:97], v72
  ds_read_b64_tr_b16 a[98:99], v72 offset:4096
  v_mfma_f32_16x16x32_bf16 v[140:143], a[64:67], a[140:143], v[140:143]
  s_waitcnt lgkmcnt(6)
  buffer_load_dwordx4 v14, s[32:35], s42 offen lds
  v_mfma_f32_16x16x32_bf16 v[144:147], a[68:71], a[128:131], v[144:147]
  ds_read_b64_tr_b16 a[100:101], v73
  ds_read_b64_tr_b16 a[102:103], v73 offset:4096
  v_mfma_f32_16x16x32_bf16 v[148:151], a[68:71], a[132:135], v[148:151]
  buffer_load_dwordx4 v15, s[32:35], s42 offen offset:1024 lds
  v_mfma_f32_16x16x32_bf16 v[152:155], a[68:71], a[136:139], v[152:155]
  ds_read_b64_tr_b16 a[104:105], v74
  ds_read_b64_tr_b16 a[106:107], v74 offset:4096
  v_mfma_f32_16x16x32_bf16 v[156:159], a[68:71], a[140:143], v[156:159]
  buffer_load_dwordx4 v16, s[32:35], s42 offen offset:2048 lds
  v_mfma_f32_16x16x32_bf16 v[160:163], a[72:75], a[128:131], v[160:163]
  ds_read_b64_tr_b16 a[108:109], v75
  ds_read_b64_tr_b16 a[110:111], v75 offset:4096
  v_mfma_f32_16x16x32_bf16 v[164:167], a[72:75], a[132:135], v[164:167]
  buffer_load_dwordx4 v17, s[32:35], s42 offen offset:3072 lds
  v_mfma_f32_16x16x32_bf16 v[168:171], a[72:75], a[136:139], v[168:171]
  s_add_u32 s42, s42, 16384
  s_add_u32 m0, s27, 12288
  ds_read_b64_tr_b16 a[112:113], v76
  ds_read_b64_tr_b16 a[114:115], v76 offset:4096
  v_mfma_f32_16x16x32_bf16 v[172:175], a[72:75], a[140:143], v[172:175]
  buffer_load_dwordx4 v14, s[32:35], s42 offen lds
  v_mfma_f32_16x16x32_bf16 v[176:179], a[76:79], a[128:131], v[176:179]
  ds_read_b64_tr_b16 a[116:117], v77
  ds_read_b64_tr_b16 a[118:119], v77 offset:4096
  v_mfma_f32_16x16x32_bf16 v[180:183], a[76:79], a[132:135], v[180:183]
  buffer_load_dwordx4 v15, s[32:35], s42 offen offset:1024 lds
  v_mfma_f32_16x16x32_bf16 v[184:187], a[76:79], a[136:139], v[184:187]
  ds_read_b64_tr_b16 a[120:121], v78
  ds_read_b64_tr_b16 a[122:123], v78 offset:4096
  v_mfma_f32_16x16x32_bf16 v[188:191], a[76:79], a[140:143], v[188:191]
  buffer_load_dwordx4 v16, s[32:35], s42 offen offset:2048 lds
  v_mfma_f32_16x16x32_bf16 v[192:195], a[80:83], a[128:131], v[192:195]
  ds_read_b64_tr_b16 a[124:125], v79
  ds_read_b64_tr_b16 a[126:127], v79 offset:4096
  v_mfma_f32_16x16x32_bf16 v[196:199], a[80:83], a[132:135], v[196:199]
  buffer_load_dwordx4 v17, s[32:35], s42 offen offset:3072 lds
  v_mfma_f32_16x16x32_bf16 v[200:203], a[80:83], a[136:139], v[200:203]
  s_add_u32 s42, s42, 16384
  v_mfma_f32_16x16x32_bf16 v[204:207], a[80:83], a[140:143], v[204:207]
  v_mfma_f32_16x16x32_bf16 v[208:211], a[84:87], a[128:131], v[208:211]
  v_mfma_f32_16x16x32_bf16 v[212:215], a[84:87], a[132:135], v[212:215]
  v_mfma_f32_16x16x32_bf16 v[216:219], a[84:87], a[136:139], v[216:219]
  v_mfma_f32_16x16x32_bf16 v[220:223], a[84:87], a[140:143], v[220:223]
  v_mfma_f32_16x16x32_bf16 v[224:227], a[88:91], a[128:131], v[224:227]
  v_mfma_f32_16x16x32_bf16 v[228:231], a[88:91], a[132:135], v[228:231]
  v_mfma_f32_16x16x32_bf16 v[232:235], a[88:91], a[136:139], v[232:235]
  v_mfma_f32_16x16x32_bf16 v[236:239], a[88:91], a[140:143], v[236:239]
  v_mfma_f32_16x16x32_bf16 v[240:243], a[92:95], a[128:131], v[240:243]
  v_mfma_f32_16x16x32_bf16 v[244:247], a[92:95], a[132:135], v[244:247]
  v_mfma_f32_16x16x32_bf16 v[248:251], a[92:95], a[136:139], v[248:251]
  v_mfma_f32_16x16x32_bf16 v[252:255], a[92:95], a[140:143], v[252:255]
  s_waitcnt lgkmcnt(14)
  v_mfma_f32_16x16x32_bf16 v[128:131], a[96:99], a[144:147], v[128:131]
  ds_read_b128 a[128:131], v23 offset:24576
  ds_read_b128 a[132:135], v23 offset:25600
  v_mfma_f32_16x16x32_bf16 v[132:135], a[96:99], a[148:151], v[132:135]
  ds_read_b128 a[136:139], v23 offset:26624
  ds_read_b128 a[140:143], v23 offset:27648
  v_mfma_f32_16x16x32_bf16 v[136:139], a[96:99], a[152:155], v[136:139]
  s_waitcnt vmcnt(8)
  s_add_u32 m0, s7, 0
  ds_read_b64_tr_b16 a[64:65], v64
  ds_read_b64_tr_b16 a[66:67], v64 offset:4096
  v_mfma_f32_16x16x32_bf16 v[140:143], a[96:99], a[156:159], v[140:143]
  s_waitcnt lgkmcnt(6)
  buffer_load_dwordx4 v14, s[32:35], s42 offen lds
  v_mfma_f32_16x16x32_bf16 v[144:147], a[100:103], a[144:147], v[144:147]
  ds_read_b64_tr_b16 a[68:69], v65
  ds_read_b64_tr_b16 a[70:71], v65 offset:4096
  v_mfma_f32_16x16x32_bf16 v[148:151], a[100:103], a[148:151], v[148:151]
  buffer_load_dwordx4 v15, s[32:35], s42 offen offset:1024 lds
  v_mfma_f32_16x16x32_bf16 v[152:155], a[100:103], a[152:155], v[152:155]
  ds_read_b64_tr_b16 a[72:73], v66
  ds_read_b64_tr_b16 a[74:75], v66 offset:4096
  v_mfma_f32_16x16x32_bf16 v[156:159], a[100:103], a[156:159], v[156:159]
  buffer_load_dwordx4 v16, s[32:35], s42 offen offset:2048 lds
  v_mfma_f32_16x16x32_bf16 v[160:163], a[104:107], a[144:147], v[160:163]
  ds_read_b64_tr_b16 a[76:77], v67
  ds_read_b64_tr_b16 a[78:79], v67 offset:4096
  v_mfma_f32_16x16x32_bf16 v[164:167], a[104:107], a[148:151], v[164:167]
  buffer_load_dwordx4 v17, s[32:35], s42 offen offset:3072 lds
  v_mfma_f32_16x16x32_bf16 v[168:171], a[104:107], a[152:155], v[168:171]
  s_add_u32 s42, s42, 16384
  s_add_u32 m0, s7, 4096
  ds_read_b64_tr_b16 a[80:81], v68
  ds_read_b64_tr_b16 a[82:83], v68 offset:4096
  v_mfma_f32_16x16x32_bf16 v[172:175], a[104:107], a[156:159], v[172:175]
  buffer_load_dwordx4 v14, s[32:35], s42 offen lds
  v_mfma_f32_16x16x32_bf16 v[176:179], a[108:111], a[144:147], v[176:179]
  ds_read_b64_tr_b16 a[84:85], v69
  ds_read_b64_tr_b16 a[86:87], v69 offset:4096
  v_mfma_f32_16x16x32_bf16 v[180:183], a[108:111], a[148:151], v[180:183]
  buffer_load_dwordx4 v15, s[32:35], s42 offen offset:1024 lds
  v_mfma_f32_16x16x32_bf16 v[184:187], a[108:111], a[152:155], v[184:187]
  ds_read_b64_tr_b16 a[88:89], v70
  ds_read_b64_tr_b16 a[90:91], v70 offset:4096
  v_mfma_f32_16x16x32_bf16 v[188:191], a[108:111], a[156:159], v[188:191]
  buffer_load_dwordx4 v16, s[32:35], s42 offen offset:2048 lds
  v_mfma_f32_16x16x32_bf16 v[192:195], a[112:115], a[144:147], v[192:195]
  ds_read_b64_tr_b16 a[92:93], v71
  ds_read_b64_tr_b16 a[94:95], v71 offset:4096
  v_mfma_f32_16x16x32_bf16 v[196:199], a[112:115], a[148:151], v[196:199]
  buffer_load_dwordx4 v17, s[32:35], s42 offen offset:3072 lds
  v_mfma_f32_16x16x32_bf16 v[200:203], a[112:115], a[152:155], v[200:203]
  s_add_u32 s42, s42, 16384
  v_mfma_f32_16x16x32_bf16 v[204:207], a[112:115], a[156:159], v[204:207]
  v_mfma_f32_16x16x32_bf16 v[208:211], a[116:119], a[144:147], v[208:211]
  v_mfma_f32_16x16x32_bf16 v[212:215], a[116:119], a[148:151], v[212:215]
  v_mfma_f32_16x16x32_bf16 v[216:219], a[116:119], a[152:155], v[216:219]
  v_mfma_f32_16x16x32_bf16 v[220:223], a[116:119], a[156:159], v[220:223]
  v_mfma_f32_16x16x32_bf16 v[224:227], a[120:123], a[144:147], v[224:227]
  v_mfma_f32_16x16x32_bf16 v[228:231], a[120:123], a[148:151], v[228:231]
  v_mfma_f32_16x16x32_bf16 v[232:235], a[120:123], a[152:155], v[232:235]
  v_mfma_f32_16x16x32_bf16 v[236:239], a[120:123], a[156:159], v[236:239]
  v_mfma_f32_16x16x32_bf16 v[240:243], a[124:127], a[144:147], v[240:243]
  v_mfma_f32_16x16x32_bf16 v[244:247], a[124:127], a[148:151], v[244:247]
  v_mfma_f32_16x16x32_bf16 v[248:251], a[124:127], a[152:155], v[248:251]
  v_mfma_f32_16x16x32_bf16 v[252:255], a[124:127], a[156:159], v[252:255]
  s_waitcnt lgkmcnt(14)
  v_mfma_f32_16x16x32_bf16 v[128:131], a[64:67], a[128:131], v[128:131]
  ds_read_b128 a[144:147], v23 offset:28672
  ds_read_b128 a[148:151], v23 offset:29696
  v_mfma_f32_16x16x32_bf16 v[132:135], a[64:67], a[132:135], v[132:135]
  ds_read_b128 a[152:155], v23 offset:30720
  ds_read_b128 a[156:159], v23 offset:31744
  v_mfma_f32_16x16x32_bf16 v[136:139], a[64:67], a[136:139], v[136:139]
  s_waitcnt vmcnt(8)
  s_add_u32 m0, s27, 0
  ds_read_b64_tr_b16 a[96:97], v64 offset:8192
  ds_read_b64_tr_b16 a[98:99], v64 offset:12288
  v_mfma_f32_16x16x32_bf16 v[140:143], a[64:67], a[140:143], v[140:143]
  s_waitcnt lgkmcnt(6)
  buffer_load_dwordx4 v14, s[32:35], s42 offen lds
  v_mfma_f32_16x16x32_bf16 v[144:147], a[68:71], a[128:131], v[144:147]
  ds_read_b64_tr_b16 a[100:101], v65 offset:8192
  ds_read_b64_tr_b16 a[102:103], v65 offset:12288
  v_mfma_f32_16x16x32_bf16 v[148:151], a[68:71], a[132:135], v[148:151]
  buffer_load_dwordx4 v15, s[32:35], s42 offen offset:1024 lds
  v_mfma_f32_16x16x32_bf16 v[152:155], a[68:71], a[136:139], v[152:155]
  ds_read_b64_tr_b16 a[104:105], v66 offset:8192
  ds_read_b64_tr_b16 a[106:107], v66 offset:12288
  v_mfma_f32_16x16x32_bf16 v[156:159], a[68:71], a[140:143], v[156:159]
  buffer_load_dwordx4 v16, s[32:35], s42 offen offset:2048 lds
  v_mfma_f32_16x16x32_bf16 v[160:163], a[72:75], a[128:131], v[160:163]
  ds_read_b64_tr_b16 a[108:109], v67 offset:8192
  ds_read_b64_tr_b16 a[110:111], v67 offset:12288
  v_mfma_f32_16x16x32_bf16 v[164:167], a[72:75], a[132:135], v[164:167]
  buffer_load_dwordx4 v17, s[32:35], s42 offen offset:3072 lds
  v_mfma_f32_16x16x32_bf16 v[168:171], a[72:75], a[136:139], v[168:171]
  s_add_u32 s42, s42, 16384
  s_add_u32 m0, s27, 4096
  ds_read_b64_tr_b16 a[112:113], v68 offset:8192
  ds_read_b64_tr_b16 a[114:115], v68 offset:12288
  v_mfma_f32_16x16x32_bf16 v[172:175], a[72:75], a[140:143], v[172:175]
  buffer_load_dwordx4 v14, s[32:35], s42 offen lds
  v_mfma_f32_16x16x32_bf16 v[176:179], a[76:79], a[128:131], v[176:179]
  ds_read_b64_tr_b16 a[116:117], v69 offset:8192
  ds_read_b64_tr_b16 a[118:119], v69 offset:12288
  v_mfma_f32_16x16x32_bf16 v[180:183], a[76:79], a[132:135], v[180:183]
  buffer_load_dwordx4 v15, s[32:35], s42 offen offset:1024 lds
  v_mfma_f32_16x16x32_bf16 v[184:187], a[76:79], a[136:139], v[184:187]
  ds_read_b64_tr_b16 a[120:121], v70 offset:8192
  ds_read_b64_tr_b16 a[122:123], v70 offset:12288
  v_mfma_f32_16x16x32_bf16 v[188:191], a[76:79], a[140:143], v[188:191]
  buffer_load_dwordx4 v16, s[32:35], s42 offen offset:2048 lds
  v_mfma_f32_16x16x32_bf16 v[192:195], a[80:83], a[128:131], v[192:195]
  ds_read_b64_tr_b16 a[124:125], v71 offset:8192
  ds_read_b64_tr_b16 a[126:127], v71 offset:12288
  v_mfma_f32_16x16x32_bf16 v[196:199], a[80:83], a[132:135], v[196:199]
  buffer_load_dwordx4 v17, s[32:35], s42 offen offset:3072 lds
  v_mfma_f32_16x16x32_bf16 v[200:203], a[80:83], a[136:139], v[200:203]
  s_add_u32 s42, s42, 16384
  v_mfma_f32_16x16x32_bf16 v[204:207], a[80:83], a[140:143], v[204:207]
  v_mfma_f32_16x16x32_bf16 v[208:211], a[84:87], a[128:131], v[208:211]
  v_mfma_f32_16x16x32_bf16 v[212:215], a[84:87], a[132:135], v[212:215]
  v_mfma_f32_16x16x32_bf16 v[216:219], a[84:87], a[136:139], v[216:219]
  v_mfma_f32_16x16x32_bf16 v[220:223], a[84:87], a[140:143], v[220:223]
  v_mfma_f32_16x16x32_bf16 v[224:227], a[88:91], a[128:131], v[224:227]
  v_mfma_f32_16x16x32_bf16 v[228:231], a[88:91], a[132:135], v[228:231]
  v_mfma_f32_16x16x32_bf16 v[232:235], a[88:91], a[136:139], v[232:235]
  v_mfma_f32_16x16x32_bf16 v[236:239], a[88:91], a[140:143], v[236:239]
  v_mfma_f32_16x16x32_bf16 v[240:243], a[92:95], a[128:131], v[240:243]
  v_mfma_f32_16x16x32_bf16 v[244:247], a[92:95], a[132:135], v[244:247]
  v_mfma_f32_16x16x32_bf16 v[248:251], a[92:95], a[136:139], v[248:251]
  v_mfma_f32_16x16x32_bf16 v[252:255], a[92:95], a[140:143], v[252:255]
  s_waitcnt lgkmcnt(14)
  v_mfma_f32_16x16x32_bf16 v[128:131], a[96:99], a[144:147], v[128:131]
  ds_read_b128 a[128:131], v23 offset:32768
  ds_read_b128 a[132:135], v23 offset:33792
  v_mfma_f32_16x16x32_bf16 v[132:135], a[96:99], a[148:151], v[132:135]
  ds_read_b128 a[136:139], v23 offset:34816
  ds_read_b128 a[140:143], v23 offset:35840
  v_mfma_f32_16x16x32_bf16 v[136:139], a[96:99], a[152:155], v[136:139]
  s_waitcnt vmcnt(8)
  s_add_u32 m0, s27, 8192
  ds_read_b64_tr_b16 a[64:65], v72
  ds_read_b64_tr_b16 a[66:67], v72 offset:4096
  v_mfma_f32_16x16x32_bf16 v[140:143], a[96:99], a[156:159], v[140:143]
  s_waitcnt lgkmcnt(6)
  buffer_load_dwordx4 v14, s[32:35], s42 offen lds
  v_mfma_f32_16x16x32_bf16 v[144:147], a[100:103], a[144:147], v[144:147]
  ds_read_b64_tr_b16 a[68:69], v73
  ds_read_b64_tr_b16 a[70:71], v73 offset:4096
  v_mfma_f32_16x16x32_bf16 v[148:151], a[100:103], a[148:151], v[148:151]
  buffer_load_dwordx4 v15, s[32:35], s42 offen offset:1024 lds
  v_mfma_f32_16x16x32_bf16 v[152:155], a[100:103], a[152:155], v[152:155]
  ds_read_b64_tr_b16 a[72:73], v74
  ds_read_b64_tr_b16 a[74:75], v74 offset:4096
  v_mfma_f32_16x16x32_bf16 v[156:159], a[100:103], a[156:159], v[156:159]
  buffer_load_dwordx4 v16, s[32:35], s42 offen offset:2048 lds
  v_mfma_f32_16x16x32_bf16 v[160:163], a[104:107], a[144:147], v[160:163]
  ds_read_b64_tr_b16 a[76:77], v75
  ds_read_b64_tr_b16 a[78:79], v75 offset:4096
  v_mfma_f32_16x16x32_bf16 v[164:167], a[104:107], a[148:151], v[164:167]
  buffer_load_dwordx4 v17, s[32:35], s42 offen offset:3072 lds
  v_mfma_f32_16x16x32_bf16 v[168:171], a[104:107], a[152:155], v[168:171]
  s_add_u32 s42, s42, 16384
  s_add_u32 m0, s27, 12288
  ds_read_b64_tr_b16 a[80:81], v76
  ds_read_b64_tr_b16 a[82:83], v76 offset:4096
  v_mfma_f32_16x16x32_bf16 v[172:175], a[104:107], a[156:159], v[172:175]
  buffer_load_dwordx4 v14, s[32:35], s42 offen lds
  v_mfma_f32_16x16x32_bf16 v[176:179], a[108:111], a[144:147], v[176:179]
  ds_read_b64_tr_b16 a[84:85], v77
  ds_read_b64_tr_b16 a[86:87], v77 offset:4096
  v_mfma_f32_16x16x32_bf16 v[180:183], a[108:111], a[148:151], v[180:183]
  buffer_load_dwordx4 v15, s[32:35], s42 offen offset:1024 lds
  v_mfma_f32_16x16x32_bf16 v[184:187], a[108:111], a[152:155], v[184:187]
  ds_read_b64_tr_b16 a[88:89], v78
  ds_read_b64_tr_b16 a[90:91], v78 offset:4096
  v_mfma_f32_16x16x32_bf16 v[188:191], a[108:111], a[156:159], v[188:191]
  buffer_load_dwordx4 v16, s[32:35], s42 offen offset:2048 lds
  v_mfma_f32_16x16x32_bf16 v[192:195], a[112:115], a[144:147], v[192:195]
  ds_read_b64_tr_b16 a[92:93], v79
  ds_read_b64_tr_b16 a[94:95], v79 offset:4096
  v_mfma_f32_16x16x32_bf16 v[196:199], a[112:115], a[148:151], v[196:199]
  buffer_load_dwordx4 v17, s[32:35], s42 offen offset:3072 lds
  v_mfma_f32_16x16x32_bf16 v[200:203], a[112:115], a[152:155], v[200:203]
  s_add_u32 s42, s42, 16384
  v_mfma_f32_16x16x32_bf16 v[204:207], a[112:115], a[156:159], v[204:207]
  v_mfma_f32_16x16x32_bf16 v[208:211], a[116:119], a[144:147], v[208:211]
  v_mfma_f32_16x16x32_bf16 v[212:215], a[116:119], a[148:151], v[212:215]
  v_mfma_f32_16x16x32_bf16 v[216:219], a[116:119], a[152:155], v[216:219]
  v_mfma_f32_16x16x32_bf16 v[220:223], a[116:119], a[156:159], v[220:223]
  v_mfma_f32_16x16x32_bf16 v[224:227], a[120:123], a[144:147], v[224:227]
  v_mfma_f32_16x16x32_bf16 v[228:231], a[120:123], a[148:151], v[228:231]
  v_mfma_f32_16x16x32_bf16 v[232:235], a[120:123], a[152:155], v[232:235]
  v_mfma_f32_16x16x32_bf16 v[236:239], a[120:123], a[156:159], v[236:239]
  v_mfma_f32_16x16x32_bf16 v[240:243], a[124:127], a[144:147], v[240:243]
  v_mfma_f32_16x16x32_bf16 v[244:247], a[124:127], a[148:151], v[244:247]
  v_mfma_f32_16x16x32_bf16 v[248:251], a[124:127], a[152:155], v[248:251]
  v_mfma_f32_16x16x32_bf16 v[252:255], a[124:127], a[156:159], v[252:255]
  s_waitcnt lgkmcnt(14)
  v_mfma_f32_16x16x32_bf16 v[128:131], a[64:67], a[128:131], v[128:131]
  ds_read_b128 a[144:147], v23 offset:36864
  ds_read_b128 a[148:151], v23 offset:37888
  v_mfma_f32_16x16x32_bf16 v[132:135], a[64:67], a[132:135], v[132:135]
  ds_read_b128 a[152:155], v23 offset:38912
  ds_read_b128 a[156:159], v23 offset:39936
  v_mfma_f32_16x16x32_bf16 v[136:139], a[64:67], a[136:139], v[136:139]
  s_waitcnt vmcnt(8)
  s_add_u32 m0, s7, 0
  ds_read_b64_tr_b16 a[96:97], v64
  ds_read_b64_tr_b16 a[98:99], v64 offset:4096
  v_mfma_f32_16x16x32_bf16 v[140:143], a[64:67], a[140:143], v[140:143]
  s_waitcnt lgkmcnt(6)
  buffer_load_dwordx4 v14, s[32:35], s42 offen lds
  v_mfma_f32_16x16x32_bf16 v[144:147], a[68:71], a[128:131], v[144:147]
  ds_read_b64_tr_b16 a[100:101], v65
  ds_read_b64_tr_b16 a[102:103], v65 offset:4096
  v_mfma_f32_16x16x32_bf16 v[148:151], a[68:71], a[132:135], v[148:151]
  buffer_load_dwordx4 v15, s[32:35], s42 offen offset:1024 lds
  v_mfma_f32_16x16x32_bf16 v[152:155], a[68:71], a[136:139], v[152:155]
  ds_read_b64_tr_b16 a[104:105], v66
  ds_read_b64_tr_b16 a[106:107], v66 offset:4096
  v_mfma_f32_16x16x32_bf16 v[156:159], a[68:71], a[140:143], v[156:159]
  buffer_load_dwordx4 v16, s[32:35], s42 offen offset:2048 lds
  v_mfma_f32_16x16x32_bf16 v[160:163], a[72:75], a[128:131], v[160:163]
  ds_read_b64_tr_b16 a[108:109], v67
  ds_read_b64_tr_b16 a[110:111], v67 offset:4096
  v_mfma_f32_16x16x32_bf16 v[164:167], a[72:75], a[132:135], v[164:167]
  buffer_load_dwordx4 v17, s[32:35], s42 offen offset:3072 lds
  v_mfma_f32_16x16x32_bf16 v[168:171], a[72:75], a[136:139], v[168:171]
  s_add_u32 s42, s42, 16384
  s_add_u32 m0, s7, 4096
  ds_read_b64_tr_b16 a[112:113], v68
  ds_read_b64_tr_b16 a[114:115], v68 offset:4096
  v_mfma_f32_16x16x32_bf16 v[172:175], a[72:75], a[140:143], v[172:175]
  buffer_load_dwordx4 v14, s[32:35], s42 offen lds
  v_mfma_f32_16x16x32_bf16 v[176:179], a[76:79], a[128:131], v[176:179]
  ds_read_b64_tr_b16 a[116:117], v69
  ds_read_b64_tr_b16 a[118:119], v69 offset:4096
  v_mfma_f32_16x16x32_bf16 v[180:183], a[76:79], a[132:135], v[180:183]
  buffer_load_dwordx4 v15, s[32:35], s42 offen offset:1024 lds
  v_mfma_f32_16x16x32_bf16 v[184:187], a[76:79], a[136:139], v[184:187]
  ds_read_b64_tr_b16 a[120:121], v70
  ds_read_b64_tr_b16 a[122:123], v70 offset:4096
  v_mfma_f32_16x16x32_bf16 v[188:191], a[76:79], a[140:143], v[188:191]
  buffer_load_dwordx4 v16, s[32:35], s42 offen offset:2048 lds
  v_mfma_f32_16x16x32_bf16 v[192:195], a[80:83], a[128:131], v[192:195]
  ds_read_b64_tr_b16 a[124:125], v71
  ds_read_b64_tr_b16 a[126:127], v71 offset:4096
  v_mfma_f32_16x16x32_bf16 v[196:199], a[80:83], a[132:135], v[196:199]
  buffer_load_dwordx4 v17, s[32:35], s42 offen offset:3072 lds
  v_mfma_f32_16x16x32_bf16 v[200:203], a[80:83], a[136:139], v[200:203]
  s_add_u32 s42, s42, 16384
  v_mfma_f32_16x16x32_bf16 v[204:207], a[80:83], a[140:143], v[204:207]
  v_mfma_f32_16x16x32_bf16 v[208:211], a[84:87], a[128:131], v[208:211]
  v_mfma_f32_16x16x32_bf16 v[212:215], a[84:87], a[132:135], v[212:215]
  v_mfma_f32_16x16x32_bf16 v[216:219], a[84:87], a[136:139], v[216:219]
  v_mfma_f32_16x16x32_bf16 v[220:223], a[84:87], a[140:143], v[220:223]
  v_mfma_f32_16x16x32_bf16 v[224:227], a[88:91], a[128:131], v[224:227]
  v_mfma_f32_16x16x32_bf16 v[228:231], a[88:91], a[132:135], v[228:231]
  v_mfma_f32_16x16x32_bf16 v[232:235], a[88:91], a[136:139], v[232:235]
  v_mfma_f32_16x16x32_bf16 v[236:239], a[88:91], a[140:143], v[236:239]
  v_mfma_f32_16x16x32_bf16 v[240:243], a[92:95], a[128:131], v[240:243]
  v_mfma_f32_16x16x32_bf16 v[244:247], a[92:95], a[132:135], v[244:247]
  v_mfma_f32_16x16x32_bf16 v[248:251], a[92:95], a[136:139], v[248:251]
  v_mfma_f32_16x16x32_bf16 v[252:255], a[92:95], a[140:143], v[252:255]
  s_waitcnt lgkmcnt(14)
  v_mfma_f32_16x16x32_bf16 v[128:131], a[96:99], a[144:147], v[128:131]
  ds_read_b128 a[128:131], v23 offset:40960
  ds_read_b128 a[132:135], v23 offset:41984
  v_mfma_f32_16x16x32_bf16 v[132:135], a[96:99], a[148:151], v[132:135]
  ds_read_b128 a[136:139], v23 offset:43008
  ds_read_b128 a[140:143], v23 offset:44032
  v_mfma_f32_16x16x32_bf16 v[136:139], a[96:99], a[152:155], v[136:139]
  s_waitcnt vmcnt(8)
  s_add_u32 m0, s27, 0
  ds_read_b64_tr_b16 a[64:65], v64 offset:8192
  ds_read_b64_tr_b16 a[66:67], v64 offset:12288
  v_mfma_f32_16x16x32_bf16 v[140:143], a[96:99], a[156:159], v[140:143]
  s_waitcnt lgkmcnt(6)
  buffer_load_dwordx4 v14, s[32:35], s42 offen lds
  v_mfma_f32_16x16x32_bf16 v[144:147], a[100:103], a[144:147], v[144:147]
  ds_read_b64_tr_b16 a[68:69], v65 offset:8192
  ds_read_b64_tr_b16 a[70:71], v65 offset:12288
  v_mfma_f32_16x16x32_bf16 v[148:151], a[100:103], a[148:151], v[148:151]
  buffer_load_dwordx4 v15, s[32:35], s42 offen offset:1024 lds
  v_mfma_f32_16x16x32_bf16 v[152:155], a[100:103], a[152:155], v[152:155]
  ds_read_b64_tr_b16 a[72:73], v66 offset:8192
  ds_read_b64_tr_b16 a[74:75], v66 offset:12288
  v_mfma_f32_16x16x32_bf16 v[156:159], a[100:103], a[156:159], v[156:159]
  buffer_load_dwordx4 v16, s[32:35], s42 offen offset:2048 lds
  v_mfma_f32_16x16x32_bf16 v[160:163], a[104:107], a[144:147], v[160:163]
  ds_read_b64_tr_b16 a[76:77], v67 offset:8192
  ds_read_b64_tr_b16 a[78:79], v67 offset:12288
  v_mfma_f32_16x16x32_bf16 v[164:167], a[104:107], a[148:151], v[164:167]
  buffer_load_dwordx4 v17, s[32:35], s42 offen offset:3072 lds
  v_mfma_f32_16x16x32_bf16 v[168:171], a[104:107], a[152:155], v[168:171]
  s_add_u32 s42, s42, 16384
  s_add_u32 m0, s27, 4096
  ds_read_b64_tr_b16 a[80:81], v68 offset:8192
  ds_read_b64_tr_b16 a[82:83], v68 offset:12288
  v_mfma_f32_16x16x32_bf16 v[172:175], a[104:107], a[156:159], v[172:175]
  buffer_load_dwordx4 v14, s[32:35], s42 offen lds
  v_mfma_f32_16x16x32_bf16 v[176:179], a[108:111], a[144:147], v[176:179]
  ds_read_b64_tr_b16 a[84:85], v69 offset:8192
  ds_read_b64_tr_b16 a[86:87], v69 offset:12288
  v_mfma_f32_16x16x32_bf16 v[180:183], a[108:111], a[148:151], v[180:183]
  buffer_load_dwordx4 v15, s[32:35], s42 offen offset:1024 lds
  v_mfma_f32_16x16x32_bf16 v[184:187], a[108:111], a[152:155], v[184:187]
  ds_read_b64_tr_b16 a[88:89], v70 offset:8192
  ds_read_b64_tr_b16 a[90:91], v70 offset:12288
  v_mfma_f32_16x16x32_bf16 v[188:191], a[108:111], a[156:159], v[188:191]
  buffer_load_dwordx4 v16, s[32:35], s42 offen offset:2048 lds
  v_mfma_f32_16x16x32_bf16 v[192:195], a[112:115], a[144:147], v[192:195]
  ds_read_b64_tr_b16 a[92:93], v71 offset:8192
  ds_read_b64_tr_b16 a[94:95], v71 offset:12288
  v_mfma_f32_16x16x32_bf16 v[196:199], a[112:115], a[148:151], v[196:199]
  buffer_load_dwordx4 v17, s[32:35], s42 offen offset:3072 lds
  v_mfma_f32_16x16x32_bf16 v[200:203], a[112:115], a[152:155], v[200:203]
  s_add_u32 s42, s42, 16384
  v_mfma_f32_16x16x32_bf16 v[204:207], a[112:115], a[156:159], v[204:207]
  v_mfma_f32_16x16x32_bf16 v[208:211], a[116:119], a[144:147], v[208:211]
  v_mfma_f32_16x16x32_bf16 v[212:215], a[116:119], a[148:151], v[212:215]
  v_mfma_f32_16x16x32_bf16 v[216:219], a[116:119], a[152:155], v[216:219]
  v_mfma_f32_16x16x32_bf16 v[220:223], a[116:119], a[156:159], v[220:223]
  v_mfma_f32_16x16x32_bf16 v[224:227], a[120:123], a[144:147], v[224:227]
  v_mfma_f32_16x16x32_bf16 v[228:231], a[120:123], a[148:151], v[228:231]
  v_mfma_f32_16x16x32_bf16 v[232:235], a[120:123], a[152:155], v[232:235]
  v_mfma_f32_16x16x32_bf16 v[236:239], a[120:123], a[156:159], v[236:239]
  v_mfma_f32_16x16x32_bf16 v[240:243], a[124:127], a[144:147], v[240:243]
  v_mfma_f32_16x16x32_bf16 v[244:247], a[124:127], a[148:151], v[244:247]
  v_mfma_f32_16x16x32_bf16 v[248:251], a[124:127], a[152:155], v[248:251]
  v_mfma_f32_16x16x32_bf16 v[252:255], a[124:127], a[156:159], v[252:255]
  s_waitcnt lgkmcnt(14)
  v_mfma_f32_16x16x32_bf16 v[128:131], a[64:67], a[128:131], v[128:131]
  ds_read_b128 a[144:147], v23 offset:45056
  ds_read_b128 a[148:151], v23 offset:46080
  v_mfma_f32_16x16x32_bf16 v[132:135], a[64:67], a[132:135], v[132:135]
  ds_read_b128 a[152:155], v23 offset:47104
  ds_read_b128 a[156:159], v23 offset:48128
  v_mfma_f32_16x16x32_bf16 v[136:139], a[64:67], a[136:139], v[136:139]
  s_waitcnt vmcnt(8)
  s_add_u32 m0, s27, 8192
  ds_read_b64_tr_b16 a[96:97], v72
  ds_read_b64_tr_b16 a[98:99], v72 offset:4096
  v_mfma_f32_16x16x32_bf16 v[140:143], a[64:67], a[140:143], v[140:143]
  s_waitcnt lgkmcnt(6)
  buffer_load_dwordx4 v14, s[32:35], s42 offen lds
  v_mfma_f32_16x16x32_bf16 v[144:147], a[68:71], a[128:131], v[144:147]
  ds_read_b64_tr_b16 a[100:101], v73
  ds_read_b64_tr_b16 a[102:103], v73 offset:4096
  v_mfma_f32_16x16x32_bf16 v[148:151], a[68:71], a[132:135], v[148:151]
  buffer_load_dwordx4 v15, s[32:35], s42 offen offset:1024 lds
  v_mfma_f32_16x16x32_bf16 v[152:155], a[68:71], a[136:139], v[152:155]
  ds_read_b64_tr_b16 a[104:105], v74
  ds_read_b64_tr_b16 a[106:107], v74 offset:4096
  v_mfma_f32_16x16x32_bf16 v[156:159], a[68:71], a[140:143], v[156:159]
  buffer_load_dwordx4 v16, s[32:35], s42 offen offset:2048 lds
  v_mfma_f32_16x16x32_bf16 v[160:163], a[72:75], a[128:131], v[160:163]
  ds_read_b64_tr_b16 a[108:109], v75
  ds_read_b64_tr_b16 a[110:111], v75 offset:4096
  v_mfma_f32_16x16x32_bf16 v[164:167], a[72:75], a[132:135], v[164:167]
  buffer_load_dwordx4 v17, s[32:35], s42 offen offset:3072 lds
  v_mfma_f32_16x16x32_bf16 v[168:171], a[72:75], a[136:139], v[168:171]
  s_add_u32 s42, s42, 16384
  s_add_u32 m0, s27, 12288
  ds_read_b64_tr_b16 a[112:113], v76
  ds_read_b64_tr_b16 a[114:115], v76 offset:4096
  v_mfma_f32_16x16x32_bf16 v[172:175], a[72:75], a[140:143], v[172:175]
  buffer_load_dwordx4 v14, s[32:35], s42 offen lds
  v_mfma_f32_16x16x32_bf16 v[176:179], a[76:79], a[128:131], v[176:179]
  ds_read_b64_tr_b16 a[116:117], v77
  ds_read_b64_tr_b16 a[118:119], v77 offset:4096
  v_mfma_f32_16x16x32_bf16 v[180:183], a[76:79], a[132:135], v[180:183]
  buffer_load_dwordx4 v15, s[32:35], s42 offen offset:1024 lds
  v_mfma_f32_16x16x32_bf16 v[184:187], a[76:79], a[136:139], v[184:187]
  ds_read_b64_tr_b16 a[120:121], v78
  ds_read_b64_tr_b16 a[122:123], v78 offset:4096
  v_mfma_f32_16x16x32_bf16 v[188:191], a[76:79], a[140:143], v[188:191]
  buffer_load_dwordx4 v16, s[32:35], s42 offen offset:2048 lds
  v_mfma_f32_16x16x32_bf16 v[192:195], a[80:83], a[128:131], v[192:195]
  ds_read_b64_tr_b16 a[124:125], v79
  ds_read_b64_tr_b16 a[126:127], v79 offset:4096
  v_mfma_f32_16x16x32_bf16 v[196:199], a[80:83], a[132:135], v[196:199]
  buffer_load_dwordx4 v17, s[32:35], s42 offen offset:3072 lds
  v_mfma_f32_16x16x32_bf16 v[200:203], a[80:83], a[136:139], v[200:203]
  s_add_u32 s42, s42, 16384
  v_mfma_f32_16x16x32_bf16 v[204:207], a[80:83], a[140:143], v[204:207]
  v_mfma_f32_16x16x32_bf16 v[208:211], a[84:87], a[128:131], v[208:211]
  v_mfma_f32_16x16x32_bf16 v[212:215], a[84:87], a[132:135], v[212:215]
  v_mfma_f32_16x16x32_bf16 v[216:219], a[84:87], a[136:139], v[216:219]
  v_mfma_f32_16x16x32_bf16 v[220:223], a[84:87], a[140:143], v[220:223]
  v_mfma_f32_16x16x32_bf16 v[224:227], a[88:91], a[128:131], v[224:227]
  v_mfma_f32_16x16x32_bf16 v[228:231], a[88:91], a[132:135], v[228:231]
  v_mfma_f32_16x16x32_bf16 v[232:235], a[88:91], a[136:139], v[232:235]
  v_mfma_f32_16x16x32_bf16 v[236:239], a[88:91], a[140:143], v[236:239]
  v_mfma_f32_16x16x32_bf16 v[240:243], a[92:95], a[128:131], v[240:243]
  v_mfma_f32_16x16x32_bf16 v[244:247], a[92:95], a[132:135], v[244:247]
  v_mfma_f32_16x16x32_bf16 v[248:251], a[92:95], a[136:139], v[248:251]
  v_mfma_f32_16x16x32_bf16 v[252:255], a[92:95], a[140:143], v[252:255]
  s_waitcnt lgkmcnt(14)
  v_mfma_f32_16x16x32_bf16 v[128:131], a[96:99], a[144:147], v[128:131]
  ds_read_b128 a[128:131], v23 offset:49152
  ds_read_b128 a[132:135], v23 offset:50176
  v_mfma_f32_16x16x32_bf16 v[132:135], a[96:99], a[148:151], v[132:135]
  ds_read_b128 a[136:139], v23 offset:51200
  ds_read_b128 a[140:143], v23 offset:52224
  v_mfma_f32_16x16x32_bf16 v[136:139], a[96:99], a[152:155], v[136:139]
  s_waitcnt vmcnt(8)
  s_add_u32 m0, s7, 0
  ds_read_b64_tr_b16 a[64:65], v64
  ds_read_b64_tr_b16 a[66:67], v64 offset:4096
  v_mfma_f32_16x16x32_bf16 v[140:143], a[96:99], a[156:159], v[140:143]
  s_waitcnt lgkmcnt(6)
  buffer_load_dwordx4 v14, s[32:35], s42 offen lds
  v_mfma_f32_16x16x32_bf16 v[144:147], a[100:103], a[144:147], v[144:147]
  ds_read_b64_tr_b16 a[68:69], v65
  ds_read_b64_tr_b16 a[70:71], v65 offset:4096
  v_mfma_f32_16x16x32_bf16 v[148:151], a[100:103], a[148:151], v[148:151]
  buffer_load_dwordx4 v15, s[32:35], s42 offen offset:1024 lds
  v_mfma_f32_16x16x32_bf16 v[152:155], a[100:103], a[152:155], v[152:155]
  ds_read_b64_tr_b16 a[72:73], v66
  ds_read_b64_tr_b16 a[74:75], v66 offset:4096
  v_mfma_f32_16x16x32_bf16 v[156:159], a[100:103], a[156:159], v[156:159]
  buffer_load_dwordx4 v16, s[32:35], s42 offen offset:2048 lds
  v_mfma_f32_16x16x32_bf16 v[160:163], a[104:107], a[144:147], v[160:163]
  ds_read_b64_tr_b16 a[76:77], v67
  ds_read_b64_tr_b16 a[78:79], v67 offset:4096
  v_mfma_f32_16x16x32_bf16 v[164:167], a[104:107], a[148:151], v[164:167]
  buffer_load_dwordx4 v17, s[32:35], s42 offen offset:3072 lds
  v_mfma_f32_16x16x32_bf16 v[168:171], a[104:107], a[152:155], v[168:171]
  s_add_u32 s42, s42, 16384
  s_add_u32 m0, s7, 4096
  ds_read_b64_tr_b16 a[80:81], v68
  ds_read_b64_tr_b16 a[82:83], v68 offset:4096
  v_mfma_f32_16x16x32_bf16 v[172:175], a[104:107], a[156:159], v[172:175]
  buffer_load_dwordx4 v14, s[32:35], s42 offen lds
  v_mfma_f32_16x16x32_bf16 v[176:179], a[108:111], a[144:147], v[176:179]
  ds_read_b64_tr_b16 a[84:85], v69
  ds_read_b64_tr_b16 a[86:87], v69 offset:4096
  v_mfma_f32_16x16x32_bf16 v[180:183], a[108:111], a[148:151], v[180:183]
  buffer_load_dwordx4 v15, s[32:35], s42 offen offset:1024 lds
  v_mfma_f32_16x16x32_bf16 v[184:187], a[108:111], a[152:155], v[184:187]
  ds_read_b64_tr_b16 a[88:89], v70
  ds_read_b64_tr_b16 a[90:91], v70 offset:4096
  v_mfma_f32_16x16x32_bf16 v[188:191], a[108:111], a[156:159], v[188:191]
  buffer_load_dwordx4 v16, s[32:35], s42 offen offset:2048 lds
  v_mfma_f32_16x16x32_bf16 v[192:195], a[112:115], a[144:147], v[192:195]
  ds_read_b64_tr_b16 a[92:93], v71
  ds_read_b64_tr_b16 a[94:95], v71 offset:4096
  v_mfma_f32_16x16x32_bf16 v[196:199], a[112:115], a[148:151], v[196:199]
  buffer_load_dwordx4 v17, s[32:35], s42 offen offset:3072 lds
  v_mfma_f32_16x16x32_bf16 v[200:203], a[112:115], a[152:155], v[200:203]
  s_add_u32 s42, s42, 16384
  v_mfma_f32_16x16x32_bf16 v[204:207], a[112:115], a[156:159], v[204:207]
  v_mfma_f32_16x16x32_bf16 v[208:211], a[116:119], a[144:147], v[208:211]
  v_mfma_f32_16x16x32_bf16 v[212:215], a[116:119], a[148:151], v[212:215]
  v_mfma_f32_16x16x32_bf16 v[216:219], a[116:119], a[152:155], v[216:219]
  v_mfma_f32_16x16x32_bf16 v[220:223], a[116:119], a[156:159], v[220:223]
  v_mfma_f32_16x16x32_bf16 v[224:227], a[120:123], a[144:147], v[224:227]
  v_mfma_f32_16x16x32_bf16 v[228:231], a[120:123], a[148:151], v[228:231]
  v_mfma_f32_16x16x32_bf16 v[232:235], a[120:123], a[152:155], v[232:235]
  v_mfma_f32_16x16x32_bf16 v[236:239], a[120:123], a[156:159], v[236:239]
  v_mfma_f32_16x16x32_bf16 v[240:243], a[124:127], a[144:147], v[240:243]
  v_mfma_f32_16x16x32_bf16 v[244:247], a[124:127], a[148:151], v[244:247]
  v_mfma_f32_16x16x32_bf16 v[248:251], a[124:127], a[152:155], v[248:251]
  v_mfma_f32_16x16x32_bf16 v[252:255], a[124:127], a[156:159], v[252:255]
  s_waitcnt lgkmcnt(14)
  v_mfma_f32_16x16x32_bf16 v[128:131], a[64:67], a[128:131], v[128:131]
  ds_read_b128 a[144:147], v23 offset:53248
  ds_read_b128 a[148:151], v23 offset:54272
  v_mfma_f32_16x16x32_bf16 v[132:135], a[64:67], a[132:135], v[132:135]
  ds_read_b128 a[152:155], v23 offset:55296
  ds_read_b128 a[156:159], v23 offset:56320
  v_mfma_f32_16x16x32_bf16 v[136:139], a[64:67], a[136:139], v[136:139]
  s_waitcnt vmcnt(8)
  s_add_u32 m0, s27, 0
  ds_read_b64_tr_b16 a[96:97], v64 offset:8192
  ds_read_b64_tr_b16 a[98:99], v64 offset:12288
  v_mfma_f32_16x16x32_bf16 v[140:143], a[64:67], a[140:143], v[140:143]
  s_waitcnt lgkmcnt(6)
  buffer_load_dwordx4 v14, s[32:35], s42 offen lds
  v_mfma_f32_16x16x32_bf16 v[144:147], a[68:71], a[128:131], v[144:147]
  ds_read_b64_tr_b16 a[100:101], v65 offset:8192
  ds_read_b64_tr_b16 a[102:103], v65 offset:12288
  v_mfma_f32_16x16x32_bf16 v[148:151], a[68:71], a[132:135], v[148:151]
  buffer_load_dwordx4 v15, s[32:35], s42 offen offset:1024 lds
  v_mfma_f32_16x16x32_bf16 v[152:155], a[68:71], a[136:139], v[152:155]
  ds_read_b64_tr_b16 a[104:105], v66 offset:8192
  ds_read_b64_tr_b16 a[106:107], v66 offset:12288
  v_mfma_f32_16x16x32_bf16 v[156:159], a[68:71], a[140:143], v[156:159]
  buffer_load_dwordx4 v16, s[32:35], s42 offen offset:2048 lds
  v_mfma_f32_16x16x32_bf16 v[160:163], a[72:75], a[128:131], v[160:163]
  ds_read_b64_tr_b16 a[108:109], v67 offset:8192
  ds_read_b64_tr_b16 a[110:111], v67 offset:12288
  v_mfma_f32_16x16x32_bf16 v[164:167], a[72:75], a[132:135], v[164:167]
  buffer_load_dwordx4 v17, s[32:35], s42 offen offset:3072 lds
  v_mfma_f32_16x16x32_bf16 v[168:171], a[72:75], a[136:139], v[168:171]
  s_add_u32 s42, s42, 16384
  s_add_u32 m0, s27, 4096
  ds_read_b64_tr_b16 a[112:113], v68 offset:8192
  ds_read_b64_tr_b16 a[114:115], v68 offset:12288
  v_mfma_f32_16x16x32_bf16 v[172:175], a[72:75], a[140:143], v[172:175]
  buffer_load_dwordx4 v14, s[32:35], s42 offen lds
  v_mfma_f32_16x16x32_bf16 v[176:179], a[76:79], a[128:131], v[176:179]
  ds_read_b64_tr_b16 a[116:117], v69 offset:8192
  ds_read_b64_tr_b16 a[118:119], v69 offset:12288
  v_mfma_f32_16x16x32_bf16 v[180:183], a[76:79], a[132:135], v[180:183]
  buffer_load_dwordx4 v15, s[32:35], s42 offen offset:1024 lds
  v_mfma_f32_16x16x32_bf16 v[184:187], a[76:79], a[136:139], v[184:187]
  ds_read_b64_tr_b16 a[120:121], v70 offset:8192
  ds_read_b64_tr_b16 a[122:123], v70 offset:12288
  v_mfma_f32_16x16x32_bf16 v[188:191], a[76:79], a[140:143], v[188:191]
  buffer_load_dwordx4 v16, s[32:35], s42 offen offset:2048 lds
  v_mfma_f32_16x16x32_bf16 v[192:195], a[80:83], a[128:131], v[192:195]
  ds_read_b64_tr_b16 a[124:125], v71 offset:8192
  ds_read_b64_tr_b16 a[126:127], v71 offset:12288
  v_mfma_f32_16x16x32_bf16 v[196:199], a[80:83], a[132:135], v[196:199]
  buffer_load_dwordx4 v17, s[32:35], s42 offen offset:3072 lds
  v_mfma_f32_16x16x32_bf16 v[200:203], a[80:83], a[136:139], v[200:203]
  s_add_u32 s42, s42, 16384
  v_mfma_f32_16x16x32_bf16 v[204:207], a[80:83], a[140:143], v[204:207]
  v_mfma_f32_16x16x32_bf16 v[208:211], a[84:87], a[128:131], v[208:211]
  v_mfma_f32_16x16x32_bf16 v[212:215], a[84:87], a[132:135], v[212:215]
  v_mfma_f32_16x16x32_bf16 v[216:219], a[84:87], a[136:139], v[216:219]
  v_mfma_f32_16x16x32_bf16 v[220:223], a[84:87], a[140:143], v[220:223]
  v_mfma_f32_16x16x32_bf16 v[224:227], a[88:91], a[128:131], v[224:227]
  v_mfma_f32_16x16x32_bf16 v[228:231], a[88:91], a[132:135], v[228:231]
  v_mfma_f32_16x16x32_bf16 v[232:235], a[88:91], a[136:139], v[232:235]
  v_mfma_f32_16x16x32_bf16 v[236:239], a[88:91], a[140:143], v[236:239]
  v_mfma_f32_16x16x32_bf16 v[240:243], a[92:95], a[128:131], v[240:243]
  v_mfma_f32_16x16x32_bf16 v[244:247], a[92:95], a[132:135], v[244:247]
  v_mfma_f32_16x16x32_bf16 v[248:251], a[92:95], a[136:139], v[248:251]
  v_mfma_f32_16x16x32_bf16 v[252:255], a[92:95], a[140:143], v[252:255]
  s_waitcnt lgkmcnt(14)
  v_mfma_f32_16x16x32_bf16 v[128:131], a[96:99], a[144:147], v[128:131]
  ds_read_b128 a[128:131], v23 offset:57344
  ds_read_b128 a[132:135], v23 offset:58368
  v_mfma_f32_16x16x32_bf16 v[132:135], a[96:99], a[148:151], v[132:135]
  ds_read_b128 a[136:139], v23 offset:59392
  ds_read_b128 a[140:143], v23 offset:60416
  v_mfma_f32_16x16x32_bf16 v[136:139], a[96:99], a[152:155], v[136:139]
  s_waitcnt vmcnt(8)
  ds_read_b64_tr_b16 a[64:65], v72
  ds_read_b64_tr_b16 a[66:67], v72 offset:4096
  v_mfma_f32_16x16x32_bf16 v[140:143], a[96:99], a[156:159], v[140:143]
  s_waitcnt lgkmcnt(15)
  ds_read_b64_tr_b16 a[68:69], v73
  ds_read_b64_tr_b16 a[70:71], v73 offset:4096
  v_mfma_f32_16x16x32_bf16 v[144:147], a[100:103], a[144:147], v[144:147]
  ds_read_b64_tr_b16 a[72:73], v74
  ds_read_b64_tr_b16 a[74:75], v74 offset:4096
  v_mfma_f32_16x16x32_bf16 v[148:151], a[100:103], a[148:151], v[148:151]
  ds_read_b64_tr_b16 a[76:77], v75
  ds_read_b64_tr_b16 a[78:79], v75 offset:4096
  v_mfma_f32_16x16x32_bf16 v[152:155], a[100:103], a[152:155], v[152:155]
  ds_read_b64_tr_b16 a[80:81], v76
  ds_read_b64_tr_b16 a[82:83], v76 offset:4096
  v_mfma_f32_16x16x32_bf16 v[156:159], a[100:103], a[156:159], v[156:159]
  ds_read_b64_tr_b16 a[84:85], v77
  ds_read_b64_tr_b16 a[86:87], v77 offset:4096
  v_mfma_f32_16x16x32_bf16 v[160:163], a[104:107], a[144:147], v[160:163]
  ds_read_b64_tr_b16 a[88:89], v78
  ds_read_b64_tr_b16 a[90:91], v78 offset:4096
  v_mfma_f32_16x16x32_bf16 v[164:167], a[104:107], a[148:151], v[164:167]
  ds_read_b64_tr_b16 a[92:93], v79
  ds_read_b64_tr_b16 a[94:95], v79 offset:4096
  v_mfma_f32_16x16x32_bf16 v[168:171], a[104:107], a[152:155], v[168:171]
  v_mfma_f32_16x16x32_bf16 v[172:175], a[104:107], a[156:159], v[172:175]
  s_waitcnt lgkmcnt(15)
  v_mfma_f32_16x16x32_bf16 v[176:179], a[108:111], a[144:147], v[176:179]
  v_mfma_f32_16x16x32_bf16 v[180:183], a[108:111], a[148:151], v[180:183]
  v_mfma_f32_16x16x32_bf16 v[184:187], a[108:111], a[152:155], v[184:187]
  v_mfma_f32_16x16x32_bf16 v[188:191], a[108:111], a[156:159], v[188:191]
  v_mfma_f32_16x16x32_bf16 v[192:195], a[112:115], a[144:147], v[192:195]
  v_mfma_f32_16x16x32_bf16 v[196:199], a[112:115], a[148:151], v[196:199]
  v_mfma_f32_16x16x32_bf16 v[200:203], a[112:115], a[152:155], v[200:203]
  v_mfma_f32_16x16x32_bf16 v[204:207], a[112:115], a[156:159], v[204:207]
  v_mfma_f32_16x16x32_bf16 v[208:211], a[116:119], a[144:147], v[208:211]
  v_mfma_f32_16x16x32_bf16 v[212:215], a[116:119], a[148:151], v[212:215]
  v_mfma_f32_16x16x32_bf16 v[216:219], a[116:119], a[152:155], v[216:219]
  v_mfma_f32_16x16x32_bf16 v[220:223], a[116:119], a[156:159], v[220:223]
  v_mfma_f32_16x16x32_bf16 v[224:227], a[120:123], a[144:147], v[224:227]
  v_mfma_f32_16x16x32_bf16 v[228:231], a[120:123], a[148:151], v[228:231]
  v_mfma_f32_16x16x32_bf16 v[232:235], a[120:123], a[152:155], v[232:235]
  v_mfma_f32_16x16x32_bf16 v[236:239], a[120:123], a[156:159], v[236:239]
  v_mfma_f32_16x16x32_bf16 v[240:243], a[124:127], a[144:147], v[240:243]
  v_mfma_f32_16x16x32_bf16 v[244:247], a[124:127], a[148:151], v[244:247]
  v_mfma_f32_16x16x32_bf16 v[248:251], a[124:127], a[152:155], v[248:251]
  v_mfma_f32_16x16x32_bf16 v[252:255], a[124:127], a[156:159], v[252:255]
  s_waitcnt lgkmcnt(14)
  v_mfma_f32_16x16x32_bf16 v[128:131], a[64:67], a[128:131], v[128:131]
  ds_read_b128 a[144:147], v23 offset:61440
  ds_read_b128 a[148:151], v23 offset:62464
  v_mfma_f32_16x16x32_bf16 v[132:135], a[64:67], a[132:135], v[132:135]
  ds_read_b128 a[152:155], v23 offset:63488
  ds_read_b128 a[156:159], v23 offset:64512
  v_mfma_f32_16x16x32_bf16 v[136:139], a[64:67], a[136:139], v[136:139]
  s_waitcnt vmcnt(0)
  ds_read_b64_tr_b16 a[96:97], v64
  ds_read_b64_tr_b16 a[98:99], v64 offset:4096
  v_mfma_f32_16x16x32_bf16 v[140:143], a[64:67], a[140:143], v[140:143]
  s_waitcnt lgkmcnt(15)
  ds_read_b64_tr_b16 a[100:101], v65
  ds_read_b64_tr_b16 a[102:103], v65 offset:4096
  v_mfma_f32_16x16x32_bf16 v[144:147], a[68:71], a[128:131], v[144:147]
  ds_read_b64_tr_b16 a[104:105], v66
  ds_read_b64_tr_b16 a[106:107], v66 offset:4096
  v_mfma_f32_16x16x32_bf16 v[148:151], a[68:71], a[132:135], v[148:151]
  ds_read_b64_tr_b16 a[108:109], v67
  ds_read_b64_tr_b16 a[110:111], v67 offset:4096
  v_mfma_f32_16x16x32_bf16 v[152:155], a[68:71], a[136:139], v[152:155]
  ds_read_b64_tr_b16 a[112:113], v68
  ds_read_b64_tr_b16 a[114:115], v68 offset:4096
  v_mfma_f32_16x16x32_bf16 v[156:159], a[68:71], a[140:143], v[156:159]
  ds_read_b64_tr_b16 a[116:117], v69
  ds_read_b64_tr_b16 a[118:119], v69 offset:4096
  v_mfma_f32_16x16x32_bf16 v[160:163], a[72:75], a[128:131], v[160:163]
  ds_read_b64_tr_b16 a[120:121], v70
  ds_read_b64_tr_b16 a[122:123], v70 offset:4096
  v_mfma_f32_16x16x32_bf16 v[164:167], a[72:75], a[132:135], v[164:167]
  ds_read_b64_tr_b16 a[124:125], v71
  ds_read_b64_tr_b16 a[126:127], v71 offset:4096
  v_mfma_f32_16x16x32_bf16 v[168:171], a[72:75], a[136:139], v[168:171]
  v_mfma_f32_16x16x32_bf16 v[172:175], a[72:75], a[140:143], v[172:175]
  s_waitcnt lgkmcnt(15)
  v_mfma_f32_16x16x32_bf16 v[176:179], a[76:79], a[128:131], v[176:179]
  v_mfma_f32_16x16x32_bf16 v[180:183], a[76:79], a[132:135], v[180:183]
  v_mfma_f32_16x16x32_bf16 v[184:187], a[76:79], a[136:139], v[184:187]
  v_mfma_f32_16x16x32_bf16 v[188:191], a[76:79], a[140:143], v[188:191]
  v_mfma_f32_16x16x32_bf16 v[192:195], a[80:83], a[128:131], v[192:195]
  v_mfma_f32_16x16x32_bf16 v[196:199], a[80:83], a[132:135], v[196:199]
  v_mfma_f32_16x16x32_bf16 v[200:203], a[80:83], a[136:139], v[200:203]
  v_mfma_f32_16x16x32_bf16 v[204:207], a[80:83], a[140:143], v[204:207]
  v_mfma_f32_16x16x32_bf16 v[208:211], a[84:87], a[128:131], v[208:211]
  v_mfma_f32_16x16x32_bf16 v[212:215], a[84:87], a[132:135], v[212:215]
  v_mfma_f32_16x16x32_bf16 v[216:219], a[84:87], a[136:139], v[216:219]
  v_mfma_f32_16x16x32_bf16 v[220:223], a[84:87], a[140:143], v[220:223]
  v_mfma_f32_16x16x32_bf16 v[224:227], a[88:91], a[128:131], v[224:227]
  v_mfma_f32_16x16x32_bf16 v[228:231], a[88:91], a[132:135], v[228:231]
  v_mfma_f32_16x16x32_bf16 v[232:235], a[88:91], a[136:139], v[232:235]
  v_mfma_f32_16x16x32_bf16 v[236:239], a[88:91], a[140:143], v[236:239]
  v_mfma_f32_16x16x32_bf16 v[240:243], a[92:95], a[128:131], v[240:243]
  v_mfma_f32_16x16x32_bf16 v[244:247], a[92:95], a[132:135], v[244:247]
  v_mfma_f32_16x16x32_bf16 v[248:251], a[92:95], a[136:139], v[248:251]
  v_mfma_f32_16x16x32_bf16 v[252:255], a[92:95], a[140:143], v[252:255]
  s_waitcnt lgkmcnt(14)
  v_mfma_f32_16x16x32_bf16 v[128:131], a[96:99], a[144:147], v[128:131]
  v_mfma_f32_16x16x32_bf16 v[132:135], a[96:99], a[148:151], v[132:135]
  v_mfma_f32_16x16x32_bf16 v[136:139], a[96:99], a[152:155], v[136:139]
  v_mfma_f32_16x16x32_bf16 v[140:143], a[96:99], a[156:159], v[140:143]
  s_waitcnt lgkmcnt(12)
  v_mfma_f32_16x16x32_bf16 v[144:147], a[100:103], a[144:147], v[144:147]
  v_mfma_f32_16x16x32_bf16 v[148:151], a[100:103], a[148:151], v[148:151]
  v_mfma_f32_16x16x32_bf16 v[152:155], a[100:103], a[152:155], v[152:155]
  v_mfma_f32_16x16x32_bf16 v[156:159], a[100:103], a[156:159], v[156:159]
  s_waitcnt lgkmcnt(10)
  v_mfma_f32_16x16x32_bf16 v[160:163], a[104:107], a[144:147], v[160:163]
  v_mfma_f32_16x16x32_bf16 v[164:167], a[104:107], a[148:151], v[164:167]
  v_mfma_f32_16x16x32_bf16 v[168:171], a[104:107], a[152:155], v[168:171]
  v_mfma_f32_16x16x32_bf16 v[172:175], a[104:107], a[156:159], v[172:175]
  s_waitcnt lgkmcnt(8)
  v_mfma_f32_16x16x32_bf16 v[176:179], a[108:111], a[144:147], v[176:179]
  v_mfma_f32_16x16x32_bf16 v[180:183], a[108:111], a[148:151], v[180:183]
  v_mfma_f32_16x16x32_bf16 v[184:187], a[108:111], a[152:155], v[184:187]
  v_mfma_f32_16x16x32_bf16 v[188:191], a[108:111], a[156:159], v[188:191]
  s_waitcnt lgkmcnt(6)
  v_mfma_f32_16x16x32_bf16 v[192:195], a[112:115], a[144:147], v[192:195]
  v_mfma_f32_16x16x32_bf16 v[196:199], a[112:115], a[148:151], v[196:199]
  v_mfma_f32_16x16x32_bf16 v[200:203], a[112:115], a[152:155], v[200:203]
  v_mfma_f32_16x16x32_bf16 v[204:207], a[112:115], a[156:159], v[204:207]
  s_waitcnt lgkmcnt(4)
  v_mfma_f32_16x16x32_bf16 v[208:211], a[116:119], a[144:147], v[208:211]
  v_mfma_f32_16x16x32_bf16 v[212:215], a[116:119], a[148:151], v[212:215]
  v_mfma_f32_16x16x32_bf16 v[216:219], a[116:119], a[152:155], v[216:219]
  v_mfma_f32_16x16x32_bf16 v[220:223], a[116:119], a[156:159], v[220:223]
  s_waitcnt lgkmcnt(2)
  v_mfma_f32_16x16x32_bf16 v[224:227], a[120:123], a[144:147], v[224:227]
  v_mfma_f32_16x16x32_bf16 v[228:231], a[120:123], a[148:151], v[228:231]
  v_mfma_f32_16x16x32_bf16 v[232:235], a[120:123], a[152:155], v[232:235]
  v_mfma_f32_16x16x32_bf16 v[236:239], a[120:123], a[156:159], v[236:239]
  s_waitcnt lgkmcnt(0)
  v_mfma_f32_16x16x32_bf16 v[240:243], a[124:127], a[144:147], v[240:243]
  v_mfma_f32_16x16x32_bf16 v[244:247], a[124:127], a[148:151], v[244:247]
  v_mfma_f32_16x16x32_bf16 v[248:251], a[124:127], a[152:155], v[248:251]
  v_mfma_f32_16x16x32_bf16 v[252:255], a[124:127], a[156:159], v[252:255]
  v_cvt_pk_bf16_f32 v48, v128, v129
  v_cvt_pk_bf16_f32 v49, v130, v131
  v_cvt_pk_bf16_f32 v50, v144, v145
  v_cvt_pk_bf16_f32 v51, v146, v147
  buffer_store_dwordx4 v[48:51], v7, s[16:19], s3 offen sc1
  v_cvt_pk_bf16_f32 v52, v132, v133
  v_cvt_pk_bf16_f32 v53, v134, v135
  v_cvt_pk_bf16_f32 v54, v148, v149
  v_cvt_pk_bf16_f32 v55, v150, v151
  buffer_store_dwordx4 v[52:55], v7, s[16:19], s3 offen offset:1024 sc1
  v_cvt_pk_bf16_f32 v56, v136, v137
  v_cvt_pk_bf16_f32 v57, v138, v139
  v_cvt_pk_bf16_f32 v58, v152, v153
  v_cvt_pk_bf16_f32 v59, v154, v155
  buffer_store_dwordx4 v[56:59], v7, s[16:19], s3 offen offset:2048 sc1
  v_cvt_pk_bf16_f32 v60, v140, v141
  v_cvt_pk_bf16_f32 v61, v142, v143
  v_cvt_pk_bf16_f32 v62, v156, v157
  v_cvt_pk_bf16_f32 v63, v158, v159
  buffer_store_dwordx4 v[60:63], v7, s[16:19], s3 offen offset:3072 sc1
  s_add_u32 s3, s3, 4096
  v_cvt_pk_bf16_f32 v48, v160, v161
  v_cvt_pk_bf16_f32 v49, v162, v163
  v_cvt_pk_bf16_f32 v50, v176, v177
  v_cvt_pk_bf16_f32 v51, v178, v179
  buffer_store_dwordx4 v[48:51], v7, s[16:19], s3 offen sc1
  v_cvt_pk_bf16_f32 v52, v164, v165
  v_cvt_pk_bf16_f32 v53, v166, v167
  v_cvt_pk_bf16_f32 v54, v180, v181
  v_cvt_pk_bf16_f32 v55, v182, v183
  buffer_store_dwordx4 v[52:55], v7, s[16:19], s3 offen offset:1024 sc1
  v_cvt_pk_bf16_f32 v56, v168, v169
  v_cvt_pk_bf16_f32 v57, v170, v171
  v_cvt_pk_bf16_f32 v58, v184, v185
  v_cvt_pk_bf16_f32 v59, v186, v187
  buffer_store_dwordx4 v[56:59], v7, s[16:19], s3 offen offset:2048 sc1
  v_cvt_pk_bf16_f32 v60, v172, v173
  v_cvt_pk_bf16_f32 v61, v174, v175
  v_cvt_pk_bf16_f32 v62, v188, v189
  v_cvt_pk_bf16_f32 v63, v190, v191
  buffer_store_dwordx4 v[60:63], v7, s[16:19], s3 offen offset:3072 sc1
  s_add_u32 s3, s3, 4096
  v_cvt_pk_bf16_f32 v48, v192, v193
  v_cvt_pk_bf16_f32 v49, v194, v195
  v_cvt_pk_bf16_f32 v50, v208, v209
  v_cvt_pk_bf16_f32 v51, v210, v211
  buffer_store_dwordx4 v[48:51], v7, s[16:19], s3 offen sc1
  v_cvt_pk_bf16_f32 v52, v196, v197
  v_cvt_pk_bf16_f32 v53, v198, v199
  v_cvt_pk_bf16_f32 v54, v212, v213
  v_cvt_pk_bf16_f32 v55, v214, v215
  buffer_store_dwordx4 v[52:55], v7, s[16:19], s3 offen offset:1024 sc1
  v_cvt_pk_bf16_f32 v56, v200, v201
  v_cvt_pk_bf16_f32 v57, v202, v203
  v_cvt_pk_bf16_f32 v58, v216, v217
  v_cvt_pk_bf16_f32 v59, v218, v219
  buffer_store_dwordx4 v[56:59], v7, s[16:19], s3 offen offset:2048 sc1
  v_cvt_pk_bf16_f32 v60, v204, v205
  v_cvt_pk_bf16_f32 v61, v206, v207
  v_cvt_pk_bf16_f32 v62, v220, v221
  v_cvt_pk_bf16_f32 v63, v222, v223
  buffer_store_dwordx4 v[60:63], v7, s[16:19], s3 offen offset:3072 sc1
  s_add_u32 s3, s3, 4096
  v_cvt_pk_bf16_f32 v48, v224, v225
  v_cvt_pk_bf16_f32 v49, v226, v227
  v_cvt_pk_bf16_f32 v50, v240, v241
  v_cvt_pk_bf16_f32 v51, v242, v243
  buffer_store_dwordx4 v[48:51], v7, s[16:19], s3 offen sc1
  v_cvt_pk_bf16_f32 v52, v228, v229
  v_cvt_pk_bf16_f32 v53, v230, v231
  v_cvt_pk_bf16_f32 v54, v244, v245
  v_cvt_pk_bf16_f32 v55, v246, v247
  buffer_store_dwordx4 v[52:55], v7, s[16:19], s3 offen offset:1024 sc1
  v_cvt_pk_bf16_f32 v56, v232, v233
  v_cvt_pk_bf16_f32 v57, v234, v235
  v_cvt_pk_bf16_f32 v58, v248, v249
  v_cvt_pk_bf16_f32 v59, v250, v251
  buffer_store_dwordx4 v[56:59], v7, s[16:19], s3 offen offset:2048 sc1
  v_cvt_pk_bf16_f32 v60, v236, v237
  v_cvt_pk_bf16_f32 v61, v238, v239
  v_cvt_pk_bf16_f32 v62, v252, v253
  v_cvt_pk_bf16_f32 v63, v254, v255
  buffer_store_dwordx4 v[60:63], v7, s[16:19], s3 offen offset:3072 sc1
  s_add_u32 s3, s3, 4096
  s_mov_b32 s44, 0x71800000
  v_cmp_gt_f32 vcc, s44, v80
  s_nop 3
  s_mov_b64 s[56:57], vcc
  v_cmp_gt_f32 vcc, s44, v84
  s_nop 3
  s_and_b64 s[56:57], s[56:57], vcc
  v_cmp_gt_f32 vcc, s44, v88
  s_nop 3
  s_and_b64 s[56:57], s[56:57], vcc
  v_cmp_gt_f32 vcc, s44, v92
  s_nop 3
  s_and_b64 s[56:57], s[56:57], vcc
  s_mov_b32 s44, 0x3b800000
  v_cmp_le_f32 vcc, s44, v28
  s_nop 3
  s_and_b64 s[56:57], s[56:57], vcc
  v_cmp_le_f32 vcc, s44, v29
  s_nop 3
  s_and_b64 s[56:57], s[56:57], vcc
  v_cmp_le_f32 vcc, s44, v30
  s_nop 3
  s_and_b64 s[56:57], s[56:57], vcc
  v_cmp_le_f32 vcc, s44, v31
  s_nop 3
  s_and_b64 s[56:57], s[56:57], vcc
  s_nop 7
  v_mov_b32 v1, 504
  v_cmp_class_f32 vcc, v128, v1
  s_nop 3
  s_and_b64 s[56:57], s[56:57], vcc
  v_cmp_class_f32 vcc, v132, v1
  s_nop 3
  s_and_b64 s[56:57], s[56:57], vcc
  v_cmp_class_f32 vcc, v136, v1
  s_nop 3
  s_and_b64 s[56:57], s[56:57], vcc
  v_cmp_class_f32 vcc, v140, v1
  s_nop 3
  s_and_b64 s[56:57], s[56:57], vcc
  s_cmp_eq_u64 s[56:57], -1
  s_cselect_b32 s44, 0, 1
  v_mov_b32 v2, s44
  v_mov_b32 v1, s27
  ds_write_b32 v1, v2
  s_mov_b32 s28, s96
  s_mov_b32 s29, s97
  s_mov_b32 s30, 2097152
  s_mov_b32 s31, 131072
  s_mov_b32 s48, s98
  s_mov_b32 s49, s99
  s_mov_b32 s50, 2097152
  s_mov_b32 s51, 131072
  v_and_b32 v1, 15, v0
  s_lshl_b32 s44, s26, 6
  s_lshl_b32 s45, s24, 4
  s_add_u32 s44, s44, s45
  v_add_u32 v1, s44, v1
  v_lshlrev_b32 v1, 10, v1
  v_lshrrev_b32 v2, 4, v0
  v_lshl_add_u32 v1, v2, 3, v1
  s_lshl_b32 s44, s25, 7
  v_add_u32 v22, s44, v1
  buffer_load_dwordx2 v[32:33], v22, s[28:31], 0 offen
  buffer_load_dwordx2 v[34:35], v22, s[28:31], 0 offen offset:32
  buffer_load_dwordx2 v[36:37], v22, s[28:31], 0 offen offset:64
  buffer_load_dwordx2 v[38:39], v22, s[28:31], 0 offen offset:96
  s_waitcnt vmcnt(4) lgkmcnt(0)
  s_barrier
  v_mov_b32 v1, 98304
  ds_read_b32 v2, v1
  ds_read_b32 v3, v1 offset:16384
  ds_read_b32 v4, v1 offset:32768
  ds_read_b32 v5, v1 offset:49152
  s_waitcnt lgkmcnt(2)
  v_or_b32 v2, v2, v3
  s_waitcnt lgkmcnt(0)
  v_or_b32 v4, v4, v5
  v_or_b32 v2, v2, v4
  s_nop 0
  v_readfirstlane_b32 s44, v2
  s_nop 3
  s_andn2_b32 s44, s44, s6
  s_cbranch_scc1 L_k3_slow
  s_cmp_eq_u32 s24, 0
  s_cbranch_scc0 L_k3_cpollok
  s_add_u32 s44, s26, 32
  s_lshl_b32 s44, s44, 8
  s_add_u32 s44, s44, 6160384
  v_mov_b32 v6, 1
  v_lshlrev_b32 v5, 25, v0
  v_mov_b32 v1, 0
  s_mov_b32 s45, 0
  buffer_atomic_add v6, v5, s[16:19], s44 offen sc0 sc1
  s_waitcnt vmcnt(0)
  v_readfirstlane_b32 s43, v6
  s_nop 3
  s_add_u32 s43, s43, 1
L_k3_cpoll:
  s_cmp_ge_u32 s43, 16
  s_cbranch_scc1 L_k3_cpollok
  s_sleep 1
  buffer_load_dword v6, v1, s[16:19], s44 offen sc1
  s_waitcnt vmcnt(0)
  v_readfirstlane_b32 s43, v6
  s_nop 3
  s_add_u32 s45, s45, 1
  s_cmp_lt_u32 s45, 524288
  s_cbranch_scc1 L_k3_cpoll
L_k3_cpollok:
  s_barrier
  s_lshl_b32 s42, s26, 2
  s_lshr_b32 s43, s25, 1
  s_add_u32 s42, s42, s43
  s_lshl_b32 s42, s42, 2
  s_and_b32 s43, s25, 1
  s_lshl_b32 s43, s43, 1
  s_add_u32 s42, s42, s43
  s_lshl_b32 s42, s42, 2
  s_add_u32 s42, s42, s24
  s_lshl_b32 s42, s42, 10
  s_add_u32 s43, s42, 6291456
  s_add_u32 s42, s42, 8388608
  buffer_load_dwordx4 v[192:195], v7, s[16:19], s43 offen sc1
  s_add_u32 s43, s43, 4096
  buffer_load_dwordx4 v[196:199], v7, s[16:19], s43 offen sc1
  s_add_u32 s43, s43, 4096
  buffer_load_dwordx4 v[128:131], v7, s[16:19], s42 offen sc1
  s_add_u32 s44, s42, 4096
  buffer_load_dwordx4 v[160:163], v7, s[16:19], s44 offen sc1
  s_add_u32 s42, s42, 2097152
  buffer_load_dwordx4 v[132:135], v7, s[16:19], s42 offen sc1
  s_add_u32 s44, s42, 4096
  buffer_load_dwordx4 v[164:167], v7, s[16:19], s44 offen sc1
  s_add_u32 s42, s42, 2097152
  buffer_load_dwordx4 v[136:139], v7, s[16:19], s42 offen sc1
  s_add_u32 s44, s42, 4096
  buffer_load_dwordx4 v[168:171], v7, s[16:19], s44 offen sc1
  s_add_u32 s42, s42, 2097152
  buffer_load_dwordx4 v[140:143], v7, s[16:19], s42 offen sc1
  s_add_u32 s44, s42, 4096
  buffer_load_dwordx4 v[172:175], v7, s[16:19], s44 offen sc1
  s_add_u32 s42, s42, 2097152
  buffer_load_dwordx4 v[144:147], v7, s[16:19], s42 offen sc1
  s_add_u32 s44, s42, 4096
  buffer_load_dwordx4 v[176:179], v7, s[16:19], s44 offen sc1
  s_add_u32 s42, s42, 2097152
  buffer_load_dwordx4 v[148:151], v7, s[16:19], s42 offen sc1
  s_add_u32 s44, s42, 4096
  buffer_load_dwordx4 v[180:183], v7, s[16:19], s44 offen sc1
  s_add_u32 s42, s42, 2097152
  buffer_load_dwordx4 v[152:155], v7, s[16:19], s42 offen sc1
  s_add_u32 s44, s42, 4096
  buffer_load_dwordx4 v[184:187], v7, s[16:19], s44 offen sc1
  s_add_u32 s42, s42, 2097152
  buffer_load_dwordx4 v[156:159], v7, s[16:19], s42 offen sc1
  s_add_u32 s44, s42, 4096
  buffer_load_dwordx4 v[188:191], v7, s[16:19], s44 offen sc1
  v_and_b32 v2, 15, v0
  v_lshrrev_b32 v3, 2, v2
  v_lshrrev_b32 v4, 4, v0
  v_and_b32 v5, 1, v2
  v_lshlrev_b32 v5, 4, v5
  v_mov_b32 v6, 16256
  v_lshlrev_b32 v5, v5, v6
  v_cmp_eq_u32 vcc, v3, v4
  s_nop 1
  v_cndmask_b32 v5, 0, v5, vcc
  v_bfe_u32 v3, v2, 1, 1
  v_cmp_eq_u32 vcc, 0, v3
  s_nop 1
  v_cndmask_b32 v224, 0, v5, vcc
  v_sub_u32 v225, v5, v224
  v_mov_b32 v226, 0
  v_mov_b32 v227, 0
  v_mov_b32 v228, 0
  v_mov_b32 v229, 0
  v_mov_b32 v230, v224
  v_mov_b32 v231, v225
  s_waitcnt vmcnt(15)
  v_mfma_f32_16x16x32_bf16 v[200:203], v[224:227], v[128:131], 0
  v_mfma_f32_16x16x32_bf16 v[204:207], v[228:231], v[128:131], 0
  s_waitcnt vmcnt(14)
  v_mfma_f32_16x16x32_bf16 v[208:211], v[224:227], v[160:163], 0
  v_mfma_f32_16x16x32_bf16 v[212:215], v[228:231], v[160:163], 0
  s_waitcnt vmcnt(13)
  v_mfma_f32_16x16x32_bf16 v[200:203], v[224:227], v[132:135], v[200:203]
  v_mfma_f32_16x16x32_bf16 v[204:207], v[228:231], v[132:135], v[204:207]
  s_waitcnt vmcnt(12)
  v_mfma_f32_16x16x32_bf16 v[208:211], v[224:227], v[164:167], v[208:211]
  v_mfma_f32_16x16x32_bf16 v[212:215], v[228:231], v[164:167], v[212:215]
  s_waitcnt vmcnt(11)
  v_mfma_f32_16x16x32_bf16 v[200:203], v[224:227], v[136:139], v[200:203]
  v_mfma_f32_16x16x32_bf16 v[204:207], v[228:231], v[136:139], v[204:207]
  s_waitcnt vmcnt(10)
  v_mfma_f32_16x16x32_bf16 v[208:211], v[224:227], v[168:171], v[208:211]
  v_mfma_f32_16x16x32_bf16 v[212:215], v[228:231], v[168:171], v[212:215]
  s_waitcnt vmcnt(9)
  v_mfma_f32_16x16x32_bf16 v[200:203], v[224:227], v[140:143], v[200:203]
  v_mfma_f32_16x16x32_bf16 v[204:207], v[228:231], v[140:143], v[204:207]
  s_waitcnt vmcnt(8)
  v_mfma_f32_16x16x32_bf16 v[208:211], v[224:227], v[172:175], v[208:211]
  v_mfma_f32_16x16x32_bf16 v[212:215], v[228:231], v[172:175], v[212:215]
  s_waitcnt vmcnt(7)
  v_mfma_f32_16x16x32_bf16 v[200:203], v[224:227], v[144:147], v[200:203]
  v_mfma_f32_16x16x32_bf16 v[204:207], v[228:231], v[144:147], v[204:207]
  s_waitcnt vmcnt(6)
  v_mfma_f32_16x16x32_bf16 v[208:211], v[224:227], v[176:179], v[208:211]
  v_mfma_f32_16x16x32_bf16 v[212:215], v[228:231], v[176:179], v[212:215]
  s_waitcnt vmcnt(5)
  v_mfma_f32_16x16x32_bf16 v[200:203], v[224:227], v[148:151], v[200:203]
  v_mfma_f32_16x16x32_bf16 v[204:207], v[228:231], v[148:151], v[204:207]
  s_waitcnt vmcnt(4)
  v_mfma_f32_16x16x32_bf16 v[208:211], v[224:227], v[180:183], v[208:211]
  v_mfma_f32_16x16x32_bf16 v[212:215], v[228:231], v[180:183], v[212:215]
  s_waitcnt vmcnt(3)
  v_mfma_f32_16x16x32_bf16 v[200:203], v[224:227], v[152:155], v[200:203]
  v_mfma_f32_16x16x32_bf16 v[204:207], v[228:231], v[152:155], v[204:207]
  s_waitcnt vmcnt(2)
  v_mfma_f32_16x16x32_bf16 v[208:211], v[224:227], v[184:187], v[208:211]
  v_mfma_f32_16x16x32_bf16 v[212:215], v[228:231], v[184:187], v[212:215]
  s_waitcnt vmcnt(1)
  v_mfma_f32_16x16x32_bf16 v[200:203], v[224:227], v[156:159], v[200:203]
  v_mfma_f32_16x16x32_bf16 v[204:207], v[228:231], v[156:159], v[204:207]
  s_waitcnt vmcnt(0)
  v_mfma_f32_16x16x32_bf16 v[208:211], v[224:227], v[188:191], v[208:211]
  v_mfma_f32_16x16x32_bf16 v[212:215], v[228:231], v[188:191], v[212:215]
  v_lshlrev_b32 v4, 16, v192
  v_lshlrev_b32 v5, 16, v32
  s_nop 1
  v_fma_f32 v200, v200, v4, v5
  v_and_b32 v4, 4294901760, v192
  v_and_b32 v5, 4294901760, v32
  v_fma_f32 v201, v201, v4, v5
  v_lshlrev_b32 v4, 16, v193
  v_lshlrev_b32 v5, 16, v33
  v_fma_f32 v202, v202, v4, v5
  v_and_b32 v4, 4294901760, v193
  v_and_b32 v5, 4294901760, v33
  v_fma_f32 v203, v203, v4, v5
  v_lshlrev_b32 v4, 16, v194
  v_lshlrev_b32 v5, 16, v34
  v_fma_f32 v204, v204, v4, v5
  v_and_b32 v4, 4294901760, v194
  v_and_b32 v5, 4294901760, v34
  v_fma_f32 v205, v205, v4, v5
  v_lshlrev_b32 v4, 16, v195
  v_lshlrev_b32 v5, 16, v35
  v_fma_f32 v206, v206, v4, v5
  v_and_b32 v4, 4294901760, v195
  v_and_b32 v5, 4294901760, v35
  v_fma_f32 v207, v207, v4, v5
  v_cvt_pk_bf16_f32 v216, v200, v201
  v_cvt_pk_bf16_f32 v217, v202, v203
  v_cvt_pk_bf16_f32 v218, v204, v205
  v_cvt_pk_bf16_f32 v219, v206, v207
  buffer_store_dwordx2 v[216:217], v22, s[48:51], 0 offen
  buffer_store_dwordx2 v[218:219], v22, s[48:51], 0 offen offset:32
  v_lshlrev_b32 v4, 16, v196
  v_lshlrev_b32 v5, 16, v36
  v_fma_f32 v208, v208, v4, v5
  v_and_b32 v4, 4294901760, v196
  v_and_b32 v5, 4294901760, v36
  v_fma_f32 v209, v209, v4, v5
  v_lshlrev_b32 v4, 16, v197
  v_lshlrev_b32 v5, 16, v37
  v_fma_f32 v210, v210, v4, v5
  v_and_b32 v4, 4294901760, v197
  v_and_b32 v5, 4294901760, v37
  v_fma_f32 v211, v211, v4, v5
  v_lshlrev_b32 v4, 16, v198
  v_lshlrev_b32 v5, 16, v38
  v_fma_f32 v212, v212, v4, v5
  v_and_b32 v4, 4294901760, v198
  v_and_b32 v5, 4294901760, v38
  v_fma_f32 v213, v213, v4, v5
  v_lshlrev_b32 v4, 16, v199
  v_lshlrev_b32 v5, 16, v39
  v_fma_f32 v214, v214, v4, v5
  v_and_b32 v4, 4294901760, v199
  v_and_b32 v5, 4294901760, v39
  v_fma_f32 v215, v215, v4, v5
  v_cvt_pk_bf16_f32 v220, v208, v209
  v_cvt_pk_bf16_f32 v221, v210, v211
  v_cvt_pk_bf16_f32 v222, v212, v213
  v_cvt_pk_bf16_f32 v223, v214, v215
  buffer_store_dwordx2 v[220:221], v22, s[48:51], 0 offen offset:64
  buffer_store_dwordx2 v[222:223], v22, s[48:51], 0 offen offset:96
  s_branch L_k3_end
L_k3_slow:
  s_mov_b32 s6, 1
  v_mov_b32 v128, 0
  v_mov_b32 v129, 0
  v_mov_b32 v130, 0
  v_mov_b32 v131, 0
  v_mov_b32 v132, 0
  v_mov_b32 v133, 0
  v_mov_b32 v134, 0
  v_mov_b32 v135, 0
  v_mov_b32 v136, 0
  v_mov_b32 v137, 0
  v_mov_b32 v138, 0
  v_mov_b32 v139, 0
  v_mov_b32 v140, 0
  v_mov_b32 v141, 0
  v_mov_b32 v142, 0
  v_mov_b32 v143, 0
  v_mov_b32 v144, 0
  v_mov_b32 v145, 0
  v_mov_b32 v146, 0
  v_mov_b32 v147, 0
  v_mov_b32 v148, 0
  v_mov_b32 v149, 0
  v_mov_b32 v150, 0
  v_mov_b32 v151, 0
  v_mov_b32 v152, 0
  v_mov_b32 v153, 0
  v_mov_b32 v154, 0
  v_mov_b32 v155, 0
  v_mov_b32 v156, 0
  v_mov_b32 v157, 0
  v_mov_b32 v158, 0
  v_mov_b32 v159, 0
  v_mov_b32 v160, 0
  v_mov_b32 v161, 0
  v_mov_b32 v162, 0
  v_mov_b32 v163, 0
  v_mov_b32 v164, 0
  v_mov_b32 v165, 0
  v_mov_b32 v166, 0
  v_mov_b32 v167, 0
  v_mov_b32 v168, 0
  v_mov_b32 v169, 0
  v_mov_b32 v170, 0
  v_mov_b32 v171, 0
  v_mov_b32 v172, 0
  v_mov_b32 v173, 0
  v_mov_b32 v174, 0
  v_mov_b32 v175, 0
  v_mov_b32 v176, 0
  v_mov_b32 v177, 0
  v_mov_b32 v178, 0
  v_mov_b32 v179, 0
  v_mov_b32 v180, 0
  v_mov_b32 v181, 0
  v_mov_b32 v182, 0
  v_mov_b32 v183, 0
  v_mov_b32 v184, 0
  v_mov_b32 v185, 0
  v_mov_b32 v186, 0
  v_mov_b32 v187, 0
  v_mov_b32 v188, 0
  v_mov_b32 v189, 0
  v_mov_b32 v190, 0
  v_mov_b32 v191, 0
  v_mov_b32 v192, 0
  v_mov_b32 v193, 0
  v_mov_b32 v194, 0
  v_mov_b32 v195, 0
  v_mov_b32 v196, 0
  v_mov_b32 v197, 0
  v_mov_b32 v198, 0
  v_mov_b32 v199, 0
  v_mov_b32 v200, 0
  v_mov_b32 v201, 0
  v_mov_b32 v202, 0
  v_mov_b32 v203, 0
  v_mov_b32 v204, 0
  v_mov_b32 v205, 0
  v_mov_b32 v206, 0
  v_mov_b32 v207, 0
  v_mov_b32 v208, 0
  v_mov_b32 v209, 0
  v_mov_b32 v210, 0
  v_mov_b32 v211, 0
  v_mov_b32 v212, 0
  v_mov_b32 v213, 0
  v_mov_b32 v214, 0
  v_mov_b32 v215, 0
  v_mov_b32 v216, 0
  v_mov_b32 v217, 0
  v_mov_b32 v218, 0
  v_mov_b32 v219, 0
  v_mov_b32 v220, 0
  v_mov_b32 v221, 0
  v_mov_b32 v222, 0
  v_mov_b32 v223, 0
  v_mov_b32 v224, 0
  v_mov_b32 v225, 0
  v_mov_b32 v226, 0
  v_mov_b32 v227, 0
  v_mov_b32 v228, 0
  v_mov_b32 v229, 0
  v_mov_b32 v230, 0
  v_mov_b32 v231, 0
  v_mov_b32 v232, 0
  v_mov_b32 v233, 0
  v_mov_b32 v234, 0
  v_mov_b32 v235, 0
  v_mov_b32 v236, 0
  v_mov_b32 v237, 0
  v_mov_b32 v238, 0
  v_mov_b32 v239, 0
  v_mov_b32 v240, 0
  v_mov_b32 v241, 0
  v_mov_b32 v242, 0
  v_mov_b32 v243, 0
  v_mov_b32 v244, 0
  v_mov_b32 v245, 0
  v_mov_b32 v246, 0
  v_mov_b32 v247, 0
  v_mov_b32 v248, 0
  v_mov_b32 v249, 0
  v_mov_b32 v250, 0
  v_mov_b32 v251, 0
  v_mov_b32 v252, 0
  v_mov_b32 v253, 0
  v_mov_b32 v254, 0
  v_mov_b32 v255, 0
  v_mov_b32 v80, 0
  v_mov_b32 v81, 0
  v_mov_b32 v82, 0
  v_mov_b32 v83, 0
  v_mov_b32 v72, 4286578688
  v_mov_b32 v84, 0
  v_mov_b32 v85, 0
  v_mov_b32 v86, 0
  v_mov_b32 v87, 0
  v_mov_b32 v73, 4286578688
  v_mov_b32 v88, 0
  v_mov_b32 v89, 0
  v_mov_b32 v90, 0
  v_mov_b32 v91, 0
  v_mov_b32 v74, 4286578688
  v_mov_b32 v92, 0
  v_mov_b32 v93, 0
  v_mov_b32 v94, 0
  v_mov_b32 v95, 0
  v_mov_b32 v75, 4286578688
  s_mov_b32 s20, 0
  s_mov_b32 s45, 32
L_k3_slowloop:
  s_barrier
  s_add_u32 m0, s21, 0
  s_nop 0
  buffer_load_dwordx4 v8, s[8:11], s20 offen lds
  buffer_load_dwordx4 v9, s[8:11], s20 offen offset:1024 lds
  buffer_load_dwordx4 v10, s[8:11], s20 offen offset:2048 lds
  buffer_load_dwordx4 v11, s[8:11], s20 offen offset:3072 lds
  s_add_u32 m0, s21, 49152
  s_nop 0
  buffer_load_dwordx4 v12, s[12:15], s20 offen lds
  buffer_load_dwordx4 v13, s[12:15], s20 offen offset:1024 lds
  buffer_load_dwordx4 v12, s[12:15], s20 offen offset:2048 lds
  buffer_load_dwordx4 v13, s[12:15], s20 offen offset:3072 lds
  s_add_u32 s20, s20, 16384
  s_waitcnt vmcnt(0)
  s_barrier
  ds_read_b128 a[64:67], v116
  ds_read_b128 a[68:71], v117
  ds_read_b128 a[72:75], v118
  ds_read_b128 a[76:79], v119
  ds_read_b128 a[80:83], v116 offset:4096
  ds_read_b128 a[84:87], v117 offset:4096
  ds_read_b128 a[88:91], v118 offset:4096
  ds_read_b128 a[92:95], v119 offset:4096
  ds_read_b64_tr_b16 a[96:97], v120
  ds_read_b64_tr_b16 a[98:99], v120 offset:4096
  ds_read_b64_tr_b16 a[100:101], v121
  ds_read_b64_tr_b16 a[102:103], v121 offset:4096
  ds_read_b64_tr_b16 a[104:105], v122
  ds_read_b64_tr_b16 a[106:107], v122 offset:4096
  ds_read_b64_tr_b16 a[108:109], v123
  ds_read_b64_tr_b16 a[110:111], v123 offset:4096
  ds_read_b64_tr_b16 a[112:113], v124
  ds_read_b64_tr_b16 a[114:115], v124 offset:4096
  ds_read_b64_tr_b16 a[116:117], v125
  ds_read_b64_tr_b16 a[118:119], v125 offset:4096
  ds_read_b64_tr_b16 a[120:121], v126
  ds_read_b64_tr_b16 a[122:123], v126 offset:4096
  ds_read_b64_tr_b16 a[124:125], v127
  ds_read_b64_tr_b16 a[126:127], v127 offset:4096
  s_waitcnt lgkmcnt(15)
  v_mfma_f32_16x16x32_bf16 v[32:35], a[64:67], a[0:3], 0
  v_mfma_f32_16x16x32_bf16 v[32:35], a[68:71], a[16:19], v[32:35]
  v_mfma_f32_16x16x32_bf16 v[32:35], a[72:75], a[32:35], v[32:35]
  v_mfma_f32_16x16x32_bf16 v[32:35], a[76:79], a[48:51], v[32:35]
  v_mfma_f32_16x16x32_bf16 v[36:39], a[80:83], a[0:3], 0
  v_mfma_f32_16x16x32_bf16 v[36:39], a[84:87], a[16:19], v[36:39]
  v_mfma_f32_16x16x32_bf16 v[36:39], a[88:91], a[32:35], v[36:39]
  v_mfma_f32_16x16x32_bf16 v[36:39], a[92:95], a[48:51], v[36:39]
  v_mfma_f32_16x16x32_bf16 v[40:43], a[64:67], a[4:7], 0
  v_mfma_f32_16x16x32_bf16 v[40:43], a[68:71], a[20:23], v[40:43]
  v_mfma_f32_16x16x32_bf16 v[40:43], a[72:75], a[36:39], v[40:43]
  v_mfma_f32_16x16x32_bf16 v[40:43], a[76:79], a[52:55], v[40:43]
  v_mfma_f32_16x16x32_bf16 v[44:47], a[80:83], a[4:7], 0
  v_mfma_f32_16x16x32_bf16 v[44:47], a[84:87], a[20:23], v[44:47]
  v_mfma_f32_16x16x32_bf16 v[44:47], a[88:91], a[36:39], v[44:47]
  v_mfma_f32_16x16x32_bf16 v[44:47], a[92:95], a[52:55], v[44:47]
  s_waitcnt lgkmcnt(14)
  v_max3_f32 v4, v32, v33, v34
  v_max3_f32 v4, v4, v35, v36
  v_max3_f32 v4, v4, v37, v38
  v_max3_f32 v4, v4, v39, v72
  v_mov_b32 v5, v4
  s_nop 1
  v_permlane16_swap_b32 v4, v5
  v_max_f32 v4, v4, v5
  v_mov_b32 v5, v4
  s_nop 1
  v_permlane32_swap_b32 v4, v5
  v_max_f32 v4, v4, v5
  v_sub_f32 v5, v72, v4
  v_exp_f32 v5, v5
  v_mov_b32 v72, v4
  v_mul_f32 v128, v128, v5
  v_mul_f32 v129, v129, v5
  v_mul_f32 v130, v130, v5
  v_mul_f32 v131, v131, v5
  v_mul_f32 v144, v144, v5
  v_mul_f32 v145, v145, v5
  v_mul_f32 v146, v146, v5
  v_mul_f32 v147, v147, v5
  v_mul_f32 v160, v160, v5
  v_mul_f32 v161, v161, v5
  v_mul_f32 v162, v162, v5
  v_mul_f32 v163, v163, v5
  v_mul_f32 v176, v176, v5
  v_mul_f32 v177, v177, v5
  v_mul_f32 v178, v178, v5
  v_mul_f32 v179, v179, v5
  v_mul_f32 v192, v192, v5
  v_mul_f32 v193, v193, v5
  v_mul_f32 v194, v194, v5
  v_mul_f32 v195, v195, v5
  v_mul_f32 v208, v208, v5
  v_mul_f32 v209, v209, v5
  v_mul_f32 v210, v210, v5
  v_mul_f32 v211, v211, v5
  v_mul_f32 v224, v224, v5
  v_mul_f32 v225, v225, v5
  v_mul_f32 v226, v226, v5
  v_mul_f32 v227, v227, v5
  v_mul_f32 v240, v240, v5
  v_mul_f32 v241, v241, v5
  v_mul_f32 v242, v242, v5
  v_mul_f32 v243, v243, v5
  v_mul_f32 v80, v80, v5
  v_mul_f32 v81, v81, v5
  v_mul_f32 v82, v82, v5
  v_mul_f32 v83, v83, v5
  v_sub_f32 v32, v32, v4
  v_exp_f32 v32, v32
  v_sub_f32 v33, v33, v4
  v_exp_f32 v33, v33
  v_sub_f32 v34, v34, v4
  v_exp_f32 v34, v34
  v_sub_f32 v35, v35, v4
  v_exp_f32 v35, v35
  v_cvt_pk_bf16_f32 v96, v32, v33
  v_cvt_pk_bf16_f32 v97, v34, v35
  v_sub_f32 v36, v36, v4
  v_exp_f32 v36, v36
  v_sub_f32 v37, v37, v4
  v_exp_f32 v37, v37
  v_sub_f32 v38, v38, v4
  v_exp_f32 v38, v38
  v_sub_f32 v39, v39, v4
  v_exp_f32 v39, v39
  v_cvt_pk_bf16_f32 v98, v36, v37
  v_cvt_pk_bf16_f32 v99, v38, v39
  v_max3_f32 v4, v40, v41, v42
  v_max3_f32 v4, v4, v43, v44
  v_max3_f32 v4, v4, v45, v46
  v_max3_f32 v4, v4, v47, v73
  v_mov_b32 v5, v4
  s_nop 1
  v_permlane16_swap_b32 v4, v5
  v_max_f32 v4, v4, v5
  v_mov_b32 v5, v4
  s_nop 1
  v_permlane32_swap_b32 v4, v5
  v_max_f32 v4, v4, v5
  v_sub_f32 v5, v73, v4
  v_exp_f32 v5, v5
  v_mov_b32 v73, v4
  v_mul_f32 v132, v132, v5
  v_mul_f32 v133, v133, v5
  v_mul_f32 v134, v134, v5
  v_mul_f32 v135, v135, v5
  v_mul_f32 v148, v148, v5
  v_mul_f32 v149, v149, v5
  v_mul_f32 v150, v150, v5
  v_mul_f32 v151, v151, v5
  v_mul_f32 v164, v164, v5
  v_mul_f32 v165, v165, v5
  v_mul_f32 v166, v166, v5
  v_mul_f32 v167, v167, v5
  v_mul_f32 v180, v180, v5
  v_mul_f32 v181, v181, v5
  v_mul_f32 v182, v182, v5
  v_mul_f32 v183, v183, v5
  v_mul_f32 v196, v196, v5
  v_mul_f32 v197, v197, v5
  v_mul_f32 v198, v198, v5
  v_mul_f32 v199, v199, v5
  v_mul_f32 v212, v212, v5
  v_mul_f32 v213, v213, v5
  v_mul_f32 v214, v214, v5
  v_mul_f32 v215, v215, v5
  v_mul_f32 v228, v228, v5
  v_mul_f32 v229, v229, v5
  v_mul_f32 v230, v230, v5
  v_mul_f32 v231, v231, v5
  v_mul_f32 v244, v244, v5
  v_mul_f32 v245, v245, v5
  v_mul_f32 v246, v246, v5
  v_mul_f32 v247, v247, v5
  v_mul_f32 v84, v84, v5
  v_mul_f32 v85, v85, v5
  v_mul_f32 v86, v86, v5
  v_mul_f32 v87, v87, v5
  v_sub_f32 v40, v40, v4
  v_exp_f32 v40, v40
  v_sub_f32 v41, v41, v4
  v_exp_f32 v41, v41
  v_sub_f32 v42, v42, v4
  v_exp_f32 v42, v42
  v_sub_f32 v43, v43, v4
  v_exp_f32 v43, v43
  v_cvt_pk_bf16_f32 v100, v40, v41
  v_cvt_pk_bf16_f32 v101, v42, v43
  v_sub_f32 v44, v44, v4
  v_exp_f32 v44, v44
  v_sub_f32 v45, v45, v4
  v_exp_f32 v45, v45
  v_sub_f32 v46, v46, v4
  v_exp_f32 v46, v46
  v_sub_f32 v47, v47, v4
  v_exp_f32 v47, v47
  v_cvt_pk_bf16_f32 v102, v44, v45
  v_cvt_pk_bf16_f32 v103, v46, v47
  v_mfma_f32_16x16x32_bf16 v[128:131], a[96:99], v[96:99], v[128:131]
  s_waitcnt lgkmcnt(12)
  v_mfma_f32_16x16x32_bf16 v[144:147], a[100:103], v[96:99], v[144:147]
  s_waitcnt lgkmcnt(10)
  v_mfma_f32_16x16x32_bf16 v[160:163], a[104:107], v[96:99], v[160:163]
  s_waitcnt lgkmcnt(8)
  v_mfma_f32_16x16x32_bf16 v[176:179], a[108:111], v[96:99], v[176:179]
  s_waitcnt lgkmcnt(6)
  v_mfma_f32_16x16x32_bf16 v[192:195], a[112:115], v[96:99], v[192:195]
  s_waitcnt lgkmcnt(4)
  v_mfma_f32_16x16x32_bf16 v[208:211], a[116:119], v[96:99], v[208:211]
  s_waitcnt lgkmcnt(2)
  v_mfma_f32_16x16x32_bf16 v[224:227], a[120:123], v[96:99], v[224:227]
  s_waitcnt lgkmcnt(0)
  v_mfma_f32_16x16x32_bf16 v[240:243], a[124:127], v[96:99], v[240:243]
  v_mfma_f32_16x16x32_bf16 v[80:83], v[112:115], v[96:99], v[80:83]
  v_mfma_f32_16x16x32_bf16 v[132:135], a[96:99], v[100:103], v[132:135]
  v_mfma_f32_16x16x32_bf16 v[148:151], a[100:103], v[100:103], v[148:151]
  v_mfma_f32_16x16x32_bf16 v[164:167], a[104:107], v[100:103], v[164:167]
  v_mfma_f32_16x16x32_bf16 v[180:183], a[108:111], v[100:103], v[180:183]
  v_mfma_f32_16x16x32_bf16 v[196:199], a[112:115], v[100:103], v[196:199]
  v_mfma_f32_16x16x32_bf16 v[212:215], a[116:119], v[100:103], v[212:215]
  v_mfma_f32_16x16x32_bf16 v[228:231], a[120:123], v[100:103], v[228:231]
  v_mfma_f32_16x16x32_bf16 v[244:247], a[124:127], v[100:103], v[244:247]
  v_mfma_f32_16x16x32_bf16 v[84:87], v[112:115], v[100:103], v[84:87]
  v_mfma_f32_16x16x32_bf16 v[48:51], a[64:67], a[8:11], 0
  v_mfma_f32_16x16x32_bf16 v[48:51], a[68:71], a[24:27], v[48:51]
  v_mfma_f32_16x16x32_bf16 v[48:51], a[72:75], a[40:43], v[48:51]
  v_mfma_f32_16x16x32_bf16 v[48:51], a[76:79], a[56:59], v[48:51]
  v_mfma_f32_16x16x32_bf16 v[52:55], a[80:83], a[8:11], 0
  v_mfma_f32_16x16x32_bf16 v[52:55], a[84:87], a[24:27], v[52:55]
  v_mfma_f32_16x16x32_bf16 v[52:55], a[88:91], a[40:43], v[52:55]
  v_mfma_f32_16x16x32_bf16 v[52:55], a[92:95], a[56:59], v[52:55]
  v_mfma_f32_16x16x32_bf16 v[56:59], a[64:67], a[12:15], 0
  v_mfma_f32_16x16x32_bf16 v[56:59], a[68:71], a[28:31], v[56:59]
  v_mfma_f32_16x16x32_bf16 v[56:59], a[72:75], a[44:47], v[56:59]
  v_mfma_f32_16x16x32_bf16 v[56:59], a[76:79], a[60:63], v[56:59]
  v_mfma_f32_16x16x32_bf16 v[60:63], a[80:83], a[12:15], 0
  v_mfma_f32_16x16x32_bf16 v[60:63], a[84:87], a[28:31], v[60:63]
  v_mfma_f32_16x16x32_bf16 v[60:63], a[88:91], a[44:47], v[60:63]
  v_mfma_f32_16x16x32_bf16 v[60:63], a[92:95], a[60:63], v[60:63]
  v_max3_f32 v4, v48, v49, v50
  v_max3_f32 v4, v4, v51, v52
  v_max3_f32 v4, v4, v53, v54
  v_max3_f32 v4, v4, v55, v74
  v_mov_b32 v5, v4
  s_nop 1
  v_permlane16_swap_b32 v4, v5
  v_max_f32 v4, v4, v5
  v_mov_b32 v5, v4
  s_nop 1
  v_permlane32_swap_b32 v4, v5
  v_max_f32 v4, v4, v5
  v_sub_f32 v5, v74, v4
  v_exp_f32 v5, v5
  v_mov_b32 v74, v4
  v_mul_f32 v136, v136, v5
  v_mul_f32 v137, v137, v5
  v_mul_f32 v138, v138, v5
  v_mul_f32 v139, v139, v5
  v_mul_f32 v152, v152, v5
  v_mul_f32 v153, v153, v5
  v_mul_f32 v154, v154, v5
  v_mul_f32 v155, v155, v5
  v_mul_f32 v168, v168, v5
  v_mul_f32 v169, v169, v5
  v_mul_f32 v170, v170, v5
  v_mul_f32 v171, v171, v5
  v_mul_f32 v184, v184, v5
  v_mul_f32 v185, v185, v5
  v_mul_f32 v186, v186, v5
  v_mul_f32 v187, v187, v5
  v_mul_f32 v200, v200, v5
  v_mul_f32 v201, v201, v5
  v_mul_f32 v202, v202, v5
  v_mul_f32 v203, v203, v5
  v_mul_f32 v216, v216, v5
  v_mul_f32 v217, v217, v5
  v_mul_f32 v218, v218, v5
  v_mul_f32 v219, v219, v5
  v_mul_f32 v232, v232, v5
  v_mul_f32 v233, v233, v5
  v_mul_f32 v234, v234, v5
  v_mul_f32 v235, v235, v5
  v_mul_f32 v248, v248, v5
  v_mul_f32 v249, v249, v5
  v_mul_f32 v250, v250, v5
  v_mul_f32 v251, v251, v5
  v_mul_f32 v88, v88, v5
  v_mul_f32 v89, v89, v5
  v_mul_f32 v90, v90, v5
  v_mul_f32 v91, v91, v5
  v_sub_f32 v48, v48, v4
  v_exp_f32 v48, v48
  v_sub_f32 v49, v49, v4
  v_exp_f32 v49, v49
  v_sub_f32 v50, v50, v4
  v_exp_f32 v50, v50
  v_sub_f32 v51, v51, v4
  v_exp_f32 v51, v51
  v_cvt_pk_bf16_f32 v104, v48, v49
  v_cvt_pk_bf16_f32 v105, v50, v51
  v_sub_f32 v52, v52, v4
  v_exp_f32 v52, v52
  v_sub_f32 v53, v53, v4
  v_exp_f32 v53, v53
  v_sub_f32 v54, v54, v4
  v_exp_f32 v54, v54
  v_sub_f32 v55, v55, v4
  v_exp_f32 v55, v55
  v_cvt_pk_bf16_f32 v106, v52, v53
  v_cvt_pk_bf16_f32 v107, v54, v55
  v_max3_f32 v4, v56, v57, v58
  v_max3_f32 v4, v4, v59, v60
  v_max3_f32 v4, v4, v61, v62
  v_max3_f32 v4, v4, v63, v75
  v_mov_b32 v5, v4
  s_nop 1
  v_permlane16_swap_b32 v4, v5
  v_max_f32 v4, v4, v5
  v_mov_b32 v5, v4
  s_nop 1
  v_permlane32_swap_b32 v4, v5
  v_max_f32 v4, v4, v5
  v_sub_f32 v5, v75, v4
  v_exp_f32 v5, v5
  v_mov_b32 v75, v4
  v_mul_f32 v140, v140, v5
  v_mul_f32 v141, v141, v5
  v_mul_f32 v142, v142, v5
  v_mul_f32 v143, v143, v5
  v_mul_f32 v156, v156, v5
  v_mul_f32 v157, v157, v5
  v_mul_f32 v158, v158, v5
  v_mul_f32 v159, v159, v5
  v_mul_f32 v172, v172, v5
  v_mul_f32 v173, v173, v5
  v_mul_f32 v174, v174, v5
  v_mul_f32 v175, v175, v5
  v_mul_f32 v188, v188, v5
  v_mul_f32 v189, v189, v5
  v_mul_f32 v190, v190, v5
  v_mul_f32 v191, v191, v5
  v_mul_f32 v204, v204, v5
  v_mul_f32 v205, v205, v5
  v_mul_f32 v206, v206, v5
  v_mul_f32 v207, v207, v5
  v_mul_f32 v220, v220, v5
  v_mul_f32 v221, v221, v5
  v_mul_f32 v222, v222, v5
  v_mul_f32 v223, v223, v5
  v_mul_f32 v236, v236, v5
  v_mul_f32 v237, v237, v5
  v_mul_f32 v238, v238, v5
  v_mul_f32 v239, v239, v5
  v_mul_f32 v252, v252, v5
  v_mul_f32 v253, v253, v5
  v_mul_f32 v254, v254, v5
  v_mul_f32 v255, v255, v5
  v_mul_f32 v92, v92, v5
  v_mul_f32 v93, v93, v5
  v_mul_f32 v94, v94, v5
  v_mul_f32 v95, v95, v5
  v_sub_f32 v56, v56, v4
  v_exp_f32 v56, v56
  v_sub_f32 v57, v57, v4
  v_exp_f32 v57, v57
  v_sub_f32 v58, v58, v4
  v_exp_f32 v58, v58
  v_sub_f32 v59, v59, v4
  v_exp_f32 v59, v59
  v_cvt_pk_bf16_f32 v108, v56, v57
  v_cvt_pk_bf16_f32 v109, v58, v59
  v_sub_f32 v60, v60, v4
  v_exp_f32 v60, v60
  v_sub_f32 v61, v61, v4
  v_exp_f32 v61, v61
  v_sub_f32 v62, v62, v4
  v_exp_f32 v62, v62
  v_sub_f32 v63, v63, v4
  v_exp_f32 v63, v63
  v_cvt_pk_bf16_f32 v110, v60, v61
  v_cvt_pk_bf16_f32 v111, v62, v63
  v_mfma_f32_16x16x32_bf16 v[136:139], a[96:99], v[104:107], v[136:139]
  v_mfma_f32_16x16x32_bf16 v[152:155], a[100:103], v[104:107], v[152:155]
  v_mfma_f32_16x16x32_bf16 v[168:171], a[104:107], v[104:107], v[168:171]
  v_mfma_f32_16x16x32_bf16 v[184:187], a[108:111], v[104:107], v[184:187]
  v_mfma_f32_16x16x32_bf16 v[200:203], a[112:115], v[104:107], v[200:203]
  v_mfma_f32_16x16x32_bf16 v[216:219], a[116:119], v[104:107], v[216:219]
  v_mfma_f32_16x16x32_bf16 v[232:235], a[120:123], v[104:107], v[232:235]
  v_mfma_f32_16x16x32_bf16 v[248:251], a[124:127], v[104:107], v[248:251]
  v_mfma_f32_16x16x32_bf16 v[88:91], v[112:115], v[104:107], v[88:91]
  v_mfma_f32_16x16x32_bf16 v[140:143], a[96:99], v[108:111], v[140:143]
  v_mfma_f32_16x16x32_bf16 v[156:159], a[100:103], v[108:111], v[156:159]
  v_mfma_f32_16x16x32_bf16 v[172:175], a[104:107], v[108:111], v[172:175]
  v_mfma_f32_16x16x32_bf16 v[188:191], a[108:111], v[108:111], v[188:191]
  v_mfma_f32_16x16x32_bf16 v[204:207], a[112:115], v[108:111], v[204:207]
  v_mfma_f32_16x16x32_bf16 v[220:223], a[116:119], v[108:111], v[220:223]
  v_mfma_f32_16x16x32_bf16 v[236:239], a[120:123], v[108:111], v[236:239]
  v_mfma_f32_16x16x32_bf16 v[252:255], a[124:127], v[108:111], v[252:255]
  v_mfma_f32_16x16x32_bf16 v[92:95], v[112:115], v[108:111], v[92:95]
  ds_read_b128 a[64:67], v116 offset:8192
  ds_read_b128 a[68:71], v117 offset:8192
  ds_read_b128 a[72:75], v118 offset:8192
  ds_read_b128 a[76:79], v119 offset:8192
  ds_read_b128 a[80:83], v116 offset:12288
  ds_read_b128 a[84:87], v117 offset:12288
  ds_read_b128 a[88:91], v118 offset:12288
  ds_read_b128 a[92:95], v119 offset:12288
  ds_read_b64_tr_b16 a[96:97], v120 offset:8192
  ds_read_b64_tr_b16 a[98:99], v120 offset:12288
  ds_read_b64_tr_b16 a[100:101], v121 offset:8192
  ds_read_b64_tr_b16 a[102:103], v121 offset:12288
  ds_read_b64_tr_b16 a[104:105], v122 offset:8192
  ds_read_b64_tr_b16 a[106:107], v122 offset:12288
  ds_read_b64_tr_b16 a[108:109], v123 offset:8192
  ds_read_b64_tr_b16 a[110:111], v123 offset:12288
  ds_read_b64_tr_b16 a[112:113], v124 offset:8192
  ds_read_b64_tr_b16 a[114:115], v124 offset:12288
  ds_read_b64_tr_b16 a[116:117], v125 offset:8192
  ds_read_b64_tr_b16 a[118:119], v125 offset:12288
  ds_read_b64_tr_b16 a[120:121], v126 offset:8192
  ds_read_b64_tr_b16 a[122:123], v126 offset:12288
  ds_read_b64_tr_b16 a[124:125], v127 offset:8192
  ds_read_b64_tr_b16 a[126:127], v127 offset:12288
  s_waitcnt lgkmcnt(15)
  v_mfma_f32_16x16x32_bf16 v[32:35], a[64:67], a[0:3], 0
  v_mfma_f32_16x16x32_bf16 v[32:35], a[68:71], a[16:19], v[32:35]
  v_mfma_f32_16x16x32_bf16 v[32:35], a[72:75], a[32:35], v[32:35]
  v_mfma_f32_16x16x32_bf16 v[32:35], a[76:79], a[48:51], v[32:35]
  v_mfma_f32_16x16x32_bf16 v[36:39], a[80:83], a[0:3], 0
  v_mfma_f32_16x16x32_bf16 v[36:39], a[84:87], a[16:19], v[36:39]
  v_mfma_f32_16x16x32_bf16 v[36:39], a[88:91], a[32:35], v[36:39]
  v_mfma_f32_16x16x32_bf16 v[36:39], a[92:95], a[48:51], v[36:39]
  v_mfma_f32_16x16x32_bf16 v[40:43], a[64:67], a[4:7], 0
  v_mfma_f32_16x16x32_bf16 v[40:43], a[68:71], a[20:23], v[40:43]
  v_mfma_f32_16x16x32_bf16 v[40:43], a[72:75], a[36:39], v[40:43]
  v_mfma_f32_16x16x32_bf16 v[40:43], a[76:79], a[52:55], v[40:43]
  v_mfma_f32_16x16x32_bf16 v[44:47], a[80:83], a[4:7], 0
  v_mfma_f32_16x16x32_bf16 v[44:47], a[84:87], a[20:23], v[44:47]
  v_mfma_f32_16x16x32_bf16 v[44:47], a[88:91], a[36:39], v[44:47]
  v_mfma_f32_16x16x32_bf16 v[44:47], a[92:95], a[52:55], v[44:47]
  s_waitcnt lgkmcnt(14)
  v_max3_f32 v4, v32, v33, v34
  v_max3_f32 v4, v4, v35, v36
  v_max3_f32 v4, v4, v37, v38
  v_max3_f32 v4, v4, v39, v72
  v_mov_b32 v5, v4
  s_nop 1
  v_permlane16_swap_b32 v4, v5
  v_max_f32 v4, v4, v5
  v_mov_b32 v5, v4
  s_nop 1
  v_permlane32_swap_b32 v4, v5
  v_max_f32 v4, v4, v5
  v_sub_f32 v5, v72, v4
  v_exp_f32 v5, v5
  v_mov_b32 v72, v4
  v_mul_f32 v128, v128, v5
  v_mul_f32 v129, v129, v5
  v_mul_f32 v130, v130, v5
  v_mul_f32 v131, v131, v5
  v_mul_f32 v144, v144, v5
  v_mul_f32 v145, v145, v5
  v_mul_f32 v146, v146, v5
  v_mul_f32 v147, v147, v5
  v_mul_f32 v160, v160, v5
  v_mul_f32 v161, v161, v5
  v_mul_f32 v162, v162, v5
  v_mul_f32 v163, v163, v5
  v_mul_f32 v176, v176, v5
  v_mul_f32 v177, v177, v5
  v_mul_f32 v178, v178, v5
  v_mul_f32 v179, v179, v5
  v_mul_f32 v192, v192, v5
  v_mul_f32 v193, v193, v5
  v_mul_f32 v194, v194, v5
  v_mul_f32 v195, v195, v5
  v_mul_f32 v208, v208, v5
  v_mul_f32 v209, v209, v5
  v_mul_f32 v210, v210, v5
  v_mul_f32 v211, v211, v5
  v_mul_f32 v224, v224, v5
  v_mul_f32 v225, v225, v5
  v_mul_f32 v226, v226, v5
  v_mul_f32 v227, v227, v5
  v_mul_f32 v240, v240, v5
  v_mul_f32 v241, v241, v5
  v_mul_f32 v242, v242, v5
  v_mul_f32 v243, v243, v5
  v_mul_f32 v80, v80, v5
  v_mul_f32 v81, v81, v5
  v_mul_f32 v82, v82, v5
  v_mul_f32 v83, v83, v5
  v_sub_f32 v32, v32, v4
  v_exp_f32 v32, v32
  v_sub_f32 v33, v33, v4
  v_exp_f32 v33, v33
  v_sub_f32 v34, v34, v4
  v_exp_f32 v34, v34
  v_sub_f32 v35, v35, v4
  v_exp_f32 v35, v35
  v_cvt_pk_bf16_f32 v96, v32, v33
  v_cvt_pk_bf16_f32 v97, v34, v35
  v_sub_f32 v36, v36, v4
  v_exp_f32 v36, v36
  v_sub_f32 v37, v37, v4
  v_exp_f32 v37, v37
  v_sub_f32 v38, v38, v4
  v_exp_f32 v38, v38
  v_sub_f32 v39, v39, v4
  v_exp_f32 v39, v39
  v_cvt_pk_bf16_f32 v98, v36, v37
  v_cvt_pk_bf16_f32 v99, v38, v39
  v_max3_f32 v4, v40, v41, v42
  v_max3_f32 v4, v4, v43, v44
  v_max3_f32 v4, v4, v45, v46
  v_max3_f32 v4, v4, v47, v73
  v_mov_b32 v5, v4
  s_nop 1
  v_permlane16_swap_b32 v4, v5
  v_max_f32 v4, v4, v5
  v_mov_b32 v5, v4
  s_nop 1
  v_permlane32_swap_b32 v4, v5
  v_max_f32 v4, v4, v5
  v_sub_f32 v5, v73, v4
  v_exp_f32 v5, v5
  v_mov_b32 v73, v4
  v_mul_f32 v132, v132, v5
  v_mul_f32 v133, v133, v5
  v_mul_f32 v134, v134, v5
  v_mul_f32 v135, v135, v5
  v_mul_f32 v148, v148, v5
  v_mul_f32 v149, v149, v5
  v_mul_f32 v150, v150, v5
  v_mul_f32 v151, v151, v5
  v_mul_f32 v164, v164, v5
  v_mul_f32 v165, v165, v5
  v_mul_f32 v166, v166, v5
  v_mul_f32 v167, v167, v5
  v_mul_f32 v180, v180, v5
  v_mul_f32 v181, v181, v5
  v_mul_f32 v182, v182, v5
  v_mul_f32 v183, v183, v5
  v_mul_f32 v196, v196, v5
  v_mul_f32 v197, v197, v5
  v_mul_f32 v198, v198, v5
  v_mul_f32 v199, v199, v5
  v_mul_f32 v212, v212, v5
  v_mul_f32 v213, v213, v5
  v_mul_f32 v214, v214, v5
  v_mul_f32 v215, v215, v5
  v_mul_f32 v228, v228, v5
  v_mul_f32 v229, v229, v5
  v_mul_f32 v230, v230, v5
  v_mul_f32 v231, v231, v5
  v_mul_f32 v244, v244, v5
  v_mul_f32 v245, v245, v5
  v_mul_f32 v246, v246, v5
  v_mul_f32 v247, v247, v5
  v_mul_f32 v84, v84, v5
  v_mul_f32 v85, v85, v5
  v_mul_f32 v86, v86, v5
  v_mul_f32 v87, v87, v5
  v_sub_f32 v40, v40, v4
  v_exp_f32 v40, v40
  v_sub_f32 v41, v41, v4
  v_exp_f32 v41, v41
  v_sub_f32 v42, v42, v4
  v_exp_f32 v42, v42
  v_sub_f32 v43, v43, v4
  v_exp_f32 v43, v43
  v_cvt_pk_bf16_f32 v100, v40, v41
  v_cvt_pk_bf16_f32 v101, v42, v43
  v_sub_f32 v44, v44, v4
  v_exp_f32 v44, v44
  v_sub_f32 v45, v45, v4
  v_exp_f32 v45, v45
  v_sub_f32 v46, v46, v4
  v_exp_f32 v46, v46
  v_sub_f32 v47, v47, v4
  v_exp_f32 v47, v47
  v_cvt_pk_bf16_f32 v102, v44, v45
  v_cvt_pk_bf16_f32 v103, v46, v47
  v_mfma_f32_16x16x32_bf16 v[128:131], a[96:99], v[96:99], v[128:131]
  s_waitcnt lgkmcnt(12)
  v_mfma_f32_16x16x32_bf16 v[144:147], a[100:103], v[96:99], v[144:147]
  s_waitcnt lgkmcnt(10)
  v_mfma_f32_16x16x32_bf16 v[160:163], a[104:107], v[96:99], v[160:163]
  s_waitcnt lgkmcnt(8)
  v_mfma_f32_16x16x32_bf16 v[176:179], a[108:111], v[96:99], v[176:179]
  s_waitcnt lgkmcnt(6)
  v_mfma_f32_16x16x32_bf16 v[192:195], a[112:115], v[96:99], v[192:195]
  s_waitcnt lgkmcnt(4)
  v_mfma_f32_16x16x32_bf16 v[208:211], a[116:119], v[96:99], v[208:211]
  s_waitcnt lgkmcnt(2)
  v_mfma_f32_16x16x32_bf16 v[224:227], a[120:123], v[96:99], v[224:227]
  s_waitcnt lgkmcnt(0)
  v_mfma_f32_16x16x32_bf16 v[240:243], a[124:127], v[96:99], v[240:243]
  v_mfma_f32_16x16x32_bf16 v[80:83], v[112:115], v[96:99], v[80:83]
  v_mfma_f32_16x16x32_bf16 v[132:135], a[96:99], v[100:103], v[132:135]
  v_mfma_f32_16x16x32_bf16 v[148:151], a[100:103], v[100:103], v[148:151]
  v_mfma_f32_16x16x32_bf16 v[164:167], a[104:107], v[100:103], v[164:167]
  v_mfma_f32_16x16x32_bf16 v[180:183], a[108:111], v[100:103], v[180:183]
  v_mfma_f32_16x16x32_bf16 v[196:199], a[112:115], v[100:103], v[196:199]
  v_mfma_f32_16x16x32_bf16 v[212:215], a[116:119], v[100:103], v[212:215]
  v_mfma_f32_16x16x32_bf16 v[228:231], a[120:123], v[100:103], v[228:231]
  v_mfma_f32_16x16x32_bf16 v[244:247], a[124:127], v[100:103], v[244:247]
  v_mfma_f32_16x16x32_bf16 v[84:87], v[112:115], v[100:103], v[84:87]
  v_mfma_f32_16x16x32_bf16 v[48:51], a[64:67], a[8:11], 0
  v_mfma_f32_16x16x32_bf16 v[48:51], a[68:71], a[24:27], v[48:51]
  v_mfma_f32_16x16x32_bf16 v[48:51], a[72:75], a[40:43], v[48:51]
  v_mfma_f32_16x16x32_bf16 v[48:51], a[76:79], a[56:59], v[48:51]
  v_mfma_f32_16x16x32_bf16 v[52:55], a[80:83], a[8:11], 0
  v_mfma_f32_16x16x32_bf16 v[52:55], a[84:87], a[24:27], v[52:55]
  v_mfma_f32_16x16x32_bf16 v[52:55], a[88:91], a[40:43], v[52:55]
  v_mfma_f32_16x16x32_bf16 v[52:55], a[92:95], a[56:59], v[52:55]
  v_mfma_f32_16x16x32_bf16 v[56:59], a[64:67], a[12:15], 0
  v_mfma_f32_16x16x32_bf16 v[56:59], a[68:71], a[28:31], v[56:59]
  v_mfma_f32_16x16x32_bf16 v[56:59], a[72:75], a[44:47], v[56:59]
  v_mfma_f32_16x16x32_bf16 v[56:59], a[76:79], a[60:63], v[56:59]
  v_mfma_f32_16x16x32_bf16 v[60:63], a[80:83], a[12:15], 0
  v_mfma_f32_16x16x32_bf16 v[60:63], a[84:87], a[28:31], v[60:63]
  v_mfma_f32_16x16x32_bf16 v[60:63], a[88:91], a[44:47], v[60:63]
  v_mfma_f32_16x16x32_bf16 v[60:63], a[92:95], a[60:63], v[60:63]
  v_max3_f32 v4, v48, v49, v50
  v_max3_f32 v4, v4, v51, v52
  v_max3_f32 v4, v4, v53, v54
  v_max3_f32 v4, v4, v55, v74
  v_mov_b32 v5, v4
  s_nop 1
  v_permlane16_swap_b32 v4, v5
  v_max_f32 v4, v4, v5
  v_mov_b32 v5, v4
  s_nop 1
  v_permlane32_swap_b32 v4, v5
  v_max_f32 v4, v4, v5
  v_sub_f32 v5, v74, v4
  v_exp_f32 v5, v5
  v_mov_b32 v74, v4
  v_mul_f32 v136, v136, v5
  v_mul_f32 v137, v137, v5
  v_mul_f32 v138, v138, v5
  v_mul_f32 v139, v139, v5
  v_mul_f32 v152, v152, v5
  v_mul_f32 v153, v153, v5
  v_mul_f32 v154, v154, v5
  v_mul_f32 v155, v155, v5
  v_mul_f32 v168, v168, v5
  v_mul_f32 v169, v169, v5
  v_mul_f32 v170, v170, v5
  v_mul_f32 v171, v171, v5
  v_mul_f32 v184, v184, v5
  v_mul_f32 v185, v185, v5
  v_mul_f32 v186, v186, v5
  v_mul_f32 v187, v187, v5
  v_mul_f32 v200, v200, v5
  v_mul_f32 v201, v201, v5
  v_mul_f32 v202, v202, v5
  v_mul_f32 v203, v203, v5
  v_mul_f32 v216, v216, v5
  v_mul_f32 v217, v217, v5
  v_mul_f32 v218, v218, v5
  v_mul_f32 v219, v219, v5
  v_mul_f32 v232, v232, v5
  v_mul_f32 v233, v233, v5
  v_mul_f32 v234, v234, v5
  v_mul_f32 v235, v235, v5
  v_mul_f32 v248, v248, v5
  v_mul_f32 v249, v249, v5
  v_mul_f32 v250, v250, v5
  v_mul_f32 v251, v251, v5
  v_mul_f32 v88, v88, v5
  v_mul_f32 v89, v89, v5
  v_mul_f32 v90, v90, v5
  v_mul_f32 v91, v91, v5
  v_sub_f32 v48, v48, v4
  v_exp_f32 v48, v48
  v_sub_f32 v49, v49, v4
  v_exp_f32 v49, v49
  v_sub_f32 v50, v50, v4
  v_exp_f32 v50, v50
  v_sub_f32 v51, v51, v4
  v_exp_f32 v51, v51
  v_cvt_pk_bf16_f32 v104, v48, v49
  v_cvt_pk_bf16_f32 v105, v50, v51
  v_sub_f32 v52, v52, v4
  v_exp_f32 v52, v52
  v_sub_f32 v53, v53, v4
  v_exp_f32 v53, v53
  v_sub_f32 v54, v54, v4
  v_exp_f32 v54, v54
  v_sub_f32 v55, v55, v4
  v_exp_f32 v55, v55
  v_cvt_pk_bf16_f32 v106, v52, v53
  v_cvt_pk_bf16_f32 v107, v54, v55
  v_max3_f32 v4, v56, v57, v58
  v_max3_f32 v4, v4, v59, v60
  v_max3_f32 v4, v4, v61, v62
  v_max3_f32 v4, v4, v63, v75
  v_mov_b32 v5, v4
  s_nop 1
  v_permlane16_swap_b32 v4, v5
  v_max_f32 v4, v4, v5
  v_mov_b32 v5, v4
  s_nop 1
  v_permlane32_swap_b32 v4, v5
  v_max_f32 v4, v4, v5
  v_sub_f32 v5, v75, v4
  v_exp_f32 v5, v5
  v_mov_b32 v75, v4
  v_mul_f32 v140, v140, v5
  v_mul_f32 v141, v141, v5
  v_mul_f32 v142, v142, v5
  v_mul_f32 v143, v143, v5
  v_mul_f32 v156, v156, v5
  v_mul_f32 v157, v157, v5
  v_mul_f32 v158, v158, v5
  v_mul_f32 v159, v159, v5
  v_mul_f32 v172, v172, v5
  v_mul_f32 v173, v173, v5
  v_mul_f32 v174, v174, v5
  v_mul_f32 v175, v175, v5
  v_mul_f32 v188, v188, v5
  v_mul_f32 v189, v189, v5
  v_mul_f32 v190, v190, v5
  v_mul_f32 v191, v191, v5
  v_mul_f32 v204, v204, v5
  v_mul_f32 v205, v205, v5
  v_mul_f32 v206, v206, v5
  v_mul_f32 v207, v207, v5
  v_mul_f32 v220, v220, v5
  v_mul_f32 v221, v221, v5
  v_mul_f32 v222, v222, v5
  v_mul_f32 v223, v223, v5
  v_mul_f32 v236, v236, v5
  v_mul_f32 v237, v237, v5
  v_mul_f32 v238, v238, v5
  v_mul_f32 v239, v239, v5
  v_mul_f32 v252, v252, v5
  v_mul_f32 v253, v253, v5
  v_mul_f32 v254, v254, v5
  v_mul_f32 v255, v255, v5
  v_mul_f32 v92, v92, v5
  v_mul_f32 v93, v93, v5
  v_mul_f32 v94, v94, v5
  v_mul_f32 v95, v95, v5
  v_sub_f32 v56, v56, v4
  v_exp_f32 v56, v56
  v_sub_f32 v57, v57, v4
  v_exp_f32 v57, v57
  v_sub_f32 v58, v58, v4
  v_exp_f32 v58, v58
  v_sub_f32 v59, v59, v4
  v_exp_f32 v59, v59
  v_cvt_pk_bf16_f32 v108, v56, v57
  v_cvt_pk_bf16_f32 v109, v58, v59
  v_sub_f32 v60, v60, v4
  v_exp_f32 v60, v60
  v_sub_f32 v61, v61, v4
  v_exp_f32 v61, v61
  v_sub_f32 v62, v62, v4
  v_exp_f32 v62, v62
  v_sub_f32 v63, v63, v4
  v_exp_f32 v63, v63
  v_cvt_pk_bf16_f32 v110, v60, v61
  v_cvt_pk_bf16_f32 v111, v62, v63
  v_mfma_f32_16x16x32_bf16 v[136:139], a[96:99], v[104:107], v[136:139]
  v_mfma_f32_16x16x32_bf16 v[152:155], a[100:103], v[104:107], v[152:155]
  v_mfma_f32_16x16x32_bf16 v[168:171], a[104:107], v[104:107], v[168:171]
  v_mfma_f32_16x16x32_bf16 v[184:187], a[108:111], v[104:107], v[184:187]
  v_mfma_f32_16x16x32_bf16 v[200:203], a[112:115], v[104:107], v[200:203]
  v_mfma_f32_16x16x32_bf16 v[216:219], a[116:119], v[104:107], v[216:219]
  v_mfma_f32_16x16x32_bf16 v[232:235], a[120:123], v[104:107], v[232:235]
  v_mfma_f32_16x16x32_bf16 v[248:251], a[124:127], v[104:107], v[248:251]
  v_mfma_f32_16x16x32_bf16 v[88:91], v[112:115], v[104:107], v[88:91]
  v_mfma_f32_16x16x32_bf16 v[140:143], a[96:99], v[108:111], v[140:143]
  v_mfma_f32_16x16x32_bf16 v[156:159], a[100:103], v[108:111], v[156:159]
  v_mfma_f32_16x16x32_bf16 v[172:175], a[104:107], v[108:111], v[172:175]
  v_mfma_f32_16x16x32_bf16 v[188:191], a[108:111], v[108:111], v[188:191]
  v_mfma_f32_16x16x32_bf16 v[204:207], a[112:115], v[108:111], v[204:207]
  v_mfma_f32_16x16x32_bf16 v[220:223], a[116:119], v[108:111], v[220:223]
  v_mfma_f32_16x16x32_bf16 v[236:239], a[120:123], v[108:111], v[236:239]
  v_mfma_f32_16x16x32_bf16 v[252:255], a[124:127], v[108:111], v[252:255]
  v_mfma_f32_16x16x32_bf16 v[92:95], v[112:115], v[108:111], v[92:95]
  s_waitcnt lgkmcnt(0)
  s_sub_u32 s45, s45, 1
  s_cmp_lg_u32 s45, 0
  s_cbranch_scc1 L_k3_slowloop
  s_nop 15
  s_barrier
  v_lshrrev_b32 v1, 4, v0
  v_and_b32 v2, 15, v0
  s_mov_b32 s43, 1024
  v_add_u32 v3, 0, v1
  v_lshlrev_b32 v3, 1, v3
  v_xor_b32 v3, v3, v2
  v_lshlrev_b32 v3, 4, v3
  v_mul_lo_u32 v14, v1, s43
  v_add_u32 v14, v14, v3
  v_add_u32 v3, 4, v1
  v_lshlrev_b32 v3, 1, v3
  v_xor_b32 v3, v3, v2
  v_lshlrev_b32 v3, 4, v3
  v_mul_lo_u32 v15, v1, s43
  v_add_u32 v15, v15, v3
  v_add_u32 v15, 3072, v15
  v_add_u32 v3, 0, v1
  v_lshlrev_b32 v3, 1, v3
  v_xor_b32 v3, v3, v2
  v_lshlrev_b32 v3, 4, v3
  v_mul_lo_u32 v16, v1, s43
  v_add_u32 v16, v16, v3
  v_add_u32 v16, 6144, v16
  v_add_u32 v3, 4, v1
  v_lshlrev_b32 v3, 1, v3
  v_xor_b32 v3, v3, v2
  v_lshlrev_b32 v3, 4, v3
  v_mul_lo_u32 v17, v1, s43
  v_add_u32 v17, v17, v3
  v_add_u32 v17, 9216, v17
  s_lshl_b32 s42, s25, 19
  s_lshl_b32 s43, s24, 8
  s_add_u32 s42, s42, s43
  s_lshl_b32 s7, s24, 13
  s_add_u32 s7, s7, 65536
  s_add_u32 m0, s27, 0
  s_nop 0
  buffer_load_dwordx4 v14, s[32:35], s42 offen lds
  buffer_load_dwordx4 v15, s[32:35], s42 offen offset:1024 lds
  buffer_load_dwordx4 v16, s[32:35], s42 offen offset:2048 lds
  buffer_load_dwordx4 v17, s[32:35], s42 offen offset:3072 lds
  s_add_u32 s42, s42, 16384
  s_add_u32 m0, s27, 4096
  s_nop 0
  buffer_load_dwordx4 v14, s[32:35], s42 offen lds
  buffer_load_dwordx4 v15, s[32:35], s42 offen offset:1024 lds
  buffer_load_dwordx4 v16, s[32:35], s42 offen offset:2048 lds
  buffer_load_dwordx4 v17, s[32:35], s42 offen offset:3072 lds
  s_add_u32 s42, s42, 16384
  s_add_u32 m0, s27, 8192
  s_nop 0
  buffer_load_dwordx4 v14, s[32:35], s42 offen lds
  buffer_load_dwordx4 v15, s[32:35], s42 offen offset:1024 lds
  buffer_load_dwordx4 v16, s[32:35], s42 offen offset:2048 lds
  buffer_load_dwordx4 v17, s[32:35], s42 offen offset:3072 lds
  s_add_u32 s42, s42, 16384
  s_add_u32 m0, s27, 12288
  s_nop 0
  buffer_load_dwordx4 v14, s[32:35], s42 offen lds
  buffer_load_dwordx4 v15, s[32:35], s42 offen offset:1024 lds
  buffer_load_dwordx4 v16, s[32:35], s42 offen offset:2048 lds
  buffer_load_dwordx4 v17, s[32:35], s42 offen offset:3072 lds
  s_add_u32 s42, s42, 16384
  s_add_u32 m0, s7, 0
  s_nop 0
  buffer_load_dwordx4 v14, s[32:35], s42 offen lds
  buffer_load_dwordx4 v15, s[32:35], s42 offen offset:1024 lds
  buffer_load_dwordx4 v16, s[32:35], s42 offen offset:2048 lds
  buffer_load_dwordx4 v17, s[32:35], s42 offen offset:3072 lds
  s_add_u32 s42, s42, 16384
  s_add_u32 m0, s7, 4096
  s_nop 0
  buffer_load_dwordx4 v14, s[32:35], s42 offen lds
  buffer_load_dwordx4 v15, s[32:35], s42 offen offset:1024 lds
  buffer_load_dwordx4 v16, s[32:35], s42 offen offset:2048 lds
  buffer_load_dwordx4 v17, s[32:35], s42 offen offset:3072 lds
  s_add_u32 s42, s42, 16384
  s_branch L_k3_norm
L_k3_end:
  s_endpgm
.section .rodata,"a"
.p2align 6
.amdhsa_kernel recurrent_scan__gqa_block_cached__mixer_token_mlp__prompt_kernel
  .amdhsa_next_free_vgpr 512
  .amdhsa_next_free_sgpr 102
  .amdhsa_accum_offset 256
  .amdhsa_group_segment_fixed_size 0
  .amdhsa_kernarg_size 104
  .amdhsa_user_sgpr_count 2
  .amdhsa_user_sgpr_kernarg_segment_ptr 1
  .amdhsa_system_sgpr_workgroup_id_x 1
.end_amdhsa_kernel
```
